```python
import torch

def _softmax(x, axis=-1):
    return torch.softmax(x, dim=axis)
def _gelu(x):
    return torch.nn.functional.gelu(x, approximate="tanh")
def _silu(x):
    return torch.nn.functional.silu(x)
def _sigmoid(x):
    return torch.sigmoid(x)
def _layernorm(x, axis=-1, eps=1e-5):
    m = x.mean(dim=axis, keepdim=True)
    v = x.var(dim=axis, keepdim=True, unbiased=False)
    return (x - m) / torch.sqrt(v + eps)
def _scatter_add(tgt, idx, src, axis=0):
    return tgt.clone().index_add_(axis, idx, src)
def _segment_sum(src, seg, n):
    out = torch.zeros((n,) + src.shape[1:], dtype=src.dtype)
    return out.index_add_(0, seg, src)
def _pad(x, pw):
    flat = tuple(v for pair in reversed(pw) for v in pair)
    return torch.nn.functional.pad(x, flat)

kernel_name = 'gated_mix__compressed_kv_cla__geglu_ffn__prompt'

def setup_inputs():

    _w = (lambda a: (lambda t: t.to(torch.bfloat16) if t.is_floating_point() else t)(torch.as_tensor(a)))
    def _A_setup():
        B, H, Sq, Sk, D, M = 1, 32, 2048, 2048, 128, 640
        Dc = 4 * D
        return {
            "x": _w((lambda *s: torch.randn(*s, dtype=torch.bfloat16) * 0.05)(B, Sq, M)),
            "c_kv": _w((lambda *s: torch.randn(*s, dtype=torch.bfloat16) * 0.4)(B, Sk, Dc)),
            "w_q": _w((lambda *s: torch.randn(*s, dtype=torch.bfloat16) * 6.4)(M, H, D) * (M ** -0.5)),
            "w_uk": _w((lambda *s: torch.randn(*s, dtype=torch.bfloat16) * 6.4)(Dc, H, D) * (Dc ** -0.5)),
            "w_uv": _w((lambda *s: torch.randn(*s, dtype=torch.bfloat16) * 0.4)(Dc, H, D) * (Dc ** -0.5)),
            "w_o": _w((lambda *s: torch.randn(*s, dtype=torch.bfloat16) * 0.4)(H, D, M) * ((H * D) ** -0.5)),
        }
    _A_in = _A_setup()

    def _B_setup():
        B, S, D, F = 1, 2048, 640, 1728
        return {
            "x": _w((lambda *s: torch.randn(*s, dtype=torch.bfloat16) * 0.05)(B, S, D)),
            "w_gate": _w((lambda *s: torch.randn(*s, dtype=torch.bfloat16) * 0.05)(D, F)),
            "w_up": _w((lambda *s: torch.randn(*s, dtype=torch.bfloat16) * 0.05)(D, F)),
            "w_down": _w((lambda *s: torch.randn(*s, dtype=torch.bfloat16) * 0.05)(F, D)),
        }
    _B_in = _B_setup()

    return {
        "A_x": _A_in["x"],
        "A_c_kv": _A_in["c_kv"],
        "A_w_q": _A_in["w_q"],
        "A_w_uk": _A_in["w_uk"],
        "A_w_uv": _A_in["w_uv"],
        "A_w_o": _A_in["w_o"],
        "B_x": _B_in["x"],
        "B_w_gate": _B_in["w_gate"],
        "B_w_up": _B_in["w_up"],
        "B_w_down": _B_in["w_down"],
        "gate_w": _w((lambda *s: torch.randn(*s, dtype=torch.bfloat16) * 0.05)(640) * 16.0),
    }

def reference(A_x, A_c_kv, A_w_q, A_w_uk, A_w_uv, A_w_o, B_x, B_w_gate, B_w_up, B_w_down, gate_w):
    def _A_ref(x, c_kv, w_q, w_uk, w_uv, w_o):
        B, Sq, M = x.shape[0], x.shape[1], x.shape[2]
        Sk = c_kv.shape[1]
        H, D = w_q.shape[1], w_q.shape[2]
        q = torch.einsum("bqm,mhd->bhqd", x, w_q)
        k = torch.einsum("bkc,chd->bhkd", c_kv, w_uk)
        v = torch.einsum("bkc,chd->bhkd", c_kv, w_uv)
        scores = torch.einsum("bhqd,bhkd->bhqk", q, k) * (D ** -0.5)
        off = Sk - Sq
        qi = torch.arange(Sq)[:, None]
        kj = torch.arange(Sk)[None, :]
        cmask = kj <= (qi + off)
        scores = torch.where(cmask[None, None], scores, -1e9)
        p = _softmax(scores, axis=-1)
        ctx = torch.einsum("bhqk,bhkd->bhqd", p, v)
        return torch.einsum("bhqd,hdm->bqm", ctx, w_o)

    def _B_ref(x, w_gate, w_up, w_down):
        return (_gelu(x @ w_gate) * (x @ w_up)) @ w_down

    x = A_x
    g = _sigmoid((x * gate_w).sum(-1, keepdims=True))
    a = _A_ref(x, A_c_kv, A_w_q, A_w_uk, A_w_uv, A_w_o)
    b = _B_ref(x, B_w_gate, B_w_up, B_w_down)
    return g * a + (1 - g) * b
```

```asm
; @launch kernel=gated_mix__compressed_kv_cla__geglu_ffn__prompt_kernel grid=(256,1,1) block=(512,1,1) lds=163840
.amdgcn_target "amdgcn-amd-amdhsa--gfx950"
.text
.globl gated_mix__compressed_kv_cla__geglu_ffn__prompt_kernel
.p2align 8
.type gated_mix__compressed_kv_cla__geglu_ffn__prompt_kernel,@function
gated_mix__compressed_kv_cla__geglu_ffn__prompt_kernel:
  s_cmp_ge_u32 s2, 256
  s_cbranch_scc1 F_END
  s_load_dwordx16 s[36:51], s[0:1], 0
  s_load_dwordx8 s[52:59], s[0:1], 64
  s_load_dwordx4 s[60:63], s[0:1], 96
  v_lshrrev_b32 v1, 6, v0
  v_and_b32 v44, 63, v0
  v_readfirstlane_b32 s28, v1
  s_and_b32 s29, s2, 7
  s_lshr_b32 s30, s2, 3
  s_and_b32 s31, s30, 7
  s_lshr_b32 s32, s30, 3
  s_lshr_b32 s97, s30, 4
  s_and_b32 s33, s32, 1
  s_lshl_b32 s66, s29, 1
  s_add_u32 s96, s66, s33
  v_lshlrev_b32 v16, 4, v44
  v_lshrrev_b32 v45, 3, v44
  v_and_b32 v46, 7, v44
  v_lshrrev_b32 v47, 4, v44
  v_xor_b32 v52, v46, v47
  v_lshlrev_b32 v52, 4, v52
  v_and_b32 v53, 1, v47
  v_lshlrev_b32 v53, 1, v53
  v_xor_b32 v53, v53, v46
  v_lshlrev_b32 v53, 4, v53
  s_cmp_ge_u32 s28, 4
  s_cbranch_scc1 F_B
  v_mul_u32_u24 v48, 1024, v45
  v_add_u32 v32, v48, v52
  v_xor_b32 v49, 64, v32
  v_add_u32 v33, 7168, v49
  v_add_u32 v34, 14336, v32
  v_add_u32 v35, 21504, v49
  v_mul_u32_u24 v48, 8192, v45
  v_add_u32 v36, v48, v53
  v_xor_b32 v49, 64, v36
  v_add_u32 v37, 64512, v49
  v_add_u32 v38, 129024, v36
  v_add_u32 v39, 193536, v49
  s_lshl_b32 s65, s31, 2
  s_add_u32 s65, s65, s28
  s_lshl_b32 s65, s65, 16
  s_lshl_b32 s66, s96, 2
  s_add_u32 s66, s66, s28
  s_lshl_b32 s66, s66, 7
  s_lshl_b32 s64, s28, 13
  s_waitcnt lgkmcnt(0)
  s_mov_b32 s4, s38
  s_mov_b32 s5, s39
  s_mov_b32 s6, 2097152
  s_mov_b32 s7, 0x20000
  s_cmp_eq_u32 s97, 0
  s_cselect_b32 s8, s42, s44
  s_cselect_b32 s9, s43, s45
  s_mov_b32 s10, 4194304
  s_mov_b32 s11, 0x20000
  s_add_u32 m0, s64, 0
  s_nop 0
  buffer_load_dwordx4 v32, s[4:7], s65 offen offset:0 lds
  buffer_load_dwordx4 v33, s[4:7], s65 offen offset:1024 lds
  buffer_load_dwordx4 v34, s[4:7], s65 offen offset:2048 lds
  buffer_load_dwordx4 v35, s[4:7], s65 offen offset:3072 lds
  s_add_u32 s65, s65, 32768
  s_add_u32 m0, s64, 4096
  s_nop 0
  buffer_load_dwordx4 v32, s[4:7], s65 offen offset:0 lds
  buffer_load_dwordx4 v33, s[4:7], s65 offen offset:1024 lds
  buffer_load_dwordx4 v34, s[4:7], s65 offen offset:2048 lds
  buffer_load_dwordx4 v35, s[4:7], s65 offen offset:3072 lds
  s_sub_u32 s65, s65, 32640
  s_add_u32 m0, s64, 65536
  s_nop 0
  buffer_load_dwordx4 v36, s[8:11], s66 offen offset:0 lds
  buffer_load_dwordx4 v37, s[8:11], s66 offen offset:1024 lds
  buffer_load_dwordx4 v38, s[8:11], s66 offen offset:2048 lds
  buffer_load_dwordx4 v39, s[8:11], s66 offen offset:3072 lds
  s_add_u32 s66, s66, 262144
  s_add_u32 m0, s64, 69632
  s_nop 0
  buffer_load_dwordx4 v36, s[8:11], s66 offen offset:0 lds
  buffer_load_dwordx4 v37, s[8:11], s66 offen offset:1024 lds
  buffer_load_dwordx4 v38, s[8:11], s66 offen offset:2048 lds
  buffer_load_dwordx4 v39, s[8:11], s66 offen offset:3072 lds
  s_add_u32 s66, s66, 262144
  s_add_u32 m0, s64, 32768
  s_nop 0
  buffer_load_dwordx4 v32, s[4:7], s65 offen offset:0 lds
  buffer_load_dwordx4 v33, s[4:7], s65 offen offset:1024 lds
  buffer_load_dwordx4 v34, s[4:7], s65 offen offset:2048 lds
  buffer_load_dwordx4 v35, s[4:7], s65 offen offset:3072 lds
  s_add_u32 s65, s65, 32768
  s_add_u32 m0, s64, 36864
  s_nop 0
  buffer_load_dwordx4 v32, s[4:7], s65 offen offset:0 lds
  buffer_load_dwordx4 v33, s[4:7], s65 offen offset:1024 lds
  buffer_load_dwordx4 v34, s[4:7], s65 offen offset:2048 lds
  buffer_load_dwordx4 v35, s[4:7], s65 offen offset:3072 lds
  s_sub_u32 s65, s65, 32640
  s_add_u32 m0, s64, 98304
  s_nop 0
  buffer_load_dwordx4 v36, s[8:11], s66 offen offset:0 lds
  buffer_load_dwordx4 v37, s[8:11], s66 offen offset:1024 lds
  buffer_load_dwordx4 v38, s[8:11], s66 offen offset:2048 lds
  buffer_load_dwordx4 v39, s[8:11], s66 offen offset:3072 lds
  s_add_u32 s66, s66, 262144
  s_add_u32 m0, s64, 102400
  s_nop 0
  buffer_load_dwordx4 v36, s[8:11], s66 offen offset:0 lds
  buffer_load_dwordx4 v37, s[8:11], s66 offen offset:1024 lds
  buffer_load_dwordx4 v38, s[8:11], s66 offen offset:2048 lds
  buffer_load_dwordx4 v39, s[8:11], s66 offen offset:3072 lds
  s_add_u32 s66, s66, 262144
  s_mov_b32 s12, s62
  s_mov_b32 s13, s63
  s_mov_b32 s14, 100663296
  s_mov_b32 s15, 0x20000
  s_mov_b32 s16, s36
  s_mov_b32 s17, s37
  s_mov_b32 s18, 2621440
  s_mov_b32 s19, 0x20000
  s_lshl_b32 s80, s29, 2
  s_add_u32 s80, s80, s32
  s_mul_i32 s79, s29, 3
  s_add_u32 s79, s79, s32
  s_add_u32 s33, s29, 24
  s_cmp_lt_u32 s32, 3
  s_cselect_b32 s79, s79, s33
  s_cmp_lt_u32 s79, 27
  s_cselect_b32 s73, 1, 0
  s_cselect_b32 s79, s79, 0
  s_and_b32 s81, s28, 3
  s_cmp_eq_u32 s81, 2
  s_cselect_b32 s20, s50, s52
  s_cselect_b32 s21, s51, s53
  s_mul_i32 s33, s73, 2211840
  s_cmp_lt_u32 s81, 2
  s_cselect_b32 s20, s40, s20
  s_cselect_b32 s21, s41, s21
  s_cselect_b32 s22, 5242880, s33
  s_mov_b32 s23, 0x20000
  s_mov_b32 s33, 3456
  s_cselect_b32 s35, 8192, s33
  s_lshl_b32 s33, s80, 8
  s_lshl_b32 s34, s79, 7
  s_cmp_lt_u32 s81, 2
  s_cselect_b32 s68, s33, s34
  s_cselect_b32 s33, s81, 0
  s_lshl_b32 s33, s33, 7
  s_add_u32 s68, s68, s33
  s_lshl_b32 s69, s35, 5
  v_mul_u32_u24 v48, s35, v45
  v_add_u32 v6, v48, v53
  v_xor_b32 v49, 64, v6
  s_lshl_b32 s33, s35, 3
  s_sub_u32 s33, s33, 1024
  v_add_u32 v7, s33, v49
  s_lshl_b32 s34, s33, 1
  v_add_u32 v8, s34, v6
  v_add_u32 v9, s34, v7
  v_mul_u32_u24 v48, 1280, v45
  v_add_u32 v2, v48, v52
  v_xor_b32 v49, 64, v2
  v_add_u32 v3, 9216, v49
  v_add_u32 v4, 18432, v2
  v_add_u32 v5, 27648, v49
  s_sub_u32 s33, 15, s31
  s_cmp_lt_u32 s28, 2
  s_cselect_b32 s33, s33, s31
  s_lshl_b32 s33, s33, 1
  s_and_b32 s34, s28, 1
  s_add_u32 s33, s33, s34
  s_mul_i32 s67, s33, 81920
  v_and_b32 v48, 15, v44
  v_lshrrev_b32 v49, 1, v48
  v_xor_b32 v49, v49, v47
  v_lshlrev_b32 v49, 4, v49
  v_lshl_add_u32 v54, v48, 7, v49
  v_bfe_u32 v48, v44, 2, 2
  v_lshl_add_u32 v49, v47, 3, v48
  v_lshlrev_b32 v49, 7, v49
  v_lshrrev_b32 v48, 1, v48
  v_and_b32 v50, 1, v47
  v_lshl_or_b32 v48, v50, 1, v48
  v_lshlrev_b32 v48, 5, v48
  v_and_b32 v50, 3, v44
  v_lshlrev_b32 v50, 3, v50
  v_add3_u32 v55, v49, v48, v50
  s_and_b32 s33, s28, 1
  s_lshl_b32 s34, s33, 14
  v_add_u32 v40, s34, v54
  v_xor_b32 v41, 64, v40
  s_lshr_b32 s34, s28, 1
  s_lshl_b32 s34, s34, 13
  s_add_u32 s34, s34, 65536
  v_add_u32 v42, s34, v55
  v_xor_b32 v43, 32, v42
  v_xor_b32 v44, 64, v42
  v_xor_b32 v45, 96, v42
  s_lshl_b32 s34, s33, 13
  s_add_u32 s34, s34, 65536
  v_add_u32 v27, s34, v55
  v_xor_b32 v28, 32, v27
  v_xor_b32 v29, 64, v27
  v_xor_b32 v30, 96, v27
  s_lshl_b32 s34, s33, 6
  s_add_u32 s34, s34, 81920
  v_xor_b32 v31, s34, v55
  v_xor_b32 v14, 32, v31
  s_bfe_u32 s33, s28, 0x10001
  s_lshl_b32 s33, s33, 12
  s_add_u32 s34, s33, 0
  v_add_u32 v23, s34, v54
  v_xor_b32 v24, 64, v23
  s_sub_u32 s34, 12288, s33
  v_add_u32 v25, s34, v54
  v_xor_b32 v26, 64, v25
  s_lshl_b32 s33, s96, 1
  s_add_u32 s33, s33, 0
  s_lshl_b32 s70, s33, 19
  s_lshl_b32 s33, s31, 16
  s_add_u32 s70, s70, s33
  s_and_b32 s33, s28, 1
  s_lshl_b32 s33, s33, 15
  s_add_u32 s70, s70, s33
  s_bfe_u32 s33, s28, 0x10001
  s_add_u32 s34, s97, 11
  s_lshl_b32 s33, s33, s34
  s_add_u32 s70, s70, s33
  s_lshl_b32 s33, s97, 24
  s_add_u32 s70, s70, s33
  s_lshr_b32 s33, 4096, s97
  s_add_u32 s71, s70, s33
  s_sub_u32 s91, 15, s31
  s_lshl_b32 s33, s91, 3
  s_add_u32 s89, s33, s81
  s_add_u32 s90, s33, 7
  s_sub_u32 s90, s90, s81
  s_and_b32 s34, s28, 2
  s_add_u32 s33, s33, s34
  s_mul_i32 s33, s33, 182
  s_lshl_b32 s34, s79, 1
  s_add_u32 s33, s33, s34
  s_and_b32 s34, s28, 1
  s_add_u32 s33, s33, s34
  s_add_u32 s33, s33, 32896
  s_lshl_b32 s72, s33, 10
  s_cmp_eq_u32 s73, 1
  s_cselect_b32 s72, s72, 92274688
  s_lshl_b32 s82, s91, 1
  s_add_u32 s82, s82, 2
  s_lshl_b32 s83, s31, 1
  s_sub_u32 s83, 32, s83
  s_mov_b32 s95, 0
  s_mov_b32 s24, s60
  s_mov_b32 s25, s61
  s_mov_b32 s26, 256
  s_mov_b32 s27, 0x20000
  v_lshrrev_b32 v52, 4, v16
  v_add_u32 v48, 0, v52
  v_mul_u32_u24 v49, 3277, v48
  v_lshrrev_b32 v49, 16, v49
  v_mul_u32_u24 v50, 20, v49
  v_sub_u32 v50, v48, v50
  v_bfe_u32 v51, v49, 2, 1
  v_lshlrev_b32 v51, 1, v51
  v_xor_b32 v50, v50, v51
  v_lshlrev_b32 v50, 4, v50
  v_mul_u32_u24 v49, 1280, v49
  v_add_u32 v17, v49, v50
  v_add_u32 v48, 64, v52
  v_mul_u32_u24 v49, 3277, v48
  v_lshrrev_b32 v49, 16, v49
  v_mul_u32_u24 v50, 20, v49
  v_sub_u32 v50, v48, v50
  v_bfe_u32 v51, v49, 2, 1
  v_lshlrev_b32 v51, 1, v51
  v_xor_b32 v50, v50, v51
  v_lshlrev_b32 v50, 4, v50
  v_mul_u32_u24 v49, 1280, v49
  v_add_u32 v18, v49, v50
  v_subrev_u32 v18, 1024, v18
  v_add_u32 v48, 128, v52
  v_mul_u32_u24 v49, 3277, v48
  v_lshrrev_b32 v49, 16, v49
  v_mul_u32_u24 v50, 20, v49
  v_sub_u32 v50, v48, v50
  v_bfe_u32 v51, v49, 2, 1
  v_lshlrev_b32 v51, 1, v51
  v_xor_b32 v50, v50, v51
  v_lshlrev_b32 v50, 4, v50
  v_mul_u32_u24 v49, 1280, v49
  v_add_u32 v19, v49, v50
  v_subrev_u32 v19, 2048, v19
  v_add_u32 v48, 192, v52
  v_mul_u32_u24 v49, 3277, v48
  v_lshrrev_b32 v49, 16, v49
  v_mul_u32_u24 v50, 20, v49
  v_sub_u32 v50, v48, v50
  v_bfe_u32 v51, v49, 2, 1
  v_lshlrev_b32 v51, 1, v51
  v_xor_b32 v50, v50, v51
  v_lshlrev_b32 v50, 4, v50
  v_mul_u32_u24 v49, 1280, v49
  v_add_u32 v20, v49, v50
  v_subrev_u32 v20, 3072, v20
  v_add_u32 v48, 256, v52
  v_mul_u32_u24 v49, 3277, v48
  v_lshrrev_b32 v49, 16, v49
  v_mul_u32_u24 v50, 20, v49
  v_sub_u32 v50, v48, v50
  v_bfe_u32 v51, v49, 2, 1
  v_lshlrev_b32 v51, 1, v51
  v_xor_b32 v50, v50, v51
  v_lshlrev_b32 v50, 4, v50
  v_mul_u32_u24 v49, 1280, v49
  v_add_u32 v21, v49, v50
  v_bfe_u32 v49, v52, 2, 2
  v_lshl_add_u32 v49, v47, 2, v49
  v_mul_u32_u24 v49, 320, v49
  v_and_b32 v50, 3, v52
  v_lshl_add_u32 v49, v50, 3, v49
  v_and_b32 v50, 1, v47
  v_lshl_add_u32 v22, v50, 5, v49
  s_cmp_eq_u32 s97, 0
  s_cbranch_scc0 F_VA
  s_waitcnt vmcnt(16) lgkmcnt(0)
  s_barrier
  ds_read_b128 v[80:83], v40 offset:0
  ds_read_b64_tr_b16 v[96:97], v42 offset:0
  ds_read_b64_tr_b16 v[98:99], v42 offset:512
  ds_read_b64_tr_b16 v[100:101], v43 offset:0
  ds_read_b64_tr_b16 v[102:103], v43 offset:512
  ds_read_b64_tr_b16 v[104:105], v44 offset:0
  ds_read_b64_tr_b16 v[106:107], v44 offset:512
  ds_read_b64_tr_b16 v[108:109], v45 offset:0
  ds_read_b64_tr_b16 v[110:111], v45 offset:512
  ds_read_b128 v[84:87], v40 offset:2048
  s_waitcnt lgkmcnt(7)
  v_mfma_f32_16x16x32_bf16 v[128:131], v[96:99], v[80:83], 0
  ds_read_b128 v[88:91], v40 offset:4096
  s_waitcnt lgkmcnt(6)
  v_mfma_f32_16x16x32_bf16 v[132:135], v[100:103], v[80:83], 0
  s_waitcnt lgkmcnt(4)
  v_mfma_f32_16x16x32_bf16 v[136:139], v[104:107], v[80:83], 0
  s_waitcnt lgkmcnt(2)
  v_mfma_f32_16x16x32_bf16 v[140:143], v[108:111], v[80:83], 0
  s_waitcnt lgkmcnt(1)
  v_mfma_f32_16x16x32_bf16 v[156:159], v[108:111], v[84:87], 0
  ds_read_b128 v[92:95], v40 offset:6144
  v_mfma_f32_16x16x32_bf16 v[152:155], v[104:107], v[84:87], 0
  v_mfma_f32_16x16x32_bf16 v[148:151], v[100:103], v[84:87], 0
  v_mfma_f32_16x16x32_bf16 v[144:147], v[96:99], v[84:87], 0
  s_waitcnt lgkmcnt(1)
  v_mfma_f32_16x16x32_bf16 v[160:163], v[96:99], v[88:91], 0
  ds_read_b128 v[80:83], v40 offset:8192
  v_mfma_f32_16x16x32_bf16 v[164:167], v[100:103], v[88:91], 0
  ds_read_b64_tr_b16 v[112:113], v42 offset:4096
  v_mfma_f32_16x16x32_bf16 v[168:171], v[104:107], v[88:91], 0
  v_mfma_f32_16x16x32_bf16 v[172:175], v[108:111], v[88:91], 0
  ds_read_b64_tr_b16 v[114:115], v42 offset:4608
  s_waitcnt lgkmcnt(3)
  v_mfma_f32_16x16x32_bf16 v[188:191], v[108:111], v[92:95], 0
  ds_read_b128 v[84:87], v40 offset:10240
  v_mfma_f32_16x16x32_bf16 v[184:187], v[104:107], v[92:95], 0
  ds_read_b64_tr_b16 v[116:117], v43 offset:4096
  v_mfma_f32_16x16x32_bf16 v[180:183], v[100:103], v[92:95], 0
  v_mfma_f32_16x16x32_bf16 v[176:179], v[96:99], v[92:95], 0
  ds_read_b64_tr_b16 v[118:119], v43 offset:4608
  s_waitcnt lgkmcnt(5)
  v_mfma_f32_16x16x32_bf16 v[192:195], v[96:99], v[80:83], 0
  ds_read_b128 v[88:91], v40 offset:12288
  v_mfma_f32_16x16x32_bf16 v[196:199], v[100:103], v[80:83], 0
  ds_read_b64_tr_b16 v[120:121], v44 offset:4096
  v_mfma_f32_16x16x32_bf16 v[200:203], v[104:107], v[80:83], 0
  v_mfma_f32_16x16x32_bf16 v[204:207], v[108:111], v[80:83], 0
  ds_read_b64_tr_b16 v[122:123], v44 offset:4608
  s_waitcnt lgkmcnt(5)
  v_mfma_f32_16x16x32_bf16 v[220:223], v[108:111], v[84:87], 0
  ds_read_b128 v[92:95], v40 offset:14336
  v_mfma_f32_16x16x32_bf16 v[216:219], v[104:107], v[84:87], 0
  ds_read_b64_tr_b16 v[124:125], v45 offset:4096
  v_mfma_f32_16x16x32_bf16 v[212:215], v[100:103], v[84:87], 0
  v_mfma_f32_16x16x32_bf16 v[208:211], v[96:99], v[84:87], 0
  ds_read_b64_tr_b16 v[126:127], v45 offset:4608
  s_waitcnt lgkmcnt(5)
  v_mfma_f32_16x16x32_bf16 v[224:227], v[96:99], v[88:91], 0
  ds_read_b128 v[80:83], v41 offset:0
  v_mfma_f32_16x16x32_bf16 v[228:231], v[100:103], v[88:91], 0
  v_mfma_f32_16x16x32_bf16 v[232:235], v[104:107], v[88:91], 0
  v_mfma_f32_16x16x32_bf16 v[236:239], v[108:111], v[88:91], 0
  s_waitcnt lgkmcnt(3)
  v_mfma_f32_16x16x32_bf16 v[252:255], v[108:111], v[92:95], 0
  ds_read_b128 v[84:87], v41 offset:2048
  v_mfma_f32_16x16x32_bf16 v[248:251], v[104:107], v[92:95], 0
  v_mfma_f32_16x16x32_bf16 v[244:247], v[100:103], v[92:95], 0
  v_mfma_f32_16x16x32_bf16 v[240:243], v[96:99], v[92:95], 0
  s_waitcnt lgkmcnt(1)
  v_mfma_f32_16x16x32_bf16 v[128:131], v[112:115], v[80:83], v[128:131]
  ds_read_b128 v[88:91], v41 offset:4096
  v_mfma_f32_16x16x32_bf16 v[132:135], v[116:119], v[80:83], v[132:135]
  v_mfma_f32_16x16x32_bf16 v[136:139], v[120:123], v[80:83], v[136:139]
  v_mfma_f32_16x16x32_bf16 v[140:143], v[124:127], v[80:83], v[140:143]
  s_waitcnt lgkmcnt(1)
  v_mfma_f32_16x16x32_bf16 v[156:159], v[124:127], v[84:87], v[156:159]
  ds_read_b128 v[92:95], v41 offset:6144
  v_mfma_f32_16x16x32_bf16 v[152:155], v[120:123], v[84:87], v[152:155]
  v_mfma_f32_16x16x32_bf16 v[148:151], v[116:119], v[84:87], v[148:151]
  v_mfma_f32_16x16x32_bf16 v[144:147], v[112:115], v[84:87], v[144:147]
  s_waitcnt lgkmcnt(1)
  v_mfma_f32_16x16x32_bf16 v[160:163], v[112:115], v[88:91], v[160:163]
  ds_read_b128 v[80:83], v41 offset:8192
  v_mfma_f32_16x16x32_bf16 v[164:167], v[116:119], v[88:91], v[164:167]
  v_mfma_f32_16x16x32_bf16 v[168:171], v[120:123], v[88:91], v[168:171]
  v_mfma_f32_16x16x32_bf16 v[172:175], v[124:127], v[88:91], v[172:175]
  s_waitcnt lgkmcnt(1)
  v_mfma_f32_16x16x32_bf16 v[188:191], v[124:127], v[92:95], v[188:191]
  ds_read_b128 v[84:87], v41 offset:10240
  v_mfma_f32_16x16x32_bf16 v[184:187], v[120:123], v[92:95], v[184:187]
  v_mfma_f32_16x16x32_bf16 v[180:183], v[116:119], v[92:95], v[180:183]
  v_mfma_f32_16x16x32_bf16 v[176:179], v[112:115], v[92:95], v[176:179]
  s_waitcnt lgkmcnt(1)
  v_mfma_f32_16x16x32_bf16 v[192:195], v[112:115], v[80:83], v[192:195]
  ds_read_b128 v[88:91], v41 offset:12288
  v_mfma_f32_16x16x32_bf16 v[196:199], v[116:119], v[80:83], v[196:199]
  v_mfma_f32_16x16x32_bf16 v[200:203], v[120:123], v[80:83], v[200:203]
  v_mfma_f32_16x16x32_bf16 v[204:207], v[124:127], v[80:83], v[204:207]
  s_waitcnt lgkmcnt(1)
  v_mfma_f32_16x16x32_bf16 v[220:223], v[124:127], v[84:87], v[220:223]
  ds_read_b128 v[92:95], v41 offset:14336
  v_mfma_f32_16x16x32_bf16 v[216:219], v[120:123], v[84:87], v[216:219]
  v_mfma_f32_16x16x32_bf16 v[212:215], v[116:119], v[84:87], v[212:215]
  v_mfma_f32_16x16x32_bf16 v[208:211], v[112:115], v[84:87], v[208:211]
  s_waitcnt vmcnt(0) lgkmcnt(0)
  s_barrier
  v_mfma_f32_16x16x32_bf16 v[224:227], v[112:115], v[88:91], v[224:227]
  ds_read_b128 v[80:83], v40 offset:32768
  ds_read_b64_tr_b16 v[96:97], v42 offset:32768
  v_mfma_f32_16x16x32_bf16 v[228:231], v[116:119], v[88:91], v[228:231]
  ds_read_b64_tr_b16 v[98:99], v42 offset:33280
  ds_read_b64_tr_b16 v[100:101], v43 offset:32768
  v_mfma_f32_16x16x32_bf16 v[232:235], v[120:123], v[88:91], v[232:235]
  ds_read_b64_tr_b16 v[102:103], v43 offset:33280
  ds_read_b64_tr_b16 v[104:105], v44 offset:32768
  v_mfma_f32_16x16x32_bf16 v[236:239], v[124:127], v[88:91], v[236:239]
  ds_read_b64_tr_b16 v[106:107], v44 offset:33280
  ds_read_b64_tr_b16 v[108:109], v45 offset:32768
  v_mfma_f32_16x16x32_bf16 v[252:255], v[124:127], v[92:95], v[252:255]
  ds_read_b64_tr_b16 v[110:111], v45 offset:33280
  ds_read_b128 v[84:87], v40 offset:34816
  v_mfma_f32_16x16x32_bf16 v[248:251], v[120:123], v[92:95], v[248:251]
  v_mfma_f32_16x16x32_bf16 v[244:247], v[116:119], v[92:95], v[244:247]
  v_mfma_f32_16x16x32_bf16 v[240:243], v[112:115], v[92:95], v[240:243]
  s_waitcnt lgkmcnt(7)
  v_mfma_f32_16x16x32_bf16 v[128:131], v[96:99], v[80:83], v[128:131]
  ds_read_b128 v[88:91], v40 offset:36864
  s_add_u32 m0, s64, 0
  s_waitcnt lgkmcnt(6)
  v_mfma_f32_16x16x32_bf16 v[132:135], v[100:103], v[80:83], v[132:135]
  buffer_load_dwordx4 v32, s[4:7], s65 offen offset:0 lds
  s_waitcnt lgkmcnt(4)
  v_mfma_f32_16x16x32_bf16 v[136:139], v[104:107], v[80:83], v[136:139]
  s_waitcnt lgkmcnt(2)
  v_mfma_f32_16x16x32_bf16 v[140:143], v[108:111], v[80:83], v[140:143]
  buffer_load_dwordx4 v33, s[4:7], s65 offen offset:1024 lds
  s_waitcnt lgkmcnt(1)
  v_mfma_f32_16x16x32_bf16 v[156:159], v[108:111], v[84:87], v[156:159]
  ds_read_b128 v[92:95], v40 offset:38912
  v_mfma_f32_16x16x32_bf16 v[152:155], v[104:107], v[84:87], v[152:155]
  buffer_load_dwordx4 v34, s[4:7], s65 offen offset:2048 lds
  v_mfma_f32_16x16x32_bf16 v[148:151], v[100:103], v[84:87], v[148:151]
  v_mfma_f32_16x16x32_bf16 v[144:147], v[96:99], v[84:87], v[144:147]
  buffer_load_dwordx4 v35, s[4:7], s65 offen offset:3072 lds
  s_add_u32 s65, s65, 32768
  s_add_u32 m0, s64, 4096
  s_waitcnt lgkmcnt(1)
  v_mfma_f32_16x16x32_bf16 v[160:163], v[96:99], v[88:91], v[160:163]
  ds_read_b128 v[80:83], v40 offset:40960
  v_mfma_f32_16x16x32_bf16 v[164:167], v[100:103], v[88:91], v[164:167]
  ds_read_b64_tr_b16 v[112:113], v42 offset:36864
  buffer_load_dwordx4 v32, s[4:7], s65 offen offset:0 lds
  v_mfma_f32_16x16x32_bf16 v[168:171], v[104:107], v[88:91], v[168:171]
  v_mfma_f32_16x16x32_bf16 v[172:175], v[108:111], v[88:91], v[172:175]
  ds_read_b64_tr_b16 v[114:115], v42 offset:37376
  buffer_load_dwordx4 v33, s[4:7], s65 offen offset:1024 lds
  s_waitcnt lgkmcnt(3)
  v_mfma_f32_16x16x32_bf16 v[188:191], v[108:111], v[92:95], v[188:191]
  ds_read_b128 v[84:87], v40 offset:43008
  v_mfma_f32_16x16x32_bf16 v[184:187], v[104:107], v[92:95], v[184:187]
  ds_read_b64_tr_b16 v[116:117], v43 offset:36864
  buffer_load_dwordx4 v34, s[4:7], s65 offen offset:2048 lds
  v_mfma_f32_16x16x32_bf16 v[180:183], v[100:103], v[92:95], v[180:183]
  v_mfma_f32_16x16x32_bf16 v[176:179], v[96:99], v[92:95], v[176:179]
  ds_read_b64_tr_b16 v[118:119], v43 offset:37376
  buffer_load_dwordx4 v35, s[4:7], s65 offen offset:3072 lds
  s_sub_u32 s65, s65, 32640
  s_add_u32 m0, s64, 65536
  s_waitcnt lgkmcnt(5)
  v_mfma_f32_16x16x32_bf16 v[192:195], v[96:99], v[80:83], v[192:195]
  ds_read_b128 v[88:91], v40 offset:45056
  v_mfma_f32_16x16x32_bf16 v[196:199], v[100:103], v[80:83], v[196:199]
  ds_read_b64_tr_b16 v[120:121], v44 offset:36864
  buffer_load_dwordx4 v36, s[8:11], s66 offen offset:0 lds
  v_mfma_f32_16x16x32_bf16 v[200:203], v[104:107], v[80:83], v[200:203]
  v_mfma_f32_16x16x32_bf16 v[204:207], v[108:111], v[80:83], v[204:207]
  ds_read_b64_tr_b16 v[122:123], v44 offset:37376
  buffer_load_dwordx4 v37, s[8:11], s66 offen offset:1024 lds
  s_waitcnt lgkmcnt(5)
  v_mfma_f32_16x16x32_bf16 v[220:223], v[108:111], v[84:87], v[220:223]
  ds_read_b128 v[92:95], v40 offset:47104
  v_mfma_f32_16x16x32_bf16 v[216:219], v[104:107], v[84:87], v[216:219]
  ds_read_b64_tr_b16 v[124:125], v45 offset:36864
  buffer_load_dwordx4 v38, s[8:11], s66 offen offset:2048 lds
  v_mfma_f32_16x16x32_bf16 v[212:215], v[100:103], v[84:87], v[212:215]
  v_mfma_f32_16x16x32_bf16 v[208:211], v[96:99], v[84:87], v[208:211]
  ds_read_b64_tr_b16 v[126:127], v45 offset:37376
  buffer_load_dwordx4 v39, s[8:11], s66 offen offset:3072 lds
  s_add_u32 s66, s66, 262144
  s_add_u32 m0, s64, 69632
  s_waitcnt lgkmcnt(5)
  v_mfma_f32_16x16x32_bf16 v[224:227], v[96:99], v[88:91], v[224:227]
  ds_read_b128 v[80:83], v41 offset:32768
  v_mfma_f32_16x16x32_bf16 v[228:231], v[100:103], v[88:91], v[228:231]
  buffer_load_dwordx4 v36, s[8:11], s66 offen offset:0 lds
  v_mfma_f32_16x16x32_bf16 v[232:235], v[104:107], v[88:91], v[232:235]
  v_mfma_f32_16x16x32_bf16 v[236:239], v[108:111], v[88:91], v[236:239]
  buffer_load_dwordx4 v37, s[8:11], s66 offen offset:1024 lds
  s_waitcnt lgkmcnt(3)
  v_mfma_f32_16x16x32_bf16 v[252:255], v[108:111], v[92:95], v[252:255]
  ds_read_b128 v[84:87], v41 offset:34816
  v_mfma_f32_16x16x32_bf16 v[248:251], v[104:107], v[92:95], v[248:251]
  buffer_load_dwordx4 v38, s[8:11], s66 offen offset:2048 lds
  v_mfma_f32_16x16x32_bf16 v[244:247], v[100:103], v[92:95], v[244:247]
  v_mfma_f32_16x16x32_bf16 v[240:243], v[96:99], v[92:95], v[240:243]
  buffer_load_dwordx4 v39, s[8:11], s66 offen offset:3072 lds
  s_add_u32 s66, s66, 262144
  s_waitcnt lgkmcnt(1)
  v_mfma_f32_16x16x32_bf16 v[128:131], v[112:115], v[80:83], v[128:131]
  ds_read_b128 v[88:91], v41 offset:36864
  v_mfma_f32_16x16x32_bf16 v[132:135], v[116:119], v[80:83], v[132:135]
  v_mfma_f32_16x16x32_bf16 v[136:139], v[120:123], v[80:83], v[136:139]
  v_mfma_f32_16x16x32_bf16 v[140:143], v[124:127], v[80:83], v[140:143]
  s_waitcnt lgkmcnt(1)
  v_mfma_f32_16x16x32_bf16 v[156:159], v[124:127], v[84:87], v[156:159]
  ds_read_b128 v[92:95], v41 offset:38912
  v_mfma_f32_16x16x32_bf16 v[152:155], v[120:123], v[84:87], v[152:155]
  v_mfma_f32_16x16x32_bf16 v[148:151], v[116:119], v[84:87], v[148:151]
  v_mfma_f32_16x16x32_bf16 v[144:147], v[112:115], v[84:87], v[144:147]
  s_waitcnt lgkmcnt(1)
  v_mfma_f32_16x16x32_bf16 v[160:163], v[112:115], v[88:91], v[160:163]
  ds_read_b128 v[80:83], v41 offset:40960
  v_mfma_f32_16x16x32_bf16 v[164:167], v[116:119], v[88:91], v[164:167]
  v_mfma_f32_16x16x32_bf16 v[168:171], v[120:123], v[88:91], v[168:171]
  v_mfma_f32_16x16x32_bf16 v[172:175], v[124:127], v[88:91], v[172:175]
  s_waitcnt lgkmcnt(1)
  v_mfma_f32_16x16x32_bf16 v[188:191], v[124:127], v[92:95], v[188:191]
  ds_read_b128 v[84:87], v41 offset:43008
  v_mfma_f32_16x16x32_bf16 v[184:187], v[120:123], v[92:95], v[184:187]
  v_mfma_f32_16x16x32_bf16 v[180:183], v[116:119], v[92:95], v[180:183]
  v_mfma_f32_16x16x32_bf16 v[176:179], v[112:115], v[92:95], v[176:179]
  s_waitcnt lgkmcnt(1)
  v_mfma_f32_16x16x32_bf16 v[192:195], v[112:115], v[80:83], v[192:195]
  ds_read_b128 v[88:91], v41 offset:45056
  v_mfma_f32_16x16x32_bf16 v[196:199], v[116:119], v[80:83], v[196:199]
  v_mfma_f32_16x16x32_bf16 v[200:203], v[120:123], v[80:83], v[200:203]
  v_mfma_f32_16x16x32_bf16 v[204:207], v[124:127], v[80:83], v[204:207]
  s_waitcnt lgkmcnt(1)
  v_mfma_f32_16x16x32_bf16 v[220:223], v[124:127], v[84:87], v[220:223]
  ds_read_b128 v[92:95], v41 offset:47104
  v_mfma_f32_16x16x32_bf16 v[216:219], v[120:123], v[84:87], v[216:219]
  v_mfma_f32_16x16x32_bf16 v[212:215], v[116:119], v[84:87], v[212:215]
  v_mfma_f32_16x16x32_bf16 v[208:211], v[112:115], v[84:87], v[208:211]
  s_waitcnt vmcnt(0) lgkmcnt(0)
  s_barrier
  v_mfma_f32_16x16x32_bf16 v[224:227], v[112:115], v[88:91], v[224:227]
  ds_read_b128 v[80:83], v40 offset:0
  ds_read_b64_tr_b16 v[96:97], v42 offset:0
  v_mfma_f32_16x16x32_bf16 v[228:231], v[116:119], v[88:91], v[228:231]
  ds_read_b64_tr_b16 v[98:99], v42 offset:512
  ds_read_b64_tr_b16 v[100:101], v43 offset:0
  v_mfma_f32_16x16x32_bf16 v[232:235], v[120:123], v[88:91], v[232:235]
  ds_read_b64_tr_b16 v[102:103], v43 offset:512
  ds_read_b64_tr_b16 v[104:105], v44 offset:0
  v_mfma_f32_16x16x32_bf16 v[236:239], v[124:127], v[88:91], v[236:239]
  ds_read_b64_tr_b16 v[106:107], v44 offset:512
  ds_read_b64_tr_b16 v[108:109], v45 offset:0
  v_mfma_f32_16x16x32_bf16 v[252:255], v[124:127], v[92:95], v[252:255]
  ds_read_b64_tr_b16 v[110:111], v45 offset:512
  ds_read_b128 v[84:87], v40 offset:2048
  v_mfma_f32_16x16x32_bf16 v[248:251], v[120:123], v[92:95], v[248:251]
  v_mfma_f32_16x16x32_bf16 v[244:247], v[116:119], v[92:95], v[244:247]
  v_mfma_f32_16x16x32_bf16 v[240:243], v[112:115], v[92:95], v[240:243]
  s_waitcnt lgkmcnt(7)
  v_mfma_f32_16x16x32_bf16 v[128:131], v[96:99], v[80:83], v[128:131]
  ds_read_b128 v[88:91], v40 offset:4096
  s_add_u32 m0, s64, 32768
  s_waitcnt lgkmcnt(6)
  v_mfma_f32_16x16x32_bf16 v[132:135], v[100:103], v[80:83], v[132:135]
  buffer_load_dwordx4 v32, s[4:7], s65 offen offset:0 lds
  s_waitcnt lgkmcnt(4)
  v_mfma_f32_16x16x32_bf16 v[136:139], v[104:107], v[80:83], v[136:139]
  s_waitcnt lgkmcnt(2)
  v_mfma_f32_16x16x32_bf16 v[140:143], v[108:111], v[80:83], v[140:143]
  buffer_load_dwordx4 v33, s[4:7], s65 offen offset:1024 lds
  s_waitcnt lgkmcnt(1)
  v_mfma_f32_16x16x32_bf16 v[156:159], v[108:111], v[84:87], v[156:159]
  ds_read_b128 v[92:95], v40 offset:6144
  v_mfma_f32_16x16x32_bf16 v[152:155], v[104:107], v[84:87], v[152:155]
  buffer_load_dwordx4 v34, s[4:7], s65 offen offset:2048 lds
  v_mfma_f32_16x16x32_bf16 v[148:151], v[100:103], v[84:87], v[148:151]
  v_mfma_f32_16x16x32_bf16 v[144:147], v[96:99], v[84:87], v[144:147]
  buffer_load_dwordx4 v35, s[4:7], s65 offen offset:3072 lds
  s_add_u32 s65, s65, 32768
  s_add_u32 m0, s64, 36864
  s_waitcnt lgkmcnt(1)
  v_mfma_f32_16x16x32_bf16 v[160:163], v[96:99], v[88:91], v[160:163]
  ds_read_b128 v[80:83], v40 offset:8192
  v_mfma_f32_16x16x32_bf16 v[164:167], v[100:103], v[88:91], v[164:167]
  ds_read_b64_tr_b16 v[112:113], v42 offset:4096
  buffer_load_dwordx4 v32, s[4:7], s65 offen offset:0 lds
  v_mfma_f32_16x16x32_bf16 v[168:171], v[104:107], v[88:91], v[168:171]
  v_mfma_f32_16x16x32_bf16 v[172:175], v[108:111], v[88:91], v[172:175]
  ds_read_b64_tr_b16 v[114:115], v42 offset:4608
  buffer_load_dwordx4 v33, s[4:7], s65 offen offset:1024 lds
  s_waitcnt lgkmcnt(3)
  v_mfma_f32_16x16x32_bf16 v[188:191], v[108:111], v[92:95], v[188:191]
  ds_read_b128 v[84:87], v40 offset:10240
  v_mfma_f32_16x16x32_bf16 v[184:187], v[104:107], v[92:95], v[184:187]
  ds_read_b64_tr_b16 v[116:117], v43 offset:4096
  buffer_load_dwordx4 v34, s[4:7], s65 offen offset:2048 lds
  v_mfma_f32_16x16x32_bf16 v[180:183], v[100:103], v[92:95], v[180:183]
  v_mfma_f32_16x16x32_bf16 v[176:179], v[96:99], v[92:95], v[176:179]
  ds_read_b64_tr_b16 v[118:119], v43 offset:4608
  buffer_load_dwordx4 v35, s[4:7], s65 offen offset:3072 lds
  s_sub_u32 s65, s65, 32640
  s_add_u32 m0, s64, 98304
  s_waitcnt lgkmcnt(5)
  v_mfma_f32_16x16x32_bf16 v[192:195], v[96:99], v[80:83], v[192:195]
  ds_read_b128 v[88:91], v40 offset:12288
  v_mfma_f32_16x16x32_bf16 v[196:199], v[100:103], v[80:83], v[196:199]
  ds_read_b64_tr_b16 v[120:121], v44 offset:4096
  buffer_load_dwordx4 v36, s[8:11], s66 offen offset:0 lds
  v_mfma_f32_16x16x32_bf16 v[200:203], v[104:107], v[80:83], v[200:203]
  v_mfma_f32_16x16x32_bf16 v[204:207], v[108:111], v[80:83], v[204:207]
  ds_read_b64_tr_b16 v[122:123], v44 offset:4608
  buffer_load_dwordx4 v37, s[8:11], s66 offen offset:1024 lds
  s_waitcnt lgkmcnt(5)
  v_mfma_f32_16x16x32_bf16 v[220:223], v[108:111], v[84:87], v[220:223]
  ds_read_b128 v[92:95], v40 offset:14336
  v_mfma_f32_16x16x32_bf16 v[216:219], v[104:107], v[84:87], v[216:219]
  ds_read_b64_tr_b16 v[124:125], v45 offset:4096
  buffer_load_dwordx4 v38, s[8:11], s66 offen offset:2048 lds
  v_mfma_f32_16x16x32_bf16 v[212:215], v[100:103], v[84:87], v[212:215]
  v_mfma_f32_16x16x32_bf16 v[208:211], v[96:99], v[84:87], v[208:211]
  ds_read_b64_tr_b16 v[126:127], v45 offset:4608
  buffer_load_dwordx4 v39, s[8:11], s66 offen offset:3072 lds
  s_add_u32 s66, s66, 262144
  s_add_u32 m0, s64, 102400
  s_waitcnt lgkmcnt(5)
  v_mfma_f32_16x16x32_bf16 v[224:227], v[96:99], v[88:91], v[224:227]
  ds_read_b128 v[80:83], v41 offset:0
  v_mfma_f32_16x16x32_bf16 v[228:231], v[100:103], v[88:91], v[228:231]
  buffer_load_dwordx4 v36, s[8:11], s66 offen offset:0 lds
  v_mfma_f32_16x16x32_bf16 v[232:235], v[104:107], v[88:91], v[232:235]
  v_mfma_f32_16x16x32_bf16 v[236:239], v[108:111], v[88:91], v[236:239]
  buffer_load_dwordx4 v37, s[8:11], s66 offen offset:1024 lds
  s_waitcnt lgkmcnt(3)
  v_mfma_f32_16x16x32_bf16 v[252:255], v[108:111], v[92:95], v[252:255]
  ds_read_b128 v[84:87], v41 offset:2048
  v_mfma_f32_16x16x32_bf16 v[248:251], v[104:107], v[92:95], v[248:251]
  buffer_load_dwordx4 v38, s[8:11], s66 offen offset:2048 lds
  v_mfma_f32_16x16x32_bf16 v[244:247], v[100:103], v[92:95], v[244:247]
  v_mfma_f32_16x16x32_bf16 v[240:243], v[96:99], v[92:95], v[240:243]
  buffer_load_dwordx4 v39, s[8:11], s66 offen offset:3072 lds
  s_add_u32 s66, s66, 262144
  s_waitcnt lgkmcnt(1)
  v_mfma_f32_16x16x32_bf16 v[128:131], v[112:115], v[80:83], v[128:131]
  ds_read_b128 v[88:91], v41 offset:4096
  v_mfma_f32_16x16x32_bf16 v[132:135], v[116:119], v[80:83], v[132:135]
  v_mfma_f32_16x16x32_bf16 v[136:139], v[120:123], v[80:83], v[136:139]
  v_mfma_f32_16x16x32_bf16 v[140:143], v[124:127], v[80:83], v[140:143]
  s_waitcnt lgkmcnt(1)
  v_mfma_f32_16x16x32_bf16 v[156:159], v[124:127], v[84:87], v[156:159]
  ds_read_b128 v[92:95], v41 offset:6144
  v_mfma_f32_16x16x32_bf16 v[152:155], v[120:123], v[84:87], v[152:155]
  v_mfma_f32_16x16x32_bf16 v[148:151], v[116:119], v[84:87], v[148:151]
  v_mfma_f32_16x16x32_bf16 v[144:147], v[112:115], v[84:87], v[144:147]
  s_waitcnt lgkmcnt(1)
  v_mfma_f32_16x16x32_bf16 v[160:163], v[112:115], v[88:91], v[160:163]
  ds_read_b128 v[80:83], v41 offset:8192
  v_mfma_f32_16x16x32_bf16 v[164:167], v[116:119], v[88:91], v[164:167]
  v_mfma_f32_16x16x32_bf16 v[168:171], v[120:123], v[88:91], v[168:171]
  v_mfma_f32_16x16x32_bf16 v[172:175], v[124:127], v[88:91], v[172:175]
  s_waitcnt lgkmcnt(1)
  v_mfma_f32_16x16x32_bf16 v[188:191], v[124:127], v[92:95], v[188:191]
  ds_read_b128 v[84:87], v41 offset:10240
  v_mfma_f32_16x16x32_bf16 v[184:187], v[120:123], v[92:95], v[184:187]
  v_mfma_f32_16x16x32_bf16 v[180:183], v[116:119], v[92:95], v[180:183]
  v_mfma_f32_16x16x32_bf16 v[176:179], v[112:115], v[92:95], v[176:179]
  s_waitcnt lgkmcnt(1)
  v_mfma_f32_16x16x32_bf16 v[192:195], v[112:115], v[80:83], v[192:195]
  ds_read_b128 v[88:91], v41 offset:12288
  v_mfma_f32_16x16x32_bf16 v[196:199], v[116:119], v[80:83], v[196:199]
  v_mfma_f32_16x16x32_bf16 v[200:203], v[120:123], v[80:83], v[200:203]
  v_mfma_f32_16x16x32_bf16 v[204:207], v[124:127], v[80:83], v[204:207]
  s_waitcnt lgkmcnt(1)
  v_mfma_f32_16x16x32_bf16 v[220:223], v[124:127], v[84:87], v[220:223]
  ds_read_b128 v[92:95], v41 offset:14336
  v_mfma_f32_16x16x32_bf16 v[216:219], v[120:123], v[84:87], v[216:219]
  v_mfma_f32_16x16x32_bf16 v[212:215], v[116:119], v[84:87], v[212:215]
  v_mfma_f32_16x16x32_bf16 v[208:211], v[112:115], v[84:87], v[208:211]
  s_waitcnt vmcnt(0) lgkmcnt(0)
  s_barrier
  v_mfma_f32_16x16x32_bf16 v[224:227], v[112:115], v[88:91], v[224:227]
  ds_read_b128 v[80:83], v40 offset:32768
  ds_read_b64_tr_b16 v[96:97], v42 offset:32768
  v_mfma_f32_16x16x32_bf16 v[228:231], v[116:119], v[88:91], v[228:231]
  ds_read_b64_tr_b16 v[98:99], v42 offset:33280
  ds_read_b64_tr_b16 v[100:101], v43 offset:32768
  v_mfma_f32_16x16x32_bf16 v[232:235], v[120:123], v[88:91], v[232:235]
  ds_read_b64_tr_b16 v[102:103], v43 offset:33280
  ds_read_b64_tr_b16 v[104:105], v44 offset:32768
  v_mfma_f32_16x16x32_bf16 v[236:239], v[124:127], v[88:91], v[236:239]
  ds_read_b64_tr_b16 v[106:107], v44 offset:33280
  ds_read_b64_tr_b16 v[108:109], v45 offset:32768
  v_mfma_f32_16x16x32_bf16 v[252:255], v[124:127], v[92:95], v[252:255]
  ds_read_b64_tr_b16 v[110:111], v45 offset:33280
  ds_read_b128 v[84:87], v40 offset:34816
  v_mfma_f32_16x16x32_bf16 v[248:251], v[120:123], v[92:95], v[248:251]
  v_mfma_f32_16x16x32_bf16 v[244:247], v[116:119], v[92:95], v[244:247]
  v_mfma_f32_16x16x32_bf16 v[240:243], v[112:115], v[92:95], v[240:243]
  s_waitcnt lgkmcnt(7)
  v_mfma_f32_16x16x32_bf16 v[128:131], v[96:99], v[80:83], v[128:131]
  ds_read_b128 v[88:91], v40 offset:36864
  s_add_u32 m0, s64, 0
  s_waitcnt lgkmcnt(6)
  v_mfma_f32_16x16x32_bf16 v[132:135], v[100:103], v[80:83], v[132:135]
  buffer_load_dwordx4 v32, s[4:7], s65 offen offset:0 lds
  s_waitcnt lgkmcnt(4)
  v_mfma_f32_16x16x32_bf16 v[136:139], v[104:107], v[80:83], v[136:139]
  s_waitcnt lgkmcnt(2)
  v_mfma_f32_16x16x32_bf16 v[140:143], v[108:111], v[80:83], v[140:143]
  buffer_load_dwordx4 v33, s[4:7], s65 offen offset:1024 lds
  s_waitcnt lgkmcnt(1)
  v_mfma_f32_16x16x32_bf16 v[156:159], v[108:111], v[84:87], v[156:159]
  ds_read_b128 v[92:95], v40 offset:38912
  v_mfma_f32_16x16x32_bf16 v[152:155], v[104:107], v[84:87], v[152:155]
  buffer_load_dwordx4 v34, s[4:7], s65 offen offset:2048 lds
  v_mfma_f32_16x16x32_bf16 v[148:151], v[100:103], v[84:87], v[148:151]
  v_mfma_f32_16x16x32_bf16 v[144:147], v[96:99], v[84:87], v[144:147]
  buffer_load_dwordx4 v35, s[4:7], s65 offen offset:3072 lds
  s_add_u32 s65, s65, 32768
  s_add_u32 m0, s64, 4096
  s_waitcnt lgkmcnt(1)
  v_mfma_f32_16x16x32_bf16 v[160:163], v[96:99], v[88:91], v[160:163]
  ds_read_b128 v[80:83], v40 offset:40960
  v_mfma_f32_16x16x32_bf16 v[164:167], v[100:103], v[88:91], v[164:167]
  ds_read_b64_tr_b16 v[112:113], v42 offset:36864
  buffer_load_dwordx4 v32, s[4:7], s65 offen offset:0 lds
  v_mfma_f32_16x16x32_bf16 v[168:171], v[104:107], v[88:91], v[168:171]
  v_mfma_f32_16x16x32_bf16 v[172:175], v[108:111], v[88:91], v[172:175]
  ds_read_b64_tr_b16 v[114:115], v42 offset:37376
  buffer_load_dwordx4 v33, s[4:7], s65 offen offset:1024 lds
  s_waitcnt lgkmcnt(3)
  v_mfma_f32_16x16x32_bf16 v[188:191], v[108:111], v[92:95], v[188:191]
  ds_read_b128 v[84:87], v40 offset:43008
  v_mfma_f32_16x16x32_bf16 v[184:187], v[104:107], v[92:95], v[184:187]
  ds_read_b64_tr_b16 v[116:117], v43 offset:36864
  buffer_load_dwordx4 v34, s[4:7], s65 offen offset:2048 lds
  v_mfma_f32_16x16x32_bf16 v[180:183], v[100:103], v[92:95], v[180:183]
  v_mfma_f32_16x16x32_bf16 v[176:179], v[96:99], v[92:95], v[176:179]
  ds_read_b64_tr_b16 v[118:119], v43 offset:37376
  buffer_load_dwordx4 v35, s[4:7], s65 offen offset:3072 lds
  s_sub_u32 s65, s65, 32640
  s_add_u32 m0, s64, 65536
  s_waitcnt lgkmcnt(5)
  v_mfma_f32_16x16x32_bf16 v[192:195], v[96:99], v[80:83], v[192:195]
  ds_read_b128 v[88:91], v40 offset:45056
  v_mfma_f32_16x16x32_bf16 v[196:199], v[100:103], v[80:83], v[196:199]
  ds_read_b64_tr_b16 v[120:121], v44 offset:36864
  buffer_load_dwordx4 v36, s[8:11], s66 offen offset:0 lds
  v_mfma_f32_16x16x32_bf16 v[200:203], v[104:107], v[80:83], v[200:203]
  v_mfma_f32_16x16x32_bf16 v[204:207], v[108:111], v[80:83], v[204:207]
  ds_read_b64_tr_b16 v[122:123], v44 offset:37376
  buffer_load_dwordx4 v37, s[8:11], s66 offen offset:1024 lds
  s_waitcnt lgkmcnt(5)
  v_mfma_f32_16x16x32_bf16 v[220:223], v[108:111], v[84:87], v[220:223]
  ds_read_b128 v[92:95], v40 offset:47104
  v_mfma_f32_16x16x32_bf16 v[216:219], v[104:107], v[84:87], v[216:219]
  ds_read_b64_tr_b16 v[124:125], v45 offset:36864
  buffer_load_dwordx4 v38, s[8:11], s66 offen offset:2048 lds
  v_mfma_f32_16x16x32_bf16 v[212:215], v[100:103], v[84:87], v[212:215]
  v_mfma_f32_16x16x32_bf16 v[208:211], v[96:99], v[84:87], v[208:211]
  ds_read_b64_tr_b16 v[126:127], v45 offset:37376
  buffer_load_dwordx4 v39, s[8:11], s66 offen offset:3072 lds
  s_add_u32 s66, s66, 262144
  s_add_u32 m0, s64, 69632
  s_waitcnt lgkmcnt(5)
  v_mfma_f32_16x16x32_bf16 v[224:227], v[96:99], v[88:91], v[224:227]
  ds_read_b128 v[80:83], v41 offset:32768
  v_mfma_f32_16x16x32_bf16 v[228:231], v[100:103], v[88:91], v[228:231]
  buffer_load_dwordx4 v36, s[8:11], s66 offen offset:0 lds
  v_mfma_f32_16x16x32_bf16 v[232:235], v[104:107], v[88:91], v[232:235]
  v_mfma_f32_16x16x32_bf16 v[236:239], v[108:111], v[88:91], v[236:239]
  buffer_load_dwordx4 v37, s[8:11], s66 offen offset:1024 lds
  s_waitcnt lgkmcnt(3)
  v_mfma_f32_16x16x32_bf16 v[252:255], v[108:111], v[92:95], v[252:255]
  ds_read_b128 v[84:87], v41 offset:34816
  v_mfma_f32_16x16x32_bf16 v[248:251], v[104:107], v[92:95], v[248:251]
  buffer_load_dwordx4 v38, s[8:11], s66 offen offset:2048 lds
  v_mfma_f32_16x16x32_bf16 v[244:247], v[100:103], v[92:95], v[244:247]
  v_mfma_f32_16x16x32_bf16 v[240:243], v[96:99], v[92:95], v[240:243]
  buffer_load_dwordx4 v39, s[8:11], s66 offen offset:3072 lds
  s_add_u32 s66, s66, 262144
  s_waitcnt lgkmcnt(1)
  v_mfma_f32_16x16x32_bf16 v[128:131], v[112:115], v[80:83], v[128:131]
  ds_read_b128 v[88:91], v41 offset:36864
  v_mfma_f32_16x16x32_bf16 v[132:135], v[116:119], v[80:83], v[132:135]
  v_mfma_f32_16x16x32_bf16 v[136:139], v[120:123], v[80:83], v[136:139]
  v_mfma_f32_16x16x32_bf16 v[140:143], v[124:127], v[80:83], v[140:143]
  s_waitcnt lgkmcnt(1)
  v_mfma_f32_16x16x32_bf16 v[156:159], v[124:127], v[84:87], v[156:159]
  ds_read_b128 v[92:95], v41 offset:38912
  v_mfma_f32_16x16x32_bf16 v[152:155], v[120:123], v[84:87], v[152:155]
  v_mfma_f32_16x16x32_bf16 v[148:151], v[116:119], v[84:87], v[148:151]
  v_mfma_f32_16x16x32_bf16 v[144:147], v[112:115], v[84:87], v[144:147]
  s_waitcnt lgkmcnt(1)
  v_mfma_f32_16x16x32_bf16 v[160:163], v[112:115], v[88:91], v[160:163]
  ds_read_b128 v[80:83], v41 offset:40960
  v_mfma_f32_16x16x32_bf16 v[164:167], v[116:119], v[88:91], v[164:167]
  v_mfma_f32_16x16x32_bf16 v[168:171], v[120:123], v[88:91], v[168:171]
  v_mfma_f32_16x16x32_bf16 v[172:175], v[124:127], v[88:91], v[172:175]
  s_waitcnt lgkmcnt(1)
  v_mfma_f32_16x16x32_bf16 v[188:191], v[124:127], v[92:95], v[188:191]
  ds_read_b128 v[84:87], v41 offset:43008
  v_mfma_f32_16x16x32_bf16 v[184:187], v[120:123], v[92:95], v[184:187]
  v_mfma_f32_16x16x32_bf16 v[180:183], v[116:119], v[92:95], v[180:183]
  v_mfma_f32_16x16x32_bf16 v[176:179], v[112:115], v[92:95], v[176:179]
  s_waitcnt lgkmcnt(1)
  v_mfma_f32_16x16x32_bf16 v[192:195], v[112:115], v[80:83], v[192:195]
  ds_read_b128 v[88:91], v41 offset:45056
  v_mfma_f32_16x16x32_bf16 v[196:199], v[116:119], v[80:83], v[196:199]
  v_mfma_f32_16x16x32_bf16 v[200:203], v[120:123], v[80:83], v[200:203]
  v_mfma_f32_16x16x32_bf16 v[204:207], v[124:127], v[80:83], v[204:207]
  s_waitcnt lgkmcnt(1)
  v_mfma_f32_16x16x32_bf16 v[220:223], v[124:127], v[84:87], v[220:223]
  ds_read_b128 v[92:95], v41 offset:47104
  v_mfma_f32_16x16x32_bf16 v[216:219], v[120:123], v[84:87], v[216:219]
  v_mfma_f32_16x16x32_bf16 v[212:215], v[116:119], v[84:87], v[212:215]
  v_mfma_f32_16x16x32_bf16 v[208:211], v[112:115], v[84:87], v[208:211]
  s_waitcnt vmcnt(0) lgkmcnt(0)
  s_barrier
  v_mfma_f32_16x16x32_bf16 v[224:227], v[112:115], v[88:91], v[224:227]
  ds_read_b128 v[80:83], v40 offset:0
  ds_read_b64_tr_b16 v[96:97], v42 offset:0
  v_mfma_f32_16x16x32_bf16 v[228:231], v[116:119], v[88:91], v[228:231]
  ds_read_b64_tr_b16 v[98:99], v42 offset:512
  ds_read_b64_tr_b16 v[100:101], v43 offset:0
  v_mfma_f32_16x16x32_bf16 v[232:235], v[120:123], v[88:91], v[232:235]
  ds_read_b64_tr_b16 v[102:103], v43 offset:512
  ds_read_b64_tr_b16 v[104:105], v44 offset:0
  v_mfma_f32_16x16x32_bf16 v[236:239], v[124:127], v[88:91], v[236:239]
  ds_read_b64_tr_b16 v[106:107], v44 offset:512
  ds_read_b64_tr_b16 v[108:109], v45 offset:0
  v_mfma_f32_16x16x32_bf16 v[252:255], v[124:127], v[92:95], v[252:255]
  ds_read_b64_tr_b16 v[110:111], v45 offset:512
  ds_read_b128 v[84:87], v40 offset:2048
  v_mfma_f32_16x16x32_bf16 v[248:251], v[120:123], v[92:95], v[248:251]
  v_mfma_f32_16x16x32_bf16 v[244:247], v[116:119], v[92:95], v[244:247]
  v_mfma_f32_16x16x32_bf16 v[240:243], v[112:115], v[92:95], v[240:243]
  s_waitcnt lgkmcnt(7)
  v_mfma_f32_16x16x32_bf16 v[128:131], v[96:99], v[80:83], v[128:131]
  ds_read_b128 v[88:91], v40 offset:4096
  s_add_u32 m0, s64, 32768
  s_waitcnt lgkmcnt(6)
  v_mfma_f32_16x16x32_bf16 v[132:135], v[100:103], v[80:83], v[132:135]
  buffer_load_dwordx4 v32, s[4:7], s65 offen offset:0 lds
  s_waitcnt lgkmcnt(4)
  v_mfma_f32_16x16x32_bf16 v[136:139], v[104:107], v[80:83], v[136:139]
  s_waitcnt lgkmcnt(2)
  v_mfma_f32_16x16x32_bf16 v[140:143], v[108:111], v[80:83], v[140:143]
  buffer_load_dwordx4 v33, s[4:7], s65 offen offset:1024 lds
  s_waitcnt lgkmcnt(1)
  v_mfma_f32_16x16x32_bf16 v[156:159], v[108:111], v[84:87], v[156:159]
  ds_read_b128 v[92:95], v40 offset:6144
  v_mfma_f32_16x16x32_bf16 v[152:155], v[104:107], v[84:87], v[152:155]
  buffer_load_dwordx4 v34, s[4:7], s65 offen offset:2048 lds
  v_mfma_f32_16x16x32_bf16 v[148:151], v[100:103], v[84:87], v[148:151]
  v_mfma_f32_16x16x32_bf16 v[144:147], v[96:99], v[84:87], v[144:147]
  buffer_load_dwordx4 v35, s[4:7], s65 offen offset:3072 lds
  s_add_u32 s65, s65, 32768
  s_add_u32 m0, s64, 36864
  s_waitcnt lgkmcnt(1)
  v_mfma_f32_16x16x32_bf16 v[160:163], v[96:99], v[88:91], v[160:163]
  ds_read_b128 v[80:83], v40 offset:8192
  v_mfma_f32_16x16x32_bf16 v[164:167], v[100:103], v[88:91], v[164:167]
  ds_read_b64_tr_b16 v[112:113], v42 offset:4096
  buffer_load_dwordx4 v32, s[4:7], s65 offen offset:0 lds
  v_mfma_f32_16x16x32_bf16 v[168:171], v[104:107], v[88:91], v[168:171]
  v_mfma_f32_16x16x32_bf16 v[172:175], v[108:111], v[88:91], v[172:175]
  ds_read_b64_tr_b16 v[114:115], v42 offset:4608
  buffer_load_dwordx4 v33, s[4:7], s65 offen offset:1024 lds
  s_waitcnt lgkmcnt(3)
  v_mfma_f32_16x16x32_bf16 v[188:191], v[108:111], v[92:95], v[188:191]
  ds_read_b128 v[84:87], v40 offset:10240
  v_mfma_f32_16x16x32_bf16 v[184:187], v[104:107], v[92:95], v[184:187]
  ds_read_b64_tr_b16 v[116:117], v43 offset:4096
  buffer_load_dwordx4 v34, s[4:7], s65 offen offset:2048 lds
  v_mfma_f32_16x16x32_bf16 v[180:183], v[100:103], v[92:95], v[180:183]
  v_mfma_f32_16x16x32_bf16 v[176:179], v[96:99], v[92:95], v[176:179]
  ds_read_b64_tr_b16 v[118:119], v43 offset:4608
  buffer_load_dwordx4 v35, s[4:7], s65 offen offset:3072 lds
  s_sub_u32 s65, s65, 32640
  s_add_u32 m0, s64, 98304
  s_waitcnt lgkmcnt(5)
  v_mfma_f32_16x16x32_bf16 v[192:195], v[96:99], v[80:83], v[192:195]
  ds_read_b128 v[88:91], v40 offset:12288
  v_mfma_f32_16x16x32_bf16 v[196:199], v[100:103], v[80:83], v[196:199]
  ds_read_b64_tr_b16 v[120:121], v44 offset:4096
  buffer_load_dwordx4 v36, s[8:11], s66 offen offset:0 lds
  v_mfma_f32_16x16x32_bf16 v[200:203], v[104:107], v[80:83], v[200:203]
  v_mfma_f32_16x16x32_bf16 v[204:207], v[108:111], v[80:83], v[204:207]
  ds_read_b64_tr_b16 v[122:123], v44 offset:4608
  buffer_load_dwordx4 v37, s[8:11], s66 offen offset:1024 lds
  s_waitcnt lgkmcnt(5)
  v_mfma_f32_16x16x32_bf16 v[220:223], v[108:111], v[84:87], v[220:223]
  ds_read_b128 v[92:95], v40 offset:14336
  v_mfma_f32_16x16x32_bf16 v[216:219], v[104:107], v[84:87], v[216:219]
  ds_read_b64_tr_b16 v[124:125], v45 offset:4096
  buffer_load_dwordx4 v38, s[8:11], s66 offen offset:2048 lds
  v_mfma_f32_16x16x32_bf16 v[212:215], v[100:103], v[84:87], v[212:215]
  v_mfma_f32_16x16x32_bf16 v[208:211], v[96:99], v[84:87], v[208:211]
  ds_read_b64_tr_b16 v[126:127], v45 offset:4608
  buffer_load_dwordx4 v39, s[8:11], s66 offen offset:3072 lds
  s_add_u32 s66, s66, 262144
  s_add_u32 m0, s64, 102400
  s_waitcnt lgkmcnt(5)
  v_mfma_f32_16x16x32_bf16 v[224:227], v[96:99], v[88:91], v[224:227]
  ds_read_b128 v[80:83], v41 offset:0
  v_mfma_f32_16x16x32_bf16 v[228:231], v[100:103], v[88:91], v[228:231]
  buffer_load_dwordx4 v36, s[8:11], s66 offen offset:0 lds
  v_mfma_f32_16x16x32_bf16 v[232:235], v[104:107], v[88:91], v[232:235]
  v_mfma_f32_16x16x32_bf16 v[236:239], v[108:111], v[88:91], v[236:239]
  buffer_load_dwordx4 v37, s[8:11], s66 offen offset:1024 lds
  s_waitcnt lgkmcnt(3)
  v_mfma_f32_16x16x32_bf16 v[252:255], v[108:111], v[92:95], v[252:255]
  ds_read_b128 v[84:87], v41 offset:2048
  v_mfma_f32_16x16x32_bf16 v[248:251], v[104:107], v[92:95], v[248:251]
  buffer_load_dwordx4 v38, s[8:11], s66 offen offset:2048 lds
  v_mfma_f32_16x16x32_bf16 v[244:247], v[100:103], v[92:95], v[244:247]
  v_mfma_f32_16x16x32_bf16 v[240:243], v[96:99], v[92:95], v[240:243]
  buffer_load_dwordx4 v39, s[8:11], s66 offen offset:3072 lds
  s_add_u32 s66, s66, 262144
  s_waitcnt lgkmcnt(1)
  v_mfma_f32_16x16x32_bf16 v[128:131], v[112:115], v[80:83], v[128:131]
  ds_read_b128 v[88:91], v41 offset:4096
  v_mfma_f32_16x16x32_bf16 v[132:135], v[116:119], v[80:83], v[132:135]
  v_mfma_f32_16x16x32_bf16 v[136:139], v[120:123], v[80:83], v[136:139]
  v_mfma_f32_16x16x32_bf16 v[140:143], v[124:127], v[80:83], v[140:143]
  s_waitcnt lgkmcnt(1)
  v_mfma_f32_16x16x32_bf16 v[156:159], v[124:127], v[84:87], v[156:159]
  ds_read_b128 v[92:95], v41 offset:6144
  v_mfma_f32_16x16x32_bf16 v[152:155], v[120:123], v[84:87], v[152:155]
  v_mfma_f32_16x16x32_bf16 v[148:151], v[116:119], v[84:87], v[148:151]
  v_mfma_f32_16x16x32_bf16 v[144:147], v[112:115], v[84:87], v[144:147]
  s_waitcnt lgkmcnt(1)
  v_mfma_f32_16x16x32_bf16 v[160:163], v[112:115], v[88:91], v[160:163]
  ds_read_b128 v[80:83], v41 offset:8192
  v_mfma_f32_16x16x32_bf16 v[164:167], v[116:119], v[88:91], v[164:167]
  v_mfma_f32_16x16x32_bf16 v[168:171], v[120:123], v[88:91], v[168:171]
  v_mfma_f32_16x16x32_bf16 v[172:175], v[124:127], v[88:91], v[172:175]
  s_waitcnt lgkmcnt(1)
  v_mfma_f32_16x16x32_bf16 v[188:191], v[124:127], v[92:95], v[188:191]
  ds_read_b128 v[84:87], v41 offset:10240
  v_mfma_f32_16x16x32_bf16 v[184:187], v[120:123], v[92:95], v[184:187]
  v_mfma_f32_16x16x32_bf16 v[180:183], v[116:119], v[92:95], v[180:183]
  v_mfma_f32_16x16x32_bf16 v[176:179], v[112:115], v[92:95], v[176:179]
  s_waitcnt lgkmcnt(1)
  v_mfma_f32_16x16x32_bf16 v[192:195], v[112:115], v[80:83], v[192:195]
  ds_read_b128 v[88:91], v41 offset:12288
  v_mfma_f32_16x16x32_bf16 v[196:199], v[116:119], v[80:83], v[196:199]
  v_mfma_f32_16x16x32_bf16 v[200:203], v[120:123], v[80:83], v[200:203]
  v_mfma_f32_16x16x32_bf16 v[204:207], v[124:127], v[80:83], v[204:207]
  s_waitcnt lgkmcnt(1)
  v_mfma_f32_16x16x32_bf16 v[220:223], v[124:127], v[84:87], v[220:223]
  ds_read_b128 v[92:95], v41 offset:14336
  v_mfma_f32_16x16x32_bf16 v[216:219], v[120:123], v[84:87], v[216:219]
  v_mfma_f32_16x16x32_bf16 v[212:215], v[116:119], v[84:87], v[212:215]
  v_mfma_f32_16x16x32_bf16 v[208:211], v[112:115], v[84:87], v[208:211]
  s_waitcnt vmcnt(0) lgkmcnt(0)
  s_barrier
  v_mfma_f32_16x16x32_bf16 v[224:227], v[112:115], v[88:91], v[224:227]
  ds_read_b128 v[80:83], v40 offset:32768
  ds_read_b64_tr_b16 v[96:97], v42 offset:32768
  v_mfma_f32_16x16x32_bf16 v[228:231], v[116:119], v[88:91], v[228:231]
  ds_read_b64_tr_b16 v[98:99], v42 offset:33280
  ds_read_b64_tr_b16 v[100:101], v43 offset:32768
  v_mfma_f32_16x16x32_bf16 v[232:235], v[120:123], v[88:91], v[232:235]
  ds_read_b64_tr_b16 v[102:103], v43 offset:33280
  ds_read_b64_tr_b16 v[104:105], v44 offset:32768
  v_mfma_f32_16x16x32_bf16 v[236:239], v[124:127], v[88:91], v[236:239]
  ds_read_b64_tr_b16 v[106:107], v44 offset:33280
  ds_read_b64_tr_b16 v[108:109], v45 offset:32768
  v_mfma_f32_16x16x32_bf16 v[252:255], v[124:127], v[92:95], v[252:255]
  ds_read_b64_tr_b16 v[110:111], v45 offset:33280
  ds_read_b128 v[84:87], v40 offset:34816
  v_mfma_f32_16x16x32_bf16 v[248:251], v[120:123], v[92:95], v[248:251]
  v_mfma_f32_16x16x32_bf16 v[244:247], v[116:119], v[92:95], v[244:247]
  v_mfma_f32_16x16x32_bf16 v[240:243], v[112:115], v[92:95], v[240:243]
  s_waitcnt lgkmcnt(7)
  v_mfma_f32_16x16x32_bf16 v[128:131], v[96:99], v[80:83], v[128:131]
  ds_read_b128 v[88:91], v40 offset:36864
  s_add_u32 m0, s64, 0
  s_waitcnt lgkmcnt(6)
  v_mfma_f32_16x16x32_bf16 v[132:135], v[100:103], v[80:83], v[132:135]
  buffer_load_dwordx4 v32, s[4:7], s65 offen offset:0 lds
  s_waitcnt lgkmcnt(4)
  v_mfma_f32_16x16x32_bf16 v[136:139], v[104:107], v[80:83], v[136:139]
  s_waitcnt lgkmcnt(2)
  v_mfma_f32_16x16x32_bf16 v[140:143], v[108:111], v[80:83], v[140:143]
  buffer_load_dwordx4 v33, s[4:7], s65 offen offset:1024 lds
  s_waitcnt lgkmcnt(1)
  v_mfma_f32_16x16x32_bf16 v[156:159], v[108:111], v[84:87], v[156:159]
  ds_read_b128 v[92:95], v40 offset:38912
  v_mfma_f32_16x16x32_bf16 v[152:155], v[104:107], v[84:87], v[152:155]
  buffer_load_dwordx4 v34, s[4:7], s65 offen offset:2048 lds
  v_mfma_f32_16x16x32_bf16 v[148:151], v[100:103], v[84:87], v[148:151]
  v_mfma_f32_16x16x32_bf16 v[144:147], v[96:99], v[84:87], v[144:147]
  buffer_load_dwordx4 v35, s[4:7], s65 offen offset:3072 lds
  s_add_u32 s65, s65, 32768
  s_add_u32 m0, s64, 4096
  s_waitcnt lgkmcnt(1)
  v_mfma_f32_16x16x32_bf16 v[160:163], v[96:99], v[88:91], v[160:163]
  ds_read_b128 v[80:83], v40 offset:40960
  v_mfma_f32_16x16x32_bf16 v[164:167], v[100:103], v[88:91], v[164:167]
  ds_read_b64_tr_b16 v[112:113], v42 offset:36864
  buffer_load_dwordx4 v32, s[4:7], s65 offen offset:0 lds
  v_mfma_f32_16x16x32_bf16 v[168:171], v[104:107], v[88:91], v[168:171]
  v_mfma_f32_16x16x32_bf16 v[172:175], v[108:111], v[88:91], v[172:175]
  ds_read_b64_tr_b16 v[114:115], v42 offset:37376
  buffer_load_dwordx4 v33, s[4:7], s65 offen offset:1024 lds
  s_waitcnt lgkmcnt(3)
  v_mfma_f32_16x16x32_bf16 v[188:191], v[108:111], v[92:95], v[188:191]
  ds_read_b128 v[84:87], v40 offset:43008
  v_mfma_f32_16x16x32_bf16 v[184:187], v[104:107], v[92:95], v[184:187]
  ds_read_b64_tr_b16 v[116:117], v43 offset:36864
  buffer_load_dwordx4 v34, s[4:7], s65 offen offset:2048 lds
  v_mfma_f32_16x16x32_bf16 v[180:183], v[100:103], v[92:95], v[180:183]
  v_mfma_f32_16x16x32_bf16 v[176:179], v[96:99], v[92:95], v[176:179]
  ds_read_b64_tr_b16 v[118:119], v43 offset:37376
  buffer_load_dwordx4 v35, s[4:7], s65 offen offset:3072 lds
  s_sub_u32 s65, s65, 32640
  s_add_u32 m0, s64, 65536
  s_waitcnt lgkmcnt(5)
  v_mfma_f32_16x16x32_bf16 v[192:195], v[96:99], v[80:83], v[192:195]
  ds_read_b128 v[88:91], v40 offset:45056
  v_mfma_f32_16x16x32_bf16 v[196:199], v[100:103], v[80:83], v[196:199]
  ds_read_b64_tr_b16 v[120:121], v44 offset:36864
  buffer_load_dwordx4 v36, s[8:11], s66 offen offset:0 lds
  v_mfma_f32_16x16x32_bf16 v[200:203], v[104:107], v[80:83], v[200:203]
  v_mfma_f32_16x16x32_bf16 v[204:207], v[108:111], v[80:83], v[204:207]
  ds_read_b64_tr_b16 v[122:123], v44 offset:37376
  buffer_load_dwordx4 v37, s[8:11], s66 offen offset:1024 lds
  s_waitcnt lgkmcnt(5)
  v_mfma_f32_16x16x32_bf16 v[220:223], v[108:111], v[84:87], v[220:223]
  ds_read_b128 v[92:95], v40 offset:47104
  v_mfma_f32_16x16x32_bf16 v[216:219], v[104:107], v[84:87], v[216:219]
  ds_read_b64_tr_b16 v[124:125], v45 offset:36864
  buffer_load_dwordx4 v38, s[8:11], s66 offen offset:2048 lds
  v_mfma_f32_16x16x32_bf16 v[212:215], v[100:103], v[84:87], v[212:215]
  v_mfma_f32_16x16x32_bf16 v[208:211], v[96:99], v[84:87], v[208:211]
  ds_read_b64_tr_b16 v[126:127], v45 offset:37376
  buffer_load_dwordx4 v39, s[8:11], s66 offen offset:3072 lds
  s_add_u32 s66, s66, 262144
  s_add_u32 m0, s64, 69632
  s_waitcnt lgkmcnt(5)
  v_mfma_f32_16x16x32_bf16 v[224:227], v[96:99], v[88:91], v[224:227]
  ds_read_b128 v[80:83], v41 offset:32768
  v_mfma_f32_16x16x32_bf16 v[228:231], v[100:103], v[88:91], v[228:231]
  buffer_load_dwordx4 v36, s[8:11], s66 offen offset:0 lds
  v_mfma_f32_16x16x32_bf16 v[232:235], v[104:107], v[88:91], v[232:235]
  v_mfma_f32_16x16x32_bf16 v[236:239], v[108:111], v[88:91], v[236:239]
  buffer_load_dwordx4 v37, s[8:11], s66 offen offset:1024 lds
  s_waitcnt lgkmcnt(3)
  v_mfma_f32_16x16x32_bf16 v[252:255], v[108:111], v[92:95], v[252:255]
  ds_read_b128 v[84:87], v41 offset:34816
  v_mfma_f32_16x16x32_bf16 v[248:251], v[104:107], v[92:95], v[248:251]
  buffer_load_dwordx4 v38, s[8:11], s66 offen offset:2048 lds
  v_mfma_f32_16x16x32_bf16 v[244:247], v[100:103], v[92:95], v[244:247]
  v_mfma_f32_16x16x32_bf16 v[240:243], v[96:99], v[92:95], v[240:243]
  buffer_load_dwordx4 v39, s[8:11], s66 offen offset:3072 lds
  s_add_u32 s66, s66, 262144
  s_waitcnt lgkmcnt(1)
  v_mfma_f32_16x16x32_bf16 v[128:131], v[112:115], v[80:83], v[128:131]
  ds_read_b128 v[88:91], v41 offset:36864
  v_mfma_f32_16x16x32_bf16 v[132:135], v[116:119], v[80:83], v[132:135]
  v_mfma_f32_16x16x32_bf16 v[136:139], v[120:123], v[80:83], v[136:139]
  v_mfma_f32_16x16x32_bf16 v[140:143], v[124:127], v[80:83], v[140:143]
  s_waitcnt lgkmcnt(1)
  v_mfma_f32_16x16x32_bf16 v[156:159], v[124:127], v[84:87], v[156:159]
  ds_read_b128 v[92:95], v41 offset:38912
  v_mfma_f32_16x16x32_bf16 v[152:155], v[120:123], v[84:87], v[152:155]
  v_mfma_f32_16x16x32_bf16 v[148:151], v[116:119], v[84:87], v[148:151]
  v_mfma_f32_16x16x32_bf16 v[144:147], v[112:115], v[84:87], v[144:147]
  s_waitcnt lgkmcnt(1)
  v_mfma_f32_16x16x32_bf16 v[160:163], v[112:115], v[88:91], v[160:163]
  ds_read_b128 v[80:83], v41 offset:40960
  v_mfma_f32_16x16x32_bf16 v[164:167], v[116:119], v[88:91], v[164:167]
  v_mfma_f32_16x16x32_bf16 v[168:171], v[120:123], v[88:91], v[168:171]
  v_mfma_f32_16x16x32_bf16 v[172:175], v[124:127], v[88:91], v[172:175]
  s_waitcnt lgkmcnt(1)
  v_mfma_f32_16x16x32_bf16 v[188:191], v[124:127], v[92:95], v[188:191]
  ds_read_b128 v[84:87], v41 offset:43008
  v_mfma_f32_16x16x32_bf16 v[184:187], v[120:123], v[92:95], v[184:187]
  v_mfma_f32_16x16x32_bf16 v[180:183], v[116:119], v[92:95], v[180:183]
  v_mfma_f32_16x16x32_bf16 v[176:179], v[112:115], v[92:95], v[176:179]
  s_waitcnt lgkmcnt(1)
  v_mfma_f32_16x16x32_bf16 v[192:195], v[112:115], v[80:83], v[192:195]
  ds_read_b128 v[88:91], v41 offset:45056
  v_mfma_f32_16x16x32_bf16 v[196:199], v[116:119], v[80:83], v[196:199]
  v_mfma_f32_16x16x32_bf16 v[200:203], v[120:123], v[80:83], v[200:203]
  v_mfma_f32_16x16x32_bf16 v[204:207], v[124:127], v[80:83], v[204:207]
  s_waitcnt lgkmcnt(1)
  v_mfma_f32_16x16x32_bf16 v[220:223], v[124:127], v[84:87], v[220:223]
  ds_read_b128 v[92:95], v41 offset:47104
  v_mfma_f32_16x16x32_bf16 v[216:219], v[120:123], v[84:87], v[216:219]
  v_mfma_f32_16x16x32_bf16 v[212:215], v[116:119], v[84:87], v[212:215]
  v_mfma_f32_16x16x32_bf16 v[208:211], v[112:115], v[84:87], v[208:211]
  s_waitcnt vmcnt(0) lgkmcnt(0)
  s_barrier
  v_mfma_f32_16x16x32_bf16 v[224:227], v[112:115], v[88:91], v[224:227]
  ds_read_b128 v[80:83], v40 offset:0
  ds_read_b64_tr_b16 v[96:97], v42 offset:0
  v_mfma_f32_16x16x32_bf16 v[228:231], v[116:119], v[88:91], v[228:231]
  ds_read_b64_tr_b16 v[98:99], v42 offset:512
  ds_read_b64_tr_b16 v[100:101], v43 offset:0
  v_mfma_f32_16x16x32_bf16 v[232:235], v[120:123], v[88:91], v[232:235]
  ds_read_b64_tr_b16 v[102:103], v43 offset:512
  ds_read_b64_tr_b16 v[104:105], v44 offset:0
  v_mfma_f32_16x16x32_bf16 v[236:239], v[124:127], v[88:91], v[236:239]
  ds_read_b64_tr_b16 v[106:107], v44 offset:512
  ds_read_b64_tr_b16 v[108:109], v45 offset:0
  v_mfma_f32_16x16x32_bf16 v[252:255], v[124:127], v[92:95], v[252:255]
  ds_read_b64_tr_b16 v[110:111], v45 offset:512
  ds_read_b128 v[84:87], v40 offset:2048
  v_mfma_f32_16x16x32_bf16 v[248:251], v[120:123], v[92:95], v[248:251]
  v_mfma_f32_16x16x32_bf16 v[244:247], v[116:119], v[92:95], v[244:247]
  v_mfma_f32_16x16x32_bf16 v[240:243], v[112:115], v[92:95], v[240:243]
  s_waitcnt lgkmcnt(7)
  v_mfma_f32_16x16x32_bf16 v[128:131], v[96:99], v[80:83], v[128:131]
  ds_read_b128 v[88:91], v40 offset:4096
  s_add_u32 m0, s64, 32768
  s_waitcnt lgkmcnt(6)
  v_mfma_f32_16x16x32_bf16 v[132:135], v[100:103], v[80:83], v[132:135]
  buffer_load_dwordx4 v32, s[4:7], s65 offen offset:0 lds
  s_waitcnt lgkmcnt(4)
  v_mfma_f32_16x16x32_bf16 v[136:139], v[104:107], v[80:83], v[136:139]
  s_waitcnt lgkmcnt(2)
  v_mfma_f32_16x16x32_bf16 v[140:143], v[108:111], v[80:83], v[140:143]
  buffer_load_dwordx4 v33, s[4:7], s65 offen offset:1024 lds
  s_waitcnt lgkmcnt(1)
  v_mfma_f32_16x16x32_bf16 v[156:159], v[108:111], v[84:87], v[156:159]
  ds_read_b128 v[92:95], v40 offset:6144
  v_mfma_f32_16x16x32_bf16 v[152:155], v[104:107], v[84:87], v[152:155]
  buffer_load_dwordx4 v34, s[4:7], s65 offen offset:2048 lds
  v_mfma_f32_16x16x32_bf16 v[148:151], v[100:103], v[84:87], v[148:151]
  v_mfma_f32_16x16x32_bf16 v[144:147], v[96:99], v[84:87], v[144:147]
  buffer_load_dwordx4 v35, s[4:7], s65 offen offset:3072 lds
  s_add_u32 s65, s65, 32768
  s_add_u32 m0, s64, 36864
  s_waitcnt lgkmcnt(1)
  v_mfma_f32_16x16x32_bf16 v[160:163], v[96:99], v[88:91], v[160:163]
  ds_read_b128 v[80:83], v40 offset:8192
  v_mfma_f32_16x16x32_bf16 v[164:167], v[100:103], v[88:91], v[164:167]
  ds_read_b64_tr_b16 v[112:113], v42 offset:4096
  buffer_load_dwordx4 v32, s[4:7], s65 offen offset:0 lds
  v_mfma_f32_16x16x32_bf16 v[168:171], v[104:107], v[88:91], v[168:171]
  v_mfma_f32_16x16x32_bf16 v[172:175], v[108:111], v[88:91], v[172:175]
  ds_read_b64_tr_b16 v[114:115], v42 offset:4608
  buffer_load_dwordx4 v33, s[4:7], s65 offen offset:1024 lds
  s_waitcnt lgkmcnt(3)
  v_mfma_f32_16x16x32_bf16 v[188:191], v[108:111], v[92:95], v[188:191]
  ds_read_b128 v[84:87], v40 offset:10240
  v_mfma_f32_16x16x32_bf16 v[184:187], v[104:107], v[92:95], v[184:187]
  ds_read_b64_tr_b16 v[116:117], v43 offset:4096
  buffer_load_dwordx4 v34, s[4:7], s65 offen offset:2048 lds
  v_mfma_f32_16x16x32_bf16 v[180:183], v[100:103], v[92:95], v[180:183]
  v_mfma_f32_16x16x32_bf16 v[176:179], v[96:99], v[92:95], v[176:179]
  ds_read_b64_tr_b16 v[118:119], v43 offset:4608
  buffer_load_dwordx4 v35, s[4:7], s65 offen offset:3072 lds
  s_sub_u32 s65, s65, 32640
  s_add_u32 m0, s64, 98304
  s_waitcnt lgkmcnt(5)
  v_mfma_f32_16x16x32_bf16 v[192:195], v[96:99], v[80:83], v[192:195]
  ds_read_b128 v[88:91], v40 offset:12288
  v_mfma_f32_16x16x32_bf16 v[196:199], v[100:103], v[80:83], v[196:199]
  ds_read_b64_tr_b16 v[120:121], v44 offset:4096
  buffer_load_dwordx4 v36, s[8:11], s66 offen offset:0 lds
  v_mfma_f32_16x16x32_bf16 v[200:203], v[104:107], v[80:83], v[200:203]
  v_mfma_f32_16x16x32_bf16 v[204:207], v[108:111], v[80:83], v[204:207]
  ds_read_b64_tr_b16 v[122:123], v44 offset:4608
  buffer_load_dwordx4 v37, s[8:11], s66 offen offset:1024 lds
  s_waitcnt lgkmcnt(5)
  v_mfma_f32_16x16x32_bf16 v[220:223], v[108:111], v[84:87], v[220:223]
  ds_read_b128 v[92:95], v40 offset:14336
  v_mfma_f32_16x16x32_bf16 v[216:219], v[104:107], v[84:87], v[216:219]
  ds_read_b64_tr_b16 v[124:125], v45 offset:4096
  buffer_load_dwordx4 v38, s[8:11], s66 offen offset:2048 lds
  v_mfma_f32_16x16x32_bf16 v[212:215], v[100:103], v[84:87], v[212:215]
  v_mfma_f32_16x16x32_bf16 v[208:211], v[96:99], v[84:87], v[208:211]
  ds_read_b64_tr_b16 v[126:127], v45 offset:4608
  buffer_load_dwordx4 v39, s[8:11], s66 offen offset:3072 lds
  s_add_u32 s66, s66, 262144
  s_add_u32 m0, s64, 102400
  s_waitcnt lgkmcnt(5)
  v_mfma_f32_16x16x32_bf16 v[224:227], v[96:99], v[88:91], v[224:227]
  ds_read_b128 v[80:83], v41 offset:0
  v_mfma_f32_16x16x32_bf16 v[228:231], v[100:103], v[88:91], v[228:231]
  buffer_load_dwordx4 v36, s[8:11], s66 offen offset:0 lds
  v_mfma_f32_16x16x32_bf16 v[232:235], v[104:107], v[88:91], v[232:235]
  v_mfma_f32_16x16x32_bf16 v[236:239], v[108:111], v[88:91], v[236:239]
  buffer_load_dwordx4 v37, s[8:11], s66 offen offset:1024 lds
  s_waitcnt lgkmcnt(3)
  v_mfma_f32_16x16x32_bf16 v[252:255], v[108:111], v[92:95], v[252:255]
  ds_read_b128 v[84:87], v41 offset:2048
  v_mfma_f32_16x16x32_bf16 v[248:251], v[104:107], v[92:95], v[248:251]
  buffer_load_dwordx4 v38, s[8:11], s66 offen offset:2048 lds
  v_mfma_f32_16x16x32_bf16 v[244:247], v[100:103], v[92:95], v[244:247]
  v_mfma_f32_16x16x32_bf16 v[240:243], v[96:99], v[92:95], v[240:243]
  buffer_load_dwordx4 v39, s[8:11], s66 offen offset:3072 lds
  s_add_u32 s66, s66, 262144
  s_waitcnt lgkmcnt(1)
  v_mfma_f32_16x16x32_bf16 v[128:131], v[112:115], v[80:83], v[128:131]
  ds_read_b128 v[88:91], v41 offset:4096
  v_mfma_f32_16x16x32_bf16 v[132:135], v[116:119], v[80:83], v[132:135]
  v_mfma_f32_16x16x32_bf16 v[136:139], v[120:123], v[80:83], v[136:139]
  v_mfma_f32_16x16x32_bf16 v[140:143], v[124:127], v[80:83], v[140:143]
  s_waitcnt lgkmcnt(1)
  v_mfma_f32_16x16x32_bf16 v[156:159], v[124:127], v[84:87], v[156:159]
  ds_read_b128 v[92:95], v41 offset:6144
  v_mfma_f32_16x16x32_bf16 v[152:155], v[120:123], v[84:87], v[152:155]
  v_mfma_f32_16x16x32_bf16 v[148:151], v[116:119], v[84:87], v[148:151]
  v_mfma_f32_16x16x32_bf16 v[144:147], v[112:115], v[84:87], v[144:147]
  s_waitcnt lgkmcnt(1)
  v_mfma_f32_16x16x32_bf16 v[160:163], v[112:115], v[88:91], v[160:163]
  ds_read_b128 v[80:83], v41 offset:8192
  v_mfma_f32_16x16x32_bf16 v[164:167], v[116:119], v[88:91], v[164:167]
  v_mfma_f32_16x16x32_bf16 v[168:171], v[120:123], v[88:91], v[168:171]
  v_mfma_f32_16x16x32_bf16 v[172:175], v[124:127], v[88:91], v[172:175]
  s_waitcnt lgkmcnt(1)
  v_mfma_f32_16x16x32_bf16 v[188:191], v[124:127], v[92:95], v[188:191]
  ds_read_b128 v[84:87], v41 offset:10240
  v_mfma_f32_16x16x32_bf16 v[184:187], v[120:123], v[92:95], v[184:187]
  v_mfma_f32_16x16x32_bf16 v[180:183], v[116:119], v[92:95], v[180:183]
  v_mfma_f32_16x16x32_bf16 v[176:179], v[112:115], v[92:95], v[176:179]
  s_waitcnt lgkmcnt(1)
  v_mfma_f32_16x16x32_bf16 v[192:195], v[112:115], v[80:83], v[192:195]
  ds_read_b128 v[88:91], v41 offset:12288
  v_mfma_f32_16x16x32_bf16 v[196:199], v[116:119], v[80:83], v[196:199]
  v_mfma_f32_16x16x32_bf16 v[200:203], v[120:123], v[80:83], v[200:203]
  v_mfma_f32_16x16x32_bf16 v[204:207], v[124:127], v[80:83], v[204:207]
  s_waitcnt lgkmcnt(1)
  v_mfma_f32_16x16x32_bf16 v[220:223], v[124:127], v[84:87], v[220:223]
  ds_read_b128 v[92:95], v41 offset:14336
  v_mfma_f32_16x16x32_bf16 v[216:219], v[120:123], v[84:87], v[216:219]
  v_mfma_f32_16x16x32_bf16 v[212:215], v[116:119], v[84:87], v[212:215]
  v_mfma_f32_16x16x32_bf16 v[208:211], v[112:115], v[84:87], v[208:211]
  s_waitcnt vmcnt(0) lgkmcnt(0)
  s_barrier
  v_mfma_f32_16x16x32_bf16 v[224:227], v[112:115], v[88:91], v[224:227]
  ds_read_b128 v[80:83], v40 offset:32768
  ds_read_b64_tr_b16 v[96:97], v42 offset:32768
  v_mfma_f32_16x16x32_bf16 v[228:231], v[116:119], v[88:91], v[228:231]
  ds_read_b64_tr_b16 v[98:99], v42 offset:33280
  ds_read_b64_tr_b16 v[100:101], v43 offset:32768
  v_mfma_f32_16x16x32_bf16 v[232:235], v[120:123], v[88:91], v[232:235]
  ds_read_b64_tr_b16 v[102:103], v43 offset:33280
  ds_read_b64_tr_b16 v[104:105], v44 offset:32768
  v_mfma_f32_16x16x32_bf16 v[236:239], v[124:127], v[88:91], v[236:239]
  ds_read_b64_tr_b16 v[106:107], v44 offset:33280
  ds_read_b64_tr_b16 v[108:109], v45 offset:32768
  v_mfma_f32_16x16x32_bf16 v[252:255], v[124:127], v[92:95], v[252:255]
  ds_read_b64_tr_b16 v[110:111], v45 offset:33280
  ds_read_b128 v[84:87], v40 offset:34816
  v_mfma_f32_16x16x32_bf16 v[248:251], v[120:123], v[92:95], v[248:251]
  v_mfma_f32_16x16x32_bf16 v[244:247], v[116:119], v[92:95], v[244:247]
  v_mfma_f32_16x16x32_bf16 v[240:243], v[112:115], v[92:95], v[240:243]
  s_waitcnt lgkmcnt(7)
  v_mfma_f32_16x16x32_bf16 v[128:131], v[96:99], v[80:83], v[128:131]
  ds_read_b128 v[88:91], v40 offset:36864
  s_add_u32 m0, s64, 0
  s_waitcnt lgkmcnt(6)
  v_mfma_f32_16x16x32_bf16 v[132:135], v[100:103], v[80:83], v[132:135]
  buffer_load_dwordx4 v2, s[16:19], s67 offen offset:0 lds
  s_waitcnt lgkmcnt(4)
  v_mfma_f32_16x16x32_bf16 v[136:139], v[104:107], v[80:83], v[136:139]
  s_waitcnt lgkmcnt(2)
  v_mfma_f32_16x16x32_bf16 v[140:143], v[108:111], v[80:83], v[140:143]
  buffer_load_dwordx4 v3, s[16:19], s67 offen offset:1024 lds
  s_waitcnt lgkmcnt(1)
  v_mfma_f32_16x16x32_bf16 v[156:159], v[108:111], v[84:87], v[156:159]
  ds_read_b128 v[92:95], v40 offset:38912
  v_mfma_f32_16x16x32_bf16 v[152:155], v[104:107], v[84:87], v[152:155]
  buffer_load_dwordx4 v4, s[16:19], s67 offen offset:2048 lds
  v_mfma_f32_16x16x32_bf16 v[148:151], v[100:103], v[84:87], v[148:151]
  v_mfma_f32_16x16x32_bf16 v[144:147], v[96:99], v[84:87], v[144:147]
  buffer_load_dwordx4 v5, s[16:19], s67 offen offset:3072 lds
  s_add_u32 s67, s67, 40960
  s_add_u32 m0, s64, 4096
  s_waitcnt lgkmcnt(1)
  v_mfma_f32_16x16x32_bf16 v[160:163], v[96:99], v[88:91], v[160:163]
  ds_read_b128 v[80:83], v40 offset:40960
  v_mfma_f32_16x16x32_bf16 v[164:167], v[100:103], v[88:91], v[164:167]
  ds_read_b64_tr_b16 v[112:113], v42 offset:36864
  buffer_load_dwordx4 v2, s[16:19], s67 offen offset:0 lds
  v_mfma_f32_16x16x32_bf16 v[168:171], v[104:107], v[88:91], v[168:171]
  v_mfma_f32_16x16x32_bf16 v[172:175], v[108:111], v[88:91], v[172:175]
  ds_read_b64_tr_b16 v[114:115], v42 offset:37376
  buffer_load_dwordx4 v3, s[16:19], s67 offen offset:1024 lds
  s_waitcnt lgkmcnt(3)
  v_mfma_f32_16x16x32_bf16 v[188:191], v[108:111], v[92:95], v[188:191]
  ds_read_b128 v[84:87], v40 offset:43008
  v_mfma_f32_16x16x32_bf16 v[184:187], v[104:107], v[92:95], v[184:187]
  ds_read_b64_tr_b16 v[116:117], v43 offset:36864
  buffer_load_dwordx4 v4, s[16:19], s67 offen offset:2048 lds
  v_mfma_f32_16x16x32_bf16 v[180:183], v[100:103], v[92:95], v[180:183]
  v_mfma_f32_16x16x32_bf16 v[176:179], v[96:99], v[92:95], v[176:179]
  ds_read_b64_tr_b16 v[118:119], v43 offset:37376
  buffer_load_dwordx4 v5, s[16:19], s67 offen offset:3072 lds
  s_sub_u32 s67, s67, 40832
  s_add_u32 m0, s64, 65536
  s_waitcnt lgkmcnt(5)
  v_mfma_f32_16x16x32_bf16 v[192:195], v[96:99], v[80:83], v[192:195]
  ds_read_b128 v[88:91], v40 offset:45056
  v_mfma_f32_16x16x32_bf16 v[196:199], v[100:103], v[80:83], v[196:199]
  ds_read_b64_tr_b16 v[120:121], v44 offset:36864
  buffer_load_dwordx4 v6, s[20:23], s68 offen offset:0 lds
  v_mfma_f32_16x16x32_bf16 v[200:203], v[104:107], v[80:83], v[200:203]
  v_mfma_f32_16x16x32_bf16 v[204:207], v[108:111], v[80:83], v[204:207]
  ds_read_b64_tr_b16 v[122:123], v44 offset:37376
  buffer_load_dwordx4 v7, s[20:23], s68 offen offset:1024 lds
  s_waitcnt lgkmcnt(5)
  v_mfma_f32_16x16x32_bf16 v[220:223], v[108:111], v[84:87], v[220:223]
  ds_read_b128 v[92:95], v40 offset:47104
  v_mfma_f32_16x16x32_bf16 v[216:219], v[104:107], v[84:87], v[216:219]
  ds_read_b64_tr_b16 v[124:125], v45 offset:36864
  buffer_load_dwordx4 v8, s[20:23], s68 offen offset:2048 lds
  v_mfma_f32_16x16x32_bf16 v[212:215], v[100:103], v[84:87], v[212:215]
  v_mfma_f32_16x16x32_bf16 v[208:211], v[96:99], v[84:87], v[208:211]
  ds_read_b64_tr_b16 v[126:127], v45 offset:37376
  buffer_load_dwordx4 v9, s[20:23], s68 offen offset:3072 lds
  s_add_u32 s68, s68, s69
  s_add_u32 m0, s64, 69632
  s_waitcnt lgkmcnt(5)
  v_mfma_f32_16x16x32_bf16 v[224:227], v[96:99], v[88:91], v[224:227]
  ds_read_b128 v[80:83], v41 offset:32768
  v_mfma_f32_16x16x32_bf16 v[228:231], v[100:103], v[88:91], v[228:231]
  buffer_load_dwordx4 v6, s[20:23], s68 offen offset:0 lds
  v_mfma_f32_16x16x32_bf16 v[232:235], v[104:107], v[88:91], v[232:235]
  v_mfma_f32_16x16x32_bf16 v[236:239], v[108:111], v[88:91], v[236:239]
  buffer_load_dwordx4 v7, s[20:23], s68 offen offset:1024 lds
  s_waitcnt lgkmcnt(3)
  v_mfma_f32_16x16x32_bf16 v[252:255], v[108:111], v[92:95], v[252:255]
  ds_read_b128 v[84:87], v41 offset:34816
  v_mfma_f32_16x16x32_bf16 v[248:251], v[104:107], v[92:95], v[248:251]
  buffer_load_dwordx4 v8, s[20:23], s68 offen offset:2048 lds
  v_mfma_f32_16x16x32_bf16 v[244:247], v[100:103], v[92:95], v[244:247]
  v_mfma_f32_16x16x32_bf16 v[240:243], v[96:99], v[92:95], v[240:243]
  buffer_load_dwordx4 v9, s[20:23], s68 offen offset:3072 lds
  s_add_u32 s68, s68, s69
  s_waitcnt lgkmcnt(1)
  v_mfma_f32_16x16x32_bf16 v[128:131], v[112:115], v[80:83], v[128:131]
  ds_read_b128 v[88:91], v41 offset:36864
  v_mfma_f32_16x16x32_bf16 v[132:135], v[116:119], v[80:83], v[132:135]
  v_mfma_f32_16x16x32_bf16 v[136:139], v[120:123], v[80:83], v[136:139]
  v_mfma_f32_16x16x32_bf16 v[140:143], v[124:127], v[80:83], v[140:143]
  s_waitcnt lgkmcnt(1)
  v_mfma_f32_16x16x32_bf16 v[156:159], v[124:127], v[84:87], v[156:159]
  ds_read_b128 v[92:95], v41 offset:38912
  v_mfma_f32_16x16x32_bf16 v[152:155], v[120:123], v[84:87], v[152:155]
  v_mfma_f32_16x16x32_bf16 v[148:151], v[116:119], v[84:87], v[148:151]
  v_mfma_f32_16x16x32_bf16 v[144:147], v[112:115], v[84:87], v[144:147]
  v_cvt_pk_bf16_f32 v128, v128, v129
  v_cvt_pk_bf16_f32 v129, v130, v131
  s_waitcnt lgkmcnt(1)
  v_mfma_f32_16x16x32_bf16 v[160:163], v[112:115], v[88:91], v[160:163]
  ds_read_b128 v[80:83], v41 offset:40960
  v_cvt_pk_bf16_f32 v130, v132, v133
  v_mfma_f32_16x16x32_bf16 v[164:167], v[116:119], v[88:91], v[164:167]
  v_cvt_pk_bf16_f32 v131, v134, v135
  buffer_store_dwordx4 v[128:131], v16, s[12:15], s70 offen offset:0 sc1
  v_mfma_f32_16x16x32_bf16 v[168:171], v[120:123], v[88:91], v[168:171]
  v_cvt_pk_bf16_f32 v136, v136, v137
  v_cvt_pk_bf16_f32 v137, v138, v139
  v_mfma_f32_16x16x32_bf16 v[172:175], v[124:127], v[88:91], v[172:175]
  v_cvt_pk_bf16_f32 v138, v140, v141
  v_cvt_pk_bf16_f32 v139, v142, v143
  s_waitcnt lgkmcnt(1)
  v_mfma_f32_16x16x32_bf16 v[188:191], v[124:127], v[92:95], v[188:191]
  ds_read_b128 v[84:87], v41 offset:43008
  buffer_store_dwordx4 v[136:139], v16, s[12:15], s70 offen offset:1024 sc1
  s_add_u32 s70, s70, 8192
  v_mfma_f32_16x16x32_bf16 v[184:187], v[120:123], v[92:95], v[184:187]
  v_cvt_pk_bf16_f32 v144, v144, v145
  v_cvt_pk_bf16_f32 v145, v146, v147
  v_mfma_f32_16x16x32_bf16 v[180:183], v[116:119], v[92:95], v[180:183]
  v_cvt_pk_bf16_f32 v146, v148, v149
  v_cvt_pk_bf16_f32 v147, v150, v151
  v_mfma_f32_16x16x32_bf16 v[176:179], v[112:115], v[92:95], v[176:179]
  buffer_store_dwordx4 v[144:147], v16, s[12:15], s71 offen offset:0 sc1
  v_cvt_pk_bf16_f32 v152, v152, v153
  s_waitcnt lgkmcnt(1)
  v_mfma_f32_16x16x32_bf16 v[192:195], v[112:115], v[80:83], v[192:195]
  ds_read_b128 v[88:91], v41 offset:45056
  v_cvt_pk_bf16_f32 v153, v154, v155
  v_mfma_f32_16x16x32_bf16 v[196:199], v[116:119], v[80:83], v[196:199]
  v_cvt_pk_bf16_f32 v154, v156, v157
  v_cvt_pk_bf16_f32 v155, v158, v159
  v_mfma_f32_16x16x32_bf16 v[200:203], v[120:123], v[80:83], v[200:203]
  buffer_store_dwordx4 v[152:155], v16, s[12:15], s71 offen offset:1024 sc1
  s_add_u32 s71, s71, 8192
  v_cvt_pk_bf16_f32 v160, v160, v161
  v_mfma_f32_16x16x32_bf16 v[204:207], v[124:127], v[80:83], v[204:207]
  v_cvt_pk_bf16_f32 v161, v162, v163
  v_cvt_pk_bf16_f32 v162, v164, v165
  s_waitcnt lgkmcnt(1)
  v_mfma_f32_16x16x32_bf16 v[220:223], v[124:127], v[84:87], v[220:223]
  ds_read_b128 v[92:95], v41 offset:47104
  v_cvt_pk_bf16_f32 v163, v166, v167
  v_mfma_f32_16x16x32_bf16 v[216:219], v[120:123], v[84:87], v[216:219]
  v_cvt_pk_bf16_f32 v168, v168, v169
  v_cvt_pk_bf16_f32 v169, v170, v171
  v_mfma_f32_16x16x32_bf16 v[212:215], v[116:119], v[84:87], v[212:215]
  v_cvt_pk_bf16_f32 v170, v172, v173
  v_cvt_pk_bf16_f32 v171, v174, v175
  v_mfma_f32_16x16x32_bf16 v[208:211], v[112:115], v[84:87], v[208:211]
  v_cvt_pk_bf16_f32 v176, v176, v177
  v_cvt_pk_bf16_f32 v177, v178, v179
  s_waitcnt vmcnt(4) lgkmcnt(0)
  s_barrier
  v_mfma_f32_16x16x32_bf16 v[224:227], v[112:115], v[88:91], v[224:227]
  ds_read_b64_tr_b16 v[80:81], v27 offset:0
  ds_read_b64_tr_b16 v[82:83], v27 offset:512
  v_cvt_pk_bf16_f32 v178, v180, v181
  v_mfma_f32_16x16x32_bf16 v[228:231], v[116:119], v[88:91], v[228:231]
  ds_read_b128 v[96:99], v23 offset:0
  ds_read_b128 v[100:103], v23 offset:2048
  v_cvt_pk_bf16_f32 v179, v182, v183
  v_mfma_f32_16x16x32_bf16 v[232:235], v[120:123], v[88:91], v[232:235]
  ds_read_b128 v[104:107], v25 offset:0
  ds_read_b128 v[108:111], v25 offset:2048
  v_cvt_pk_bf16_f32 v184, v184, v185
  v_mfma_f32_16x16x32_bf16 v[236:239], v[124:127], v[88:91], v[236:239]
  ds_read_b64_tr_b16 v[84:85], v28 offset:0
  ds_read_b64_tr_b16 v[86:87], v28 offset:512
  v_cvt_pk_bf16_f32 v185, v186, v187
  v_mfma_f32_16x16x32_bf16 v[252:255], v[124:127], v[92:95], v[252:255]
  v_cvt_pk_bf16_f32 v186, v188, v189
  v_cvt_pk_bf16_f32 v187, v190, v191
  v_mfma_f32_16x16x32_bf16 v[248:251], v[120:123], v[92:95], v[248:251]
  v_mfma_f32_16x16x32_bf16 v[244:247], v[116:119], v[92:95], v[244:247]
  v_mfma_f32_16x16x32_bf16 v[240:243], v[112:115], v[92:95], v[240:243]
  s_branch F_QA
F_VA:
  s_waitcnt vmcnt(16) lgkmcnt(0)
  s_barrier
  ds_read_b128 v[80:83], v40 offset:0
  ds_read_b64_tr_b16 v[96:97], v42 offset:0
  ds_read_b64_tr_b16 v[98:99], v42 offset:512
  ds_read_b64_tr_b16 v[100:101], v43 offset:0
  ds_read_b64_tr_b16 v[102:103], v43 offset:512
  ds_read_b64_tr_b16 v[104:105], v44 offset:0
  ds_read_b64_tr_b16 v[106:107], v44 offset:512
  ds_read_b64_tr_b16 v[108:109], v45 offset:0
  ds_read_b64_tr_b16 v[110:111], v45 offset:512
  ds_read_b128 v[84:87], v40 offset:2048
  s_waitcnt lgkmcnt(7)
  v_mfma_f32_16x16x32_bf16 v[128:131], v[80:83], v[96:99], 0
  ds_read_b128 v[88:91], v40 offset:4096
  s_waitcnt lgkmcnt(6)
  v_mfma_f32_16x16x32_bf16 v[136:139], v[80:83], v[100:103], 0
  s_waitcnt lgkmcnt(4)
  v_mfma_f32_16x16x32_bf16 v[144:147], v[80:83], v[104:107], 0
  s_waitcnt lgkmcnt(2)
  v_mfma_f32_16x16x32_bf16 v[152:155], v[80:83], v[108:111], 0
  s_waitcnt lgkmcnt(1)
  v_mfma_f32_16x16x32_bf16 v[156:159], v[84:87], v[108:111], 0
  ds_read_b128 v[92:95], v40 offset:6144
  v_mfma_f32_16x16x32_bf16 v[148:151], v[84:87], v[104:107], 0
  v_mfma_f32_16x16x32_bf16 v[140:143], v[84:87], v[100:103], 0
  v_mfma_f32_16x16x32_bf16 v[132:135], v[84:87], v[96:99], 0
  s_waitcnt lgkmcnt(1)
  v_mfma_f32_16x16x32_bf16 v[160:163], v[88:91], v[96:99], 0
  ds_read_b128 v[80:83], v40 offset:8192
  v_mfma_f32_16x16x32_bf16 v[168:171], v[88:91], v[100:103], 0
  ds_read_b64_tr_b16 v[112:113], v42 offset:4096
  v_mfma_f32_16x16x32_bf16 v[176:179], v[88:91], v[104:107], 0
  v_mfma_f32_16x16x32_bf16 v[184:187], v[88:91], v[108:111], 0
  ds_read_b64_tr_b16 v[114:115], v42 offset:4608
  s_waitcnt lgkmcnt(3)
  v_mfma_f32_16x16x32_bf16 v[188:191], v[92:95], v[108:111], 0
  ds_read_b128 v[84:87], v40 offset:10240
  v_mfma_f32_16x16x32_bf16 v[180:183], v[92:95], v[104:107], 0
  ds_read_b64_tr_b16 v[116:117], v43 offset:4096
  v_mfma_f32_16x16x32_bf16 v[172:175], v[92:95], v[100:103], 0
  v_mfma_f32_16x16x32_bf16 v[164:167], v[92:95], v[96:99], 0
  ds_read_b64_tr_b16 v[118:119], v43 offset:4608
  s_waitcnt lgkmcnt(5)
  v_mfma_f32_16x16x32_bf16 v[192:195], v[80:83], v[96:99], 0
  ds_read_b128 v[88:91], v40 offset:12288
  v_mfma_f32_16x16x32_bf16 v[200:203], v[80:83], v[100:103], 0
  ds_read_b64_tr_b16 v[120:121], v44 offset:4096
  v_mfma_f32_16x16x32_bf16 v[208:211], v[80:83], v[104:107], 0
  v_mfma_f32_16x16x32_bf16 v[216:219], v[80:83], v[108:111], 0
  ds_read_b64_tr_b16 v[122:123], v44 offset:4608
  s_waitcnt lgkmcnt(5)
  v_mfma_f32_16x16x32_bf16 v[220:223], v[84:87], v[108:111], 0
  ds_read_b128 v[92:95], v40 offset:14336
  v_mfma_f32_16x16x32_bf16 v[212:215], v[84:87], v[104:107], 0
  ds_read_b64_tr_b16 v[124:125], v45 offset:4096
  v_mfma_f32_16x16x32_bf16 v[204:207], v[84:87], v[100:103], 0
  v_mfma_f32_16x16x32_bf16 v[196:199], v[84:87], v[96:99], 0
  ds_read_b64_tr_b16 v[126:127], v45 offset:4608
  s_waitcnt lgkmcnt(5)
  v_mfma_f32_16x16x32_bf16 v[224:227], v[88:91], v[96:99], 0
  ds_read_b128 v[80:83], v41 offset:0
  v_mfma_f32_16x16x32_bf16 v[232:235], v[88:91], v[100:103], 0
  v_mfma_f32_16x16x32_bf16 v[240:243], v[88:91], v[104:107], 0
  v_mfma_f32_16x16x32_bf16 v[248:251], v[88:91], v[108:111], 0
  s_waitcnt lgkmcnt(3)
  v_mfma_f32_16x16x32_bf16 v[252:255], v[92:95], v[108:111], 0
  ds_read_b128 v[84:87], v41 offset:2048
  v_mfma_f32_16x16x32_bf16 v[244:247], v[92:95], v[104:107], 0
  v_mfma_f32_16x16x32_bf16 v[236:239], v[92:95], v[100:103], 0
  v_mfma_f32_16x16x32_bf16 v[228:231], v[92:95], v[96:99], 0
  s_waitcnt lgkmcnt(1)
  v_mfma_f32_16x16x32_bf16 v[128:131], v[80:83], v[112:115], v[128:131]
  ds_read_b128 v[88:91], v41 offset:4096
  v_mfma_f32_16x16x32_bf16 v[136:139], v[80:83], v[116:119], v[136:139]
  v_mfma_f32_16x16x32_bf16 v[144:147], v[80:83], v[120:123], v[144:147]
  v_mfma_f32_16x16x32_bf16 v[152:155], v[80:83], v[124:127], v[152:155]
  s_waitcnt lgkmcnt(1)
  v_mfma_f32_16x16x32_bf16 v[156:159], v[84:87], v[124:127], v[156:159]
  ds_read_b128 v[92:95], v41 offset:6144
  v_mfma_f32_16x16x32_bf16 v[148:151], v[84:87], v[120:123], v[148:151]
  v_mfma_f32_16x16x32_bf16 v[140:143], v[84:87], v[116:119], v[140:143]
  v_mfma_f32_16x16x32_bf16 v[132:135], v[84:87], v[112:115], v[132:135]
  s_waitcnt lgkmcnt(1)
  v_mfma_f32_16x16x32_bf16 v[160:163], v[88:91], v[112:115], v[160:163]
  ds_read_b128 v[80:83], v41 offset:8192
  v_mfma_f32_16x16x32_bf16 v[168:171], v[88:91], v[116:119], v[168:171]
  v_mfma_f32_16x16x32_bf16 v[176:179], v[88:91], v[120:123], v[176:179]
  v_mfma_f32_16x16x32_bf16 v[184:187], v[88:91], v[124:127], v[184:187]
  s_waitcnt lgkmcnt(1)
  v_mfma_f32_16x16x32_bf16 v[188:191], v[92:95], v[124:127], v[188:191]
  ds_read_b128 v[84:87], v41 offset:10240
  v_mfma_f32_16x16x32_bf16 v[180:183], v[92:95], v[120:123], v[180:183]
  v_mfma_f32_16x16x32_bf16 v[172:175], v[92:95], v[116:119], v[172:175]
  v_mfma_f32_16x16x32_bf16 v[164:167], v[92:95], v[112:115], v[164:167]
  s_waitcnt lgkmcnt(1)
  v_mfma_f32_16x16x32_bf16 v[192:195], v[80:83], v[112:115], v[192:195]
  ds_read_b128 v[88:91], v41 offset:12288
  v_mfma_f32_16x16x32_bf16 v[200:203], v[80:83], v[116:119], v[200:203]
  v_mfma_f32_16x16x32_bf16 v[208:211], v[80:83], v[120:123], v[208:211]
  v_mfma_f32_16x16x32_bf16 v[216:219], v[80:83], v[124:127], v[216:219]
  s_waitcnt lgkmcnt(1)
  v_mfma_f32_16x16x32_bf16 v[220:223], v[84:87], v[124:127], v[220:223]
  ds_read_b128 v[92:95], v41 offset:14336
  v_mfma_f32_16x16x32_bf16 v[212:215], v[84:87], v[120:123], v[212:215]
  v_mfma_f32_16x16x32_bf16 v[204:207], v[84:87], v[116:119], v[204:207]
  v_mfma_f32_16x16x32_bf16 v[196:199], v[84:87], v[112:115], v[196:199]
  s_waitcnt vmcnt(0) lgkmcnt(0)
  s_barrier
  v_mfma_f32_16x16x32_bf16 v[224:227], v[88:91], v[112:115], v[224:227]
  ds_read_b128 v[80:83], v40 offset:32768
  ds_read_b64_tr_b16 v[96:97], v42 offset:32768
  v_mfma_f32_16x16x32_bf16 v[232:235], v[88:91], v[116:119], v[232:235]
  ds_read_b64_tr_b16 v[98:99], v42 offset:33280
  ds_read_b64_tr_b16 v[100:101], v43 offset:32768
  v_mfma_f32_16x16x32_bf16 v[240:243], v[88:91], v[120:123], v[240:243]
  ds_read_b64_tr_b16 v[102:103], v43 offset:33280
  ds_read_b64_tr_b16 v[104:105], v44 offset:32768
  v_mfma_f32_16x16x32_bf16 v[248:251], v[88:91], v[124:127], v[248:251]
  ds_read_b64_tr_b16 v[106:107], v44 offset:33280
  ds_read_b64_tr_b16 v[108:109], v45 offset:32768
  v_mfma_f32_16x16x32_bf16 v[252:255], v[92:95], v[124:127], v[252:255]
  ds_read_b64_tr_b16 v[110:111], v45 offset:33280
  ds_read_b128 v[84:87], v40 offset:34816
  v_mfma_f32_16x16x32_bf16 v[244:247], v[92:95], v[120:123], v[244:247]
  v_mfma_f32_16x16x32_bf16 v[236:239], v[92:95], v[116:119], v[236:239]
  v_mfma_f32_16x16x32_bf16 v[228:231], v[92:95], v[112:115], v[228:231]
  s_waitcnt lgkmcnt(7)
  v_mfma_f32_16x16x32_bf16 v[128:131], v[80:83], v[96:99], v[128:131]
  ds_read_b128 v[88:91], v40 offset:36864
  s_add_u32 m0, s64, 0
  s_waitcnt lgkmcnt(6)
  v_mfma_f32_16x16x32_bf16 v[136:139], v[80:83], v[100:103], v[136:139]
  buffer_load_dwordx4 v32, s[4:7], s65 offen offset:0 lds
  s_waitcnt lgkmcnt(4)
  v_mfma_f32_16x16x32_bf16 v[144:147], v[80:83], v[104:107], v[144:147]
  s_waitcnt lgkmcnt(2)
  v_mfma_f32_16x16x32_bf16 v[152:155], v[80:83], v[108:111], v[152:155]
  buffer_load_dwordx4 v33, s[4:7], s65 offen offset:1024 lds
  s_waitcnt lgkmcnt(1)
  v_mfma_f32_16x16x32_bf16 v[156:159], v[84:87], v[108:111], v[156:159]
  ds_read_b128 v[92:95], v40 offset:38912
  v_mfma_f32_16x16x32_bf16 v[148:151], v[84:87], v[104:107], v[148:151]
  buffer_load_dwordx4 v34, s[4:7], s65 offen offset:2048 lds
  v_mfma_f32_16x16x32_bf16 v[140:143], v[84:87], v[100:103], v[140:143]
  v_mfma_f32_16x16x32_bf16 v[132:135], v[84:87], v[96:99], v[132:135]
  buffer_load_dwordx4 v35, s[4:7], s65 offen offset:3072 lds
  s_add_u32 s65, s65, 32768
  s_add_u32 m0, s64, 4096
  s_waitcnt lgkmcnt(1)
  v_mfma_f32_16x16x32_bf16 v[160:163], v[88:91], v[96:99], v[160:163]
  ds_read_b128 v[80:83], v40 offset:40960
  v_mfma_f32_16x16x32_bf16 v[168:171], v[88:91], v[100:103], v[168:171]
  ds_read_b64_tr_b16 v[112:113], v42 offset:36864
  buffer_load_dwordx4 v32, s[4:7], s65 offen offset:0 lds
  v_mfma_f32_16x16x32_bf16 v[176:179], v[88:91], v[104:107], v[176:179]
  v_mfma_f32_16x16x32_bf16 v[184:187], v[88:91], v[108:111], v[184:187]
  ds_read_b64_tr_b16 v[114:115], v42 offset:37376
  buffer_load_dwordx4 v33, s[4:7], s65 offen offset:1024 lds
  s_waitcnt lgkmcnt(3)
  v_mfma_f32_16x16x32_bf16 v[188:191], v[92:95], v[108:111], v[188:191]
  ds_read_b128 v[84:87], v40 offset:43008
  v_mfma_f32_16x16x32_bf16 v[180:183], v[92:95], v[104:107], v[180:183]
  ds_read_b64_tr_b16 v[116:117], v43 offset:36864
  buffer_load_dwordx4 v34, s[4:7], s65 offen offset:2048 lds
  v_mfma_f32_16x16x32_bf16 v[172:175], v[92:95], v[100:103], v[172:175]
  v_mfma_f32_16x16x32_bf16 v[164:167], v[92:95], v[96:99], v[164:167]
  ds_read_b64_tr_b16 v[118:119], v43 offset:37376
  buffer_load_dwordx4 v35, s[4:7], s65 offen offset:3072 lds
  s_sub_u32 s65, s65, 32640
  s_add_u32 m0, s64, 65536
  s_waitcnt lgkmcnt(5)
  v_mfma_f32_16x16x32_bf16 v[192:195], v[80:83], v[96:99], v[192:195]
  ds_read_b128 v[88:91], v40 offset:45056
  v_mfma_f32_16x16x32_bf16 v[200:203], v[80:83], v[100:103], v[200:203]
  ds_read_b64_tr_b16 v[120:121], v44 offset:36864
  buffer_load_dwordx4 v36, s[8:11], s66 offen offset:0 lds
  v_mfma_f32_16x16x32_bf16 v[208:211], v[80:83], v[104:107], v[208:211]
  v_mfma_f32_16x16x32_bf16 v[216:219], v[80:83], v[108:111], v[216:219]
  ds_read_b64_tr_b16 v[122:123], v44 offset:37376
  buffer_load_dwordx4 v37, s[8:11], s66 offen offset:1024 lds
  s_waitcnt lgkmcnt(5)
  v_mfma_f32_16x16x32_bf16 v[220:223], v[84:87], v[108:111], v[220:223]
  ds_read_b128 v[92:95], v40 offset:47104
  v_mfma_f32_16x16x32_bf16 v[212:215], v[84:87], v[104:107], v[212:215]
  ds_read_b64_tr_b16 v[124:125], v45 offset:36864
  buffer_load_dwordx4 v38, s[8:11], s66 offen offset:2048 lds
  v_mfma_f32_16x16x32_bf16 v[204:207], v[84:87], v[100:103], v[204:207]
  v_mfma_f32_16x16x32_bf16 v[196:199], v[84:87], v[96:99], v[196:199]
  ds_read_b64_tr_b16 v[126:127], v45 offset:37376
  buffer_load_dwordx4 v39, s[8:11], s66 offen offset:3072 lds
  s_add_u32 s66, s66, 262144
  s_add_u32 m0, s64, 69632
  s_waitcnt lgkmcnt(5)
  v_mfma_f32_16x16x32_bf16 v[224:227], v[88:91], v[96:99], v[224:227]
  ds_read_b128 v[80:83], v41 offset:32768
  v_mfma_f32_16x16x32_bf16 v[232:235], v[88:91], v[100:103], v[232:235]
  buffer_load_dwordx4 v36, s[8:11], s66 offen offset:0 lds
  v_mfma_f32_16x16x32_bf16 v[240:243], v[88:91], v[104:107], v[240:243]
  v_mfma_f32_16x16x32_bf16 v[248:251], v[88:91], v[108:111], v[248:251]
  buffer_load_dwordx4 v37, s[8:11], s66 offen offset:1024 lds
  s_waitcnt lgkmcnt(3)
  v_mfma_f32_16x16x32_bf16 v[252:255], v[92:95], v[108:111], v[252:255]
  ds_read_b128 v[84:87], v41 offset:34816
  v_mfma_f32_16x16x32_bf16 v[244:247], v[92:95], v[104:107], v[244:247]
  buffer_load_dwordx4 v38, s[8:11], s66 offen offset:2048 lds
  v_mfma_f32_16x16x32_bf16 v[236:239], v[92:95], v[100:103], v[236:239]
  v_mfma_f32_16x16x32_bf16 v[228:231], v[92:95], v[96:99], v[228:231]
  buffer_load_dwordx4 v39, s[8:11], s66 offen offset:3072 lds
  s_add_u32 s66, s66, 262144
  s_waitcnt lgkmcnt(1)
  v_mfma_f32_16x16x32_bf16 v[128:131], v[80:83], v[112:115], v[128:131]
  ds_read_b128 v[88:91], v41 offset:36864
  v_mfma_f32_16x16x32_bf16 v[136:139], v[80:83], v[116:119], v[136:139]
  v_mfma_f32_16x16x32_bf16 v[144:147], v[80:83], v[120:123], v[144:147]
  v_mfma_f32_16x16x32_bf16 v[152:155], v[80:83], v[124:127], v[152:155]
  s_waitcnt lgkmcnt(1)
  v_mfma_f32_16x16x32_bf16 v[156:159], v[84:87], v[124:127], v[156:159]
  ds_read_b128 v[92:95], v41 offset:38912
  v_mfma_f32_16x16x32_bf16 v[148:151], v[84:87], v[120:123], v[148:151]
  v_mfma_f32_16x16x32_bf16 v[140:143], v[84:87], v[116:119], v[140:143]
  v_mfma_f32_16x16x32_bf16 v[132:135], v[84:87], v[112:115], v[132:135]
  s_waitcnt lgkmcnt(1)
  v_mfma_f32_16x16x32_bf16 v[160:163], v[88:91], v[112:115], v[160:163]
  ds_read_b128 v[80:83], v41 offset:40960
  v_mfma_f32_16x16x32_bf16 v[168:171], v[88:91], v[116:119], v[168:171]
  v_mfma_f32_16x16x32_bf16 v[176:179], v[88:91], v[120:123], v[176:179]
  v_mfma_f32_16x16x32_bf16 v[184:187], v[88:91], v[124:127], v[184:187]
  s_waitcnt lgkmcnt(1)
  v_mfma_f32_16x16x32_bf16 v[188:191], v[92:95], v[124:127], v[188:191]
  ds_read_b128 v[84:87], v41 offset:43008
  v_mfma_f32_16x16x32_bf16 v[180:183], v[92:95], v[120:123], v[180:183]
  v_mfma_f32_16x16x32_bf16 v[172:175], v[92:95], v[116:119], v[172:175]
  v_mfma_f32_16x16x32_bf16 v[164:167], v[92:95], v[112:115], v[164:167]
  s_waitcnt lgkmcnt(1)
  v_mfma_f32_16x16x32_bf16 v[192:195], v[80:83], v[112:115], v[192:195]
  ds_read_b128 v[88:91], v41 offset:45056
  v_mfma_f32_16x16x32_bf16 v[200:203], v[80:83], v[116:119], v[200:203]
  v_mfma_f32_16x16x32_bf16 v[208:211], v[80:83], v[120:123], v[208:211]
  v_mfma_f32_16x16x32_bf16 v[216:219], v[80:83], v[124:127], v[216:219]
  s_waitcnt lgkmcnt(1)
  v_mfma_f32_16x16x32_bf16 v[220:223], v[84:87], v[124:127], v[220:223]
  ds_read_b128 v[92:95], v41 offset:47104
  v_mfma_f32_16x16x32_bf16 v[212:215], v[84:87], v[120:123], v[212:215]
  v_mfma_f32_16x16x32_bf16 v[204:207], v[84:87], v[116:119], v[204:207]
  v_mfma_f32_16x16x32_bf16 v[196:199], v[84:87], v[112:115], v[196:199]
  s_waitcnt vmcnt(0) lgkmcnt(0)
  s_barrier
  v_mfma_f32_16x16x32_bf16 v[224:227], v[88:91], v[112:115], v[224:227]
  ds_read_b128 v[80:83], v40 offset:0
  ds_read_b64_tr_b16 v[96:97], v42 offset:0
  v_mfma_f32_16x16x32_bf16 v[232:235], v[88:91], v[116:119], v[232:235]
  ds_read_b64_tr_b16 v[98:99], v42 offset:512
  ds_read_b64_tr_b16 v[100:101], v43 offset:0
  v_mfma_f32_16x16x32_bf16 v[240:243], v[88:91], v[120:123], v[240:243]
  ds_read_b64_tr_b16 v[102:103], v43 offset:512
  ds_read_b64_tr_b16 v[104:105], v44 offset:0
  v_mfma_f32_16x16x32_bf16 v[248:251], v[88:91], v[124:127], v[248:251]
  ds_read_b64_tr_b16 v[106:107], v44 offset:512
  ds_read_b64_tr_b16 v[108:109], v45 offset:0
  v_mfma_f32_16x16x32_bf16 v[252:255], v[92:95], v[124:127], v[252:255]
  ds_read_b64_tr_b16 v[110:111], v45 offset:512
  ds_read_b128 v[84:87], v40 offset:2048
  v_mfma_f32_16x16x32_bf16 v[244:247], v[92:95], v[120:123], v[244:247]
  v_mfma_f32_16x16x32_bf16 v[236:239], v[92:95], v[116:119], v[236:239]
  v_mfma_f32_16x16x32_bf16 v[228:231], v[92:95], v[112:115], v[228:231]
  s_waitcnt lgkmcnt(7)
  v_mfma_f32_16x16x32_bf16 v[128:131], v[80:83], v[96:99], v[128:131]
  ds_read_b128 v[88:91], v40 offset:4096
  s_add_u32 m0, s64, 32768
  s_waitcnt lgkmcnt(6)
  v_mfma_f32_16x16x32_bf16 v[136:139], v[80:83], v[100:103], v[136:139]
  buffer_load_dwordx4 v32, s[4:7], s65 offen offset:0 lds
  s_waitcnt lgkmcnt(4)
  v_mfma_f32_16x16x32_bf16 v[144:147], v[80:83], v[104:107], v[144:147]
  s_waitcnt lgkmcnt(2)
  v_mfma_f32_16x16x32_bf16 v[152:155], v[80:83], v[108:111], v[152:155]
  buffer_load_dwordx4 v33, s[4:7], s65 offen offset:1024 lds
  s_waitcnt lgkmcnt(1)
  v_mfma_f32_16x16x32_bf16 v[156:159], v[84:87], v[108:111], v[156:159]
  ds_read_b128 v[92:95], v40 offset:6144
  v_mfma_f32_16x16x32_bf16 v[148:151], v[84:87], v[104:107], v[148:151]
  buffer_load_dwordx4 v34, s[4:7], s65 offen offset:2048 lds
  v_mfma_f32_16x16x32_bf16 v[140:143], v[84:87], v[100:103], v[140:143]
  v_mfma_f32_16x16x32_bf16 v[132:135], v[84:87], v[96:99], v[132:135]
  buffer_load_dwordx4 v35, s[4:7], s65 offen offset:3072 lds
  s_add_u32 s65, s65, 32768
  s_add_u32 m0, s64, 36864
  s_waitcnt lgkmcnt(1)
  v_mfma_f32_16x16x32_bf16 v[160:163], v[88:91], v[96:99], v[160:163]
  ds_read_b128 v[80:83], v40 offset:8192
  v_mfma_f32_16x16x32_bf16 v[168:171], v[88:91], v[100:103], v[168:171]
  ds_read_b64_tr_b16 v[112:113], v42 offset:4096
  buffer_load_dwordx4 v32, s[4:7], s65 offen offset:0 lds
  v_mfma_f32_16x16x32_bf16 v[176:179], v[88:91], v[104:107], v[176:179]
  v_mfma_f32_16x16x32_bf16 v[184:187], v[88:91], v[108:111], v[184:187]
  ds_read_b64_tr_b16 v[114:115], v42 offset:4608
  buffer_load_dwordx4 v33, s[4:7], s65 offen offset:1024 lds
  s_waitcnt lgkmcnt(3)
  v_mfma_f32_16x16x32_bf16 v[188:191], v[92:95], v[108:111], v[188:191]
  ds_read_b128 v[84:87], v40 offset:10240
  v_mfma_f32_16x16x32_bf16 v[180:183], v[92:95], v[104:107], v[180:183]
  ds_read_b64_tr_b16 v[116:117], v43 offset:4096
  buffer_load_dwordx4 v34, s[4:7], s65 offen offset:2048 lds
  v_mfma_f32_16x16x32_bf16 v[172:175], v[92:95], v[100:103], v[172:175]
  v_mfma_f32_16x16x32_bf16 v[164:167], v[92:95], v[96:99], v[164:167]
  ds_read_b64_tr_b16 v[118:119], v43 offset:4608
  buffer_load_dwordx4 v35, s[4:7], s65 offen offset:3072 lds
  s_sub_u32 s65, s65, 32640
  s_add_u32 m0, s64, 98304
  s_waitcnt lgkmcnt(5)
  v_mfma_f32_16x16x32_bf16 v[192:195], v[80:83], v[96:99], v[192:195]
  ds_read_b128 v[88:91], v40 offset:12288
  v_mfma_f32_16x16x32_bf16 v[200:203], v[80:83], v[100:103], v[200:203]
  ds_read_b64_tr_b16 v[120:121], v44 offset:4096
  buffer_load_dwordx4 v36, s[8:11], s66 offen offset:0 lds
  v_mfma_f32_16x16x32_bf16 v[208:211], v[80:83], v[104:107], v[208:211]
  v_mfma_f32_16x16x32_bf16 v[216:219], v[80:83], v[108:111], v[216:219]
  ds_read_b64_tr_b16 v[122:123], v44 offset:4608
  buffer_load_dwordx4 v37, s[8:11], s66 offen offset:1024 lds
  s_waitcnt lgkmcnt(5)
  v_mfma_f32_16x16x32_bf16 v[220:223], v[84:87], v[108:111], v[220:223]
  ds_read_b128 v[92:95], v40 offset:14336
  v_mfma_f32_16x16x32_bf16 v[212:215], v[84:87], v[104:107], v[212:215]
  ds_read_b64_tr_b16 v[124:125], v45 offset:4096
  buffer_load_dwordx4 v38, s[8:11], s66 offen offset:2048 lds
  v_mfma_f32_16x16x32_bf16 v[204:207], v[84:87], v[100:103], v[204:207]
  v_mfma_f32_16x16x32_bf16 v[196:199], v[84:87], v[96:99], v[196:199]
  ds_read_b64_tr_b16 v[126:127], v45 offset:4608
  buffer_load_dwordx4 v39, s[8:11], s66 offen offset:3072 lds
  s_add_u32 s66, s66, 262144
  s_add_u32 m0, s64, 102400
  s_waitcnt lgkmcnt(5)
  v_mfma_f32_16x16x32_bf16 v[224:227], v[88:91], v[96:99], v[224:227]
  ds_read_b128 v[80:83], v41 offset:0
  v_mfma_f32_16x16x32_bf16 v[232:235], v[88:91], v[100:103], v[232:235]
  buffer_load_dwordx4 v36, s[8:11], s66 offen offset:0 lds
  v_mfma_f32_16x16x32_bf16 v[240:243], v[88:91], v[104:107], v[240:243]
  v_mfma_f32_16x16x32_bf16 v[248:251], v[88:91], v[108:111], v[248:251]
  buffer_load_dwordx4 v37, s[8:11], s66 offen offset:1024 lds
  s_waitcnt lgkmcnt(3)
  v_mfma_f32_16x16x32_bf16 v[252:255], v[92:95], v[108:111], v[252:255]
  ds_read_b128 v[84:87], v41 offset:2048
  v_mfma_f32_16x16x32_bf16 v[244:247], v[92:95], v[104:107], v[244:247]
  buffer_load_dwordx4 v38, s[8:11], s66 offen offset:2048 lds
  v_mfma_f32_16x16x32_bf16 v[236:239], v[92:95], v[100:103], v[236:239]
  v_mfma_f32_16x16x32_bf16 v[228:231], v[92:95], v[96:99], v[228:231]
  buffer_load_dwordx4 v39, s[8:11], s66 offen offset:3072 lds
  s_add_u32 s66, s66, 262144
  s_waitcnt lgkmcnt(1)
  v_mfma_f32_16x16x32_bf16 v[128:131], v[80:83], v[112:115], v[128:131]
  ds_read_b128 v[88:91], v41 offset:4096
  v_mfma_f32_16x16x32_bf16 v[136:139], v[80:83], v[116:119], v[136:139]
  v_mfma_f32_16x16x32_bf16 v[144:147], v[80:83], v[120:123], v[144:147]
  v_mfma_f32_16x16x32_bf16 v[152:155], v[80:83], v[124:127], v[152:155]
  s_waitcnt lgkmcnt(1)
  v_mfma_f32_16x16x32_bf16 v[156:159], v[84:87], v[124:127], v[156:159]
  ds_read_b128 v[92:95], v41 offset:6144
  v_mfma_f32_16x16x32_bf16 v[148:151], v[84:87], v[120:123], v[148:151]
  v_mfma_f32_16x16x32_bf16 v[140:143], v[84:87], v[116:119], v[140:143]
  v_mfma_f32_16x16x32_bf16 v[132:135], v[84:87], v[112:115], v[132:135]
  s_waitcnt lgkmcnt(1)
  v_mfma_f32_16x16x32_bf16 v[160:163], v[88:91], v[112:115], v[160:163]
  ds_read_b128 v[80:83], v41 offset:8192
  v_mfma_f32_16x16x32_bf16 v[168:171], v[88:91], v[116:119], v[168:171]
  v_mfma_f32_16x16x32_bf16 v[176:179], v[88:91], v[120:123], v[176:179]
  v_mfma_f32_16x16x32_bf16 v[184:187], v[88:91], v[124:127], v[184:187]
  s_waitcnt lgkmcnt(1)
  v_mfma_f32_16x16x32_bf16 v[188:191], v[92:95], v[124:127], v[188:191]
  ds_read_b128 v[84:87], v41 offset:10240
  v_mfma_f32_16x16x32_bf16 v[180:183], v[92:95], v[120:123], v[180:183]
  v_mfma_f32_16x16x32_bf16 v[172:175], v[92:95], v[116:119], v[172:175]
  v_mfma_f32_16x16x32_bf16 v[164:167], v[92:95], v[112:115], v[164:167]
  s_waitcnt lgkmcnt(1)
  v_mfma_f32_16x16x32_bf16 v[192:195], v[80:83], v[112:115], v[192:195]
  ds_read_b128 v[88:91], v41 offset:12288
  v_mfma_f32_16x16x32_bf16 v[200:203], v[80:83], v[116:119], v[200:203]
  v_mfma_f32_16x16x32_bf16 v[208:211], v[80:83], v[120:123], v[208:211]
  v_mfma_f32_16x16x32_bf16 v[216:219], v[80:83], v[124:127], v[216:219]
  s_waitcnt lgkmcnt(1)
  v_mfma_f32_16x16x32_bf16 v[220:223], v[84:87], v[124:127], v[220:223]
  ds_read_b128 v[92:95], v41 offset:14336
  v_mfma_f32_16x16x32_bf16 v[212:215], v[84:87], v[120:123], v[212:215]
  v_mfma_f32_16x16x32_bf16 v[204:207], v[84:87], v[116:119], v[204:207]
  v_mfma_f32_16x16x32_bf16 v[196:199], v[84:87], v[112:115], v[196:199]
  s_waitcnt vmcnt(0) lgkmcnt(0)
  s_barrier
  v_mfma_f32_16x16x32_bf16 v[224:227], v[88:91], v[112:115], v[224:227]
  ds_read_b128 v[80:83], v40 offset:32768
  ds_read_b64_tr_b16 v[96:97], v42 offset:32768
  v_mfma_f32_16x16x32_bf16 v[232:235], v[88:91], v[116:119], v[232:235]
  ds_read_b64_tr_b16 v[98:99], v42 offset:33280
  ds_read_b64_tr_b16 v[100:101], v43 offset:32768
  v_mfma_f32_16x16x32_bf16 v[240:243], v[88:91], v[120:123], v[240:243]
  ds_read_b64_tr_b16 v[102:103], v43 offset:33280
  ds_read_b64_tr_b16 v[104:105], v44 offset:32768
  v_mfma_f32_16x16x32_bf16 v[248:251], v[88:91], v[124:127], v[248:251]
  ds_read_b64_tr_b16 v[106:107], v44 offset:33280
  ds_read_b64_tr_b16 v[108:109], v45 offset:32768
  v_mfma_f32_16x16x32_bf16 v[252:255], v[92:95], v[124:127], v[252:255]
  ds_read_b64_tr_b16 v[110:111], v45 offset:33280
  ds_read_b128 v[84:87], v40 offset:34816
  v_mfma_f32_16x16x32_bf16 v[244:247], v[92:95], v[120:123], v[244:247]
  v_mfma_f32_16x16x32_bf16 v[236:239], v[92:95], v[116:119], v[236:239]
  v_mfma_f32_16x16x32_bf16 v[228:231], v[92:95], v[112:115], v[228:231]
  s_waitcnt lgkmcnt(7)
  v_mfma_f32_16x16x32_bf16 v[128:131], v[80:83], v[96:99], v[128:131]
  ds_read_b128 v[88:91], v40 offset:36864
  s_add_u32 m0, s64, 0
  s_waitcnt lgkmcnt(6)
  v_mfma_f32_16x16x32_bf16 v[136:139], v[80:83], v[100:103], v[136:139]
  buffer_load_dwordx4 v32, s[4:7], s65 offen offset:0 lds
  s_waitcnt lgkmcnt(4)
  v_mfma_f32_16x16x32_bf16 v[144:147], v[80:83], v[104:107], v[144:147]
  s_waitcnt lgkmcnt(2)
  v_mfma_f32_16x16x32_bf16 v[152:155], v[80:83], v[108:111], v[152:155]
  buffer_load_dwordx4 v33, s[4:7], s65 offen offset:1024 lds
  s_waitcnt lgkmcnt(1)
  v_mfma_f32_16x16x32_bf16 v[156:159], v[84:87], v[108:111], v[156:159]
  ds_read_b128 v[92:95], v40 offset:38912
  v_mfma_f32_16x16x32_bf16 v[148:151], v[84:87], v[104:107], v[148:151]
  buffer_load_dwordx4 v34, s[4:7], s65 offen offset:2048 lds
  v_mfma_f32_16x16x32_bf16 v[140:143], v[84:87], v[100:103], v[140:143]
  v_mfma_f32_16x16x32_bf16 v[132:135], v[84:87], v[96:99], v[132:135]
  buffer_load_dwordx4 v35, s[4:7], s65 offen offset:3072 lds
  s_add_u32 s65, s65, 32768
  s_add_u32 m0, s64, 4096
  s_waitcnt lgkmcnt(1)
  v_mfma_f32_16x16x32_bf16 v[160:163], v[88:91], v[96:99], v[160:163]
  ds_read_b128 v[80:83], v40 offset:40960
  v_mfma_f32_16x16x32_bf16 v[168:171], v[88:91], v[100:103], v[168:171]
  ds_read_b64_tr_b16 v[112:113], v42 offset:36864
  buffer_load_dwordx4 v32, s[4:7], s65 offen offset:0 lds
  v_mfma_f32_16x16x32_bf16 v[176:179], v[88:91], v[104:107], v[176:179]
  v_mfma_f32_16x16x32_bf16 v[184:187], v[88:91], v[108:111], v[184:187]
  ds_read_b64_tr_b16 v[114:115], v42 offset:37376
  buffer_load_dwordx4 v33, s[4:7], s65 offen offset:1024 lds
  s_waitcnt lgkmcnt(3)
  v_mfma_f32_16x16x32_bf16 v[188:191], v[92:95], v[108:111], v[188:191]
  ds_read_b128 v[84:87], v40 offset:43008
  v_mfma_f32_16x16x32_bf16 v[180:183], v[92:95], v[104:107], v[180:183]
  ds_read_b64_tr_b16 v[116:117], v43 offset:36864
  buffer_load_dwordx4 v34, s[4:7], s65 offen offset:2048 lds
  v_mfma_f32_16x16x32_bf16 v[172:175], v[92:95], v[100:103], v[172:175]
  v_mfma_f32_16x16x32_bf16 v[164:167], v[92:95], v[96:99], v[164:167]
  ds_read_b64_tr_b16 v[118:119], v43 offset:37376
  buffer_load_dwordx4 v35, s[4:7], s65 offen offset:3072 lds
  s_sub_u32 s65, s65, 32640
  s_add_u32 m0, s64, 65536
  s_waitcnt lgkmcnt(5)
  v_mfma_f32_16x16x32_bf16 v[192:195], v[80:83], v[96:99], v[192:195]
  ds_read_b128 v[88:91], v40 offset:45056
  v_mfma_f32_16x16x32_bf16 v[200:203], v[80:83], v[100:103], v[200:203]
  ds_read_b64_tr_b16 v[120:121], v44 offset:36864
  buffer_load_dwordx4 v36, s[8:11], s66 offen offset:0 lds
  v_mfma_f32_16x16x32_bf16 v[208:211], v[80:83], v[104:107], v[208:211]
  v_mfma_f32_16x16x32_bf16 v[216:219], v[80:83], v[108:111], v[216:219]
  ds_read_b64_tr_b16 v[122:123], v44 offset:37376
  buffer_load_dwordx4 v37, s[8:11], s66 offen offset:1024 lds
  s_waitcnt lgkmcnt(5)
  v_mfma_f32_16x16x32_bf16 v[220:223], v[84:87], v[108:111], v[220:223]
  ds_read_b128 v[92:95], v40 offset:47104
  v_mfma_f32_16x16x32_bf16 v[212:215], v[84:87], v[104:107], v[212:215]
  ds_read_b64_tr_b16 v[124:125], v45 offset:36864
  buffer_load_dwordx4 v38, s[8:11], s66 offen offset:2048 lds
  v_mfma_f32_16x16x32_bf16 v[204:207], v[84:87], v[100:103], v[204:207]
  v_mfma_f32_16x16x32_bf16 v[196:199], v[84:87], v[96:99], v[196:199]
  ds_read_b64_tr_b16 v[126:127], v45 offset:37376
  buffer_load_dwordx4 v39, s[8:11], s66 offen offset:3072 lds
  s_add_u32 s66, s66, 262144
  s_add_u32 m0, s64, 69632
  s_waitcnt lgkmcnt(5)
  v_mfma_f32_16x16x32_bf16 v[224:227], v[88:91], v[96:99], v[224:227]
  ds_read_b128 v[80:83], v41 offset:32768
  v_mfma_f32_16x16x32_bf16 v[232:235], v[88:91], v[100:103], v[232:235]
  buffer_load_dwordx4 v36, s[8:11], s66 offen offset:0 lds
  v_mfma_f32_16x16x32_bf16 v[240:243], v[88:91], v[104:107], v[240:243]
  v_mfma_f32_16x16x32_bf16 v[248:251], v[88:91], v[108:111], v[248:251]
  buffer_load_dwordx4 v37, s[8:11], s66 offen offset:1024 lds
  s_waitcnt lgkmcnt(3)
  v_mfma_f32_16x16x32_bf16 v[252:255], v[92:95], v[108:111], v[252:255]
  ds_read_b128 v[84:87], v41 offset:34816
  v_mfma_f32_16x16x32_bf16 v[244:247], v[92:95], v[104:107], v[244:247]
  buffer_load_dwordx4 v38, s[8:11], s66 offen offset:2048 lds
  v_mfma_f32_16x16x32_bf16 v[236:239], v[92:95], v[100:103], v[236:239]
  v_mfma_f32_16x16x32_bf16 v[228:231], v[92:95], v[96:99], v[228:231]
  buffer_load_dwordx4 v39, s[8:11], s66 offen offset:3072 lds
  s_add_u32 s66, s66, 262144
  s_waitcnt lgkmcnt(1)
  v_mfma_f32_16x16x32_bf16 v[128:131], v[80:83], v[112:115], v[128:131]
  ds_read_b128 v[88:91], v41 offset:36864
  v_mfma_f32_16x16x32_bf16 v[136:139], v[80:83], v[116:119], v[136:139]
  v_mfma_f32_16x16x32_bf16 v[144:147], v[80:83], v[120:123], v[144:147]
  v_mfma_f32_16x16x32_bf16 v[152:155], v[80:83], v[124:127], v[152:155]
  s_waitcnt lgkmcnt(1)
  v_mfma_f32_16x16x32_bf16 v[156:159], v[84:87], v[124:127], v[156:159]
  ds_read_b128 v[92:95], v41 offset:38912
  v_mfma_f32_16x16x32_bf16 v[148:151], v[84:87], v[120:123], v[148:151]
  v_mfma_f32_16x16x32_bf16 v[140:143], v[84:87], v[116:119], v[140:143]
  v_mfma_f32_16x16x32_bf16 v[132:135], v[84:87], v[112:115], v[132:135]
  s_waitcnt lgkmcnt(1)
  v_mfma_f32_16x16x32_bf16 v[160:163], v[88:91], v[112:115], v[160:163]
  ds_read_b128 v[80:83], v41 offset:40960
  v_mfma_f32_16x16x32_bf16 v[168:171], v[88:91], v[116:119], v[168:171]
  v_mfma_f32_16x16x32_bf16 v[176:179], v[88:91], v[120:123], v[176:179]
  v_mfma_f32_16x16x32_bf16 v[184:187], v[88:91], v[124:127], v[184:187]
  s_waitcnt lgkmcnt(1)
  v_mfma_f32_16x16x32_bf16 v[188:191], v[92:95], v[124:127], v[188:191]
  ds_read_b128 v[84:87], v41 offset:43008
  v_mfma_f32_16x16x32_bf16 v[180:183], v[92:95], v[120:123], v[180:183]
  v_mfma_f32_16x16x32_bf16 v[172:175], v[92:95], v[116:119], v[172:175]
  v_mfma_f32_16x16x32_bf16 v[164:167], v[92:95], v[112:115], v[164:167]
  s_waitcnt lgkmcnt(1)
  v_mfma_f32_16x16x32_bf16 v[192:195], v[80:83], v[112:115], v[192:195]
  ds_read_b128 v[88:91], v41 offset:45056
  v_mfma_f32_16x16x32_bf16 v[200:203], v[80:83], v[116:119], v[200:203]
  v_mfma_f32_16x16x32_bf16 v[208:211], v[80:83], v[120:123], v[208:211]
  v_mfma_f32_16x16x32_bf16 v[216:219], v[80:83], v[124:127], v[216:219]
  s_waitcnt lgkmcnt(1)
  v_mfma_f32_16x16x32_bf16 v[220:223], v[84:87], v[124:127], v[220:223]
  ds_read_b128 v[92:95], v41 offset:47104
  v_mfma_f32_16x16x32_bf16 v[212:215], v[84:87], v[120:123], v[212:215]
  v_mfma_f32_16x16x32_bf16 v[204:207], v[84:87], v[116:119], v[204:207]
  v_mfma_f32_16x16x32_bf16 v[196:199], v[84:87], v[112:115], v[196:199]
  s_waitcnt vmcnt(0) lgkmcnt(0)
  s_barrier
  v_mfma_f32_16x16x32_bf16 v[224:227], v[88:91], v[112:115], v[224:227]
  ds_read_b128 v[80:83], v40 offset:0
  ds_read_b64_tr_b16 v[96:97], v42 offset:0
  v_mfma_f32_16x16x32_bf16 v[232:235], v[88:91], v[116:119], v[232:235]
  ds_read_b64_tr_b16 v[98:99], v42 offset:512
  ds_read_b64_tr_b16 v[100:101], v43 offset:0
  v_mfma_f32_16x16x32_bf16 v[240:243], v[88:91], v[120:123], v[240:243]
  ds_read_b64_tr_b16 v[102:103], v43 offset:512
  ds_read_b64_tr_b16 v[104:105], v44 offset:0
  v_mfma_f32_16x16x32_bf16 v[248:251], v[88:91], v[124:127], v[248:251]
  ds_read_b64_tr_b16 v[106:107], v44 offset:512
  ds_read_b64_tr_b16 v[108:109], v45 offset:0
  v_mfma_f32_16x16x32_bf16 v[252:255], v[92:95], v[124:127], v[252:255]
  ds_read_b64_tr_b16 v[110:111], v45 offset:512
  ds_read_b128 v[84:87], v40 offset:2048
  v_mfma_f32_16x16x32_bf16 v[244:247], v[92:95], v[120:123], v[244:247]
  v_mfma_f32_16x16x32_bf16 v[236:239], v[92:95], v[116:119], v[236:239]
  v_mfma_f32_16x16x32_bf16 v[228:231], v[92:95], v[112:115], v[228:231]
  s_waitcnt lgkmcnt(7)
  v_mfma_f32_16x16x32_bf16 v[128:131], v[80:83], v[96:99], v[128:131]
  ds_read_b128 v[88:91], v40 offset:4096
  s_add_u32 m0, s64, 32768
  s_waitcnt lgkmcnt(6)
  v_mfma_f32_16x16x32_bf16 v[136:139], v[80:83], v[100:103], v[136:139]
  buffer_load_dwordx4 v32, s[4:7], s65 offen offset:0 lds
  s_waitcnt lgkmcnt(4)
  v_mfma_f32_16x16x32_bf16 v[144:147], v[80:83], v[104:107], v[144:147]
  s_waitcnt lgkmcnt(2)
  v_mfma_f32_16x16x32_bf16 v[152:155], v[80:83], v[108:111], v[152:155]
  buffer_load_dwordx4 v33, s[4:7], s65 offen offset:1024 lds
  s_waitcnt lgkmcnt(1)
  v_mfma_f32_16x16x32_bf16 v[156:159], v[84:87], v[108:111], v[156:159]
  ds_read_b128 v[92:95], v40 offset:6144
  v_mfma_f32_16x16x32_bf16 v[148:151], v[84:87], v[104:107], v[148:151]
  buffer_load_dwordx4 v34, s[4:7], s65 offen offset:2048 lds
  v_mfma_f32_16x16x32_bf16 v[140:143], v[84:87], v[100:103], v[140:143]
  v_mfma_f32_16x16x32_bf16 v[132:135], v[84:87], v[96:99], v[132:135]
  buffer_load_dwordx4 v35, s[4:7], s65 offen offset:3072 lds
  s_add_u32 s65, s65, 32768
  s_add_u32 m0, s64, 36864
  s_waitcnt lgkmcnt(1)
  v_mfma_f32_16x16x32_bf16 v[160:163], v[88:91], v[96:99], v[160:163]
  ds_read_b128 v[80:83], v40 offset:8192
  v_mfma_f32_16x16x32_bf16 v[168:171], v[88:91], v[100:103], v[168:171]
  ds_read_b64_tr_b16 v[112:113], v42 offset:4096
  buffer_load_dwordx4 v32, s[4:7], s65 offen offset:0 lds
  v_mfma_f32_16x16x32_bf16 v[176:179], v[88:91], v[104:107], v[176:179]
  v_mfma_f32_16x16x32_bf16 v[184:187], v[88:91], v[108:111], v[184:187]
  ds_read_b64_tr_b16 v[114:115], v42 offset:4608
  buffer_load_dwordx4 v33, s[4:7], s65 offen offset:1024 lds
  s_waitcnt lgkmcnt(3)
  v_mfma_f32_16x16x32_bf16 v[188:191], v[92:95], v[108:111], v[188:191]
  ds_read_b128 v[84:87], v40 offset:10240
  v_mfma_f32_16x16x32_bf16 v[180:183], v[92:95], v[104:107], v[180:183]
  ds_read_b64_tr_b16 v[116:117], v43 offset:4096
  buffer_load_dwordx4 v34, s[4:7], s65 offen offset:2048 lds
  v_mfma_f32_16x16x32_bf16 v[172:175], v[92:95], v[100:103], v[172:175]
  v_mfma_f32_16x16x32_bf16 v[164:167], v[92:95], v[96:99], v[164:167]
  ds_read_b64_tr_b16 v[118:119], v43 offset:4608
  buffer_load_dwordx4 v35, s[4:7], s65 offen offset:3072 lds
  s_sub_u32 s65, s65, 32640
  s_add_u32 m0, s64, 98304
  s_waitcnt lgkmcnt(5)
  v_mfma_f32_16x16x32_bf16 v[192:195], v[80:83], v[96:99], v[192:195]
  ds_read_b128 v[88:91], v40 offset:12288
  v_mfma_f32_16x16x32_bf16 v[200:203], v[80:83], v[100:103], v[200:203]
  ds_read_b64_tr_b16 v[120:121], v44 offset:4096
  buffer_load_dwordx4 v36, s[8:11], s66 offen offset:0 lds
  v_mfma_f32_16x16x32_bf16 v[208:211], v[80:83], v[104:107], v[208:211]
  v_mfma_f32_16x16x32_bf16 v[216:219], v[80:83], v[108:111], v[216:219]
  ds_read_b64_tr_b16 v[122:123], v44 offset:4608
  buffer_load_dwordx4 v37, s[8:11], s66 offen offset:1024 lds
  s_waitcnt lgkmcnt(5)
  v_mfma_f32_16x16x32_bf16 v[220:223], v[84:87], v[108:111], v[220:223]
  ds_read_b128 v[92:95], v40 offset:14336
  v_mfma_f32_16x16x32_bf16 v[212:215], v[84:87], v[104:107], v[212:215]
  ds_read_b64_tr_b16 v[124:125], v45 offset:4096
  buffer_load_dwordx4 v38, s[8:11], s66 offen offset:2048 lds
  v_mfma_f32_16x16x32_bf16 v[204:207], v[84:87], v[100:103], v[204:207]
  v_mfma_f32_16x16x32_bf16 v[196:199], v[84:87], v[96:99], v[196:199]
  ds_read_b64_tr_b16 v[126:127], v45 offset:4608
  buffer_load_dwordx4 v39, s[8:11], s66 offen offset:3072 lds
  s_add_u32 s66, s66, 262144
  s_add_u32 m0, s64, 102400
  s_waitcnt lgkmcnt(5)
  v_mfma_f32_16x16x32_bf16 v[224:227], v[88:91], v[96:99], v[224:227]
  ds_read_b128 v[80:83], v41 offset:0
  v_mfma_f32_16x16x32_bf16 v[232:235], v[88:91], v[100:103], v[232:235]
  buffer_load_dwordx4 v36, s[8:11], s66 offen offset:0 lds
  v_mfma_f32_16x16x32_bf16 v[240:243], v[88:91], v[104:107], v[240:243]
  v_mfma_f32_16x16x32_bf16 v[248:251], v[88:91], v[108:111], v[248:251]
  buffer_load_dwordx4 v37, s[8:11], s66 offen offset:1024 lds
  s_waitcnt lgkmcnt(3)
  v_mfma_f32_16x16x32_bf16 v[252:255], v[92:95], v[108:111], v[252:255]
  ds_read_b128 v[84:87], v41 offset:2048
  v_mfma_f32_16x16x32_bf16 v[244:247], v[92:95], v[104:107], v[244:247]
  buffer_load_dwordx4 v38, s[8:11], s66 offen offset:2048 lds
  v_mfma_f32_16x16x32_bf16 v[236:239], v[92:95], v[100:103], v[236:239]
  v_mfma_f32_16x16x32_bf16 v[228:231], v[92:95], v[96:99], v[228:231]
  buffer_load_dwordx4 v39, s[8:11], s66 offen offset:3072 lds
  s_add_u32 s66, s66, 262144
  s_waitcnt lgkmcnt(1)
  v_mfma_f32_16x16x32_bf16 v[128:131], v[80:83], v[112:115], v[128:131]
  ds_read_b128 v[88:91], v41 offset:4096
  v_mfma_f32_16x16x32_bf16 v[136:139], v[80:83], v[116:119], v[136:139]
  v_mfma_f32_16x16x32_bf16 v[144:147], v[80:83], v[120:123], v[144:147]
  v_mfma_f32_16x16x32_bf16 v[152:155], v[80:83], v[124:127], v[152:155]
  s_waitcnt lgkmcnt(1)
  v_mfma_f32_16x16x32_bf16 v[156:159], v[84:87], v[124:127], v[156:159]
  ds_read_b128 v[92:95], v41 offset:6144
  v_mfma_f32_16x16x32_bf16 v[148:151], v[84:87], v[120:123], v[148:151]
  v_mfma_f32_16x16x32_bf16 v[140:143], v[84:87], v[116:119], v[140:143]
  v_mfma_f32_16x16x32_bf16 v[132:135], v[84:87], v[112:115], v[132:135]
  s_waitcnt lgkmcnt(1)
  v_mfma_f32_16x16x32_bf16 v[160:163], v[88:91], v[112:115], v[160:163]
  ds_read_b128 v[80:83], v41 offset:8192
  v_mfma_f32_16x16x32_bf16 v[168:171], v[88:91], v[116:119], v[168:171]
  v_mfma_f32_16x16x32_bf16 v[176:179], v[88:91], v[120:123], v[176:179]
  v_mfma_f32_16x16x32_bf16 v[184:187], v[88:91], v[124:127], v[184:187]
  s_waitcnt lgkmcnt(1)
  v_mfma_f32_16x16x32_bf16 v[188:191], v[92:95], v[124:127], v[188:191]
  ds_read_b128 v[84:87], v41 offset:10240
  v_mfma_f32_16x16x32_bf16 v[180:183], v[92:95], v[120:123], v[180:183]
  v_mfma_f32_16x16x32_bf16 v[172:175], v[92:95], v[116:119], v[172:175]
  v_mfma_f32_16x16x32_bf16 v[164:167], v[92:95], v[112:115], v[164:167]
  s_waitcnt lgkmcnt(1)
  v_mfma_f32_16x16x32_bf16 v[192:195], v[80:83], v[112:115], v[192:195]
  ds_read_b128 v[88:91], v41 offset:12288
  v_mfma_f32_16x16x32_bf16 v[200:203], v[80:83], v[116:119], v[200:203]
  v_mfma_f32_16x16x32_bf16 v[208:211], v[80:83], v[120:123], v[208:211]
  v_mfma_f32_16x16x32_bf16 v[216:219], v[80:83], v[124:127], v[216:219]
  s_waitcnt lgkmcnt(1)
  v_mfma_f32_16x16x32_bf16 v[220:223], v[84:87], v[124:127], v[220:223]
  ds_read_b128 v[92:95], v41 offset:14336
  v_mfma_f32_16x16x32_bf16 v[212:215], v[84:87], v[120:123], v[212:215]
  v_mfma_f32_16x16x32_bf16 v[204:207], v[84:87], v[116:119], v[204:207]
  v_mfma_f32_16x16x32_bf16 v[196:199], v[84:87], v[112:115], v[196:199]
  s_waitcnt vmcnt(0) lgkmcnt(0)
  s_barrier
  v_mfma_f32_16x16x32_bf16 v[224:227], v[88:91], v[112:115], v[224:227]
  ds_read_b128 v[80:83], v40 offset:32768
  ds_read_b64_tr_b16 v[96:97], v42 offset:32768
  v_mfma_f32_16x16x32_bf16 v[232:235], v[88:91], v[116:119], v[232:235]
  ds_read_b64_tr_b16 v[98:99], v42 offset:33280
  ds_read_b64_tr_b16 v[100:101], v43 offset:32768
  v_mfma_f32_16x16x32_bf16 v[240:243], v[88:91], v[120:123], v[240:243]
  ds_read_b64_tr_b16 v[102:103], v43 offset:33280
  ds_read_b64_tr_b16 v[104:105], v44 offset:32768
  v_mfma_f32_16x16x32_bf16 v[248:251], v[88:91], v[124:127], v[248:251]
  ds_read_b64_tr_b16 v[106:107], v44 offset:33280
  ds_read_b64_tr_b16 v[108:109], v45 offset:32768
  v_mfma_f32_16x16x32_bf16 v[252:255], v[92:95], v[124:127], v[252:255]
  ds_read_b64_tr_b16 v[110:111], v45 offset:33280
  ds_read_b128 v[84:87], v40 offset:34816
  v_mfma_f32_16x16x32_bf16 v[244:247], v[92:95], v[120:123], v[244:247]
  v_mfma_f32_16x16x32_bf16 v[236:239], v[92:95], v[116:119], v[236:239]
  v_mfma_f32_16x16x32_bf16 v[228:231], v[92:95], v[112:115], v[228:231]
  s_waitcnt lgkmcnt(7)
  v_mfma_f32_16x16x32_bf16 v[128:131], v[80:83], v[96:99], v[128:131]
  ds_read_b128 v[88:91], v40 offset:36864
  s_add_u32 m0, s64, 0
  s_waitcnt lgkmcnt(6)
  v_mfma_f32_16x16x32_bf16 v[136:139], v[80:83], v[100:103], v[136:139]
  buffer_load_dwordx4 v32, s[4:7], s65 offen offset:0 lds
  s_waitcnt lgkmcnt(4)
  v_mfma_f32_16x16x32_bf16 v[144:147], v[80:83], v[104:107], v[144:147]
  s_waitcnt lgkmcnt(2)
  v_mfma_f32_16x16x32_bf16 v[152:155], v[80:83], v[108:111], v[152:155]
  buffer_load_dwordx4 v33, s[4:7], s65 offen offset:1024 lds
  s_waitcnt lgkmcnt(1)
  v_mfma_f32_16x16x32_bf16 v[156:159], v[84:87], v[108:111], v[156:159]
  ds_read_b128 v[92:95], v40 offset:38912
  v_mfma_f32_16x16x32_bf16 v[148:151], v[84:87], v[104:107], v[148:151]
  buffer_load_dwordx4 v34, s[4:7], s65 offen offset:2048 lds
  v_mfma_f32_16x16x32_bf16 v[140:143], v[84:87], v[100:103], v[140:143]
  v_mfma_f32_16x16x32_bf16 v[132:135], v[84:87], v[96:99], v[132:135]
  buffer_load_dwordx4 v35, s[4:7], s65 offen offset:3072 lds
  s_add_u32 s65, s65, 32768
  s_add_u32 m0, s64, 4096
  s_waitcnt lgkmcnt(1)
  v_mfma_f32_16x16x32_bf16 v[160:163], v[88:91], v[96:99], v[160:163]
  ds_read_b128 v[80:83], v40 offset:40960
  v_mfma_f32_16x16x32_bf16 v[168:171], v[88:91], v[100:103], v[168:171]
  ds_read_b64_tr_b16 v[112:113], v42 offset:36864
  buffer_load_dwordx4 v32, s[4:7], s65 offen offset:0 lds
  v_mfma_f32_16x16x32_bf16 v[176:179], v[88:91], v[104:107], v[176:179]
  v_mfma_f32_16x16x32_bf16 v[184:187], v[88:91], v[108:111], v[184:187]
  ds_read_b64_tr_b16 v[114:115], v42 offset:37376
  buffer_load_dwordx4 v33, s[4:7], s65 offen offset:1024 lds
  s_waitcnt lgkmcnt(3)
  v_mfma_f32_16x16x32_bf16 v[188:191], v[92:95], v[108:111], v[188:191]
  ds_read_b128 v[84:87], v40 offset:43008
  v_mfma_f32_16x16x32_bf16 v[180:183], v[92:95], v[104:107], v[180:183]
  ds_read_b64_tr_b16 v[116:117], v43 offset:36864
  buffer_load_dwordx4 v34, s[4:7], s65 offen offset:2048 lds
  v_mfma_f32_16x16x32_bf16 v[172:175], v[92:95], v[100:103], v[172:175]
  v_mfma_f32_16x16x32_bf16 v[164:167], v[92:95], v[96:99], v[164:167]
  ds_read_b64_tr_b16 v[118:119], v43 offset:37376
  buffer_load_dwordx4 v35, s[4:7], s65 offen offset:3072 lds
  s_sub_u32 s65, s65, 32640
  s_add_u32 m0, s64, 65536
  s_waitcnt lgkmcnt(5)
  v_mfma_f32_16x16x32_bf16 v[192:195], v[80:83], v[96:99], v[192:195]
  ds_read_b128 v[88:91], v40 offset:45056
  v_mfma_f32_16x16x32_bf16 v[200:203], v[80:83], v[100:103], v[200:203]
  ds_read_b64_tr_b16 v[120:121], v44 offset:36864
  buffer_load_dwordx4 v36, s[8:11], s66 offen offset:0 lds
  v_mfma_f32_16x16x32_bf16 v[208:211], v[80:83], v[104:107], v[208:211]
  v_mfma_f32_16x16x32_bf16 v[216:219], v[80:83], v[108:111], v[216:219]
  ds_read_b64_tr_b16 v[122:123], v44 offset:37376
  buffer_load_dwordx4 v37, s[8:11], s66 offen offset:1024 lds
  s_waitcnt lgkmcnt(5)
  v_mfma_f32_16x16x32_bf16 v[220:223], v[84:87], v[108:111], v[220:223]
  ds_read_b128 v[92:95], v40 offset:47104
  v_mfma_f32_16x16x32_bf16 v[212:215], v[84:87], v[104:107], v[212:215]
  ds_read_b64_tr_b16 v[124:125], v45 offset:36864
  buffer_load_dwordx4 v38, s[8:11], s66 offen offset:2048 lds
  v_mfma_f32_16x16x32_bf16 v[204:207], v[84:87], v[100:103], v[204:207]
  v_mfma_f32_16x16x32_bf16 v[196:199], v[84:87], v[96:99], v[196:199]
  ds_read_b64_tr_b16 v[126:127], v45 offset:37376
  buffer_load_dwordx4 v39, s[8:11], s66 offen offset:3072 lds
  s_add_u32 s66, s66, 262144
  s_add_u32 m0, s64, 69632
  s_waitcnt lgkmcnt(5)
  v_mfma_f32_16x16x32_bf16 v[224:227], v[88:91], v[96:99], v[224:227]
  ds_read_b128 v[80:83], v41 offset:32768
  v_mfma_f32_16x16x32_bf16 v[232:235], v[88:91], v[100:103], v[232:235]
  buffer_load_dwordx4 v36, s[8:11], s66 offen offset:0 lds
  v_mfma_f32_16x16x32_bf16 v[240:243], v[88:91], v[104:107], v[240:243]
  v_mfma_f32_16x16x32_bf16 v[248:251], v[88:91], v[108:111], v[248:251]
  buffer_load_dwordx4 v37, s[8:11], s66 offen offset:1024 lds
  s_waitcnt lgkmcnt(3)
  v_mfma_f32_16x16x32_bf16 v[252:255], v[92:95], v[108:111], v[252:255]
  ds_read_b128 v[84:87], v41 offset:34816
  v_mfma_f32_16x16x32_bf16 v[244:247], v[92:95], v[104:107], v[244:247]
  buffer_load_dwordx4 v38, s[8:11], s66 offen offset:2048 lds
  v_mfma_f32_16x16x32_bf16 v[236:239], v[92:95], v[100:103], v[236:239]
  v_mfma_f32_16x16x32_bf16 v[228:231], v[92:95], v[96:99], v[228:231]
  buffer_load_dwordx4 v39, s[8:11], s66 offen offset:3072 lds
  s_add_u32 s66, s66, 262144
  s_waitcnt lgkmcnt(1)
  v_mfma_f32_16x16x32_bf16 v[128:131], v[80:83], v[112:115], v[128:131]
  ds_read_b128 v[88:91], v41 offset:36864
  v_mfma_f32_16x16x32_bf16 v[136:139], v[80:83], v[116:119], v[136:139]
  v_mfma_f32_16x16x32_bf16 v[144:147], v[80:83], v[120:123], v[144:147]
  v_mfma_f32_16x16x32_bf16 v[152:155], v[80:83], v[124:127], v[152:155]
  s_waitcnt lgkmcnt(1)
  v_mfma_f32_16x16x32_bf16 v[156:159], v[84:87], v[124:127], v[156:159]
  ds_read_b128 v[92:95], v41 offset:38912
  v_mfma_f32_16x16x32_bf16 v[148:151], v[84:87], v[120:123], v[148:151]
  v_mfma_f32_16x16x32_bf16 v[140:143], v[84:87], v[116:119], v[140:143]
  v_mfma_f32_16x16x32_bf16 v[132:135], v[84:87], v[112:115], v[132:135]
  s_waitcnt lgkmcnt(1)
  v_mfma_f32_16x16x32_bf16 v[160:163], v[88:91], v[112:115], v[160:163]
  ds_read_b128 v[80:83], v41 offset:40960
  v_mfma_f32_16x16x32_bf16 v[168:171], v[88:91], v[116:119], v[168:171]
  v_mfma_f32_16x16x32_bf16 v[176:179], v[88:91], v[120:123], v[176:179]
  v_mfma_f32_16x16x32_bf16 v[184:187], v[88:91], v[124:127], v[184:187]
  s_waitcnt lgkmcnt(1)
  v_mfma_f32_16x16x32_bf16 v[188:191], v[92:95], v[124:127], v[188:191]
  ds_read_b128 v[84:87], v41 offset:43008
  v_mfma_f32_16x16x32_bf16 v[180:183], v[92:95], v[120:123], v[180:183]
  v_mfma_f32_16x16x32_bf16 v[172:175], v[92:95], v[116:119], v[172:175]
  v_mfma_f32_16x16x32_bf16 v[164:167], v[92:95], v[112:115], v[164:167]
  s_waitcnt lgkmcnt(1)
  v_mfma_f32_16x16x32_bf16 v[192:195], v[80:83], v[112:115], v[192:195]
  ds_read_b128 v[88:91], v41 offset:45056
  v_mfma_f32_16x16x32_bf16 v[200:203], v[80:83], v[116:119], v[200:203]
  v_mfma_f32_16x16x32_bf16 v[208:211], v[80:83], v[120:123], v[208:211]
  v_mfma_f32_16x16x32_bf16 v[216:219], v[80:83], v[124:127], v[216:219]
  s_waitcnt lgkmcnt(1)
  v_mfma_f32_16x16x32_bf16 v[220:223], v[84:87], v[124:127], v[220:223]
  ds_read_b128 v[92:95], v41 offset:47104
  v_mfma_f32_16x16x32_bf16 v[212:215], v[84:87], v[120:123], v[212:215]
  v_mfma_f32_16x16x32_bf16 v[204:207], v[84:87], v[116:119], v[204:207]
  v_mfma_f32_16x16x32_bf16 v[196:199], v[84:87], v[112:115], v[196:199]
  s_waitcnt vmcnt(0) lgkmcnt(0)
  s_barrier
  v_mfma_f32_16x16x32_bf16 v[224:227], v[88:91], v[112:115], v[224:227]
  ds_read_b128 v[80:83], v40 offset:0
  ds_read_b64_tr_b16 v[96:97], v42 offset:0
  v_mfma_f32_16x16x32_bf16 v[232:235], v[88:91], v[116:119], v[232:235]
  ds_read_b64_tr_b16 v[98:99], v42 offset:512
  ds_read_b64_tr_b16 v[100:101], v43 offset:0
  v_mfma_f32_16x16x32_bf16 v[240:243], v[88:91], v[120:123], v[240:243]
  ds_read_b64_tr_b16 v[102:103], v43 offset:512
  ds_read_b64_tr_b16 v[104:105], v44 offset:0
  v_mfma_f32_16x16x32_bf16 v[248:251], v[88:91], v[124:127], v[248:251]
  ds_read_b64_tr_b16 v[106:107], v44 offset:512
  ds_read_b64_tr_b16 v[108:109], v45 offset:0
  v_mfma_f32_16x16x32_bf16 v[252:255], v[92:95], v[124:127], v[252:255]
  ds_read_b64_tr_b16 v[110:111], v45 offset:512
  ds_read_b128 v[84:87], v40 offset:2048
  v_mfma_f32_16x16x32_bf16 v[244:247], v[92:95], v[120:123], v[244:247]
  v_mfma_f32_16x16x32_bf16 v[236:239], v[92:95], v[116:119], v[236:239]
  v_mfma_f32_16x16x32_bf16 v[228:231], v[92:95], v[112:115], v[228:231]
  s_waitcnt lgkmcnt(7)
  v_mfma_f32_16x16x32_bf16 v[128:131], v[80:83], v[96:99], v[128:131]
  ds_read_b128 v[88:91], v40 offset:4096
  s_add_u32 m0, s64, 32768
  s_waitcnt lgkmcnt(6)
  v_mfma_f32_16x16x32_bf16 v[136:139], v[80:83], v[100:103], v[136:139]
  buffer_load_dwordx4 v32, s[4:7], s65 offen offset:0 lds
  s_waitcnt lgkmcnt(4)
  v_mfma_f32_16x16x32_bf16 v[144:147], v[80:83], v[104:107], v[144:147]
  s_waitcnt lgkmcnt(2)
  v_mfma_f32_16x16x32_bf16 v[152:155], v[80:83], v[108:111], v[152:155]
  buffer_load_dwordx4 v33, s[4:7], s65 offen offset:1024 lds
  s_waitcnt lgkmcnt(1)
  v_mfma_f32_16x16x32_bf16 v[156:159], v[84:87], v[108:111], v[156:159]
  ds_read_b128 v[92:95], v40 offset:6144
  v_mfma_f32_16x16x32_bf16 v[148:151], v[84:87], v[104:107], v[148:151]
  buffer_load_dwordx4 v34, s[4:7], s65 offen offset:2048 lds
  v_mfma_f32_16x16x32_bf16 v[140:143], v[84:87], v[100:103], v[140:143]
  v_mfma_f32_16x16x32_bf16 v[132:135], v[84:87], v[96:99], v[132:135]
  buffer_load_dwordx4 v35, s[4:7], s65 offen offset:3072 lds
  s_add_u32 s65, s65, 32768
  s_add_u32 m0, s64, 36864
  s_waitcnt lgkmcnt(1)
  v_mfma_f32_16x16x32_bf16 v[160:163], v[88:91], v[96:99], v[160:163]
  ds_read_b128 v[80:83], v40 offset:8192
  v_mfma_f32_16x16x32_bf16 v[168:171], v[88:91], v[100:103], v[168:171]
  ds_read_b64_tr_b16 v[112:113], v42 offset:4096
  buffer_load_dwordx4 v32, s[4:7], s65 offen offset:0 lds
  v_mfma_f32_16x16x32_bf16 v[176:179], v[88:91], v[104:107], v[176:179]
  v_mfma_f32_16x16x32_bf16 v[184:187], v[88:91], v[108:111], v[184:187]
  ds_read_b64_tr_b16 v[114:115], v42 offset:4608
  buffer_load_dwordx4 v33, s[4:7], s65 offen offset:1024 lds
  s_waitcnt lgkmcnt(3)
  v_mfma_f32_16x16x32_bf16 v[188:191], v[92:95], v[108:111], v[188:191]
  ds_read_b128 v[84:87], v40 offset:10240
  v_mfma_f32_16x16x32_bf16 v[180:183], v[92:95], v[104:107], v[180:183]
  ds_read_b64_tr_b16 v[116:117], v43 offset:4096
  buffer_load_dwordx4 v34, s[4:7], s65 offen offset:2048 lds
  v_mfma_f32_16x16x32_bf16 v[172:175], v[92:95], v[100:103], v[172:175]
  v_mfma_f32_16x16x32_bf16 v[164:167], v[92:95], v[96:99], v[164:167]
  ds_read_b64_tr_b16 v[118:119], v43 offset:4608
  buffer_load_dwordx4 v35, s[4:7], s65 offen offset:3072 lds
  s_sub_u32 s65, s65, 32640
  s_add_u32 m0, s64, 98304
  s_waitcnt lgkmcnt(5)
  v_mfma_f32_16x16x32_bf16 v[192:195], v[80:83], v[96:99], v[192:195]
  ds_read_b128 v[88:91], v40 offset:12288
  v_mfma_f32_16x16x32_bf16 v[200:203], v[80:83], v[100:103], v[200:203]
  ds_read_b64_tr_b16 v[120:121], v44 offset:4096
  buffer_load_dwordx4 v36, s[8:11], s66 offen offset:0 lds
  v_mfma_f32_16x16x32_bf16 v[208:211], v[80:83], v[104:107], v[208:211]
  v_mfma_f32_16x16x32_bf16 v[216:219], v[80:83], v[108:111], v[216:219]
  ds_read_b64_tr_b16 v[122:123], v44 offset:4608
  buffer_load_dwordx4 v37, s[8:11], s66 offen offset:1024 lds
  s_waitcnt lgkmcnt(5)
  v_mfma_f32_16x16x32_bf16 v[220:223], v[84:87], v[108:111], v[220:223]
  ds_read_b128 v[92:95], v40 offset:14336
  v_mfma_f32_16x16x32_bf16 v[212:215], v[84:87], v[104:107], v[212:215]
  ds_read_b64_tr_b16 v[124:125], v45 offset:4096
  buffer_load_dwordx4 v38, s[8:11], s66 offen offset:2048 lds
  v_mfma_f32_16x16x32_bf16 v[204:207], v[84:87], v[100:103], v[204:207]
  v_mfma_f32_16x16x32_bf16 v[196:199], v[84:87], v[96:99], v[196:199]
  ds_read_b64_tr_b16 v[126:127], v45 offset:4608
  buffer_load_dwordx4 v39, s[8:11], s66 offen offset:3072 lds
  s_add_u32 s66, s66, 262144
  s_add_u32 m0, s64, 102400
  s_waitcnt lgkmcnt(5)
  v_mfma_f32_16x16x32_bf16 v[224:227], v[88:91], v[96:99], v[224:227]
  ds_read_b128 v[80:83], v41 offset:0
  v_mfma_f32_16x16x32_bf16 v[232:235], v[88:91], v[100:103], v[232:235]
  buffer_load_dwordx4 v36, s[8:11], s66 offen offset:0 lds
  v_mfma_f32_16x16x32_bf16 v[240:243], v[88:91], v[104:107], v[240:243]
  v_mfma_f32_16x16x32_bf16 v[248:251], v[88:91], v[108:111], v[248:251]
  buffer_load_dwordx4 v37, s[8:11], s66 offen offset:1024 lds
  s_waitcnt lgkmcnt(3)
  v_mfma_f32_16x16x32_bf16 v[252:255], v[92:95], v[108:111], v[252:255]
  ds_read_b128 v[84:87], v41 offset:2048
  v_mfma_f32_16x16x32_bf16 v[244:247], v[92:95], v[104:107], v[244:247]
  buffer_load_dwordx4 v38, s[8:11], s66 offen offset:2048 lds
  v_mfma_f32_16x16x32_bf16 v[236:239], v[92:95], v[100:103], v[236:239]
  v_mfma_f32_16x16x32_bf16 v[228:231], v[92:95], v[96:99], v[228:231]
  buffer_load_dwordx4 v39, s[8:11], s66 offen offset:3072 lds
  s_add_u32 s66, s66, 262144
  s_waitcnt lgkmcnt(1)
  v_mfma_f32_16x16x32_bf16 v[128:131], v[80:83], v[112:115], v[128:131]
  ds_read_b128 v[88:91], v41 offset:4096
  v_mfma_f32_16x16x32_bf16 v[136:139], v[80:83], v[116:119], v[136:139]
  v_mfma_f32_16x16x32_bf16 v[144:147], v[80:83], v[120:123], v[144:147]
  v_mfma_f32_16x16x32_bf16 v[152:155], v[80:83], v[124:127], v[152:155]
  s_waitcnt lgkmcnt(1)
  v_mfma_f32_16x16x32_bf16 v[156:159], v[84:87], v[124:127], v[156:159]
  ds_read_b128 v[92:95], v41 offset:6144
  v_mfma_f32_16x16x32_bf16 v[148:151], v[84:87], v[120:123], v[148:151]
  v_mfma_f32_16x16x32_bf16 v[140:143], v[84:87], v[116:119], v[140:143]
  v_mfma_f32_16x16x32_bf16 v[132:135], v[84:87], v[112:115], v[132:135]
  s_waitcnt lgkmcnt(1)
  v_mfma_f32_16x16x32_bf16 v[160:163], v[88:91], v[112:115], v[160:163]
  ds_read_b128 v[80:83], v41 offset:8192
  v_mfma_f32_16x16x32_bf16 v[168:171], v[88:91], v[116:119], v[168:171]
  v_mfma_f32_16x16x32_bf16 v[176:179], v[88:91], v[120:123], v[176:179]
  v_mfma_f32_16x16x32_bf16 v[184:187], v[88:91], v[124:127], v[184:187]
  s_waitcnt lgkmcnt(1)
  v_mfma_f32_16x16x32_bf16 v[188:191], v[92:95], v[124:127], v[188:191]
  ds_read_b128 v[84:87], v41 offset:10240
  v_mfma_f32_16x16x32_bf16 v[180:183], v[92:95], v[120:123], v[180:183]
  v_mfma_f32_16x16x32_bf16 v[172:175], v[92:95], v[116:119], v[172:175]
  v_mfma_f32_16x16x32_bf16 v[164:167], v[92:95], v[112:115], v[164:167]
  s_waitcnt lgkmcnt(1)
  v_mfma_f32_16x16x32_bf16 v[192:195], v[80:83], v[112:115], v[192:195]
  ds_read_b128 v[88:91], v41 offset:12288
  v_mfma_f32_16x16x32_bf16 v[200:203], v[80:83], v[116:119], v[200:203]
  v_mfma_f32_16x16x32_bf16 v[208:211], v[80:83], v[120:123], v[208:211]
  v_mfma_f32_16x16x32_bf16 v[216:219], v[80:83], v[124:127], v[216:219]
  s_waitcnt lgkmcnt(1)
  v_mfma_f32_16x16x32_bf16 v[220:223], v[84:87], v[124:127], v[220:223]
  ds_read_b128 v[92:95], v41 offset:14336
  v_mfma_f32_16x16x32_bf16 v[212:215], v[84:87], v[120:123], v[212:215]
  v_mfma_f32_16x16x32_bf16 v[204:207], v[84:87], v[116:119], v[204:207]
  v_mfma_f32_16x16x32_bf16 v[196:199], v[84:87], v[112:115], v[196:199]
  s_waitcnt vmcnt(0) lgkmcnt(0)
  s_barrier
  v_mfma_f32_16x16x32_bf16 v[224:227], v[88:91], v[112:115], v[224:227]
  ds_read_b128 v[80:83], v40 offset:32768
  ds_read_b64_tr_b16 v[96:97], v42 offset:32768
  v_mfma_f32_16x16x32_bf16 v[232:235], v[88:91], v[116:119], v[232:235]
  ds_read_b64_tr_b16 v[98:99], v42 offset:33280
  ds_read_b64_tr_b16 v[100:101], v43 offset:32768
  v_mfma_f32_16x16x32_bf16 v[240:243], v[88:91], v[120:123], v[240:243]
  ds_read_b64_tr_b16 v[102:103], v43 offset:33280
  ds_read_b64_tr_b16 v[104:105], v44 offset:32768
  v_mfma_f32_16x16x32_bf16 v[248:251], v[88:91], v[124:127], v[248:251]
  ds_read_b64_tr_b16 v[106:107], v44 offset:33280
  ds_read_b64_tr_b16 v[108:109], v45 offset:32768
  v_mfma_f32_16x16x32_bf16 v[252:255], v[92:95], v[124:127], v[252:255]
  ds_read_b64_tr_b16 v[110:111], v45 offset:33280
  ds_read_b128 v[84:87], v40 offset:34816
  v_mfma_f32_16x16x32_bf16 v[244:247], v[92:95], v[120:123], v[244:247]
  v_mfma_f32_16x16x32_bf16 v[236:239], v[92:95], v[116:119], v[236:239]
  v_mfma_f32_16x16x32_bf16 v[228:231], v[92:95], v[112:115], v[228:231]
  s_waitcnt lgkmcnt(7)
  v_mfma_f32_16x16x32_bf16 v[128:131], v[80:83], v[96:99], v[128:131]
  ds_read_b128 v[88:91], v40 offset:36864
  s_add_u32 m0, s64, 0
  s_waitcnt lgkmcnt(6)
  v_mfma_f32_16x16x32_bf16 v[136:139], v[80:83], v[100:103], v[136:139]
  buffer_load_dwordx4 v2, s[16:19], s67 offen offset:0 lds
  s_waitcnt lgkmcnt(4)
  v_mfma_f32_16x16x32_bf16 v[144:147], v[80:83], v[104:107], v[144:147]
  s_waitcnt lgkmcnt(2)
  v_mfma_f32_16x16x32_bf16 v[152:155], v[80:83], v[108:111], v[152:155]
  buffer_load_dwordx4 v3, s[16:19], s67 offen offset:1024 lds
  s_waitcnt lgkmcnt(1)
  v_mfma_f32_16x16x32_bf16 v[156:159], v[84:87], v[108:111], v[156:159]
  ds_read_b128 v[92:95], v40 offset:38912
  v_mfma_f32_16x16x32_bf16 v[148:151], v[84:87], v[104:107], v[148:151]
  buffer_load_dwordx4 v4, s[16:19], s67 offen offset:2048 lds
  v_mfma_f32_16x16x32_bf16 v[140:143], v[84:87], v[100:103], v[140:143]
  v_mfma_f32_16x16x32_bf16 v[132:135], v[84:87], v[96:99], v[132:135]
  buffer_load_dwordx4 v5, s[16:19], s67 offen offset:3072 lds
  s_add_u32 s67, s67, 40960
  s_add_u32 m0, s64, 4096
  s_waitcnt lgkmcnt(1)
  v_mfma_f32_16x16x32_bf16 v[160:163], v[88:91], v[96:99], v[160:163]
  ds_read_b128 v[80:83], v40 offset:40960
  v_mfma_f32_16x16x32_bf16 v[168:171], v[88:91], v[100:103], v[168:171]
  ds_read_b64_tr_b16 v[112:113], v42 offset:36864
  buffer_load_dwordx4 v2, s[16:19], s67 offen offset:0 lds
  v_mfma_f32_16x16x32_bf16 v[176:179], v[88:91], v[104:107], v[176:179]
  v_mfma_f32_16x16x32_bf16 v[184:187], v[88:91], v[108:111], v[184:187]
  ds_read_b64_tr_b16 v[114:115], v42 offset:37376
  buffer_load_dwordx4 v3, s[16:19], s67 offen offset:1024 lds
  s_waitcnt lgkmcnt(3)
  v_mfma_f32_16x16x32_bf16 v[188:191], v[92:95], v[108:111], v[188:191]
  ds_read_b128 v[84:87], v40 offset:43008
  v_mfma_f32_16x16x32_bf16 v[180:183], v[92:95], v[104:107], v[180:183]
  ds_read_b64_tr_b16 v[116:117], v43 offset:36864
  buffer_load_dwordx4 v4, s[16:19], s67 offen offset:2048 lds
  v_mfma_f32_16x16x32_bf16 v[172:175], v[92:95], v[100:103], v[172:175]
  v_mfma_f32_16x16x32_bf16 v[164:167], v[92:95], v[96:99], v[164:167]
  ds_read_b64_tr_b16 v[118:119], v43 offset:37376
  buffer_load_dwordx4 v5, s[16:19], s67 offen offset:3072 lds
  s_sub_u32 s67, s67, 40832
  s_add_u32 m0, s64, 65536
  s_waitcnt lgkmcnt(5)
  v_mfma_f32_16x16x32_bf16 v[192:195], v[80:83], v[96:99], v[192:195]
  ds_read_b128 v[88:91], v40 offset:45056
  v_mfma_f32_16x16x32_bf16 v[200:203], v[80:83], v[100:103], v[200:203]
  ds_read_b64_tr_b16 v[120:121], v44 offset:36864
  buffer_load_dwordx4 v6, s[20:23], s68 offen offset:0 lds
  v_mfma_f32_16x16x32_bf16 v[208:211], v[80:83], v[104:107], v[208:211]
  v_mfma_f32_16x16x32_bf16 v[216:219], v[80:83], v[108:111], v[216:219]
  ds_read_b64_tr_b16 v[122:123], v44 offset:37376
  buffer_load_dwordx4 v7, s[20:23], s68 offen offset:1024 lds
  s_waitcnt lgkmcnt(5)
  v_mfma_f32_16x16x32_bf16 v[220:223], v[84:87], v[108:111], v[220:223]
  ds_read_b128 v[92:95], v40 offset:47104
  v_mfma_f32_16x16x32_bf16 v[212:215], v[84:87], v[104:107], v[212:215]
  ds_read_b64_tr_b16 v[124:125], v45 offset:36864
  buffer_load_dwordx4 v8, s[20:23], s68 offen offset:2048 lds
  v_mfma_f32_16x16x32_bf16 v[204:207], v[84:87], v[100:103], v[204:207]
  v_mfma_f32_16x16x32_bf16 v[196:199], v[84:87], v[96:99], v[196:199]
  ds_read_b64_tr_b16 v[126:127], v45 offset:37376
  buffer_load_dwordx4 v9, s[20:23], s68 offen offset:3072 lds
  s_add_u32 s68, s68, s69
  s_add_u32 m0, s64, 69632
  s_waitcnt lgkmcnt(5)
  v_mfma_f32_16x16x32_bf16 v[224:227], v[88:91], v[96:99], v[224:227]
  ds_read_b128 v[80:83], v41 offset:32768
  v_mfma_f32_16x16x32_bf16 v[232:235], v[88:91], v[100:103], v[232:235]
  buffer_load_dwordx4 v6, s[20:23], s68 offen offset:0 lds
  v_mfma_f32_16x16x32_bf16 v[240:243], v[88:91], v[104:107], v[240:243]
  v_mfma_f32_16x16x32_bf16 v[248:251], v[88:91], v[108:111], v[248:251]
  buffer_load_dwordx4 v7, s[20:23], s68 offen offset:1024 lds
  s_waitcnt lgkmcnt(3)
  v_mfma_f32_16x16x32_bf16 v[252:255], v[92:95], v[108:111], v[252:255]
  ds_read_b128 v[84:87], v41 offset:34816
  v_mfma_f32_16x16x32_bf16 v[244:247], v[92:95], v[104:107], v[244:247]
  buffer_load_dwordx4 v8, s[20:23], s68 offen offset:2048 lds
  v_mfma_f32_16x16x32_bf16 v[236:239], v[92:95], v[100:103], v[236:239]
  v_mfma_f32_16x16x32_bf16 v[228:231], v[92:95], v[96:99], v[228:231]
  buffer_load_dwordx4 v9, s[20:23], s68 offen offset:3072 lds
  s_add_u32 s68, s68, s69
  s_waitcnt lgkmcnt(1)
  v_mfma_f32_16x16x32_bf16 v[128:131], v[80:83], v[112:115], v[128:131]
  ds_read_b128 v[88:91], v41 offset:36864
  v_mfma_f32_16x16x32_bf16 v[136:139], v[80:83], v[116:119], v[136:139]
  v_mfma_f32_16x16x32_bf16 v[144:147], v[80:83], v[120:123], v[144:147]
  v_mfma_f32_16x16x32_bf16 v[152:155], v[80:83], v[124:127], v[152:155]
  s_waitcnt lgkmcnt(1)
  v_mfma_f32_16x16x32_bf16 v[156:159], v[84:87], v[124:127], v[156:159]
  ds_read_b128 v[92:95], v41 offset:38912
  v_mfma_f32_16x16x32_bf16 v[148:151], v[84:87], v[120:123], v[148:151]
  v_mfma_f32_16x16x32_bf16 v[140:143], v[84:87], v[116:119], v[140:143]
  v_mfma_f32_16x16x32_bf16 v[132:135], v[84:87], v[112:115], v[132:135]
  s_waitcnt lgkmcnt(1)
  v_mfma_f32_16x16x32_bf16 v[160:163], v[88:91], v[112:115], v[160:163]
  ds_read_b128 v[80:83], v41 offset:40960
  v_mfma_f32_16x16x32_bf16 v[168:171], v[88:91], v[116:119], v[168:171]
  v_mfma_f32_16x16x32_bf16 v[176:179], v[88:91], v[120:123], v[176:179]
  v_mfma_f32_16x16x32_bf16 v[184:187], v[88:91], v[124:127], v[184:187]
  v_cvt_pk_bf16_f32 v128, v128, v129
  v_cvt_pk_bf16_f32 v129, v130, v131
  s_waitcnt lgkmcnt(1)
  v_mfma_f32_16x16x32_bf16 v[188:191], v[92:95], v[124:127], v[188:191]
  ds_read_b128 v[84:87], v41 offset:43008
  v_cvt_pk_bf16_f32 v130, v132, v133
  v_mfma_f32_16x16x32_bf16 v[180:183], v[92:95], v[120:123], v[180:183]
  v_cvt_pk_bf16_f32 v131, v134, v135
  buffer_store_dwordx4 v[128:131], v16, s[12:15], s70 offen offset:0 sc1
  v_mfma_f32_16x16x32_bf16 v[172:175], v[92:95], v[116:119], v[172:175]
  v_cvt_pk_bf16_f32 v136, v136, v137
  v_cvt_pk_bf16_f32 v137, v138, v139
  v_mfma_f32_16x16x32_bf16 v[164:167], v[92:95], v[112:115], v[164:167]
  v_cvt_pk_bf16_f32 v138, v140, v141
  v_cvt_pk_bf16_f32 v139, v142, v143
  s_waitcnt lgkmcnt(1)
  v_mfma_f32_16x16x32_bf16 v[192:195], v[80:83], v[112:115], v[192:195]
  ds_read_b128 v[88:91], v41 offset:45056
  buffer_store_dwordx4 v[136:139], v16, s[12:15], s70 offen offset:1024 sc1
  s_add_u32 s70, s70, 8192
  v_mfma_f32_16x16x32_bf16 v[200:203], v[80:83], v[116:119], v[200:203]
  v_cvt_pk_bf16_f32 v144, v144, v145
  v_cvt_pk_bf16_f32 v145, v146, v147
  v_mfma_f32_16x16x32_bf16 v[208:211], v[80:83], v[120:123], v[208:211]
  v_cvt_pk_bf16_f32 v146, v148, v149
  v_cvt_pk_bf16_f32 v147, v150, v151
  v_mfma_f32_16x16x32_bf16 v[216:219], v[80:83], v[124:127], v[216:219]
  buffer_store_dwordx4 v[144:147], v16, s[12:15], s71 offen offset:0 sc1
  v_cvt_pk_bf16_f32 v152, v152, v153
  s_waitcnt lgkmcnt(1)
  v_mfma_f32_16x16x32_bf16 v[220:223], v[84:87], v[124:127], v[220:223]
  ds_read_b128 v[92:95], v41 offset:47104
  v_cvt_pk_bf16_f32 v153, v154, v155
  v_mfma_f32_16x16x32_bf16 v[212:215], v[84:87], v[120:123], v[212:215]
  v_cvt_pk_bf16_f32 v154, v156, v157
  v_cvt_pk_bf16_f32 v155, v158, v159
  v_mfma_f32_16x16x32_bf16 v[204:207], v[84:87], v[116:119], v[204:207]
  buffer_store_dwordx4 v[152:155], v16, s[12:15], s71 offen offset:1024 sc1
  s_add_u32 s71, s71, 8192
  v_cvt_pk_bf16_f32 v160, v160, v161
  v_mfma_f32_16x16x32_bf16 v[196:199], v[84:87], v[112:115], v[196:199]
  v_cvt_pk_bf16_f32 v161, v162, v163
  v_cvt_pk_bf16_f32 v162, v164, v165
  s_waitcnt vmcnt(4) lgkmcnt(0)
  s_barrier
  v_mfma_f32_16x16x32_bf16 v[224:227], v[88:91], v[112:115], v[224:227]
  ds_read_b64_tr_b16 v[80:81], v27 offset:0
  ds_read_b64_tr_b16 v[82:83], v27 offset:512
  v_cvt_pk_bf16_f32 v163, v166, v167
  v_mfma_f32_16x16x32_bf16 v[232:235], v[88:91], v[116:119], v[232:235]
  ds_read_b128 v[96:99], v23 offset:0
  ds_read_b128 v[100:103], v23 offset:2048
  v_cvt_pk_bf16_f32 v168, v168, v169
  v_mfma_f32_16x16x32_bf16 v[240:243], v[88:91], v[120:123], v[240:243]
  ds_read_b128 v[104:107], v25 offset:0
  ds_read_b128 v[108:111], v25 offset:2048
  v_cvt_pk_bf16_f32 v169, v170, v171
  v_mfma_f32_16x16x32_bf16 v[248:251], v[88:91], v[124:127], v[248:251]
  ds_read_b64_tr_b16 v[84:85], v28 offset:0
  ds_read_b64_tr_b16 v[86:87], v28 offset:512
  v_cvt_pk_bf16_f32 v170, v172, v173
  v_mfma_f32_16x16x32_bf16 v[252:255], v[92:95], v[124:127], v[252:255]
  v_cvt_pk_bf16_f32 v171, v174, v175
  v_cvt_pk_bf16_f32 v176, v176, v177
  v_mfma_f32_16x16x32_bf16 v[244:247], v[92:95], v[120:123], v[244:247]
  v_cvt_pk_bf16_f32 v177, v178, v179
  v_cvt_pk_bf16_f32 v178, v180, v181
  v_mfma_f32_16x16x32_bf16 v[236:239], v[92:95], v[116:119], v[236:239]
  v_cvt_pk_bf16_f32 v179, v182, v183
  v_cvt_pk_bf16_f32 v184, v184, v185
  v_mfma_f32_16x16x32_bf16 v[228:231], v[92:95], v[112:115], v[228:231]
  v_cvt_pk_bf16_f32 v185, v186, v187
  v_cvt_pk_bf16_f32 v186, v188, v189
  v_cvt_pk_bf16_f32 v187, v190, v191
F_QA:
  s_waitcnt lgkmcnt(5)
  v_mfma_f32_16x16x32_bf16 v[32:35], v[80:83], v[96:99], 0
  ds_read_b64_tr_b16 v[88:89], v29 offset:0
  s_waitcnt lgkmcnt(5)
  v_mfma_f32_16x16x32_bf16 v[36:39], v[80:83], v[100:103], 0
  ds_read_b64_tr_b16 v[90:91], v29 offset:512
  s_waitcnt lgkmcnt(5)
  v_mfma_f32_16x16x32_bf16 v[40:43], v[80:83], v[104:107], 0
  s_waitcnt lgkmcnt(4)
  v_mfma_f32_16x16x32_bf16 v[44:47], v[80:83], v[108:111], 0
  s_waitcnt lgkmcnt(2)
  v_mfma_f32_16x16x32_bf16 v[60:63], v[84:87], v[108:111], 0
  ds_read_b64_tr_b16 v[92:93], v30 offset:0
  v_cvt_pk_bf16_f32 v192, v192, v193
  v_mfma_f32_16x16x32_bf16 v[56:59], v[84:87], v[104:107], 0
  ds_read_b64_tr_b16 v[94:95], v30 offset:512
  v_cvt_pk_bf16_f32 v193, v194, v195
  v_mfma_f32_16x16x32_bf16 v[52:55], v[84:87], v[100:103], 0
  v_cvt_pk_bf16_f32 v194, v196, v197
  v_cvt_pk_bf16_f32 v195, v198, v199
  v_mfma_f32_16x16x32_bf16 v[48:51], v[84:87], v[96:99], 0
  v_cvt_pk_bf16_f32 v200, v200, v201
  v_cvt_pk_bf16_f32 v201, v202, v203
  s_waitcnt lgkmcnt(2)
  v_mfma_f32_16x16x32_bf16 v[64:67], v[88:91], v[96:99], 0
  ds_read_b64_tr_b16 v[80:81], v31 offset:0
  v_cvt_pk_bf16_f32 v202, v204, v205
  v_mfma_f32_16x16x32_bf16 v[68:71], v[88:91], v[100:103], 0
  ds_read_b64_tr_b16 v[82:83], v31 offset:512
  v_cvt_pk_bf16_f32 v203, v206, v207
  v_mfma_f32_16x16x32_bf16 v[72:75], v[88:91], v[104:107], 0
  v_cvt_pk_bf16_f32 v208, v208, v209
  v_cvt_pk_bf16_f32 v209, v210, v211
  v_mfma_f32_16x16x32_bf16 v[76:79], v[88:91], v[108:111], 0
  ds_read_b128 v[112:115], v24 offset:0
  v_cvt_pk_bf16_f32 v210, v212, v213
  s_waitcnt lgkmcnt(3)
  v_mfma_f32_16x16x32_bf16 v[152:155], v[92:95], v[108:111], 0
  ds_read_b64_tr_b16 v[84:85], v14 offset:0
  v_cvt_pk_bf16_f32 v211, v214, v215
  v_mfma_f32_16x16x32_bf16 v[144:147], v[92:95], v[104:107], 0
  ds_read_b64_tr_b16 v[86:87], v14 offset:512
  v_cvt_pk_bf16_f32 v216, v216, v217
  v_mfma_f32_16x16x32_bf16 v[136:139], v[92:95], v[100:103], 0
  v_cvt_pk_bf16_f32 v217, v218, v219
  v_cvt_pk_bf16_f32 v218, v220, v221
  v_mfma_f32_16x16x32_bf16 v[128:131], v[92:95], v[96:99], 0
  ds_read_b128 v[116:119], v24 offset:2048
  v_cvt_pk_bf16_f32 v219, v222, v223
  s_waitcnt lgkmcnt(4)
  v_mfma_f32_16x16x32_bf16 v[132:135], v[80:83], v[96:99], 0
  ds_read_b64_tr_b16 v[88:89], v31 offset:8192
  v_cvt_pk_bf16_f32 v224, v224, v225
  v_mfma_f32_16x16x32_bf16 v[140:143], v[80:83], v[100:103], 0
  ds_read_b64_tr_b16 v[90:91], v31 offset:8704
  v_cvt_pk_bf16_f32 v225, v226, v227
  v_mfma_f32_16x16x32_bf16 v[148:151], v[80:83], v[104:107], 0
  v_cvt_pk_bf16_f32 v226, v228, v229
  v_cvt_pk_bf16_f32 v227, v230, v231
  v_mfma_f32_16x16x32_bf16 v[156:159], v[80:83], v[108:111], 0
  ds_read_b128 v[120:123], v26 offset:0
  v_cvt_pk_bf16_f32 v232, v232, v233
  s_waitcnt lgkmcnt(4)
  v_mfma_f32_16x16x32_bf16 v[188:191], v[84:87], v[108:111], 0
  ds_read_b64_tr_b16 v[92:93], v14 offset:8192
  v_cvt_pk_bf16_f32 v233, v234, v235
  v_mfma_f32_16x16x32_bf16 v[180:183], v[84:87], v[104:107], 0
  ds_read_b64_tr_b16 v[94:95], v14 offset:8704
  v_cvt_pk_bf16_f32 v234, v236, v237
  v_mfma_f32_16x16x32_bf16 v[172:175], v[84:87], v[100:103], 0
  v_cvt_pk_bf16_f32 v235, v238, v239
  v_cvt_pk_bf16_f32 v240, v240, v241
  v_mfma_f32_16x16x32_bf16 v[164:167], v[84:87], v[96:99], 0
  ds_read_b128 v[124:127], v26 offset:2048
  v_cvt_pk_bf16_f32 v241, v242, v243
  s_waitcnt lgkmcnt(4)
  v_mfma_f32_16x16x32_bf16 v[196:199], v[88:91], v[96:99], 0
  ds_read_b64_tr_b16 v[80:81], v27 offset:4096
  v_cvt_pk_bf16_f32 v242, v244, v245
  v_mfma_f32_16x16x32_bf16 v[204:207], v[88:91], v[100:103], 0
  ds_read_b64_tr_b16 v[82:83], v27 offset:4608
  v_cvt_pk_bf16_f32 v243, v246, v247
  v_mfma_f32_16x16x32_bf16 v[212:215], v[88:91], v[104:107], 0
  v_cvt_pk_bf16_f32 v248, v248, v249
  v_cvt_pk_bf16_f32 v249, v250, v251
  v_mfma_f32_16x16x32_bf16 v[220:223], v[88:91], v[108:111], 0
  v_cvt_pk_bf16_f32 v250, v252, v253
  v_cvt_pk_bf16_f32 v251, v254, v255
  s_waitcnt lgkmcnt(3)
  v_mfma_f32_16x16x32_bf16 v[252:255], v[92:95], v[108:111], 0
  ds_read_b64_tr_b16 v[84:85], v28 offset:4096
  s_add_u32 m0, s64, 32768
  v_mfma_f32_16x16x32_bf16 v[244:247], v[92:95], v[104:107], 0
  ds_read_b64_tr_b16 v[86:87], v28 offset:4608
  buffer_load_dwordx4 v2, s[16:19], s67 offen offset:0 lds
  v_mfma_f32_16x16x32_bf16 v[236:239], v[92:95], v[100:103], 0
  buffer_load_dwordx4 v3, s[16:19], s67 offen offset:1024 lds
  v_mfma_f32_16x16x32_bf16 v[228:231], v[92:95], v[96:99], 0
  buffer_load_dwordx4 v4, s[16:19], s67 offen offset:2048 lds
  s_waitcnt lgkmcnt(2)
  v_mfma_f32_16x16x32_bf16 v[32:35], v[80:83], v[112:115], v[32:35]
  ds_read_b64_tr_b16 v[88:89], v29 offset:4096
  buffer_load_dwordx4 v5, s[16:19], s67 offen offset:3072 lds
  s_add_u32 s67, s67, 40960
  s_add_u32 m0, s64, 36864
  v_mfma_f32_16x16x32_bf16 v[36:39], v[80:83], v[116:119], v[36:39]
  ds_read_b64_tr_b16 v[90:91], v29 offset:4608
  buffer_load_dwordx4 v2, s[16:19], s67 offen offset:0 lds
  v_mfma_f32_16x16x32_bf16 v[40:43], v[80:83], v[120:123], v[40:43]
  buffer_load_dwordx4 v3, s[16:19], s67 offen offset:1024 lds
  v_mfma_f32_16x16x32_bf16 v[44:47], v[80:83], v[124:127], v[44:47]
  buffer_load_dwordx4 v4, s[16:19], s67 offen offset:2048 lds
  s_waitcnt lgkmcnt(2)
  v_mfma_f32_16x16x32_bf16 v[60:63], v[84:87], v[124:127], v[60:63]
  ds_read_b64_tr_b16 v[92:93], v30 offset:4096
  buffer_load_dwordx4 v5, s[16:19], s67 offen offset:3072 lds
  s_sub_u32 s67, s67, 40832
  s_add_u32 m0, s64, 98304
  v_mfma_f32_16x16x32_bf16 v[56:59], v[84:87], v[120:123], v[56:59]
  ds_read_b64_tr_b16 v[94:95], v30 offset:4608
  buffer_load_dwordx4 v6, s[20:23], s68 offen offset:0 lds
  v_mfma_f32_16x16x32_bf16 v[52:55], v[84:87], v[116:119], v[52:55]
  buffer_load_dwordx4 v7, s[20:23], s68 offen offset:1024 lds
  v_mfma_f32_16x16x32_bf16 v[48:51], v[84:87], v[112:115], v[48:51]
  buffer_load_dwordx4 v8, s[20:23], s68 offen offset:2048 lds
  s_waitcnt lgkmcnt(2)
  v_mfma_f32_16x16x32_bf16 v[64:67], v[88:91], v[112:115], v[64:67]
  ds_read_b64_tr_b16 v[80:81], v31 offset:4096
  buffer_load_dwordx4 v9, s[20:23], s68 offen offset:3072 lds
  s_add_u32 s68, s68, s69
  s_add_u32 m0, s64, 102400
  v_mfma_f32_16x16x32_bf16 v[68:71], v[88:91], v[116:119], v[68:71]
  ds_read_b64_tr_b16 v[82:83], v31 offset:4608
  buffer_load_dwordx4 v6, s[20:23], s68 offen offset:0 lds
  v_mfma_f32_16x16x32_bf16 v[72:75], v[88:91], v[120:123], v[72:75]
  buffer_load_dwordx4 v7, s[20:23], s68 offen offset:1024 lds
  v_mfma_f32_16x16x32_bf16 v[76:79], v[88:91], v[124:127], v[76:79]
  buffer_load_dwordx4 v8, s[20:23], s68 offen offset:2048 lds
  s_waitcnt lgkmcnt(2)
  v_mfma_f32_16x16x32_bf16 v[152:155], v[92:95], v[124:127], v[152:155]
  ds_read_b64_tr_b16 v[84:85], v14 offset:4096
  buffer_load_dwordx4 v9, s[20:23], s68 offen offset:3072 lds
  s_add_u32 s68, s68, s69
  v_mfma_f32_16x16x32_bf16 v[144:147], v[92:95], v[120:123], v[144:147]
  ds_read_b64_tr_b16 v[86:87], v14 offset:4608
  buffer_store_dwordx4 v[160:163], v16, s[12:15], s70 offen offset:0 sc1
  v_mfma_f32_16x16x32_bf16 v[136:139], v[92:95], v[116:119], v[136:139]
  v_mfma_f32_16x16x32_bf16 v[128:131], v[92:95], v[112:115], v[128:131]
  s_waitcnt lgkmcnt(2)
  v_mfma_f32_16x16x32_bf16 v[132:135], v[80:83], v[112:115], v[132:135]
  ds_read_b64_tr_b16 v[88:89], v31 offset:12288
  v_mfma_f32_16x16x32_bf16 v[140:143], v[80:83], v[116:119], v[140:143]
  ds_read_b64_tr_b16 v[90:91], v31 offset:12800
  v_mfma_f32_16x16x32_bf16 v[148:151], v[80:83], v[120:123], v[148:151]
  v_mfma_f32_16x16x32_bf16 v[156:159], v[80:83], v[124:127], v[156:159]
  s_waitcnt lgkmcnt(2)
  v_mfma_f32_16x16x32_bf16 v[188:191], v[84:87], v[124:127], v[188:191]
  ds_read_b64_tr_b16 v[92:93], v14 offset:12288
  buffer_store_dwordx4 v[168:171], v16, s[12:15], s70 offen offset:1024 sc1
  s_add_u32 s70, s70, 8192
  v_mfma_f32_16x16x32_bf16 v[180:183], v[84:87], v[120:123], v[180:183]
  ds_read_b64_tr_b16 v[94:95], v14 offset:12800
  v_mfma_f32_16x16x32_bf16 v[172:175], v[84:87], v[116:119], v[172:175]
  v_mfma_f32_16x16x32_bf16 v[164:167], v[84:87], v[112:115], v[164:167]
  s_waitcnt vmcnt(2) lgkmcnt(0)
  s_barrier
  v_mfma_f32_16x16x32_bf16 v[196:199], v[88:91], v[112:115], v[196:199]
  ds_read_b64_tr_b16 v[80:81], v27 offset:32768
  ds_read_b64_tr_b16 v[82:83], v27 offset:33280
  v_mfma_f32_16x16x32_bf16 v[204:207], v[88:91], v[116:119], v[204:207]
  ds_read_b128 v[96:99], v23 offset:32768
  ds_read_b128 v[100:103], v23 offset:34816
  v_mfma_f32_16x16x32_bf16 v[212:215], v[88:91], v[120:123], v[212:215]
  ds_read_b128 v[104:107], v25 offset:32768
  ds_read_b128 v[108:111], v25 offset:34816
  v_mfma_f32_16x16x32_bf16 v[220:223], v[88:91], v[124:127], v[220:223]
  ds_read_b64_tr_b16 v[84:85], v28 offset:32768
  ds_read_b64_tr_b16 v[86:87], v28 offset:33280
  v_mfma_f32_16x16x32_bf16 v[252:255], v[92:95], v[124:127], v[252:255]
  v_mfma_f32_16x16x32_bf16 v[244:247], v[92:95], v[120:123], v[244:247]
  v_mfma_f32_16x16x32_bf16 v[236:239], v[92:95], v[116:119], v[236:239]
  v_mfma_f32_16x16x32_bf16 v[228:231], v[92:95], v[112:115], v[228:231]
  s_waitcnt lgkmcnt(5)
  v_mfma_f32_16x16x32_bf16 v[32:35], v[80:83], v[96:99], v[32:35]
  ds_read_b64_tr_b16 v[88:89], v29 offset:32768
  s_add_u32 m0, s64, 0
  s_waitcnt lgkmcnt(5)
  v_mfma_f32_16x16x32_bf16 v[36:39], v[80:83], v[100:103], v[36:39]
  ds_read_b64_tr_b16 v[90:91], v29 offset:33280
  buffer_load_dwordx4 v2, s[16:19], s67 offen offset:0 lds
  s_waitcnt lgkmcnt(5)
  v_mfma_f32_16x16x32_bf16 v[40:43], v[80:83], v[104:107], v[40:43]
  s_waitcnt lgkmcnt(4)
  v_mfma_f32_16x16x32_bf16 v[44:47], v[80:83], v[108:111], v[44:47]
  buffer_load_dwordx4 v3, s[16:19], s67 offen offset:1024 lds
  s_waitcnt lgkmcnt(2)
  v_mfma_f32_16x16x32_bf16 v[60:63], v[84:87], v[108:111], v[60:63]
  ds_read_b64_tr_b16 v[92:93], v30 offset:32768
  v_mfma_f32_16x16x32_bf16 v[56:59], v[84:87], v[104:107], v[56:59]
  ds_read_b64_tr_b16 v[94:95], v30 offset:33280
  buffer_load_dwordx4 v4, s[16:19], s67 offen offset:2048 lds
  v_mfma_f32_16x16x32_bf16 v[52:55], v[84:87], v[100:103], v[52:55]
  v_mfma_f32_16x16x32_bf16 v[48:51], v[84:87], v[96:99], v[48:51]
  buffer_load_dwordx4 v5, s[16:19], s67 offen offset:3072 lds
  s_add_u32 s67, s67, 40960
  s_add_u32 m0, s64, 4096
  s_waitcnt lgkmcnt(2)
  v_mfma_f32_16x16x32_bf16 v[64:67], v[88:91], v[96:99], v[64:67]
  ds_read_b64_tr_b16 v[80:81], v31 offset:32768
  v_mfma_f32_16x16x32_bf16 v[68:71], v[88:91], v[100:103], v[68:71]
  ds_read_b64_tr_b16 v[82:83], v31 offset:33280
  buffer_load_dwordx4 v2, s[16:19], s67 offen offset:0 lds
  v_mfma_f32_16x16x32_bf16 v[72:75], v[88:91], v[104:107], v[72:75]
  v_mfma_f32_16x16x32_bf16 v[76:79], v[88:91], v[108:111], v[76:79]
  ds_read_b128 v[112:115], v24 offset:32768
  buffer_load_dwordx4 v3, s[16:19], s67 offen offset:1024 lds
  s_waitcnt lgkmcnt(3)
  v_mfma_f32_16x16x32_bf16 v[152:155], v[92:95], v[108:111], v[152:155]
  ds_read_b64_tr_b16 v[84:85], v14 offset:32768
  v_mfma_f32_16x16x32_bf16 v[144:147], v[92:95], v[104:107], v[144:147]
  ds_read_b64_tr_b16 v[86:87], v14 offset:33280
  buffer_load_dwordx4 v4, s[16:19], s67 offen offset:2048 lds
  v_mfma_f32_16x16x32_bf16 v[136:139], v[92:95], v[100:103], v[136:139]
  v_mfma_f32_16x16x32_bf16 v[128:131], v[92:95], v[96:99], v[128:131]
  ds_read_b128 v[116:119], v24 offset:34816
  buffer_load_dwordx4 v5, s[16:19], s67 offen offset:3072 lds
  s_sub_u32 s67, s67, 40832
  s_add_u32 m0, s64, 65536
  s_waitcnt lgkmcnt(4)
  v_mfma_f32_16x16x32_bf16 v[132:135], v[80:83], v[96:99], v[132:135]
  ds_read_b64_tr_b16 v[88:89], v31 offset:40960
  v_mfma_f32_16x16x32_bf16 v[140:143], v[80:83], v[100:103], v[140:143]
  ds_read_b64_tr_b16 v[90:91], v31 offset:41472
  buffer_load_dwordx4 v6, s[20:23], s68 offen offset:0 lds
  v_mfma_f32_16x16x32_bf16 v[148:151], v[80:83], v[104:107], v[148:151]
  v_mfma_f32_16x16x32_bf16 v[156:159], v[80:83], v[108:111], v[156:159]
  ds_read_b128 v[120:123], v26 offset:32768
  buffer_load_dwordx4 v7, s[20:23], s68 offen offset:1024 lds
  s_waitcnt lgkmcnt(4)
  v_mfma_f32_16x16x32_bf16 v[188:191], v[84:87], v[108:111], v[188:191]
  ds_read_b64_tr_b16 v[92:93], v14 offset:40960
  v_mfma_f32_16x16x32_bf16 v[180:183], v[84:87], v[104:107], v[180:183]
  ds_read_b64_tr_b16 v[94:95], v14 offset:41472
  buffer_load_dwordx4 v8, s[20:23], s68 offen offset:2048 lds
  v_mfma_f32_16x16x32_bf16 v[172:175], v[84:87], v[100:103], v[172:175]
  v_mfma_f32_16x16x32_bf16 v[164:167], v[84:87], v[96:99], v[164:167]
  ds_read_b128 v[124:127], v26 offset:34816
  buffer_load_dwordx4 v9, s[20:23], s68 offen offset:3072 lds
  s_add_u32 s68, s68, s69
  s_add_u32 m0, s64, 69632
  s_waitcnt lgkmcnt(4)
  v_mfma_f32_16x16x32_bf16 v[196:199], v[88:91], v[96:99], v[196:199]
  ds_read_b64_tr_b16 v[80:81], v27 offset:36864
  v_mfma_f32_16x16x32_bf16 v[204:207], v[88:91], v[100:103], v[204:207]
  ds_read_b64_tr_b16 v[82:83], v27 offset:37376
  buffer_load_dwordx4 v6, s[20:23], s68 offen offset:0 lds
  v_mfma_f32_16x16x32_bf16 v[212:215], v[88:91], v[104:107], v[212:215]
  v_mfma_f32_16x16x32_bf16 v[220:223], v[88:91], v[108:111], v[220:223]
  buffer_load_dwordx4 v7, s[20:23], s68 offen offset:1024 lds
  s_waitcnt lgkmcnt(3)
  v_mfma_f32_16x16x32_bf16 v[252:255], v[92:95], v[108:111], v[252:255]
  ds_read_b64_tr_b16 v[84:85], v28 offset:36864
  v_mfma_f32_16x16x32_bf16 v[244:247], v[92:95], v[104:107], v[244:247]
  ds_read_b64_tr_b16 v[86:87], v28 offset:37376
  buffer_load_dwordx4 v8, s[20:23], s68 offen offset:2048 lds
  v_mfma_f32_16x16x32_bf16 v[236:239], v[92:95], v[100:103], v[236:239]
  v_mfma_f32_16x16x32_bf16 v[228:231], v[92:95], v[96:99], v[228:231]
  buffer_load_dwordx4 v9, s[20:23], s68 offen offset:3072 lds
  s_add_u32 s68, s68, s69
  s_waitcnt lgkmcnt(2)
  v_mfma_f32_16x16x32_bf16 v[32:35], v[80:83], v[112:115], v[32:35]
  ds_read_b64_tr_b16 v[88:89], v29 offset:36864
  v_mfma_f32_16x16x32_bf16 v[36:39], v[80:83], v[116:119], v[36:39]
  ds_read_b64_tr_b16 v[90:91], v29 offset:37376
  v_mfma_f32_16x16x32_bf16 v[40:43], v[80:83], v[120:123], v[40:43]
  v_mfma_f32_16x16x32_bf16 v[44:47], v[80:83], v[124:127], v[44:47]
  s_waitcnt lgkmcnt(2)
  v_mfma_f32_16x16x32_bf16 v[60:63], v[84:87], v[124:127], v[60:63]
  ds_read_b64_tr_b16 v[92:93], v30 offset:36864
  v_mfma_f32_16x16x32_bf16 v[56:59], v[84:87], v[120:123], v[56:59]
  ds_read_b64_tr_b16 v[94:95], v30 offset:37376
  v_mfma_f32_16x16x32_bf16 v[52:55], v[84:87], v[116:119], v[52:55]
  v_mfma_f32_16x16x32_bf16 v[48:51], v[84:87], v[112:115], v[48:51]
  s_waitcnt lgkmcnt(2)
  v_mfma_f32_16x16x32_bf16 v[64:67], v[88:91], v[112:115], v[64:67]
  ds_read_b64_tr_b16 v[80:81], v31 offset:36864
  v_mfma_f32_16x16x32_bf16 v[68:71], v[88:91], v[116:119], v[68:71]
  ds_read_b64_tr_b16 v[82:83], v31 offset:37376
  v_mfma_f32_16x16x32_bf16 v[72:75], v[88:91], v[120:123], v[72:75]
  v_mfma_f32_16x16x32_bf16 v[76:79], v[88:91], v[124:127], v[76:79]
  s_waitcnt lgkmcnt(2)
  v_mfma_f32_16x16x32_bf16 v[152:155], v[92:95], v[124:127], v[152:155]
  ds_read_b64_tr_b16 v[84:85], v14 offset:36864
  buffer_store_dwordx4 v[176:179], v16, s[12:15], s71 offen offset:0 sc1
  v_mfma_f32_16x16x32_bf16 v[144:147], v[92:95], v[120:123], v[144:147]
  ds_read_b64_tr_b16 v[86:87], v14 offset:37376
  v_mfma_f32_16x16x32_bf16 v[136:139], v[92:95], v[116:119], v[136:139]
  v_mfma_f32_16x16x32_bf16 v[128:131], v[92:95], v[112:115], v[128:131]
  s_waitcnt lgkmcnt(2)
  v_mfma_f32_16x16x32_bf16 v[132:135], v[80:83], v[112:115], v[132:135]
  ds_read_b64_tr_b16 v[88:89], v31 offset:45056
  v_mfma_f32_16x16x32_bf16 v[140:143], v[80:83], v[116:119], v[140:143]
  ds_read_b64_tr_b16 v[90:91], v31 offset:45568
  v_mfma_f32_16x16x32_bf16 v[148:151], v[80:83], v[120:123], v[148:151]
  v_mfma_f32_16x16x32_bf16 v[156:159], v[80:83], v[124:127], v[156:159]
  s_waitcnt lgkmcnt(2)
  v_mfma_f32_16x16x32_bf16 v[188:191], v[84:87], v[124:127], v[188:191]
  ds_read_b64_tr_b16 v[92:93], v14 offset:45056
  buffer_store_dwordx4 v[184:187], v16, s[12:15], s71 offen offset:1024 sc1
  s_add_u32 s71, s71, 8192
  v_mfma_f32_16x16x32_bf16 v[180:183], v[84:87], v[120:123], v[180:183]
  ds_read_b64_tr_b16 v[94:95], v14 offset:45568
  v_mfma_f32_16x16x32_bf16 v[172:175], v[84:87], v[116:119], v[172:175]
  v_mfma_f32_16x16x32_bf16 v[164:167], v[84:87], v[112:115], v[164:167]
  s_waitcnt vmcnt(2) lgkmcnt(0)
  s_barrier
  v_mfma_f32_16x16x32_bf16 v[196:199], v[88:91], v[112:115], v[196:199]
  ds_read_b64_tr_b16 v[80:81], v27 offset:0
  ds_read_b64_tr_b16 v[82:83], v27 offset:512
  v_mfma_f32_16x16x32_bf16 v[204:207], v[88:91], v[116:119], v[204:207]
  ds_read_b128 v[96:99], v23 offset:0
  ds_read_b128 v[100:103], v23 offset:2048
  v_mfma_f32_16x16x32_bf16 v[212:215], v[88:91], v[120:123], v[212:215]
  ds_read_b128 v[104:107], v25 offset:0
  ds_read_b128 v[108:111], v25 offset:2048
  v_mfma_f32_16x16x32_bf16 v[220:223], v[88:91], v[124:127], v[220:223]
  ds_read_b64_tr_b16 v[84:85], v28 offset:0
  ds_read_b64_tr_b16 v[86:87], v28 offset:512
  v_mfma_f32_16x16x32_bf16 v[252:255], v[92:95], v[124:127], v[252:255]
  v_mfma_f32_16x16x32_bf16 v[244:247], v[92:95], v[120:123], v[244:247]
  v_mfma_f32_16x16x32_bf16 v[236:239], v[92:95], v[116:119], v[236:239]
  v_mfma_f32_16x16x32_bf16 v[228:231], v[92:95], v[112:115], v[228:231]
  s_waitcnt lgkmcnt(5)
  v_mfma_f32_16x16x32_bf16 v[32:35], v[80:83], v[96:99], v[32:35]
  ds_read_b64_tr_b16 v[88:89], v29 offset:0
  s_add_u32 m0, s64, 32768
  s_waitcnt lgkmcnt(5)
  v_mfma_f32_16x16x32_bf16 v[36:39], v[80:83], v[100:103], v[36:39]
  ds_read_b64_tr_b16 v[90:91], v29 offset:512
  buffer_load_dwordx4 v2, s[16:19], s67 offen offset:0 lds
  s_waitcnt lgkmcnt(5)
  v_mfma_f32_16x16x32_bf16 v[40:43], v[80:83], v[104:107], v[40:43]
  s_waitcnt lgkmcnt(4)
  v_mfma_f32_16x16x32_bf16 v[44:47], v[80:83], v[108:111], v[44:47]
  buffer_load_dwordx4 v3, s[16:19], s67 offen offset:1024 lds
  s_waitcnt lgkmcnt(2)
  v_mfma_f32_16x16x32_bf16 v[60:63], v[84:87], v[108:111], v[60:63]
  ds_read_b64_tr_b16 v[92:93], v30 offset:0
  v_mfma_f32_16x16x32_bf16 v[56:59], v[84:87], v[104:107], v[56:59]
  ds_read_b64_tr_b16 v[94:95], v30 offset:512
  buffer_load_dwordx4 v4, s[16:19], s67 offen offset:2048 lds
  v_mfma_f32_16x16x32_bf16 v[52:55], v[84:87], v[100:103], v[52:55]
  v_mfma_f32_16x16x32_bf16 v[48:51], v[84:87], v[96:99], v[48:51]
  buffer_load_dwordx4 v5, s[16:19], s67 offen offset:3072 lds
  s_add_u32 s67, s67, 40960
  s_add_u32 m0, s64, 36864
  s_waitcnt lgkmcnt(2)
  v_mfma_f32_16x16x32_bf16 v[64:67], v[88:91], v[96:99], v[64:67]
  ds_read_b64_tr_b16 v[80:81], v31 offset:0
  v_mfma_f32_16x16x32_bf16 v[68:71], v[88:91], v[100:103], v[68:71]
  ds_read_b64_tr_b16 v[82:83], v31 offset:512
  buffer_load_dwordx4 v2, s[16:19], s67 offen offset:0 lds
  v_mfma_f32_16x16x32_bf16 v[72:75], v[88:91], v[104:107], v[72:75]
  v_mfma_f32_16x16x32_bf16 v[76:79], v[88:91], v[108:111], v[76:79]
  ds_read_b128 v[112:115], v24 offset:0
  buffer_load_dwordx4 v3, s[16:19], s67 offen offset:1024 lds
  s_waitcnt lgkmcnt(3)
  v_mfma_f32_16x16x32_bf16 v[152:155], v[92:95], v[108:111], v[152:155]
  ds_read_b64_tr_b16 v[84:85], v14 offset:0
  v_mfma_f32_16x16x32_bf16 v[144:147], v[92:95], v[104:107], v[144:147]
  ds_read_b64_tr_b16 v[86:87], v14 offset:512
  buffer_load_dwordx4 v4, s[16:19], s67 offen offset:2048 lds
  v_mfma_f32_16x16x32_bf16 v[136:139], v[92:95], v[100:103], v[136:139]
  v_mfma_f32_16x16x32_bf16 v[128:131], v[92:95], v[96:99], v[128:131]
  ds_read_b128 v[116:119], v24 offset:2048
  buffer_load_dwordx4 v5, s[16:19], s67 offen offset:3072 lds
  s_sub_u32 s67, s67, 40832
  s_add_u32 m0, s64, 98304
  s_waitcnt lgkmcnt(4)
  v_mfma_f32_16x16x32_bf16 v[132:135], v[80:83], v[96:99], v[132:135]
  ds_read_b64_tr_b16 v[88:89], v31 offset:8192
  v_mfma_f32_16x16x32_bf16 v[140:143], v[80:83], v[100:103], v[140:143]
  ds_read_b64_tr_b16 v[90:91], v31 offset:8704
  buffer_load_dwordx4 v6, s[20:23], s68 offen offset:0 lds
  v_mfma_f32_16x16x32_bf16 v[148:151], v[80:83], v[104:107], v[148:151]
  v_mfma_f32_16x16x32_bf16 v[156:159], v[80:83], v[108:111], v[156:159]
  ds_read_b128 v[120:123], v26 offset:0
  buffer_load_dwordx4 v7, s[20:23], s68 offen offset:1024 lds
  s_waitcnt lgkmcnt(4)
  v_mfma_f32_16x16x32_bf16 v[188:191], v[84:87], v[108:111], v[188:191]
  ds_read_b64_tr_b16 v[92:93], v14 offset:8192
  v_mfma_f32_16x16x32_bf16 v[180:183], v[84:87], v[104:107], v[180:183]
  ds_read_b64_tr_b16 v[94:95], v14 offset:8704
  buffer_load_dwordx4 v8, s[20:23], s68 offen offset:2048 lds
  v_mfma_f32_16x16x32_bf16 v[172:175], v[84:87], v[100:103], v[172:175]
  v_mfma_f32_16x16x32_bf16 v[164:167], v[84:87], v[96:99], v[164:167]
  ds_read_b128 v[124:127], v26 offset:2048
  buffer_load_dwordx4 v9, s[20:23], s68 offen offset:3072 lds
  s_add_u32 s68, s68, s69
  s_add_u32 m0, s64, 102400
  s_waitcnt lgkmcnt(4)
  v_mfma_f32_16x16x32_bf16 v[196:199], v[88:91], v[96:99], v[196:199]
  ds_read_b64_tr_b16 v[80:81], v27 offset:4096
  v_mfma_f32_16x16x32_bf16 v[204:207], v[88:91], v[100:103], v[204:207]
  ds_read_b64_tr_b16 v[82:83], v27 offset:4608
  buffer_load_dwordx4 v6, s[20:23], s68 offen offset:0 lds
  v_mfma_f32_16x16x32_bf16 v[212:215], v[88:91], v[104:107], v[212:215]
  v_mfma_f32_16x16x32_bf16 v[220:223], v[88:91], v[108:111], v[220:223]
  buffer_load_dwordx4 v7, s[20:23], s68 offen offset:1024 lds
  s_waitcnt lgkmcnt(3)
  v_mfma_f32_16x16x32_bf16 v[252:255], v[92:95], v[108:111], v[252:255]
  ds_read_b64_tr_b16 v[84:85], v28 offset:4096
  v_mfma_f32_16x16x32_bf16 v[244:247], v[92:95], v[104:107], v[244:247]
  ds_read_b64_tr_b16 v[86:87], v28 offset:4608
  buffer_load_dwordx4 v8, s[20:23], s68 offen offset:2048 lds
  v_mfma_f32_16x16x32_bf16 v[236:239], v[92:95], v[100:103], v[236:239]
  v_mfma_f32_16x16x32_bf16 v[228:231], v[92:95], v[96:99], v[228:231]
  buffer_load_dwordx4 v9, s[20:23], s68 offen offset:3072 lds
  s_add_u32 s68, s68, s69
  s_waitcnt lgkmcnt(2)
  v_mfma_f32_16x16x32_bf16 v[32:35], v[80:83], v[112:115], v[32:35]
  ds_read_b64_tr_b16 v[88:89], v29 offset:4096
  v_mfma_f32_16x16x32_bf16 v[36:39], v[80:83], v[116:119], v[36:39]
  ds_read_b64_tr_b16 v[90:91], v29 offset:4608
  v_mfma_f32_16x16x32_bf16 v[40:43], v[80:83], v[120:123], v[40:43]
  v_mfma_f32_16x16x32_bf16 v[44:47], v[80:83], v[124:127], v[44:47]
  s_waitcnt lgkmcnt(2)
  v_mfma_f32_16x16x32_bf16 v[60:63], v[84:87], v[124:127], v[60:63]
  ds_read_b64_tr_b16 v[92:93], v30 offset:4096
  v_mfma_f32_16x16x32_bf16 v[56:59], v[84:87], v[120:123], v[56:59]
  ds_read_b64_tr_b16 v[94:95], v30 offset:4608
  v_mfma_f32_16x16x32_bf16 v[52:55], v[84:87], v[116:119], v[52:55]
  v_mfma_f32_16x16x32_bf16 v[48:51], v[84:87], v[112:115], v[48:51]
  s_waitcnt lgkmcnt(2)
  v_mfma_f32_16x16x32_bf16 v[64:67], v[88:91], v[112:115], v[64:67]
  ds_read_b64_tr_b16 v[80:81], v31 offset:4096
  v_mfma_f32_16x16x32_bf16 v[68:71], v[88:91], v[116:119], v[68:71]
  ds_read_b64_tr_b16 v[82:83], v31 offset:4608
  v_mfma_f32_16x16x32_bf16 v[72:75], v[88:91], v[120:123], v[72:75]
  v_mfma_f32_16x16x32_bf16 v[76:79], v[88:91], v[124:127], v[76:79]
  s_waitcnt lgkmcnt(2)
  v_mfma_f32_16x16x32_bf16 v[152:155], v[92:95], v[124:127], v[152:155]
  ds_read_b64_tr_b16 v[84:85], v14 offset:4096
  buffer_store_dwordx4 v[192:195], v16, s[12:15], s70 offen offset:0 sc1
  v_mfma_f32_16x16x32_bf16 v[144:147], v[92:95], v[120:123], v[144:147]
  ds_read_b64_tr_b16 v[86:87], v14 offset:4608
  v_mfma_f32_16x16x32_bf16 v[136:139], v[92:95], v[116:119], v[136:139]
  v_mfma_f32_16x16x32_bf16 v[128:131], v[92:95], v[112:115], v[128:131]
  s_waitcnt lgkmcnt(2)
  v_mfma_f32_16x16x32_bf16 v[132:135], v[80:83], v[112:115], v[132:135]
  ds_read_b64_tr_b16 v[88:89], v31 offset:12288
  v_mfma_f32_16x16x32_bf16 v[140:143], v[80:83], v[116:119], v[140:143]
  ds_read_b64_tr_b16 v[90:91], v31 offset:12800
  v_mfma_f32_16x16x32_bf16 v[148:151], v[80:83], v[120:123], v[148:151]
  v_mfma_f32_16x16x32_bf16 v[156:159], v[80:83], v[124:127], v[156:159]
  s_waitcnt lgkmcnt(2)
  v_mfma_f32_16x16x32_bf16 v[188:191], v[84:87], v[124:127], v[188:191]
  ds_read_b64_tr_b16 v[92:93], v14 offset:12288
  buffer_store_dwordx4 v[200:203], v16, s[12:15], s70 offen offset:1024 sc1
  s_add_u32 s70, s70, 8192
  v_mfma_f32_16x16x32_bf16 v[180:183], v[84:87], v[120:123], v[180:183]
  ds_read_b64_tr_b16 v[94:95], v14 offset:12800
  v_mfma_f32_16x16x32_bf16 v[172:175], v[84:87], v[116:119], v[172:175]
  v_mfma_f32_16x16x32_bf16 v[164:167], v[84:87], v[112:115], v[164:167]
  s_waitcnt vmcnt(2) lgkmcnt(0)
  s_barrier
  v_mfma_f32_16x16x32_bf16 v[196:199], v[88:91], v[112:115], v[196:199]
  ds_read_b64_tr_b16 v[80:81], v27 offset:32768
  ds_read_b64_tr_b16 v[82:83], v27 offset:33280
  v_mfma_f32_16x16x32_bf16 v[204:207], v[88:91], v[116:119], v[204:207]
  ds_read_b128 v[96:99], v23 offset:32768
  ds_read_b128 v[100:103], v23 offset:34816
  v_mfma_f32_16x16x32_bf16 v[212:215], v[88:91], v[120:123], v[212:215]
  ds_read_b128 v[104:107], v25 offset:32768
  ds_read_b128 v[108:111], v25 offset:34816
  v_mfma_f32_16x16x32_bf16 v[220:223], v[88:91], v[124:127], v[220:223]
  ds_read_b64_tr_b16 v[84:85], v28 offset:32768
  ds_read_b64_tr_b16 v[86:87], v28 offset:33280
  v_mfma_f32_16x16x32_bf16 v[252:255], v[92:95], v[124:127], v[252:255]
  v_mfma_f32_16x16x32_bf16 v[244:247], v[92:95], v[120:123], v[244:247]
  v_mfma_f32_16x16x32_bf16 v[236:239], v[92:95], v[116:119], v[236:239]
  v_mfma_f32_16x16x32_bf16 v[228:231], v[92:95], v[112:115], v[228:231]
  s_waitcnt lgkmcnt(5)
  v_mfma_f32_16x16x32_bf16 v[32:35], v[80:83], v[96:99], v[32:35]
  ds_read_b64_tr_b16 v[88:89], v29 offset:32768
  s_add_u32 m0, s64, 0
  s_waitcnt lgkmcnt(5)
  v_mfma_f32_16x16x32_bf16 v[36:39], v[80:83], v[100:103], v[36:39]
  ds_read_b64_tr_b16 v[90:91], v29 offset:33280
  buffer_load_dwordx4 v2, s[16:19], s67 offen offset:0 lds
  s_waitcnt lgkmcnt(5)
  v_mfma_f32_16x16x32_bf16 v[40:43], v[80:83], v[104:107], v[40:43]
  s_waitcnt lgkmcnt(4)
  v_mfma_f32_16x16x32_bf16 v[44:47], v[80:83], v[108:111], v[44:47]
  buffer_load_dwordx4 v3, s[16:19], s67 offen offset:1024 lds
  s_waitcnt lgkmcnt(2)
  v_mfma_f32_16x16x32_bf16 v[60:63], v[84:87], v[108:111], v[60:63]
  ds_read_b64_tr_b16 v[92:93], v30 offset:32768
  v_mfma_f32_16x16x32_bf16 v[56:59], v[84:87], v[104:107], v[56:59]
  ds_read_b64_tr_b16 v[94:95], v30 offset:33280
  buffer_load_dwordx4 v4, s[16:19], s67 offen offset:2048 lds
  v_mfma_f32_16x16x32_bf16 v[52:55], v[84:87], v[100:103], v[52:55]
  v_mfma_f32_16x16x32_bf16 v[48:51], v[84:87], v[96:99], v[48:51]
  buffer_load_dwordx4 v5, s[16:19], s67 offen offset:3072 lds
  s_add_u32 s67, s67, 40960
  s_add_u32 m0, s64, 4096
  s_waitcnt lgkmcnt(2)
  v_mfma_f32_16x16x32_bf16 v[64:67], v[88:91], v[96:99], v[64:67]
  ds_read_b64_tr_b16 v[80:81], v31 offset:32768
  v_mfma_f32_16x16x32_bf16 v[68:71], v[88:91], v[100:103], v[68:71]
  ds_read_b64_tr_b16 v[82:83], v31 offset:33280
  buffer_load_dwordx4 v2, s[16:19], s67 offen offset:0 lds
  v_mfma_f32_16x16x32_bf16 v[72:75], v[88:91], v[104:107], v[72:75]
  v_mfma_f32_16x16x32_bf16 v[76:79], v[88:91], v[108:111], v[76:79]
  ds_read_b128 v[112:115], v24 offset:32768
  buffer_load_dwordx4 v3, s[16:19], s67 offen offset:1024 lds
  s_waitcnt lgkmcnt(3)
  v_mfma_f32_16x16x32_bf16 v[152:155], v[92:95], v[108:111], v[152:155]
  ds_read_b64_tr_b16 v[84:85], v14 offset:32768
  v_mfma_f32_16x16x32_bf16 v[144:147], v[92:95], v[104:107], v[144:147]
  ds_read_b64_tr_b16 v[86:87], v14 offset:33280
  buffer_load_dwordx4 v4, s[16:19], s67 offen offset:2048 lds
  v_mfma_f32_16x16x32_bf16 v[136:139], v[92:95], v[100:103], v[136:139]
  v_mfma_f32_16x16x32_bf16 v[128:131], v[92:95], v[96:99], v[128:131]
  ds_read_b128 v[116:119], v24 offset:34816
  buffer_load_dwordx4 v5, s[16:19], s67 offen offset:3072 lds
  s_sub_u32 s67, s67, 40832
  s_add_u32 m0, s64, 65536
  s_waitcnt lgkmcnt(4)
  v_mfma_f32_16x16x32_bf16 v[132:135], v[80:83], v[96:99], v[132:135]
  ds_read_b64_tr_b16 v[88:89], v31 offset:40960
  v_mfma_f32_16x16x32_bf16 v[140:143], v[80:83], v[100:103], v[140:143]
  ds_read_b64_tr_b16 v[90:91], v31 offset:41472
  buffer_load_dwordx4 v6, s[20:23], s68 offen offset:0 lds
  v_mfma_f32_16x16x32_bf16 v[148:151], v[80:83], v[104:107], v[148:151]
  v_mfma_f32_16x16x32_bf16 v[156:159], v[80:83], v[108:111], v[156:159]
  ds_read_b128 v[120:123], v26 offset:32768
  buffer_load_dwordx4 v7, s[20:23], s68 offen offset:1024 lds
  s_waitcnt lgkmcnt(4)
  v_mfma_f32_16x16x32_bf16 v[188:191], v[84:87], v[108:111], v[188:191]
  ds_read_b64_tr_b16 v[92:93], v14 offset:40960
  v_mfma_f32_16x16x32_bf16 v[180:183], v[84:87], v[104:107], v[180:183]
  ds_read_b64_tr_b16 v[94:95], v14 offset:41472
  buffer_load_dwordx4 v8, s[20:23], s68 offen offset:2048 lds
  v_mfma_f32_16x16x32_bf16 v[172:175], v[84:87], v[100:103], v[172:175]
  v_mfma_f32_16x16x32_bf16 v[164:167], v[84:87], v[96:99], v[164:167]
  ds_read_b128 v[124:127], v26 offset:34816
  buffer_load_dwordx4 v9, s[20:23], s68 offen offset:3072 lds
  s_add_u32 s68, s68, s69
  s_add_u32 m0, s64, 69632
  s_waitcnt lgkmcnt(4)
  v_mfma_f32_16x16x32_bf16 v[196:199], v[88:91], v[96:99], v[196:199]
  ds_read_b64_tr_b16 v[80:81], v27 offset:36864
  v_mfma_f32_16x16x32_bf16 v[204:207], v[88:91], v[100:103], v[204:207]
  ds_read_b64_tr_b16 v[82:83], v27 offset:37376
  buffer_load_dwordx4 v6, s[20:23], s68 offen offset:0 lds
  v_mfma_f32_16x16x32_bf16 v[212:215], v[88:91], v[104:107], v[212:215]
  v_mfma_f32_16x16x32_bf16 v[220:223], v[88:91], v[108:111], v[220:223]
  buffer_load_dwordx4 v7, s[20:23], s68 offen offset:1024 lds
  s_waitcnt lgkmcnt(3)
  v_mfma_f32_16x16x32_bf16 v[252:255], v[92:95], v[108:111], v[252:255]
  ds_read_b64_tr_b16 v[84:85], v28 offset:36864
  v_mfma_f32_16x16x32_bf16 v[244:247], v[92:95], v[104:107], v[244:247]
  ds_read_b64_tr_b16 v[86:87], v28 offset:37376
  buffer_load_dwordx4 v8, s[20:23], s68 offen offset:2048 lds
  v_mfma_f32_16x16x32_bf16 v[236:239], v[92:95], v[100:103], v[236:239]
  v_mfma_f32_16x16x32_bf16 v[228:231], v[92:95], v[96:99], v[228:231]
  buffer_load_dwordx4 v9, s[20:23], s68 offen offset:3072 lds
  s_add_u32 s68, s68, s69
  s_waitcnt lgkmcnt(2)
  v_mfma_f32_16x16x32_bf16 v[32:35], v[80:83], v[112:115], v[32:35]
  ds_read_b64_tr_b16 v[88:89], v29 offset:36864
  v_mfma_f32_16x16x32_bf16 v[36:39], v[80:83], v[116:119], v[36:39]
  ds_read_b64_tr_b16 v[90:91], v29 offset:37376
  v_mfma_f32_16x16x32_bf16 v[40:43], v[80:83], v[120:123], v[40:43]
  v_mfma_f32_16x16x32_bf16 v[44:47], v[80:83], v[124:127], v[44:47]
  s_waitcnt lgkmcnt(2)
  v_mfma_f32_16x16x32_bf16 v[60:63], v[84:87], v[124:127], v[60:63]
  ds_read_b64_tr_b16 v[92:93], v30 offset:36864
  v_mfma_f32_16x16x32_bf16 v[56:59], v[84:87], v[120:123], v[56:59]
  ds_read_b64_tr_b16 v[94:95], v30 offset:37376
  v_mfma_f32_16x16x32_bf16 v[52:55], v[84:87], v[116:119], v[52:55]
  v_mfma_f32_16x16x32_bf16 v[48:51], v[84:87], v[112:115], v[48:51]
  s_waitcnt lgkmcnt(2)
  v_mfma_f32_16x16x32_bf16 v[64:67], v[88:91], v[112:115], v[64:67]
  ds_read_b64_tr_b16 v[80:81], v31 offset:36864
  v_mfma_f32_16x16x32_bf16 v[68:71], v[88:91], v[116:119], v[68:71]
  ds_read_b64_tr_b16 v[82:83], v31 offset:37376
  v_mfma_f32_16x16x32_bf16 v[72:75], v[88:91], v[120:123], v[72:75]
  v_mfma_f32_16x16x32_bf16 v[76:79], v[88:91], v[124:127], v[76:79]
  s_waitcnt lgkmcnt(2)
  v_mfma_f32_16x16x32_bf16 v[152:155], v[92:95], v[124:127], v[152:155]
  ds_read_b64_tr_b16 v[84:85], v14 offset:36864
  buffer_store_dwordx4 v[208:211], v16, s[12:15], s71 offen offset:0 sc1
  v_mfma_f32_16x16x32_bf16 v[144:147], v[92:95], v[120:123], v[144:147]
  ds_read_b64_tr_b16 v[86:87], v14 offset:37376
  v_mfma_f32_16x16x32_bf16 v[136:139], v[92:95], v[116:119], v[136:139]
  v_mfma_f32_16x16x32_bf16 v[128:131], v[92:95], v[112:115], v[128:131]
  s_waitcnt lgkmcnt(2)
  v_mfma_f32_16x16x32_bf16 v[132:135], v[80:83], v[112:115], v[132:135]
  ds_read_b64_tr_b16 v[88:89], v31 offset:45056
  v_mfma_f32_16x16x32_bf16 v[140:143], v[80:83], v[116:119], v[140:143]
  ds_read_b64_tr_b16 v[90:91], v31 offset:45568
  v_mfma_f32_16x16x32_bf16 v[148:151], v[80:83], v[120:123], v[148:151]
  v_mfma_f32_16x16x32_bf16 v[156:159], v[80:83], v[124:127], v[156:159]
  s_waitcnt lgkmcnt(2)
  v_mfma_f32_16x16x32_bf16 v[188:191], v[84:87], v[124:127], v[188:191]
  ds_read_b64_tr_b16 v[92:93], v14 offset:45056
  buffer_store_dwordx4 v[216:219], v16, s[12:15], s71 offen offset:1024 sc1
  s_add_u32 s71, s71, 8192
  v_mfma_f32_16x16x32_bf16 v[180:183], v[84:87], v[120:123], v[180:183]
  ds_read_b64_tr_b16 v[94:95], v14 offset:45568
  v_mfma_f32_16x16x32_bf16 v[172:175], v[84:87], v[116:119], v[172:175]
  v_mfma_f32_16x16x32_bf16 v[164:167], v[84:87], v[112:115], v[164:167]
  s_waitcnt vmcnt(2) lgkmcnt(0)
  s_barrier
  v_mfma_f32_16x16x32_bf16 v[196:199], v[88:91], v[112:115], v[196:199]
  ds_read_b64_tr_b16 v[80:81], v27 offset:0
  ds_read_b64_tr_b16 v[82:83], v27 offset:512
  v_mfma_f32_16x16x32_bf16 v[204:207], v[88:91], v[116:119], v[204:207]
  ds_read_b128 v[96:99], v23 offset:0
  ds_read_b128 v[100:103], v23 offset:2048
  v_mfma_f32_16x16x32_bf16 v[212:215], v[88:91], v[120:123], v[212:215]
  ds_read_b128 v[104:107], v25 offset:0
  ds_read_b128 v[108:111], v25 offset:2048
  v_mfma_f32_16x16x32_bf16 v[220:223], v[88:91], v[124:127], v[220:223]
  ds_read_b64_tr_b16 v[84:85], v28 offset:0
  ds_read_b64_tr_b16 v[86:87], v28 offset:512
  v_mfma_f32_16x16x32_bf16 v[252:255], v[92:95], v[124:127], v[252:255]
  v_mfma_f32_16x16x32_bf16 v[244:247], v[92:95], v[120:123], v[244:247]
  v_mfma_f32_16x16x32_bf16 v[236:239], v[92:95], v[116:119], v[236:239]
  v_mfma_f32_16x16x32_bf16 v[228:231], v[92:95], v[112:115], v[228:231]
  s_waitcnt lgkmcnt(5)
  v_mfma_f32_16x16x32_bf16 v[32:35], v[80:83], v[96:99], v[32:35]
  ds_read_b64_tr_b16 v[88:89], v29 offset:0
  s_add_u32 m0, s64, 32768
  s_waitcnt lgkmcnt(5)
  v_mfma_f32_16x16x32_bf16 v[36:39], v[80:83], v[100:103], v[36:39]
  ds_read_b64_tr_b16 v[90:91], v29 offset:512
  buffer_load_dwordx4 v2, s[16:19], s67 offen offset:0 lds
  s_waitcnt lgkmcnt(5)
  v_mfma_f32_16x16x32_bf16 v[40:43], v[80:83], v[104:107], v[40:43]
  s_waitcnt lgkmcnt(4)
  v_mfma_f32_16x16x32_bf16 v[44:47], v[80:83], v[108:111], v[44:47]
  buffer_load_dwordx4 v3, s[16:19], s67 offen offset:1024 lds
  s_waitcnt lgkmcnt(2)
  v_mfma_f32_16x16x32_bf16 v[60:63], v[84:87], v[108:111], v[60:63]
  ds_read_b64_tr_b16 v[92:93], v30 offset:0
  v_mfma_f32_16x16x32_bf16 v[56:59], v[84:87], v[104:107], v[56:59]
  ds_read_b64_tr_b16 v[94:95], v30 offset:512
  buffer_load_dwordx4 v4, s[16:19], s67 offen offset:2048 lds
  v_mfma_f32_16x16x32_bf16 v[52:55], v[84:87], v[100:103], v[52:55]
  v_mfma_f32_16x16x32_bf16 v[48:51], v[84:87], v[96:99], v[48:51]
  buffer_load_dwordx4 v5, s[16:19], s67 offen offset:3072 lds
  s_add_u32 s67, s67, 40960
  s_add_u32 m0, s64, 36864
  s_waitcnt lgkmcnt(2)
  v_mfma_f32_16x16x32_bf16 v[64:67], v[88:91], v[96:99], v[64:67]
  ds_read_b64_tr_b16 v[80:81], v31 offset:0
  v_mfma_f32_16x16x32_bf16 v[68:71], v[88:91], v[100:103], v[68:71]
  ds_read_b64_tr_b16 v[82:83], v31 offset:512
  buffer_load_dwordx4 v2, s[16:19], s67 offen offset:0 lds
  v_mfma_f32_16x16x32_bf16 v[72:75], v[88:91], v[104:107], v[72:75]
  v_mfma_f32_16x16x32_bf16 v[76:79], v[88:91], v[108:111], v[76:79]
  ds_read_b128 v[112:115], v24 offset:0
  buffer_load_dwordx4 v3, s[16:19], s67 offen offset:1024 lds
  s_waitcnt lgkmcnt(3)
  v_mfma_f32_16x16x32_bf16 v[152:155], v[92:95], v[108:111], v[152:155]
  ds_read_b64_tr_b16 v[84:85], v14 offset:0
  v_mfma_f32_16x16x32_bf16 v[144:147], v[92:95], v[104:107], v[144:147]
  ds_read_b64_tr_b16 v[86:87], v14 offset:512
  buffer_load_dwordx4 v4, s[16:19], s67 offen offset:2048 lds
  v_mfma_f32_16x16x32_bf16 v[136:139], v[92:95], v[100:103], v[136:139]
  v_mfma_f32_16x16x32_bf16 v[128:131], v[92:95], v[96:99], v[128:131]
  ds_read_b128 v[116:119], v24 offset:2048
  buffer_load_dwordx4 v5, s[16:19], s67 offen offset:3072 lds
  s_sub_u32 s67, s67, 40832
  s_add_u32 m0, s64, 98304
  s_waitcnt lgkmcnt(4)
  v_mfma_f32_16x16x32_bf16 v[132:135], v[80:83], v[96:99], v[132:135]
  ds_read_b64_tr_b16 v[88:89], v31 offset:8192
  v_mfma_f32_16x16x32_bf16 v[140:143], v[80:83], v[100:103], v[140:143]
  ds_read_b64_tr_b16 v[90:91], v31 offset:8704
  buffer_load_dwordx4 v6, s[20:23], s68 offen offset:0 lds
  v_mfma_f32_16x16x32_bf16 v[148:151], v[80:83], v[104:107], v[148:151]
  v_mfma_f32_16x16x32_bf16 v[156:159], v[80:83], v[108:111], v[156:159]
  ds_read_b128 v[120:123], v26 offset:0
  buffer_load_dwordx4 v7, s[20:23], s68 offen offset:1024 lds
  s_waitcnt lgkmcnt(4)
  v_mfma_f32_16x16x32_bf16 v[188:191], v[84:87], v[108:111], v[188:191]
  ds_read_b64_tr_b16 v[92:93], v14 offset:8192
  v_mfma_f32_16x16x32_bf16 v[180:183], v[84:87], v[104:107], v[180:183]
  ds_read_b64_tr_b16 v[94:95], v14 offset:8704
  buffer_load_dwordx4 v8, s[20:23], s68 offen offset:2048 lds
  v_mfma_f32_16x16x32_bf16 v[172:175], v[84:87], v[100:103], v[172:175]
  v_mfma_f32_16x16x32_bf16 v[164:167], v[84:87], v[96:99], v[164:167]
  ds_read_b128 v[124:127], v26 offset:2048
  buffer_load_dwordx4 v9, s[20:23], s68 offen offset:3072 lds
  s_add_u32 s68, s68, s69
  s_add_u32 m0, s64, 102400
  s_waitcnt lgkmcnt(4)
  v_mfma_f32_16x16x32_bf16 v[196:199], v[88:91], v[96:99], v[196:199]
  ds_read_b64_tr_b16 v[80:81], v27 offset:4096
  v_mfma_f32_16x16x32_bf16 v[204:207], v[88:91], v[100:103], v[204:207]
  ds_read_b64_tr_b16 v[82:83], v27 offset:4608
  buffer_load_dwordx4 v6, s[20:23], s68 offen offset:0 lds
  v_mfma_f32_16x16x32_bf16 v[212:215], v[88:91], v[104:107], v[212:215]
  v_mfma_f32_16x16x32_bf16 v[220:223], v[88:91], v[108:111], v[220:223]
  buffer_load_dwordx4 v7, s[20:23], s68 offen offset:1024 lds
  s_waitcnt lgkmcnt(3)
  v_mfma_f32_16x16x32_bf16 v[252:255], v[92:95], v[108:111], v[252:255]
  ds_read_b64_tr_b16 v[84:85], v28 offset:4096
  v_mfma_f32_16x16x32_bf16 v[244:247], v[92:95], v[104:107], v[244:247]
  ds_read_b64_tr_b16 v[86:87], v28 offset:4608
  buffer_load_dwordx4 v8, s[20:23], s68 offen offset:2048 lds
  v_mfma_f32_16x16x32_bf16 v[236:239], v[92:95], v[100:103], v[236:239]
  v_mfma_f32_16x16x32_bf16 v[228:231], v[92:95], v[96:99], v[228:231]
  buffer_load_dwordx4 v9, s[20:23], s68 offen offset:3072 lds
  s_add_u32 s68, s68, s69
  s_waitcnt lgkmcnt(2)
  v_mfma_f32_16x16x32_bf16 v[32:35], v[80:83], v[112:115], v[32:35]
  ds_read_b64_tr_b16 v[88:89], v29 offset:4096
  v_mfma_f32_16x16x32_bf16 v[36:39], v[80:83], v[116:119], v[36:39]
  ds_read_b64_tr_b16 v[90:91], v29 offset:4608
  v_mfma_f32_16x16x32_bf16 v[40:43], v[80:83], v[120:123], v[40:43]
  v_mfma_f32_16x16x32_bf16 v[44:47], v[80:83], v[124:127], v[44:47]
  s_waitcnt lgkmcnt(2)
  v_mfma_f32_16x16x32_bf16 v[60:63], v[84:87], v[124:127], v[60:63]
  ds_read_b64_tr_b16 v[92:93], v30 offset:4096
  v_mfma_f32_16x16x32_bf16 v[56:59], v[84:87], v[120:123], v[56:59]
  ds_read_b64_tr_b16 v[94:95], v30 offset:4608
  v_mfma_f32_16x16x32_bf16 v[52:55], v[84:87], v[116:119], v[52:55]
  v_mfma_f32_16x16x32_bf16 v[48:51], v[84:87], v[112:115], v[48:51]
  s_waitcnt lgkmcnt(2)
  v_mfma_f32_16x16x32_bf16 v[64:67], v[88:91], v[112:115], v[64:67]
  ds_read_b64_tr_b16 v[80:81], v31 offset:4096
  v_mfma_f32_16x16x32_bf16 v[68:71], v[88:91], v[116:119], v[68:71]
  ds_read_b64_tr_b16 v[82:83], v31 offset:4608
  v_mfma_f32_16x16x32_bf16 v[72:75], v[88:91], v[120:123], v[72:75]
  v_mfma_f32_16x16x32_bf16 v[76:79], v[88:91], v[124:127], v[76:79]
  s_waitcnt lgkmcnt(2)
  v_mfma_f32_16x16x32_bf16 v[152:155], v[92:95], v[124:127], v[152:155]
  ds_read_b64_tr_b16 v[84:85], v14 offset:4096
  buffer_store_dwordx4 v[224:227], v16, s[12:15], s70 offen offset:0 sc1
  v_mfma_f32_16x16x32_bf16 v[144:147], v[92:95], v[120:123], v[144:147]
  ds_read_b64_tr_b16 v[86:87], v14 offset:4608
  v_mfma_f32_16x16x32_bf16 v[136:139], v[92:95], v[116:119], v[136:139]
  v_mfma_f32_16x16x32_bf16 v[128:131], v[92:95], v[112:115], v[128:131]
  s_waitcnt lgkmcnt(2)
  v_mfma_f32_16x16x32_bf16 v[132:135], v[80:83], v[112:115], v[132:135]
  ds_read_b64_tr_b16 v[88:89], v31 offset:12288
  v_mfma_f32_16x16x32_bf16 v[140:143], v[80:83], v[116:119], v[140:143]
  ds_read_b64_tr_b16 v[90:91], v31 offset:12800
  v_mfma_f32_16x16x32_bf16 v[148:151], v[80:83], v[120:123], v[148:151]
  v_mfma_f32_16x16x32_bf16 v[156:159], v[80:83], v[124:127], v[156:159]
  s_waitcnt lgkmcnt(2)
  v_mfma_f32_16x16x32_bf16 v[188:191], v[84:87], v[124:127], v[188:191]
  ds_read_b64_tr_b16 v[92:93], v14 offset:12288
  buffer_store_dwordx4 v[232:235], v16, s[12:15], s70 offen offset:1024 sc1
  s_add_u32 s70, s70, 8192
  v_mfma_f32_16x16x32_bf16 v[180:183], v[84:87], v[120:123], v[180:183]
  ds_read_b64_tr_b16 v[94:95], v14 offset:12800
  v_mfma_f32_16x16x32_bf16 v[172:175], v[84:87], v[116:119], v[172:175]
  v_mfma_f32_16x16x32_bf16 v[164:167], v[84:87], v[112:115], v[164:167]
  s_waitcnt vmcnt(2) lgkmcnt(0)
  s_barrier
  v_mfma_f32_16x16x32_bf16 v[196:199], v[88:91], v[112:115], v[196:199]
  ds_read_b64_tr_b16 v[80:81], v27 offset:32768
  ds_read_b64_tr_b16 v[82:83], v27 offset:33280
  v_mfma_f32_16x16x32_bf16 v[204:207], v[88:91], v[116:119], v[204:207]
  ds_read_b128 v[96:99], v23 offset:32768
  ds_read_b128 v[100:103], v23 offset:34816
  v_mfma_f32_16x16x32_bf16 v[212:215], v[88:91], v[120:123], v[212:215]
  ds_read_b128 v[104:107], v25 offset:32768
  ds_read_b128 v[108:111], v25 offset:34816
  v_mfma_f32_16x16x32_bf16 v[220:223], v[88:91], v[124:127], v[220:223]
  ds_read_b64_tr_b16 v[84:85], v28 offset:32768
  ds_read_b64_tr_b16 v[86:87], v28 offset:33280
  v_mfma_f32_16x16x32_bf16 v[252:255], v[92:95], v[124:127], v[252:255]
  v_mfma_f32_16x16x32_bf16 v[244:247], v[92:95], v[120:123], v[244:247]
  v_mfma_f32_16x16x32_bf16 v[236:239], v[92:95], v[116:119], v[236:239]
  v_mfma_f32_16x16x32_bf16 v[228:231], v[92:95], v[112:115], v[228:231]
  s_waitcnt lgkmcnt(5)
  v_mfma_f32_16x16x32_bf16 v[32:35], v[80:83], v[96:99], v[32:35]
  ds_read_b64_tr_b16 v[88:89], v29 offset:32768
  s_add_u32 m0, s64, 0
  s_waitcnt lgkmcnt(5)
  v_mfma_f32_16x16x32_bf16 v[36:39], v[80:83], v[100:103], v[36:39]
  ds_read_b64_tr_b16 v[90:91], v29 offset:33280
  buffer_load_dwordx4 v2, s[16:19], s67 offen offset:0 lds
  s_waitcnt lgkmcnt(5)
  v_mfma_f32_16x16x32_bf16 v[40:43], v[80:83], v[104:107], v[40:43]
  s_waitcnt lgkmcnt(4)
  v_mfma_f32_16x16x32_bf16 v[44:47], v[80:83], v[108:111], v[44:47]
  buffer_load_dwordx4 v3, s[16:19], s67 offen offset:1024 lds
  s_waitcnt lgkmcnt(2)
  v_mfma_f32_16x16x32_bf16 v[60:63], v[84:87], v[108:111], v[60:63]
  ds_read_b64_tr_b16 v[92:93], v30 offset:32768
  v_mfma_f32_16x16x32_bf16 v[56:59], v[84:87], v[104:107], v[56:59]
  ds_read_b64_tr_b16 v[94:95], v30 offset:33280
  buffer_load_dwordx4 v4, s[16:19], s67 offen offset:2048 lds
  v_mfma_f32_16x16x32_bf16 v[52:55], v[84:87], v[100:103], v[52:55]
  v_mfma_f32_16x16x32_bf16 v[48:51], v[84:87], v[96:99], v[48:51]
  buffer_load_dwordx4 v5, s[16:19], s67 offen offset:3072 lds
  s_add_u32 s67, s67, 40960
  s_add_u32 m0, s64, 4096
  s_waitcnt lgkmcnt(2)
  v_mfma_f32_16x16x32_bf16 v[64:67], v[88:91], v[96:99], v[64:67]
  ds_read_b64_tr_b16 v[80:81], v31 offset:32768
  v_mfma_f32_16x16x32_bf16 v[68:71], v[88:91], v[100:103], v[68:71]
  ds_read_b64_tr_b16 v[82:83], v31 offset:33280
  buffer_load_dwordx4 v2, s[16:19], s67 offen offset:0 lds
  v_mfma_f32_16x16x32_bf16 v[72:75], v[88:91], v[104:107], v[72:75]
  v_mfma_f32_16x16x32_bf16 v[76:79], v[88:91], v[108:111], v[76:79]
  ds_read_b128 v[112:115], v24 offset:32768
  buffer_load_dwordx4 v3, s[16:19], s67 offen offset:1024 lds
  s_waitcnt lgkmcnt(3)
  v_mfma_f32_16x16x32_bf16 v[152:155], v[92:95], v[108:111], v[152:155]
  ds_read_b64_tr_b16 v[84:85], v14 offset:32768
  v_mfma_f32_16x16x32_bf16 v[144:147], v[92:95], v[104:107], v[144:147]
  ds_read_b64_tr_b16 v[86:87], v14 offset:33280
  buffer_load_dwordx4 v4, s[16:19], s67 offen offset:2048 lds
  v_mfma_f32_16x16x32_bf16 v[136:139], v[92:95], v[100:103], v[136:139]
  v_mfma_f32_16x16x32_bf16 v[128:131], v[92:95], v[96:99], v[128:131]
  ds_read_b128 v[116:119], v24 offset:34816
  buffer_load_dwordx4 v5, s[16:19], s67 offen offset:3072 lds
  s_sub_u32 s67, s67, 40832
  s_add_u32 m0, s64, 65536
  s_waitcnt lgkmcnt(4)
  v_mfma_f32_16x16x32_bf16 v[132:135], v[80:83], v[96:99], v[132:135]
  ds_read_b64_tr_b16 v[88:89], v31 offset:40960
  v_mfma_f32_16x16x32_bf16 v[140:143], v[80:83], v[100:103], v[140:143]
  ds_read_b64_tr_b16 v[90:91], v31 offset:41472
  buffer_load_dwordx4 v6, s[20:23], s68 offen offset:0 lds
  v_mfma_f32_16x16x32_bf16 v[148:151], v[80:83], v[104:107], v[148:151]
  v_mfma_f32_16x16x32_bf16 v[156:159], v[80:83], v[108:111], v[156:159]
  ds_read_b128 v[120:123], v26 offset:32768
  buffer_load_dwordx4 v7, s[20:23], s68 offen offset:1024 lds
  s_waitcnt lgkmcnt(4)
  v_mfma_f32_16x16x32_bf16 v[188:191], v[84:87], v[108:111], v[188:191]
  ds_read_b64_tr_b16 v[92:93], v14 offset:40960
  v_mfma_f32_16x16x32_bf16 v[180:183], v[84:87], v[104:107], v[180:183]
  ds_read_b64_tr_b16 v[94:95], v14 offset:41472
  buffer_load_dwordx4 v8, s[20:23], s68 offen offset:2048 lds
  v_mfma_f32_16x16x32_bf16 v[172:175], v[84:87], v[100:103], v[172:175]
  v_mfma_f32_16x16x32_bf16 v[164:167], v[84:87], v[96:99], v[164:167]
  ds_read_b128 v[124:127], v26 offset:34816
  buffer_load_dwordx4 v9, s[20:23], s68 offen offset:3072 lds
  s_add_u32 s68, s68, s69
  s_add_u32 m0, s64, 69632
  s_waitcnt lgkmcnt(4)
  v_mfma_f32_16x16x32_bf16 v[196:199], v[88:91], v[96:99], v[196:199]
  ds_read_b64_tr_b16 v[80:81], v27 offset:36864
  v_mfma_f32_16x16x32_bf16 v[204:207], v[88:91], v[100:103], v[204:207]
  ds_read_b64_tr_b16 v[82:83], v27 offset:37376
  buffer_load_dwordx4 v6, s[20:23], s68 offen offset:0 lds
  v_mfma_f32_16x16x32_bf16 v[212:215], v[88:91], v[104:107], v[212:215]
  v_mfma_f32_16x16x32_bf16 v[220:223], v[88:91], v[108:111], v[220:223]
  buffer_load_dwordx4 v7, s[20:23], s68 offen offset:1024 lds
  s_waitcnt lgkmcnt(3)
  v_mfma_f32_16x16x32_bf16 v[252:255], v[92:95], v[108:111], v[252:255]
  ds_read_b64_tr_b16 v[84:85], v28 offset:36864
  v_mfma_f32_16x16x32_bf16 v[244:247], v[92:95], v[104:107], v[244:247]
  ds_read_b64_tr_b16 v[86:87], v28 offset:37376
  buffer_load_dwordx4 v8, s[20:23], s68 offen offset:2048 lds
  v_mfma_f32_16x16x32_bf16 v[236:239], v[92:95], v[100:103], v[236:239]
  v_mfma_f32_16x16x32_bf16 v[228:231], v[92:95], v[96:99], v[228:231]
  buffer_load_dwordx4 v9, s[20:23], s68 offen offset:3072 lds
  s_add_u32 s68, s68, s69
  s_waitcnt lgkmcnt(2)
  v_mfma_f32_16x16x32_bf16 v[32:35], v[80:83], v[112:115], v[32:35]
  ds_read_b64_tr_b16 v[88:89], v29 offset:36864
  v_mfma_f32_16x16x32_bf16 v[36:39], v[80:83], v[116:119], v[36:39]
  ds_read_b64_tr_b16 v[90:91], v29 offset:37376
  v_mfma_f32_16x16x32_bf16 v[40:43], v[80:83], v[120:123], v[40:43]
  v_mfma_f32_16x16x32_bf16 v[44:47], v[80:83], v[124:127], v[44:47]
  s_waitcnt lgkmcnt(2)
  v_mfma_f32_16x16x32_bf16 v[60:63], v[84:87], v[124:127], v[60:63]
  ds_read_b64_tr_b16 v[92:93], v30 offset:36864
  v_mfma_f32_16x16x32_bf16 v[56:59], v[84:87], v[120:123], v[56:59]
  ds_read_b64_tr_b16 v[94:95], v30 offset:37376
  v_mfma_f32_16x16x32_bf16 v[52:55], v[84:87], v[116:119], v[52:55]
  v_mfma_f32_16x16x32_bf16 v[48:51], v[84:87], v[112:115], v[48:51]
  s_waitcnt lgkmcnt(2)
  v_mfma_f32_16x16x32_bf16 v[64:67], v[88:91], v[112:115], v[64:67]
  ds_read_b64_tr_b16 v[80:81], v31 offset:36864
  v_mfma_f32_16x16x32_bf16 v[68:71], v[88:91], v[116:119], v[68:71]
  ds_read_b64_tr_b16 v[82:83], v31 offset:37376
  v_mfma_f32_16x16x32_bf16 v[72:75], v[88:91], v[120:123], v[72:75]
  v_mfma_f32_16x16x32_bf16 v[76:79], v[88:91], v[124:127], v[76:79]
  s_waitcnt lgkmcnt(2)
  v_mfma_f32_16x16x32_bf16 v[152:155], v[92:95], v[124:127], v[152:155]
  ds_read_b64_tr_b16 v[84:85], v14 offset:36864
  buffer_store_dwordx4 v[240:243], v16, s[12:15], s71 offen offset:0 sc1
  v_mfma_f32_16x16x32_bf16 v[144:147], v[92:95], v[120:123], v[144:147]
  ds_read_b64_tr_b16 v[86:87], v14 offset:37376
  v_mfma_f32_16x16x32_bf16 v[136:139], v[92:95], v[116:119], v[136:139]
  v_mfma_f32_16x16x32_bf16 v[128:131], v[92:95], v[112:115], v[128:131]
  s_waitcnt lgkmcnt(2)
  v_mfma_f32_16x16x32_bf16 v[132:135], v[80:83], v[112:115], v[132:135]
  ds_read_b64_tr_b16 v[88:89], v31 offset:45056
  v_mfma_f32_16x16x32_bf16 v[140:143], v[80:83], v[116:119], v[140:143]
  ds_read_b64_tr_b16 v[90:91], v31 offset:45568
  v_mfma_f32_16x16x32_bf16 v[148:151], v[80:83], v[120:123], v[148:151]
  v_mfma_f32_16x16x32_bf16 v[156:159], v[80:83], v[124:127], v[156:159]
  s_waitcnt lgkmcnt(2)
  v_mfma_f32_16x16x32_bf16 v[188:191], v[84:87], v[124:127], v[188:191]
  ds_read_b64_tr_b16 v[92:93], v14 offset:45056
  buffer_store_dwordx4 v[248:251], v16, s[12:15], s71 offen offset:1024 sc1
  s_add_u32 s71, s71, 8192
  v_mfma_f32_16x16x32_bf16 v[180:183], v[84:87], v[120:123], v[180:183]
  ds_read_b64_tr_b16 v[94:95], v14 offset:45568
  v_mfma_f32_16x16x32_bf16 v[172:175], v[84:87], v[116:119], v[172:175]
  v_mfma_f32_16x16x32_bf16 v[164:167], v[84:87], v[112:115], v[164:167]
  s_waitcnt vmcnt(2) lgkmcnt(0)
  s_barrier
  v_mfma_f32_16x16x32_bf16 v[196:199], v[88:91], v[112:115], v[196:199]
  ds_read_b64_tr_b16 v[80:81], v27 offset:0
  ds_read_b64_tr_b16 v[82:83], v27 offset:512
  v_mfma_f32_16x16x32_bf16 v[204:207], v[88:91], v[116:119], v[204:207]
  ds_read_b128 v[96:99], v23 offset:0
  ds_read_b128 v[100:103], v23 offset:2048
  v_mfma_f32_16x16x32_bf16 v[212:215], v[88:91], v[120:123], v[212:215]
  ds_read_b128 v[104:107], v25 offset:0
  ds_read_b128 v[108:111], v25 offset:2048
  v_mfma_f32_16x16x32_bf16 v[220:223], v[88:91], v[124:127], v[220:223]
  ds_read_b64_tr_b16 v[84:85], v28 offset:0
  ds_read_b64_tr_b16 v[86:87], v28 offset:512
  v_mfma_f32_16x16x32_bf16 v[252:255], v[92:95], v[124:127], v[252:255]
  v_mfma_f32_16x16x32_bf16 v[244:247], v[92:95], v[120:123], v[244:247]
  v_mfma_f32_16x16x32_bf16 v[236:239], v[92:95], v[116:119], v[236:239]
  v_mfma_f32_16x16x32_bf16 v[228:231], v[92:95], v[112:115], v[228:231]
  s_waitcnt lgkmcnt(5)
  v_mfma_f32_16x16x32_bf16 v[32:35], v[80:83], v[96:99], v[32:35]
  ds_read_b64_tr_b16 v[88:89], v29 offset:0
  s_add_u32 m0, s64, 32768
  s_waitcnt lgkmcnt(5)
  v_mfma_f32_16x16x32_bf16 v[36:39], v[80:83], v[100:103], v[36:39]
  ds_read_b64_tr_b16 v[90:91], v29 offset:512
  buffer_load_dwordx4 v2, s[16:19], s67 offen offset:0 lds
  s_waitcnt lgkmcnt(5)
  v_mfma_f32_16x16x32_bf16 v[40:43], v[80:83], v[104:107], v[40:43]
  s_waitcnt lgkmcnt(4)
  v_mfma_f32_16x16x32_bf16 v[44:47], v[80:83], v[108:111], v[44:47]
  buffer_load_dwordx4 v3, s[16:19], s67 offen offset:1024 lds
  s_waitcnt lgkmcnt(2)
  v_mfma_f32_16x16x32_bf16 v[60:63], v[84:87], v[108:111], v[60:63]
  ds_read_b64_tr_b16 v[92:93], v30 offset:0
  v_mfma_f32_16x16x32_bf16 v[56:59], v[84:87], v[104:107], v[56:59]
  ds_read_b64_tr_b16 v[94:95], v30 offset:512
  buffer_load_dwordx4 v4, s[16:19], s67 offen offset:2048 lds
  v_mfma_f32_16x16x32_bf16 v[52:55], v[84:87], v[100:103], v[52:55]
  v_mfma_f32_16x16x32_bf16 v[48:51], v[84:87], v[96:99], v[48:51]
  buffer_load_dwordx4 v5, s[16:19], s67 offen offset:3072 lds
  s_add_u32 s67, s67, 40960
  s_add_u32 m0, s64, 36864
  s_waitcnt lgkmcnt(2)
  v_mfma_f32_16x16x32_bf16 v[64:67], v[88:91], v[96:99], v[64:67]
  ds_read_b64_tr_b16 v[80:81], v31 offset:0
  v_mfma_f32_16x16x32_bf16 v[68:71], v[88:91], v[100:103], v[68:71]
  ds_read_b64_tr_b16 v[82:83], v31 offset:512
  buffer_load_dwordx4 v2, s[16:19], s67 offen offset:0 lds
  v_mfma_f32_16x16x32_bf16 v[72:75], v[88:91], v[104:107], v[72:75]
  v_mfma_f32_16x16x32_bf16 v[76:79], v[88:91], v[108:111], v[76:79]
  ds_read_b128 v[112:115], v24 offset:0
  buffer_load_dwordx4 v3, s[16:19], s67 offen offset:1024 lds
  s_waitcnt lgkmcnt(3)
  v_mfma_f32_16x16x32_bf16 v[152:155], v[92:95], v[108:111], v[152:155]
  ds_read_b64_tr_b16 v[84:85], v14 offset:0
  v_mfma_f32_16x16x32_bf16 v[144:147], v[92:95], v[104:107], v[144:147]
  ds_read_b64_tr_b16 v[86:87], v14 offset:512
  buffer_load_dwordx4 v4, s[16:19], s67 offen offset:2048 lds
  v_mfma_f32_16x16x32_bf16 v[136:139], v[92:95], v[100:103], v[136:139]
  v_mfma_f32_16x16x32_bf16 v[128:131], v[92:95], v[96:99], v[128:131]
  ds_read_b128 v[116:119], v24 offset:2048
  buffer_load_dwordx4 v5, s[16:19], s67 offen offset:3072 lds
  s_sub_u32 s67, s67, 40832
  s_add_u32 m0, s64, 98304
  s_waitcnt lgkmcnt(4)
  v_mfma_f32_16x16x32_bf16 v[132:135], v[80:83], v[96:99], v[132:135]
  ds_read_b64_tr_b16 v[88:89], v31 offset:8192
  v_mfma_f32_16x16x32_bf16 v[140:143], v[80:83], v[100:103], v[140:143]
  ds_read_b64_tr_b16 v[90:91], v31 offset:8704
  buffer_load_dwordx4 v6, s[20:23], s68 offen offset:0 lds
  v_mfma_f32_16x16x32_bf16 v[148:151], v[80:83], v[104:107], v[148:151]
  v_mfma_f32_16x16x32_bf16 v[156:159], v[80:83], v[108:111], v[156:159]
  ds_read_b128 v[120:123], v26 offset:0
  buffer_load_dwordx4 v7, s[20:23], s68 offen offset:1024 lds
  s_waitcnt lgkmcnt(4)
  v_mfma_f32_16x16x32_bf16 v[188:191], v[84:87], v[108:111], v[188:191]
  ds_read_b64_tr_b16 v[92:93], v14 offset:8192
  v_mfma_f32_16x16x32_bf16 v[180:183], v[84:87], v[104:107], v[180:183]
  ds_read_b64_tr_b16 v[94:95], v14 offset:8704
  buffer_load_dwordx4 v8, s[20:23], s68 offen offset:2048 lds
  v_mfma_f32_16x16x32_bf16 v[172:175], v[84:87], v[100:103], v[172:175]
  v_mfma_f32_16x16x32_bf16 v[164:167], v[84:87], v[96:99], v[164:167]
  ds_read_b128 v[124:127], v26 offset:2048
  buffer_load_dwordx4 v9, s[20:23], s68 offen offset:3072 lds
  s_add_u32 s68, s68, s69
  s_add_u32 m0, s64, 102400
  s_waitcnt lgkmcnt(4)
  v_mfma_f32_16x16x32_bf16 v[196:199], v[88:91], v[96:99], v[196:199]
  ds_read_b64_tr_b16 v[80:81], v27 offset:4096
  v_mfma_f32_16x16x32_bf16 v[204:207], v[88:91], v[100:103], v[204:207]
  ds_read_b64_tr_b16 v[82:83], v27 offset:4608
  buffer_load_dwordx4 v6, s[20:23], s68 offen offset:0 lds
  v_mfma_f32_16x16x32_bf16 v[212:215], v[88:91], v[104:107], v[212:215]
  v_mfma_f32_16x16x32_bf16 v[220:223], v[88:91], v[108:111], v[220:223]
  buffer_load_dwordx4 v7, s[20:23], s68 offen offset:1024 lds
  s_waitcnt lgkmcnt(3)
  v_mfma_f32_16x16x32_bf16 v[252:255], v[92:95], v[108:111], v[252:255]
  ds_read_b64_tr_b16 v[84:85], v28 offset:4096
  v_mfma_f32_16x16x32_bf16 v[244:247], v[92:95], v[104:107], v[244:247]
  ds_read_b64_tr_b16 v[86:87], v28 offset:4608
  buffer_load_dwordx4 v8, s[20:23], s68 offen offset:2048 lds
  v_mfma_f32_16x16x32_bf16 v[236:239], v[92:95], v[100:103], v[236:239]
  v_mfma_f32_16x16x32_bf16 v[228:231], v[92:95], v[96:99], v[228:231]
  buffer_load_dwordx4 v9, s[20:23], s68 offen offset:3072 lds
  s_add_u32 s68, s68, s69
  s_waitcnt lgkmcnt(2)
  v_mfma_f32_16x16x32_bf16 v[32:35], v[80:83], v[112:115], v[32:35]
  ds_read_b64_tr_b16 v[88:89], v29 offset:4096
  v_mfma_f32_16x16x32_bf16 v[36:39], v[80:83], v[116:119], v[36:39]
  ds_read_b64_tr_b16 v[90:91], v29 offset:4608
  v_mfma_f32_16x16x32_bf16 v[40:43], v[80:83], v[120:123], v[40:43]
  v_mfma_f32_16x16x32_bf16 v[44:47], v[80:83], v[124:127], v[44:47]
  s_waitcnt lgkmcnt(2)
  v_mfma_f32_16x16x32_bf16 v[60:63], v[84:87], v[124:127], v[60:63]
  ds_read_b64_tr_b16 v[92:93], v30 offset:4096
  v_mfma_f32_16x16x32_bf16 v[56:59], v[84:87], v[120:123], v[56:59]
  ds_read_b64_tr_b16 v[94:95], v30 offset:4608
  v_mfma_f32_16x16x32_bf16 v[52:55], v[84:87], v[116:119], v[52:55]
  v_mfma_f32_16x16x32_bf16 v[48:51], v[84:87], v[112:115], v[48:51]
  s_waitcnt lgkmcnt(2)
  v_mfma_f32_16x16x32_bf16 v[64:67], v[88:91], v[112:115], v[64:67]
  ds_read_b64_tr_b16 v[80:81], v31 offset:4096
  v_mfma_f32_16x16x32_bf16 v[68:71], v[88:91], v[116:119], v[68:71]
  ds_read_b64_tr_b16 v[82:83], v31 offset:4608
  v_mfma_f32_16x16x32_bf16 v[72:75], v[88:91], v[120:123], v[72:75]
  v_mfma_f32_16x16x32_bf16 v[76:79], v[88:91], v[124:127], v[76:79]
  s_waitcnt lgkmcnt(2)
  v_mfma_f32_16x16x32_bf16 v[152:155], v[92:95], v[124:127], v[152:155]
  ds_read_b64_tr_b16 v[84:85], v14 offset:4096
  v_mfma_f32_16x16x32_bf16 v[144:147], v[92:95], v[120:123], v[144:147]
  ds_read_b64_tr_b16 v[86:87], v14 offset:4608
  v_mfma_f32_16x16x32_bf16 v[136:139], v[92:95], v[116:119], v[136:139]
  v_mfma_f32_16x16x32_bf16 v[128:131], v[92:95], v[112:115], v[128:131]
  s_waitcnt lgkmcnt(2)
  v_mfma_f32_16x16x32_bf16 v[132:135], v[80:83], v[112:115], v[132:135]
  ds_read_b64_tr_b16 v[88:89], v31 offset:12288
  v_mfma_f32_16x16x32_bf16 v[140:143], v[80:83], v[116:119], v[140:143]
  ds_read_b64_tr_b16 v[90:91], v31 offset:12800
  v_mfma_f32_16x16x32_bf16 v[148:151], v[80:83], v[120:123], v[148:151]
  v_mfma_f32_16x16x32_bf16 v[156:159], v[80:83], v[124:127], v[156:159]
  s_waitcnt lgkmcnt(2)
  v_mfma_f32_16x16x32_bf16 v[188:191], v[84:87], v[124:127], v[188:191]
  ds_read_b64_tr_b16 v[92:93], v14 offset:12288
  v_mfma_f32_16x16x32_bf16 v[180:183], v[84:87], v[120:123], v[180:183]
  ds_read_b64_tr_b16 v[94:95], v14 offset:12800
  v_mfma_f32_16x16x32_bf16 v[172:175], v[84:87], v[116:119], v[172:175]
  v_mfma_f32_16x16x32_bf16 v[164:167], v[84:87], v[112:115], v[164:167]
  s_waitcnt vmcnt(0) lgkmcnt(0)
  s_barrier
  v_mfma_f32_16x16x32_bf16 v[196:199], v[88:91], v[112:115], v[196:199]
  ds_read_b64_tr_b16 v[80:81], v27 offset:32768
  ds_read_b64_tr_b16 v[82:83], v27 offset:33280
  v_mfma_f32_16x16x32_bf16 v[204:207], v[88:91], v[116:119], v[204:207]
  ds_read_b128 v[96:99], v23 offset:32768
  ds_read_b128 v[100:103], v23 offset:34816
  v_mfma_f32_16x16x32_bf16 v[212:215], v[88:91], v[120:123], v[212:215]
  ds_read_b128 v[104:107], v25 offset:32768
  ds_read_b128 v[108:111], v25 offset:34816
  v_mfma_f32_16x16x32_bf16 v[220:223], v[88:91], v[124:127], v[220:223]
  ds_read_b64_tr_b16 v[84:85], v28 offset:32768
  ds_read_b64_tr_b16 v[86:87], v28 offset:33280
  v_mfma_f32_16x16x32_bf16 v[252:255], v[92:95], v[124:127], v[252:255]
  v_mfma_f32_16x16x32_bf16 v[244:247], v[92:95], v[120:123], v[244:247]
  v_mfma_f32_16x16x32_bf16 v[236:239], v[92:95], v[116:119], v[236:239]
  v_mfma_f32_16x16x32_bf16 v[228:231], v[92:95], v[112:115], v[228:231]
  s_waitcnt lgkmcnt(5)
  v_mfma_f32_16x16x32_bf16 v[32:35], v[80:83], v[96:99], v[32:35]
  ds_read_b64_tr_b16 v[88:89], v29 offset:32768
  s_add_u32 m0, s64, 0
  s_waitcnt lgkmcnt(5)
  v_mfma_f32_16x16x32_bf16 v[36:39], v[80:83], v[100:103], v[36:39]
  ds_read_b64_tr_b16 v[90:91], v29 offset:33280
  buffer_load_dwordx4 v2, s[16:19], s67 offen offset:0 lds
  s_waitcnt lgkmcnt(5)
  v_mfma_f32_16x16x32_bf16 v[40:43], v[80:83], v[104:107], v[40:43]
  s_waitcnt lgkmcnt(4)
  v_mfma_f32_16x16x32_bf16 v[44:47], v[80:83], v[108:111], v[44:47]
  buffer_load_dwordx4 v3, s[16:19], s67 offen offset:1024 lds
  s_waitcnt lgkmcnt(2)
  v_mfma_f32_16x16x32_bf16 v[60:63], v[84:87], v[108:111], v[60:63]
  ds_read_b64_tr_b16 v[92:93], v30 offset:32768
  v_mfma_f32_16x16x32_bf16 v[56:59], v[84:87], v[104:107], v[56:59]
  ds_read_b64_tr_b16 v[94:95], v30 offset:33280
  buffer_load_dwordx4 v4, s[16:19], s67 offen offset:2048 lds
  v_mfma_f32_16x16x32_bf16 v[52:55], v[84:87], v[100:103], v[52:55]
  v_mfma_f32_16x16x32_bf16 v[48:51], v[84:87], v[96:99], v[48:51]
  buffer_load_dwordx4 v5, s[16:19], s67 offen offset:3072 lds
  s_add_u32 s67, s67, 40960
  s_add_u32 m0, s64, 4096
  s_waitcnt lgkmcnt(2)
  v_mfma_f32_16x16x32_bf16 v[64:67], v[88:91], v[96:99], v[64:67]
  ds_read_b64_tr_b16 v[80:81], v31 offset:32768
  v_mfma_f32_16x16x32_bf16 v[68:71], v[88:91], v[100:103], v[68:71]
  ds_read_b64_tr_b16 v[82:83], v31 offset:33280
  buffer_load_dwordx4 v2, s[16:19], s67 offen offset:0 lds
  v_mfma_f32_16x16x32_bf16 v[72:75], v[88:91], v[104:107], v[72:75]
  v_mfma_f32_16x16x32_bf16 v[76:79], v[88:91], v[108:111], v[76:79]
  ds_read_b128 v[112:115], v24 offset:32768
  buffer_load_dwordx4 v3, s[16:19], s67 offen offset:1024 lds
  s_waitcnt lgkmcnt(3)
  v_mfma_f32_16x16x32_bf16 v[152:155], v[92:95], v[108:111], v[152:155]
  ds_read_b64_tr_b16 v[84:85], v14 offset:32768
  v_mfma_f32_16x16x32_bf16 v[144:147], v[92:95], v[104:107], v[144:147]
  ds_read_b64_tr_b16 v[86:87], v14 offset:33280
  buffer_load_dwordx4 v4, s[16:19], s67 offen offset:2048 lds
  v_mfma_f32_16x16x32_bf16 v[136:139], v[92:95], v[100:103], v[136:139]
  v_mfma_f32_16x16x32_bf16 v[128:131], v[92:95], v[96:99], v[128:131]
  ds_read_b128 v[116:119], v24 offset:34816
  buffer_load_dwordx4 v5, s[16:19], s67 offen offset:3072 lds
  s_sub_u32 s67, s67, 40832
  s_add_u32 m0, s64, 65536
  s_waitcnt lgkmcnt(4)
  v_mfma_f32_16x16x32_bf16 v[132:135], v[80:83], v[96:99], v[132:135]
  ds_read_b64_tr_b16 v[88:89], v31 offset:40960
  v_mfma_f32_16x16x32_bf16 v[140:143], v[80:83], v[100:103], v[140:143]
  ds_read_b64_tr_b16 v[90:91], v31 offset:41472
  buffer_load_dwordx4 v6, s[20:23], s68 offen offset:0 lds
  v_mfma_f32_16x16x32_bf16 v[148:151], v[80:83], v[104:107], v[148:151]
  v_mfma_f32_16x16x32_bf16 v[156:159], v[80:83], v[108:111], v[156:159]
  ds_read_b128 v[120:123], v26 offset:32768
  buffer_load_dwordx4 v7, s[20:23], s68 offen offset:1024 lds
  s_waitcnt lgkmcnt(4)
  v_mfma_f32_16x16x32_bf16 v[188:191], v[84:87], v[108:111], v[188:191]
  ds_read_b64_tr_b16 v[92:93], v14 offset:40960
  v_mfma_f32_16x16x32_bf16 v[180:183], v[84:87], v[104:107], v[180:183]
  ds_read_b64_tr_b16 v[94:95], v14 offset:41472
  buffer_load_dwordx4 v8, s[20:23], s68 offen offset:2048 lds
  v_mfma_f32_16x16x32_bf16 v[172:175], v[84:87], v[100:103], v[172:175]
  v_mfma_f32_16x16x32_bf16 v[164:167], v[84:87], v[96:99], v[164:167]
  ds_read_b128 v[124:127], v26 offset:34816
  buffer_load_dwordx4 v9, s[20:23], s68 offen offset:3072 lds
  s_add_u32 s68, s68, s69
  s_add_u32 m0, s64, 69632
  s_waitcnt lgkmcnt(4)
  v_mfma_f32_16x16x32_bf16 v[196:199], v[88:91], v[96:99], v[196:199]
  ds_read_b64_tr_b16 v[80:81], v27 offset:36864
  v_mfma_f32_16x16x32_bf16 v[204:207], v[88:91], v[100:103], v[204:207]
  ds_read_b64_tr_b16 v[82:83], v27 offset:37376
  buffer_load_dwordx4 v6, s[20:23], s68 offen offset:0 lds
  v_mfma_f32_16x16x32_bf16 v[212:215], v[88:91], v[104:107], v[212:215]
  v_mfma_f32_16x16x32_bf16 v[220:223], v[88:91], v[108:111], v[220:223]
  buffer_load_dwordx4 v7, s[20:23], s68 offen offset:1024 lds
  s_waitcnt lgkmcnt(3)
  v_mfma_f32_16x16x32_bf16 v[252:255], v[92:95], v[108:111], v[252:255]
  ds_read_b64_tr_b16 v[84:85], v28 offset:36864
  v_mfma_f32_16x16x32_bf16 v[244:247], v[92:95], v[104:107], v[244:247]
  ds_read_b64_tr_b16 v[86:87], v28 offset:37376
  buffer_load_dwordx4 v8, s[20:23], s68 offen offset:2048 lds
  v_mfma_f32_16x16x32_bf16 v[236:239], v[92:95], v[100:103], v[236:239]
  v_mfma_f32_16x16x32_bf16 v[228:231], v[92:95], v[96:99], v[228:231]
  buffer_load_dwordx4 v9, s[20:23], s68 offen offset:3072 lds
  s_add_u32 s68, s68, s69
  s_waitcnt lgkmcnt(2)
  v_mfma_f32_16x16x32_bf16 v[32:35], v[80:83], v[112:115], v[32:35]
  ds_read_b64_tr_b16 v[88:89], v29 offset:36864
  v_mfma_f32_16x16x32_bf16 v[36:39], v[80:83], v[116:119], v[36:39]
  ds_read_b64_tr_b16 v[90:91], v29 offset:37376
  v_mfma_f32_16x16x32_bf16 v[40:43], v[80:83], v[120:123], v[40:43]
  v_mfma_f32_16x16x32_bf16 v[44:47], v[80:83], v[124:127], v[44:47]
  s_waitcnt lgkmcnt(2)
  v_mfma_f32_16x16x32_bf16 v[60:63], v[84:87], v[124:127], v[60:63]
  ds_read_b64_tr_b16 v[92:93], v30 offset:36864
  v_mfma_f32_16x16x32_bf16 v[56:59], v[84:87], v[120:123], v[56:59]
  ds_read_b64_tr_b16 v[94:95], v30 offset:37376
  v_mfma_f32_16x16x32_bf16 v[52:55], v[84:87], v[116:119], v[52:55]
  v_mfma_f32_16x16x32_bf16 v[48:51], v[84:87], v[112:115], v[48:51]
  s_waitcnt lgkmcnt(2)
  v_mfma_f32_16x16x32_bf16 v[64:67], v[88:91], v[112:115], v[64:67]
  ds_read_b64_tr_b16 v[80:81], v31 offset:36864
  v_mfma_f32_16x16x32_bf16 v[68:71], v[88:91], v[116:119], v[68:71]
  ds_read_b64_tr_b16 v[82:83], v31 offset:37376
  v_mfma_f32_16x16x32_bf16 v[72:75], v[88:91], v[120:123], v[72:75]
  v_mfma_f32_16x16x32_bf16 v[76:79], v[88:91], v[124:127], v[76:79]
  s_waitcnt lgkmcnt(2)
  v_mfma_f32_16x16x32_bf16 v[152:155], v[92:95], v[124:127], v[152:155]
  ds_read_b64_tr_b16 v[84:85], v14 offset:36864
  v_mfma_f32_16x16x32_bf16 v[144:147], v[92:95], v[120:123], v[144:147]
  ds_read_b64_tr_b16 v[86:87], v14 offset:37376
  v_mfma_f32_16x16x32_bf16 v[136:139], v[92:95], v[116:119], v[136:139]
  v_mfma_f32_16x16x32_bf16 v[128:131], v[92:95], v[112:115], v[128:131]
  s_waitcnt lgkmcnt(2)
  v_mfma_f32_16x16x32_bf16 v[132:135], v[80:83], v[112:115], v[132:135]
  ds_read_b64_tr_b16 v[88:89], v31 offset:45056
  v_mfma_f32_16x16x32_bf16 v[140:143], v[80:83], v[116:119], v[140:143]
  ds_read_b64_tr_b16 v[90:91], v31 offset:45568
  v_mfma_f32_16x16x32_bf16 v[148:151], v[80:83], v[120:123], v[148:151]
  v_mfma_f32_16x16x32_bf16 v[156:159], v[80:83], v[124:127], v[156:159]
  s_waitcnt lgkmcnt(2)
  v_mfma_f32_16x16x32_bf16 v[188:191], v[84:87], v[124:127], v[188:191]
  ds_read_b64_tr_b16 v[92:93], v14 offset:45056
  v_mfma_f32_16x16x32_bf16 v[180:183], v[84:87], v[120:123], v[180:183]
  ds_read_b64_tr_b16 v[94:95], v14 offset:45568
  v_mfma_f32_16x16x32_bf16 v[172:175], v[84:87], v[116:119], v[172:175]
  v_mfma_f32_16x16x32_bf16 v[164:167], v[84:87], v[112:115], v[164:167]
  s_waitcnt vmcnt(0) lgkmcnt(0)
  s_barrier
  v_mfma_f32_16x16x32_bf16 v[196:199], v[88:91], v[112:115], v[196:199]
  ds_read_b64_tr_b16 v[80:81], v27 offset:0
  ds_read_b64_tr_b16 v[82:83], v27 offset:512
  v_mfma_f32_16x16x32_bf16 v[204:207], v[88:91], v[116:119], v[204:207]
  ds_read_b128 v[96:99], v23 offset:0
  ds_read_b128 v[100:103], v23 offset:2048
  v_mfma_f32_16x16x32_bf16 v[212:215], v[88:91], v[120:123], v[212:215]
  ds_read_b128 v[104:107], v25 offset:0
  ds_read_b128 v[108:111], v25 offset:2048
  v_mfma_f32_16x16x32_bf16 v[220:223], v[88:91], v[124:127], v[220:223]
  ds_read_b64_tr_b16 v[84:85], v28 offset:0
  ds_read_b64_tr_b16 v[86:87], v28 offset:512
  v_mfma_f32_16x16x32_bf16 v[252:255], v[92:95], v[124:127], v[252:255]
  v_mfma_f32_16x16x32_bf16 v[244:247], v[92:95], v[120:123], v[244:247]
  v_mfma_f32_16x16x32_bf16 v[236:239], v[92:95], v[116:119], v[236:239]
  v_mfma_f32_16x16x32_bf16 v[228:231], v[92:95], v[112:115], v[228:231]
  s_waitcnt lgkmcnt(5)
  v_mfma_f32_16x16x32_bf16 v[32:35], v[80:83], v[96:99], v[32:35]
  ds_read_b64_tr_b16 v[88:89], v29 offset:0
  s_add_u32 m0, s64, 32768
  s_waitcnt lgkmcnt(5)
  v_mfma_f32_16x16x32_bf16 v[36:39], v[80:83], v[100:103], v[36:39]
  ds_read_b64_tr_b16 v[90:91], v29 offset:512
  buffer_load_dwordx4 v2, s[16:19], s67 offen offset:0 lds
  s_waitcnt lgkmcnt(5)
  v_mfma_f32_16x16x32_bf16 v[40:43], v[80:83], v[104:107], v[40:43]
  s_waitcnt lgkmcnt(4)
  v_mfma_f32_16x16x32_bf16 v[44:47], v[80:83], v[108:111], v[44:47]
  buffer_load_dwordx4 v3, s[16:19], s67 offen offset:1024 lds
  s_waitcnt lgkmcnt(2)
  v_mfma_f32_16x16x32_bf16 v[60:63], v[84:87], v[108:111], v[60:63]
  ds_read_b64_tr_b16 v[92:93], v30 offset:0
  v_mfma_f32_16x16x32_bf16 v[56:59], v[84:87], v[104:107], v[56:59]
  ds_read_b64_tr_b16 v[94:95], v30 offset:512
  buffer_load_dwordx4 v4, s[16:19], s67 offen offset:2048 lds
  v_mfma_f32_16x16x32_bf16 v[52:55], v[84:87], v[100:103], v[52:55]
  v_mfma_f32_16x16x32_bf16 v[48:51], v[84:87], v[96:99], v[48:51]
  buffer_load_dwordx4 v5, s[16:19], s67 offen offset:3072 lds
  s_add_u32 s67, s67, 40960
  s_add_u32 m0, s64, 36864
  s_waitcnt lgkmcnt(2)
  v_mfma_f32_16x16x32_bf16 v[64:67], v[88:91], v[96:99], v[64:67]
  ds_read_b64_tr_b16 v[80:81], v31 offset:0
  v_mfma_f32_16x16x32_bf16 v[68:71], v[88:91], v[100:103], v[68:71]
  ds_read_b64_tr_b16 v[82:83], v31 offset:512
  buffer_load_dwordx4 v2, s[16:19], s67 offen offset:0 lds
  v_mfma_f32_16x16x32_bf16 v[72:75], v[88:91], v[104:107], v[72:75]
  v_mfma_f32_16x16x32_bf16 v[76:79], v[88:91], v[108:111], v[76:79]
  ds_read_b128 v[112:115], v24 offset:0
  buffer_load_dwordx4 v3, s[16:19], s67 offen offset:1024 lds
  s_waitcnt lgkmcnt(3)
  v_mfma_f32_16x16x32_bf16 v[152:155], v[92:95], v[108:111], v[152:155]
  ds_read_b64_tr_b16 v[84:85], v14 offset:0
  v_mfma_f32_16x16x32_bf16 v[144:147], v[92:95], v[104:107], v[144:147]
  ds_read_b64_tr_b16 v[86:87], v14 offset:512
  buffer_load_dwordx4 v4, s[16:19], s67 offen offset:2048 lds
  v_mfma_f32_16x16x32_bf16 v[136:139], v[92:95], v[100:103], v[136:139]
  v_mfma_f32_16x16x32_bf16 v[128:131], v[92:95], v[96:99], v[128:131]
  ds_read_b128 v[116:119], v24 offset:2048
  buffer_load_dwordx4 v5, s[16:19], s67 offen offset:3072 lds
  s_sub_u32 s67, s67, 40832
  s_add_u32 m0, s64, 98304
  s_waitcnt lgkmcnt(4)
  v_mfma_f32_16x16x32_bf16 v[132:135], v[80:83], v[96:99], v[132:135]
  ds_read_b64_tr_b16 v[88:89], v31 offset:8192
  v_mfma_f32_16x16x32_bf16 v[140:143], v[80:83], v[100:103], v[140:143]
  ds_read_b64_tr_b16 v[90:91], v31 offset:8704
  buffer_load_dwordx4 v6, s[20:23], s68 offen offset:0 lds
  v_mfma_f32_16x16x32_bf16 v[148:151], v[80:83], v[104:107], v[148:151]
  v_mfma_f32_16x16x32_bf16 v[156:159], v[80:83], v[108:111], v[156:159]
  ds_read_b128 v[120:123], v26 offset:0
  buffer_load_dwordx4 v7, s[20:23], s68 offen offset:1024 lds
  s_waitcnt lgkmcnt(4)
  v_mfma_f32_16x16x32_bf16 v[188:191], v[84:87], v[108:111], v[188:191]
  ds_read_b64_tr_b16 v[92:93], v14 offset:8192
  v_mfma_f32_16x16x32_bf16 v[180:183], v[84:87], v[104:107], v[180:183]
  ds_read_b64_tr_b16 v[94:95], v14 offset:8704
  buffer_load_dwordx4 v8, s[20:23], s68 offen offset:2048 lds
  v_mfma_f32_16x16x32_bf16 v[172:175], v[84:87], v[100:103], v[172:175]
  v_mfma_f32_16x16x32_bf16 v[164:167], v[84:87], v[96:99], v[164:167]
  ds_read_b128 v[124:127], v26 offset:2048
  buffer_load_dwordx4 v9, s[20:23], s68 offen offset:3072 lds
  s_add_u32 s68, s68, s69
  s_add_u32 m0, s64, 102400
  s_waitcnt lgkmcnt(4)
  v_mfma_f32_16x16x32_bf16 v[196:199], v[88:91], v[96:99], v[196:199]
  ds_read_b64_tr_b16 v[80:81], v27 offset:4096
  v_mfma_f32_16x16x32_bf16 v[204:207], v[88:91], v[100:103], v[204:207]
  ds_read_b64_tr_b16 v[82:83], v27 offset:4608
  buffer_load_dwordx4 v6, s[20:23], s68 offen offset:0 lds
  v_mfma_f32_16x16x32_bf16 v[212:215], v[88:91], v[104:107], v[212:215]
  v_mfma_f32_16x16x32_bf16 v[220:223], v[88:91], v[108:111], v[220:223]
  buffer_load_dwordx4 v7, s[20:23], s68 offen offset:1024 lds
  s_waitcnt lgkmcnt(3)
  v_mfma_f32_16x16x32_bf16 v[252:255], v[92:95], v[108:111], v[252:255]
  ds_read_b64_tr_b16 v[84:85], v28 offset:4096
  v_mfma_f32_16x16x32_bf16 v[244:247], v[92:95], v[104:107], v[244:247]
  ds_read_b64_tr_b16 v[86:87], v28 offset:4608
  buffer_load_dwordx4 v8, s[20:23], s68 offen offset:2048 lds
  v_mfma_f32_16x16x32_bf16 v[236:239], v[92:95], v[100:103], v[236:239]
  v_mfma_f32_16x16x32_bf16 v[228:231], v[92:95], v[96:99], v[228:231]
  buffer_load_dwordx4 v9, s[20:23], s68 offen offset:3072 lds
  s_add_u32 s68, s68, s69
  s_waitcnt lgkmcnt(2)
  v_mfma_f32_16x16x32_bf16 v[32:35], v[80:83], v[112:115], v[32:35]
  ds_read_b64_tr_b16 v[88:89], v29 offset:4096
  v_mfma_f32_16x16x32_bf16 v[36:39], v[80:83], v[116:119], v[36:39]
  ds_read_b64_tr_b16 v[90:91], v29 offset:4608
  v_mfma_f32_16x16x32_bf16 v[40:43], v[80:83], v[120:123], v[40:43]
  v_mfma_f32_16x16x32_bf16 v[44:47], v[80:83], v[124:127], v[44:47]
  s_waitcnt lgkmcnt(2)
  v_mfma_f32_16x16x32_bf16 v[60:63], v[84:87], v[124:127], v[60:63]
  ds_read_b64_tr_b16 v[92:93], v30 offset:4096
  v_mfma_f32_16x16x32_bf16 v[56:59], v[84:87], v[120:123], v[56:59]
  ds_read_b64_tr_b16 v[94:95], v30 offset:4608
  v_mfma_f32_16x16x32_bf16 v[52:55], v[84:87], v[116:119], v[52:55]
  v_mfma_f32_16x16x32_bf16 v[48:51], v[84:87], v[112:115], v[48:51]
  s_waitcnt lgkmcnt(2)
  v_mfma_f32_16x16x32_bf16 v[64:67], v[88:91], v[112:115], v[64:67]
  ds_read_b64_tr_b16 v[80:81], v31 offset:4096
  v_mfma_f32_16x16x32_bf16 v[68:71], v[88:91], v[116:119], v[68:71]
  ds_read_b64_tr_b16 v[82:83], v31 offset:4608
  v_mfma_f32_16x16x32_bf16 v[72:75], v[88:91], v[120:123], v[72:75]
  v_mfma_f32_16x16x32_bf16 v[76:79], v[88:91], v[124:127], v[76:79]
  s_waitcnt lgkmcnt(2)
  v_mfma_f32_16x16x32_bf16 v[152:155], v[92:95], v[124:127], v[152:155]
  ds_read_b64_tr_b16 v[84:85], v14 offset:4096
  v_mfma_f32_16x16x32_bf16 v[144:147], v[92:95], v[120:123], v[144:147]
  ds_read_b64_tr_b16 v[86:87], v14 offset:4608
  v_mfma_f32_16x16x32_bf16 v[136:139], v[92:95], v[116:119], v[136:139]
  v_mfma_f32_16x16x32_bf16 v[128:131], v[92:95], v[112:115], v[128:131]
  s_waitcnt lgkmcnt(2)
  v_mfma_f32_16x16x32_bf16 v[132:135], v[80:83], v[112:115], v[132:135]
  ds_read_b64_tr_b16 v[88:89], v31 offset:12288
  v_mfma_f32_16x16x32_bf16 v[140:143], v[80:83], v[116:119], v[140:143]
  ds_read_b64_tr_b16 v[90:91], v31 offset:12800
  v_mfma_f32_16x16x32_bf16 v[148:151], v[80:83], v[120:123], v[148:151]
  v_mfma_f32_16x16x32_bf16 v[156:159], v[80:83], v[124:127], v[156:159]
  s_waitcnt lgkmcnt(2)
  v_mfma_f32_16x16x32_bf16 v[188:191], v[84:87], v[124:127], v[188:191]
  ds_read_b64_tr_b16 v[92:93], v14 offset:12288
  v_mfma_f32_16x16x32_bf16 v[180:183], v[84:87], v[120:123], v[180:183]
  ds_read_b64_tr_b16 v[94:95], v14 offset:12800
  v_mfma_f32_16x16x32_bf16 v[172:175], v[84:87], v[116:119], v[172:175]
  v_mfma_f32_16x16x32_bf16 v[164:167], v[84:87], v[112:115], v[164:167]
  s_waitcnt vmcnt(0) lgkmcnt(0)
  s_barrier
  v_mfma_f32_16x16x32_bf16 v[196:199], v[88:91], v[112:115], v[196:199]
  ds_read_b64_tr_b16 v[80:81], v31 offset:32768
  ds_read_b64_tr_b16 v[82:83], v31 offset:33280
  v_mfma_f32_16x16x32_bf16 v[204:207], v[88:91], v[116:119], v[204:207]
  ds_read_b128 v[96:99], v23 offset:32768
  ds_read_b128 v[100:103], v23 offset:34816
  v_mfma_f32_16x16x32_bf16 v[212:215], v[88:91], v[120:123], v[212:215]
  ds_read_b128 v[104:107], v25 offset:32768
  ds_read_b128 v[108:111], v25 offset:34816
  v_mfma_f32_16x16x32_bf16 v[220:223], v[88:91], v[124:127], v[220:223]
  ds_read_b64_tr_b16 v[84:85], v14 offset:32768
  ds_read_b64_tr_b16 v[86:87], v14 offset:33280
  v_mfma_f32_16x16x32_bf16 v[252:255], v[92:95], v[124:127], v[252:255]
  v_mfma_f32_16x16x32_bf16 v[244:247], v[92:95], v[120:123], v[244:247]
  v_mfma_f32_16x16x32_bf16 v[236:239], v[92:95], v[116:119], v[236:239]
  v_mfma_f32_16x16x32_bf16 v[228:231], v[92:95], v[112:115], v[228:231]
  s_waitcnt lgkmcnt(5)
  v_mfma_f32_16x16x32_bf16 v[132:135], v[80:83], v[96:99], v[132:135]
  ds_read_b64_tr_b16 v[88:89], v31 offset:40960
  s_waitcnt lgkmcnt(5)
  v_mfma_f32_16x16x32_bf16 v[140:143], v[80:83], v[100:103], v[140:143]
  ds_read_b64_tr_b16 v[90:91], v31 offset:41472
  s_waitcnt lgkmcnt(5)
  v_mfma_f32_16x16x32_bf16 v[148:151], v[80:83], v[104:107], v[148:151]
  ds_read_b128 v[112:115], v24 offset:32768
  s_waitcnt lgkmcnt(5)
  v_mfma_f32_16x16x32_bf16 v[156:159], v[80:83], v[108:111], v[156:159]
  ds_read_b128 v[116:119], v24 offset:34816
  s_waitcnt lgkmcnt(4)
  v_mfma_f32_16x16x32_bf16 v[188:191], v[84:87], v[108:111], v[188:191]
  ds_read_b64_tr_b16 v[92:93], v14 offset:40960
  v_mfma_f32_16x16x32_bf16 v[180:183], v[84:87], v[104:107], v[180:183]
  ds_read_b64_tr_b16 v[94:95], v14 offset:41472
  v_mfma_f32_16x16x32_bf16 v[172:175], v[84:87], v[100:103], v[172:175]
  ds_read_b128 v[120:123], v26 offset:32768
  v_mfma_f32_16x16x32_bf16 v[164:167], v[84:87], v[96:99], v[164:167]
  ds_read_b128 v[124:127], v26 offset:34816
  s_waitcnt lgkmcnt(6)
  v_mfma_f32_16x16x32_bf16 v[196:199], v[88:91], v[96:99], v[196:199]
  ds_read_b64_tr_b16 v[80:81], v31 offset:36864
  v_mfma_f32_16x16x32_bf16 v[204:207], v[88:91], v[100:103], v[204:207]
  ds_read_b64_tr_b16 v[82:83], v31 offset:37376
  v_mfma_f32_16x16x32_bf16 v[212:215], v[88:91], v[104:107], v[212:215]
  v_mfma_f32_16x16x32_bf16 v[220:223], v[88:91], v[108:111], v[220:223]
  s_waitcnt lgkmcnt(4)
  v_mfma_f32_16x16x32_bf16 v[252:255], v[92:95], v[108:111], v[252:255]
  ds_read_b64_tr_b16 v[84:85], v14 offset:36864
  v_mfma_f32_16x16x32_bf16 v[244:247], v[92:95], v[104:107], v[244:247]
  ds_read_b64_tr_b16 v[86:87], v14 offset:37376
  v_mfma_f32_16x16x32_bf16 v[236:239], v[92:95], v[100:103], v[236:239]
  v_mfma_f32_16x16x32_bf16 v[228:231], v[92:95], v[96:99], v[228:231]
  s_waitcnt lgkmcnt(2)
  v_mfma_f32_16x16x32_bf16 v[132:135], v[80:83], v[112:115], v[132:135]
  ds_read_b64_tr_b16 v[88:89], v31 offset:45056
  v_mfma_f32_16x16x32_bf16 v[140:143], v[80:83], v[116:119], v[140:143]
  ds_read_b64_tr_b16 v[90:91], v31 offset:45568
  v_mfma_f32_16x16x32_bf16 v[148:151], v[80:83], v[120:123], v[148:151]
  ds_read_b128 v[96:99], v23 offset:32768
  v_mfma_f32_16x16x32_bf16 v[156:159], v[80:83], v[124:127], v[156:159]
  ds_read_b128 v[100:103], v23 offset:34816
  s_waitcnt lgkmcnt(4)
  v_mfma_f32_16x16x32_bf16 v[188:191], v[84:87], v[124:127], v[188:191]
  ds_read_b64_tr_b16 v[92:93], v14 offset:45056
  s_mov_b32 s94, 0xbdd2d3e8
  v_mov_b32 v1, 0xc0135761
  v_mfma_f32_16x16x32_bf16 v[180:183], v[84:87], v[120:123], v[180:183]
  ds_read_b64_tr_b16 v[94:95], v14 offset:45568
  v_mfma_f32_16x16x32_bf16 v[172:175], v[84:87], v[116:119], v[172:175]
  ds_read_b128 v[104:107], v25 offset:32768
  v_mfma_f32_16x16x32_bf16 v[164:167], v[84:87], v[112:115], v[164:167]
  ds_read_b128 v[108:111], v25 offset:34816
  s_waitcnt lgkmcnt(6)
  v_mfma_f32_16x16x32_bf16 v[196:199], v[88:91], v[112:115], v[196:199]
  ds_read_b64_tr_b16 v[80:81], v27 offset:32768
  v_mfma_f32_16x16x32_bf16 v[204:207], v[88:91], v[116:119], v[204:207]
  ds_read_b64_tr_b16 v[82:83], v27 offset:33280
  v_mfma_f32_16x16x32_bf16 v[212:215], v[88:91], v[120:123], v[212:215]
  v_mfma_f32_16x16x32_bf16 v[220:223], v[88:91], v[124:127], v[220:223]
  s_waitcnt lgkmcnt(4)
  v_mfma_f32_16x16x32_bf16 v[252:255], v[92:95], v[124:127], v[252:255]
  ds_read_b64_tr_b16 v[84:85], v28 offset:32768
  v_mfma_f32_16x16x32_bf16 v[244:247], v[92:95], v[120:123], v[244:247]
  ds_read_b64_tr_b16 v[86:87], v28 offset:33280
  v_mfma_f32_16x16x32_bf16 v[236:239], v[92:95], v[116:119], v[236:239]
  v_mfma_f32_16x16x32_bf16 v[228:231], v[92:95], v[112:115], v[228:231]
  s_waitcnt lgkmcnt(2)
  v_mfma_f32_16x16x32_bf16 v[32:35], v[80:83], v[96:99], v[32:35]
  ds_read_b64_tr_b16 v[88:89], v29 offset:32768
  v_mfma_f32_16x16x32_bf16 v[36:39], v[80:83], v[100:103], v[36:39]
  ds_read_b64_tr_b16 v[90:91], v29 offset:33280
  v_mfma_f32_16x16x32_bf16 v[40:43], v[80:83], v[104:107], v[40:43]
  ds_read_b128 v[112:115], v24 offset:32768
  v_mul_f32 v160, v132, v132
  v_mfma_f32_16x16x32_bf16 v[44:47], v[80:83], v[108:111], v[44:47]
  ds_read_b128 v[116:119], v24 offset:34816
  v_mul_f32 v161, v133, v133
  s_waitcnt lgkmcnt(4)
  v_mfma_f32_16x16x32_bf16 v[60:63], v[84:87], v[108:111], v[60:63]
  ds_read_b64_tr_b16 v[92:93], v30 offset:32768
  v_mul_f32 v162, v134, v134
  v_mfma_f32_16x16x32_bf16 v[56:59], v[84:87], v[104:107], v[56:59]
  ds_read_b64_tr_b16 v[94:95], v30 offset:33280
  v_mul_f32 v163, v135, v135
  v_mfma_f32_16x16x32_bf16 v[52:55], v[84:87], v[100:103], v[52:55]
  ds_read_b128 v[120:123], v26 offset:32768
  v_fma_f32 v160, v160, s94, v1
  v_mfma_f32_16x16x32_bf16 v[48:51], v[84:87], v[96:99], v[48:51]
  ds_read_b128 v[124:127], v26 offset:34816
  v_fma_f32 v161, v161, s94, v1
  s_waitcnt lgkmcnt(6)
  v_mfma_f32_16x16x32_bf16 v[64:67], v[88:91], v[96:99], v[64:67]
  ds_read_b64_tr_b16 v[80:81], v27 offset:36864
  v_fma_f32 v162, v162, s94, v1
  v_mfma_f32_16x16x32_bf16 v[68:71], v[88:91], v[100:103], v[68:71]
  ds_read_b64_tr_b16 v[82:83], v27 offset:37376
  v_fma_f32 v163, v163, s94, v1
  v_mfma_f32_16x16x32_bf16 v[72:75], v[88:91], v[104:107], v[72:75]
  v_mul_f32 v160, v160, v132
  v_mul_f32 v161, v161, v133
  v_mfma_f32_16x16x32_bf16 v[76:79], v[88:91], v[108:111], v[76:79]
  v_mul_f32 v162, v162, v134
  v_mul_f32 v163, v163, v135
  s_waitcnt lgkmcnt(4)
  v_mfma_f32_16x16x32_bf16 v[152:155], v[92:95], v[108:111], v[152:155]
  ds_read_b64_tr_b16 v[84:85], v28 offset:36864
  v_exp_f32 v160, v160
  v_mfma_f32_16x16x32_bf16 v[144:147], v[92:95], v[104:107], v[144:147]
  ds_read_b64_tr_b16 v[86:87], v28 offset:37376
  v_mul_f32 v132, v132, v196
  v_mfma_f32_16x16x32_bf16 v[136:139], v[92:95], v[100:103], v[136:139]
  v_exp_f32 v161, v161
  v_mul_f32 v133, v133, v197
  v_mfma_f32_16x16x32_bf16 v[128:131], v[92:95], v[96:99], v[128:131]
  v_exp_f32 v162, v162
  v_mul_f32 v134, v134, v198
  s_waitcnt lgkmcnt(2)
  v_mfma_f32_16x16x32_bf16 v[32:35], v[80:83], v[112:115], v[32:35]
  ds_read_b64_tr_b16 v[88:89], v29 offset:36864
  v_exp_f32 v163, v163
  v_mfma_f32_16x16x32_bf16 v[36:39], v[80:83], v[116:119], v[36:39]
  ds_read_b64_tr_b16 v[90:91], v29 offset:37376
  v_mul_f32 v135, v135, v199
  v_mfma_f32_16x16x32_bf16 v[40:43], v[80:83], v[120:123], v[40:43]
  v_add_f32 v160, 1.0, v160
  v_add_f32 v161, 1.0, v161
  v_mfma_f32_16x16x32_bf16 v[44:47], v[80:83], v[124:127], v[44:47]
  v_add_f32 v162, 1.0, v162
  v_add_f32 v163, 1.0, v163
  s_waitcnt lgkmcnt(2)
  v_mfma_f32_16x16x32_bf16 v[60:63], v[84:87], v[124:127], v[60:63]
  ds_read_b64_tr_b16 v[92:93], v30 offset:36864
  v_rcp_f32 v160, v160
  v_mfma_f32_16x16x32_bf16 v[56:59], v[84:87], v[120:123], v[56:59]
  ds_read_b64_tr_b16 v[94:95], v30 offset:37376
  v_rcp_f32 v161, v161
  v_mfma_f32_16x16x32_bf16 v[52:55], v[84:87], v[116:119], v[52:55]
  v_rcp_f32 v162, v162
  v_rcp_f32 v163, v163
  v_mfma_f32_16x16x32_bf16 v[48:51], v[84:87], v[112:115], v[48:51]
  v_mul_f32 v160, v160, v132
  v_mul_f32 v161, v161, v133
  s_waitcnt lgkmcnt(0)
  s_barrier
  v_mfma_f32_16x16x32_bf16 v[64:67], v[88:91], v[112:115], v[64:67]
  v_mul_f32 v162, v162, v134
  v_mul_f32 v163, v163, v135
  v_mfma_f32_16x16x32_bf16 v[68:71], v[88:91], v[116:119], v[68:71]
  v_cvt_pk_bf16_f32 v224, v160, v161
  v_cvt_pk_bf16_f32 v225, v162, v163
  v_mfma_f32_16x16x32_bf16 v[72:75], v[88:91], v[120:123], v[72:75]
  v_mul_f32 v168, v164, v164
  v_mul_f32 v169, v165, v165
  v_mfma_f32_16x16x32_bf16 v[76:79], v[88:91], v[124:127], v[76:79]
  v_mul_f32 v170, v166, v166
  v_mul_f32 v171, v167, v167
  v_mfma_f32_16x16x32_bf16 v[152:155], v[92:95], v[124:127], v[152:155]
  v_fma_f32 v168, v168, s94, v1
  v_fma_f32 v169, v169, s94, v1
  v_mfma_f32_16x16x32_bf16 v[144:147], v[92:95], v[120:123], v[144:147]
  v_fma_f32 v170, v170, s94, v1
  v_fma_f32 v171, v171, s94, v1
  v_mfma_f32_16x16x32_bf16 v[136:139], v[92:95], v[116:119], v[136:139]
  v_mul_f32 v168, v168, v164
  v_mul_f32 v169, v169, v165
  v_mfma_f32_16x16x32_bf16 v[128:131], v[92:95], v[112:115], v[128:131]
  v_mul_f32 v170, v170, v166
  v_mul_f32 v171, v171, v167
  s_mov_b32 s93, s72
  s_lshl_b32 s85, s31, 1
  s_add_u32 s85, s85, 3
  s_mul_i32 s84, s85, 52
  s_lshr_b32 s84, s84, 8
  s_mul_i32 s84, s84, 5
  s_sub_u32 s85, s85, s84
  s_lshl_b32 s85, s85, 15
  v_exp_f32 v168, v168
  v_mul_f32 v164, v164, v228
  v_exp_f32 v169, v169
  v_mul_f32 v165, v165, v229
  v_exp_f32 v170, v170
  v_mul_f32 v166, v166, v230
  v_exp_f32 v171, v171
  v_mul_f32 v167, v167, v231
  v_add_f32 v168, 1.0, v168
  v_add_f32 v169, 1.0, v169
  v_add_f32 v170, 1.0, v170
  v_add_f32 v171, 1.0, v171
  v_rcp_f32 v168, v168
  v_rcp_f32 v169, v169
  v_rcp_f32 v170, v170
  v_rcp_f32 v171, v171
  v_mul_f32 v168, v168, v164
  v_mul_f32 v169, v169, v165
  v_mul_f32 v170, v170, v166
  v_mul_f32 v171, v171, v167
  v_cvt_pk_bf16_f32 v226, v168, v169
  v_cvt_pk_bf16_f32 v227, v170, v171
  v_pk_mul_f32 v[176:177], v[140:141], v[140:141]
  v_pk_mul_f32 v[178:179], v[142:143], v[142:143]
  v_pk_mul_f32 v[184:185], v[172:173], v[172:173]
  v_pk_mul_f32 v[186:187], v[174:175], v[174:175]
  v_pk_fma_f32 v[176:177], v[176:177], s[94:95], v[0:1] op_sel:[0,0,1] op_sel_hi:[1,0,1]
  v_pk_fma_f32 v[178:179], v[178:179], s[94:95], v[0:1] op_sel:[0,0,1] op_sel_hi:[1,0,1]
  v_pk_fma_f32 v[184:185], v[184:185], s[94:95], v[0:1] op_sel:[0,0,1] op_sel_hi:[1,0,1]
  v_pk_fma_f32 v[186:187], v[186:187], s[94:95], v[0:1] op_sel:[0,0,1] op_sel_hi:[1,0,1]
  v_pk_mul_f32 v[176:177], v[176:177], v[140:141]
  v_pk_mul_f32 v[178:179], v[178:179], v[142:143]
  v_pk_mul_f32 v[184:185], v[184:185], v[172:173]
  v_pk_mul_f32 v[186:187], v[186:187], v[174:175]
  v_exp_f32 v176, v176
  v_exp_f32 v177, v177
  v_exp_f32 v178, v178
  v_exp_f32 v179, v179
  v_pk_mul_f32 v[140:141], v[140:141], v[204:205]
  v_pk_mul_f32 v[142:143], v[142:143], v[206:207]
  v_exp_f32 v184, v184
  v_exp_f32 v185, v185
  v_exp_f32 v186, v186
  v_exp_f32 v187, v187
  v_pk_mul_f32 v[172:173], v[172:173], v[236:237]
  v_pk_mul_f32 v[174:175], v[174:175], v[238:239]
  v_pk_add_f32 v[176:177], v[176:177], 1.0 op_sel_hi:[1,0]
  v_pk_add_f32 v[178:179], v[178:179], 1.0 op_sel_hi:[1,0]
  v_pk_add_f32 v[184:185], v[184:185], 1.0 op_sel_hi:[1,0]
  v_pk_add_f32 v[186:187], v[186:187], 1.0 op_sel_hi:[1,0]
  v_rcp_f32 v176, v176
  v_rcp_f32 v177, v177
  v_rcp_f32 v178, v178
  v_rcp_f32 v179, v179
  v_rcp_f32 v184, v184
  v_rcp_f32 v185, v185
  v_rcp_f32 v186, v186
  v_rcp_f32 v187, v187
  v_pk_mul_f32 v[176:177], v[176:177], v[140:141]
  v_pk_mul_f32 v[178:179], v[178:179], v[142:143]
  v_pk_mul_f32 v[184:185], v[184:185], v[172:173]
  v_pk_mul_f32 v[186:187], v[186:187], v[174:175]
  v_cvt_pk_bf16_f32 v232, v176, v177
  v_cvt_pk_bf16_f32 v233, v178, v179
  v_cvt_pk_bf16_f32 v234, v184, v185
  v_cvt_pk_bf16_f32 v235, v186, v187
  v_pk_mul_f32 v[160:161], v[148:149], v[148:149]
  v_pk_mul_f32 v[162:163], v[150:151], v[150:151]
  v_pk_mul_f32 v[168:169], v[180:181], v[180:181]
  v_pk_mul_f32 v[170:171], v[182:183], v[182:183]
  v_pk_fma_f32 v[160:161], v[160:161], s[94:95], v[0:1] op_sel:[0,0,1] op_sel_hi:[1,0,1]
  v_pk_fma_f32 v[162:163], v[162:163], s[94:95], v[0:1] op_sel:[0,0,1] op_sel_hi:[1,0,1]
  v_pk_fma_f32 v[168:169], v[168:169], s[94:95], v[0:1] op_sel:[0,0,1] op_sel_hi:[1,0,1]
  v_pk_fma_f32 v[170:171], v[170:171], s[94:95], v[0:1] op_sel:[0,0,1] op_sel_hi:[1,0,1]
  v_pk_mul_f32 v[160:161], v[160:161], v[148:149]
  v_pk_mul_f32 v[162:163], v[162:163], v[150:151]
  v_pk_mul_f32 v[168:169], v[168:169], v[180:181]
  v_pk_mul_f32 v[170:171], v[170:171], v[182:183]
  v_exp_f32 v160, v160
  v_exp_f32 v161, v161
  v_exp_f32 v162, v162
  v_exp_f32 v163, v163
  v_pk_mul_f32 v[148:149], v[148:149], v[212:213]
  v_pk_mul_f32 v[150:151], v[150:151], v[214:215]
  v_exp_f32 v168, v168
  v_exp_f32 v169, v169
  v_exp_f32 v170, v170
  v_exp_f32 v171, v171
  v_pk_mul_f32 v[180:181], v[180:181], v[244:245]
  v_pk_mul_f32 v[182:183], v[182:183], v[246:247]
  v_pk_add_f32 v[160:161], v[160:161], 1.0 op_sel_hi:[1,0]
  v_pk_add_f32 v[162:163], v[162:163], 1.0 op_sel_hi:[1,0]
  v_pk_add_f32 v[168:169], v[168:169], 1.0 op_sel_hi:[1,0]
  v_pk_add_f32 v[170:171], v[170:171], 1.0 op_sel_hi:[1,0]
  v_rcp_f32 v160, v160
  v_rcp_f32 v161, v161
  v_rcp_f32 v162, v162
  v_rcp_f32 v163, v163
  v_rcp_f32 v168, v168
  v_rcp_f32 v169, v169
  v_rcp_f32 v170, v170
  v_rcp_f32 v171, v171
  v_pk_mul_f32 v[160:161], v[160:161], v[148:149]
  v_pk_mul_f32 v[162:163], v[162:163], v[150:151]
  v_pk_mul_f32 v[168:169], v[168:169], v[180:181]
  v_pk_mul_f32 v[170:171], v[170:171], v[182:183]
  v_cvt_pk_bf16_f32 v240, v160, v161
  v_cvt_pk_bf16_f32 v241, v162, v163
  v_cvt_pk_bf16_f32 v242, v168, v169
  v_cvt_pk_bf16_f32 v243, v170, v171
  v_pk_mul_f32 v[176:177], v[156:157], v[156:157]
  v_pk_mul_f32 v[178:179], v[158:159], v[158:159]
  v_pk_mul_f32 v[184:185], v[188:189], v[188:189]
  v_pk_mul_f32 v[186:187], v[190:191], v[190:191]
  v_pk_fma_f32 v[176:177], v[176:177], s[94:95], v[0:1] op_sel:[0,0,1] op_sel_hi:[1,0,1]
  v_pk_fma_f32 v[178:179], v[178:179], s[94:95], v[0:1] op_sel:[0,0,1] op_sel_hi:[1,0,1]
  v_pk_fma_f32 v[184:185], v[184:185], s[94:95], v[0:1] op_sel:[0,0,1] op_sel_hi:[1,0,1]
  v_pk_fma_f32 v[186:187], v[186:187], s[94:95], v[0:1] op_sel:[0,0,1] op_sel_hi:[1,0,1]
  v_pk_mul_f32 v[176:177], v[176:177], v[156:157]
  v_pk_mul_f32 v[178:179], v[178:179], v[158:159]
  v_pk_mul_f32 v[184:185], v[184:185], v[188:189]
  v_pk_mul_f32 v[186:187], v[186:187], v[190:191]
  v_exp_f32 v176, v176
  v_exp_f32 v177, v177
  v_exp_f32 v178, v178
  v_exp_f32 v179, v179
  v_pk_mul_f32 v[156:157], v[156:157], v[220:221]
  v_pk_mul_f32 v[158:159], v[158:159], v[222:223]
  v_exp_f32 v184, v184
  v_exp_f32 v185, v185
  v_exp_f32 v186, v186
  v_exp_f32 v187, v187
  v_pk_mul_f32 v[188:189], v[188:189], v[252:253]
  v_pk_mul_f32 v[190:191], v[190:191], v[254:255]
  v_pk_add_f32 v[176:177], v[176:177], 1.0 op_sel_hi:[1,0]
  v_pk_add_f32 v[178:179], v[178:179], 1.0 op_sel_hi:[1,0]
  v_pk_add_f32 v[184:185], v[184:185], 1.0 op_sel_hi:[1,0]
  v_pk_add_f32 v[186:187], v[186:187], 1.0 op_sel_hi:[1,0]
  v_rcp_f32 v176, v176
  v_rcp_f32 v177, v177
  v_rcp_f32 v178, v178
  v_rcp_f32 v179, v179
  v_rcp_f32 v184, v184
  v_rcp_f32 v185, v185
  v_rcp_f32 v186, v186
  v_rcp_f32 v187, v187
  v_pk_mul_f32 v[176:177], v[176:177], v[156:157]
  v_pk_mul_f32 v[178:179], v[178:179], v[158:159]
  v_pk_mul_f32 v[184:185], v[184:185], v[188:189]
  v_pk_mul_f32 v[186:187], v[186:187], v[190:191]
  v_cvt_pk_bf16_f32 v248, v176, v177
  v_cvt_pk_bf16_f32 v249, v178, v179
  v_cvt_pk_bf16_f32 v250, v184, v185
  v_cvt_pk_bf16_f32 v251, v186, v187
  s_add_u32 s33, s85, 131072
  s_sub_u32 s34, s33, 163840
  s_cselect_b32 s33, s33, s34
  s_lshl_b32 s34, s28, 12
  s_add_u32 s33, s33, s34
  v_add_u32 v24, s33, v16
  v_xor_b32 v25, 4096, v24
  s_mov_b32 s34, 0x3e0293ee
  s_bitcmp1_b32 s28, 0
  s_cbranch_scc1 F_X1A
  v_pk_mul_f32 v[36:37], v[36:37], s[34:35] op_sel_hi:[1,0]
  v_pk_mul_f32 v[38:39], v[38:39], s[34:35] op_sel_hi:[1,0]
  v_pk_mul_f32 v[52:53], v[52:53], s[34:35] op_sel_hi:[1,0]
  v_pk_mul_f32 v[54:55], v[54:55], s[34:35] op_sel_hi:[1,0]
  v_cvt_pk_bf16_f32 v96, v36, v37
  v_cvt_pk_bf16_f32 v97, v38, v39
  v_cvt_pk_bf16_f32 v98, v52, v53
  v_cvt_pk_bf16_f32 v99, v54, v55
  ds_write_b128 v24, v[96:99] offset:0
  v_pk_mul_f32 v[68:69], v[68:69], s[34:35] op_sel_hi:[1,0]
  v_pk_mul_f32 v[70:71], v[70:71], s[34:35] op_sel_hi:[1,0]
  v_pk_mul_f32 v[136:137], v[136:137], s[34:35] op_sel_hi:[1,0]
  v_pk_mul_f32 v[138:139], v[138:139], s[34:35] op_sel_hi:[1,0]
  v_cvt_pk_bf16_f32 v100, v68, v69
  v_cvt_pk_bf16_f32 v101, v70, v71
  v_cvt_pk_bf16_f32 v102, v136, v137
  v_cvt_pk_bf16_f32 v103, v138, v139
  ds_write_b128 v24, v[100:103] offset:1024
  v_pk_mul_f32 v[40:41], v[40:41], s[34:35] op_sel_hi:[1,0]
  v_pk_mul_f32 v[42:43], v[42:43], s[34:35] op_sel_hi:[1,0]
  v_pk_mul_f32 v[56:57], v[56:57], s[34:35] op_sel_hi:[1,0]
  v_pk_mul_f32 v[58:59], v[58:59], s[34:35] op_sel_hi:[1,0]
  v_cvt_pk_bf16_f32 v104, v40, v41
  v_cvt_pk_bf16_f32 v105, v42, v43
  v_cvt_pk_bf16_f32 v106, v56, v57
  v_cvt_pk_bf16_f32 v107, v58, v59
  ds_write_b128 v24, v[104:107] offset:2048
  v_pk_mul_f32 v[72:73], v[72:73], s[34:35] op_sel_hi:[1,0]
  v_pk_mul_f32 v[74:75], v[74:75], s[34:35] op_sel_hi:[1,0]
  v_pk_mul_f32 v[144:145], v[144:145], s[34:35] op_sel_hi:[1,0]
  v_pk_mul_f32 v[146:147], v[146:147], s[34:35] op_sel_hi:[1,0]
  v_cvt_pk_bf16_f32 v108, v72, v73
  v_cvt_pk_bf16_f32 v109, v74, v75
  v_cvt_pk_bf16_f32 v110, v144, v145
  v_cvt_pk_bf16_f32 v111, v146, v147
  ds_write_b128 v24, v[108:111] offset:3072
  v_pk_mul_f32 v[32:33], v[32:33], s[34:35] op_sel_hi:[1,0]
  v_pk_mul_f32 v[34:35], v[34:35], s[34:35] op_sel_hi:[1,0]
  v_pk_mul_f32 v[48:49], v[48:49], s[34:35] op_sel_hi:[1,0]
  v_pk_mul_f32 v[50:51], v[50:51], s[34:35] op_sel_hi:[1,0]
  v_cvt_pk_bf16_f32 v192, v32, v33
  v_cvt_pk_bf16_f32 v193, v34, v35
  v_cvt_pk_bf16_f32 v194, v48, v49
  v_cvt_pk_bf16_f32 v195, v50, v51
  v_pk_mul_f32 v[64:65], v[64:65], s[34:35] op_sel_hi:[1,0]
  v_pk_mul_f32 v[66:67], v[66:67], s[34:35] op_sel_hi:[1,0]
  v_pk_mul_f32 v[128:129], v[128:129], s[34:35] op_sel_hi:[1,0]
  v_pk_mul_f32 v[130:131], v[130:131], s[34:35] op_sel_hi:[1,0]
  v_cvt_pk_bf16_f32 v196, v64, v65
  v_cvt_pk_bf16_f32 v197, v66, v67
  v_cvt_pk_bf16_f32 v198, v128, v129
  v_cvt_pk_bf16_f32 v199, v130, v131
  v_pk_mul_f32 v[44:45], v[44:45], s[34:35] op_sel_hi:[1,0]
  v_pk_mul_f32 v[46:47], v[46:47], s[34:35] op_sel_hi:[1,0]
  v_pk_mul_f32 v[60:61], v[60:61], s[34:35] op_sel_hi:[1,0]
  v_pk_mul_f32 v[62:63], v[62:63], s[34:35] op_sel_hi:[1,0]
  v_cvt_pk_bf16_f32 v208, v44, v45
  v_cvt_pk_bf16_f32 v209, v46, v47
  v_cvt_pk_bf16_f32 v210, v60, v61
  v_cvt_pk_bf16_f32 v211, v62, v63
  v_pk_mul_f32 v[76:77], v[76:77], s[34:35] op_sel_hi:[1,0]
  v_pk_mul_f32 v[78:79], v[78:79], s[34:35] op_sel_hi:[1,0]
  v_pk_mul_f32 v[152:153], v[152:153], s[34:35] op_sel_hi:[1,0]
  v_pk_mul_f32 v[154:155], v[154:155], s[34:35] op_sel_hi:[1,0]
  v_cvt_pk_bf16_f32 v212, v76, v77
  v_cvt_pk_bf16_f32 v213, v78, v79
  v_cvt_pk_bf16_f32 v214, v152, v153
  v_cvt_pk_bf16_f32 v215, v154, v155
  s_branch F_X2A
F_X1A:
  v_pk_mul_f32 v[32:33], v[32:33], s[34:35] op_sel_hi:[1,0]
  v_pk_mul_f32 v[34:35], v[34:35], s[34:35] op_sel_hi:[1,0]
  v_pk_mul_f32 v[48:49], v[48:49], s[34:35] op_sel_hi:[1,0]
  v_pk_mul_f32 v[50:51], v[50:51], s[34:35] op_sel_hi:[1,0]
  v_cvt_pk_bf16_f32 v96, v32, v33
  v_cvt_pk_bf16_f32 v97, v34, v35
  v_cvt_pk_bf16_f32 v98, v48, v49
  v_cvt_pk_bf16_f32 v99, v50, v51
  ds_write_b128 v24, v[96:99] offset:0
  v_pk_mul_f32 v[64:65], v[64:65], s[34:35] op_sel_hi:[1,0]
  v_pk_mul_f32 v[66:67], v[66:67], s[34:35] op_sel_hi:[1,0]
  v_pk_mul_f32 v[128:129], v[128:129], s[34:35] op_sel_hi:[1,0]
  v_pk_mul_f32 v[130:131], v[130:131], s[34:35] op_sel_hi:[1,0]
  v_cvt_pk_bf16_f32 v100, v64, v65
  v_cvt_pk_bf16_f32 v101, v66, v67
  v_cvt_pk_bf16_f32 v102, v128, v129
  v_cvt_pk_bf16_f32 v103, v130, v131
  ds_write_b128 v24, v[100:103] offset:1024
  v_pk_mul_f32 v[44:45], v[44:45], s[34:35] op_sel_hi:[1,0]
  v_pk_mul_f32 v[46:47], v[46:47], s[34:35] op_sel_hi:[1,0]
  v_pk_mul_f32 v[60:61], v[60:61], s[34:35] op_sel_hi:[1,0]
  v_pk_mul_f32 v[62:63], v[62:63], s[34:35] op_sel_hi:[1,0]
  v_cvt_pk_bf16_f32 v104, v44, v45
  v_cvt_pk_bf16_f32 v105, v46, v47
  v_cvt_pk_bf16_f32 v106, v60, v61
  v_cvt_pk_bf16_f32 v107, v62, v63
  ds_write_b128 v24, v[104:107] offset:2048
  v_pk_mul_f32 v[76:77], v[76:77], s[34:35] op_sel_hi:[1,0]
  v_pk_mul_f32 v[78:79], v[78:79], s[34:35] op_sel_hi:[1,0]
  v_pk_mul_f32 v[152:153], v[152:153], s[34:35] op_sel_hi:[1,0]
  v_pk_mul_f32 v[154:155], v[154:155], s[34:35] op_sel_hi:[1,0]
  v_cvt_pk_bf16_f32 v108, v76, v77
  v_cvt_pk_bf16_f32 v109, v78, v79
  v_cvt_pk_bf16_f32 v110, v152, v153
  v_cvt_pk_bf16_f32 v111, v154, v155
  ds_write_b128 v24, v[108:111] offset:3072
  v_pk_mul_f32 v[36:37], v[36:37], s[34:35] op_sel_hi:[1,0]
  v_pk_mul_f32 v[38:39], v[38:39], s[34:35] op_sel_hi:[1,0]
  v_pk_mul_f32 v[52:53], v[52:53], s[34:35] op_sel_hi:[1,0]
  v_pk_mul_f32 v[54:55], v[54:55], s[34:35] op_sel_hi:[1,0]
  v_cvt_pk_bf16_f32 v200, v36, v37
  v_cvt_pk_bf16_f32 v201, v38, v39
  v_cvt_pk_bf16_f32 v202, v52, v53
  v_cvt_pk_bf16_f32 v203, v54, v55
  v_pk_mul_f32 v[68:69], v[68:69], s[34:35] op_sel_hi:[1,0]
  v_pk_mul_f32 v[70:71], v[70:71], s[34:35] op_sel_hi:[1,0]
  v_pk_mul_f32 v[136:137], v[136:137], s[34:35] op_sel_hi:[1,0]
  v_pk_mul_f32 v[138:139], v[138:139], s[34:35] op_sel_hi:[1,0]
  v_cvt_pk_bf16_f32 v204, v68, v69
  v_cvt_pk_bf16_f32 v205, v70, v71
  v_cvt_pk_bf16_f32 v206, v136, v137
  v_cvt_pk_bf16_f32 v207, v138, v139
  v_pk_mul_f32 v[40:41], v[40:41], s[34:35] op_sel_hi:[1,0]
  v_pk_mul_f32 v[42:43], v[42:43], s[34:35] op_sel_hi:[1,0]
  v_pk_mul_f32 v[56:57], v[56:57], s[34:35] op_sel_hi:[1,0]
  v_pk_mul_f32 v[58:59], v[58:59], s[34:35] op_sel_hi:[1,0]
  v_cvt_pk_bf16_f32 v216, v40, v41
  v_cvt_pk_bf16_f32 v217, v42, v43
  v_cvt_pk_bf16_f32 v218, v56, v57
  v_cvt_pk_bf16_f32 v219, v58, v59
  v_pk_mul_f32 v[72:73], v[72:73], s[34:35] op_sel_hi:[1,0]
  v_pk_mul_f32 v[74:75], v[74:75], s[34:35] op_sel_hi:[1,0]
  v_pk_mul_f32 v[144:145], v[144:145], s[34:35] op_sel_hi:[1,0]
  v_pk_mul_f32 v[146:147], v[146:147], s[34:35] op_sel_hi:[1,0]
  v_cvt_pk_bf16_f32 v220, v72, v73
  v_cvt_pk_bf16_f32 v221, v74, v75
  v_cvt_pk_bf16_f32 v222, v144, v145
  v_cvt_pk_bf16_f32 v223, v146, v147
F_X2A:
  s_lshr_b32 s64, s29, 1
  s_sub_u32 s65, 15, s31
  s_bitcmp1_b32 s29, 0
  s_cselect_b32 s65, s65, s31
  s_mov_b32 s66, s32
  s_mov_b32 s67, s95
  s_mov_b32 s68, s81
  v_lshrrev_b32 v112, 4, v16
  s_mul_i32 s69, s28, 5120
  s_mul_i32 s34, s66, 320
  s_mul_i32 s33, s28, 20480
  s_add_u32 s34, s34, s33
  s_mul_i32 s70, s64, 573440
  s_add_u32 s70, s70, s34
  s_mul_i32 s71, s64, 1310720
  s_add_u32 s71, s71, s34
  s_lshl_b32 s74, s65, 3
  s_lshl_b32 s33, s68, 1
  s_add_u32 s74, s74, s33
  s_mul_i32 s72, s74, 182
  s_mul_i32 s33, s64, 14
  s_add_u32 s72, s72, s33
  s_add_u32 s72, s72, s67
  s_add_u32 s72, s72, 32896
  s_lshl_b32 s72, s72, 10
  s_mul_i32 s33, s67, 186368
  s_add_u32 s72, s72, s33
  s_lshl_b32 s33, s33, 1
  s_sub_u32 s77, 186368, s33
  s_add_u32 s73, s72, s77
  v_and_b32 v113, 15, v112
  v_lshlrev_b32 v11, 3, v113
  s_add_u32 s76, s74, s67
  s_lshl_b32 s76, s76, 7
  s_add_u32 s76, s76, 58720256
  v_lshrrev_b32 v115, 4, v112
  v_xor_b32 v23, 32, v22
  v_mul_u32_u24 v113, 1280, v113
  v_lshl_add_u32 v10, v115, 3, v113
  s_lshl_b32 s75, s65, 2
  s_add_u32 s75, s75, s66
  s_mov_b32 s4, s54
  s_mov_b32 s5, s55
  s_mov_b32 s6, 2211840
  s_mov_b32 s7, 0x20000
  s_mov_b32 s8, s46
  s_mov_b32 s9, s47
  s_mov_b32 s10, 5242880
  s_mov_b32 s11, 0x20000
  s_mov_b32 s16, s54
  s_mov_b32 s17, s55
  s_mov_b32 s18, 2211840
  s_mov_b32 s19, 0x20000
  s_cmp_lt_u32 s28, 4
  s_cselect_b32 s18, 2211840, 0
  s_mov_b32 s20, s62
  s_mov_b32 s21, s63
  s_mov_b32 s22, 100663296
  s_mov_b32 s23, 0x20000
  s_cmp_lt_u32 s64, 3
  s_cselect_b32 s22, 100663296, 0
  v_and_b32 v113, 15, v112
  v_lshlrev_b32 v114, 2, v115
  v_sub_u32 v113, v113, v114
  v_mov_b32 v114, 0xf149f2ca
  v_cmp_le_i32 vcc, 0, v113
  s_nop 1
  v_cndmask_b32 v28, v114, 0, vcc
  v_cmp_le_i32 vcc, 1, v113
  s_nop 1
  v_cndmask_b32 v29, v114, 0, vcc
  v_cmp_le_i32 vcc, 2, v113
  s_nop 1
  v_cndmask_b32 v30, v114, 0, vcc
  v_cmp_le_i32 vcc, 3, v113
  s_nop 1
  v_cndmask_b32 v31, v114, 0, vcc
  s_waitcnt lgkmcnt(0)
  s_barrier
  s_bitcmp1_b32 s28, 0
  s_cbranch_scc1 F_X3A
  ds_read_b128 v[200:203], v25 offset:0
  ds_read_b128 v[204:207], v25 offset:1024
  ds_read_b128 v[216:219], v25 offset:2048
  ds_read_b128 v[220:223], v25 offset:3072
  s_branch F_X4A
F_X3A:
  ds_read_b128 v[192:195], v25 offset:0
  ds_read_b128 v[196:199], v25 offset:1024
  ds_read_b128 v[208:211], v25 offset:2048
  ds_read_b128 v[212:215], v25 offset:3072
F_X4A:
  v_add_u32 v24, s85, v16
  ds_read_b128 v[32:35], v24 offset:0
  ds_read_b128 v[36:39], v24 offset:1024
  ds_read_b128 v[40:43], v24 offset:2048
  ds_read_b128 v[44:47], v24 offset:3072
  s_lshl_b32 s33, s89, 7
  s_add_u32 s33, s33, 58720256
  s_lshl_b32 s34, s90, 7
  s_add_u32 s34, s34, 58720256
  buffer_load_dword v26, v11, s[12:15], s33 offen sc1
  buffer_load_dword v27, v11, s[12:15], s34 offen sc1
  v_mov_b32 v25, v24
  s_add_u32 s85, s85, 32768
  s_sub_u32 s33, s85, 163840
  s_cselect_b32 s85, s85, s33
  s_setprio 0
  s_cmp_eq_u32 s89, 0
  s_cselect_b32 s33, 1.0, 0
  v_mul_f32 v112, s33, v28
  v_mul_f32 v113, s33, v29
  v_mul_f32 v114, s33, v30
  v_mul_f32 v115, s33, v31
  s_waitcnt lgkmcnt(3)
  s_nop 0
  v_mfma_f32_16x16x32_bf16 v[64:67], v[32:35], v[192:195], v[112:115]
  v_mfma_f32_16x16x32_bf16 v[68:71], v[32:35], v[208:211], 0
  s_waitcnt lgkmcnt(2)
  v_mfma_f32_16x16x32_bf16 v[64:67], v[36:39], v[196:199], v[64:67]
  v_mfma_f32_16x16x32_bf16 v[68:71], v[36:39], v[212:215], v[68:71]
  s_waitcnt lgkmcnt(1)
  v_mfma_f32_16x16x32_bf16 v[64:67], v[40:43], v[200:203], v[64:67]
  v_mfma_f32_16x16x32_bf16 v[68:71], v[40:43], v[216:219], v[68:71]
  s_waitcnt lgkmcnt(0)
  v_mfma_f32_16x16x32_bf16 v[64:67], v[44:47], v[204:207], v[64:67]
  v_mfma_f32_16x16x32_bf16 v[68:71], v[44:47], v[220:223], v[68:71]
  ds_read_b128 v[32:35], v24 offset:0
  ds_read_b128 v[36:39], v24 offset:1024
  ds_read_b128 v[40:43], v24 offset:2048
  ds_read_b128 v[44:47], v24 offset:3072
  ds_read_b128 v[48:51], v24 offset:4096
  ds_read_b128 v[52:55], v24 offset:5120
  v_mov_b32 v228, 0
  v_mov_b32 v229, 0
  v_max3_f32 v64, v64, v65, v66
  v_max_f32 v64, v64, v67
  v_max3_f32 v68, v68, v69, v70
  v_max_f32 v68, v68, v71
  v_mov_b32 v65, v64
  v_mov_b32 v69, v68
  s_nop 0
  v_permlane32_swap_b32 v64, v65
  v_permlane32_swap_b32 v68, v69
  v_max_f32 v64, v64, v65
  v_max_f32 v68, v68, v69
  v_mov_b32 v65, v64
  v_mov_b32 v69, v68
  s_nop 0
  v_permlane16_swap_b32 v64, v65
  v_permlane16_swap_b32 v68, v69
  v_max_f32 v64, v64, v65
  v_max_f32 v68, v68, v69
  v_sub_f32 v112, 0, v64
  v_sub_f32 v120, v28, v64
  v_sub_f32 v113, 0, v64
  v_sub_f32 v121, v29, v64
  v_sub_f32 v114, 0, v64
  v_sub_f32 v122, v30, v64
  v_sub_f32 v115, 0, v64
  v_sub_f32 v123, v31, v64
  v_sub_f32 v116, 0, v68
  v_sub_f32 v124, v28, v68
  v_sub_f32 v117, 0, v68
  v_sub_f32 v125, v29, v68
  v_sub_f32 v118, 0, v68
  v_sub_f32 v126, v30, v68
  v_sub_f32 v119, 0, v68
  v_sub_f32 v127, v31, v68
  s_sub_u32 s84, s82, 2
  s_sub_u32 s92, s82, 4
  s_waitcnt lgkmcnt(4)
  v_mfma_f32_16x16x32_bf16 v[64:67], v[32:35], v[192:195], v[112:115]
  ds_read_b128 v[56:59], v24 offset:6144
  v_mov_b32 v25, v24
  v_mfma_f32_16x16x32_bf16 v[68:71], v[32:35], v[208:211], v[116:119]
  v_mfma_f32_16x16x32_bf16 v[64:67], v[36:39], v[196:199], v[64:67]
  ds_read_b128 v[60:63], v24 offset:7168
  v_mfma_f32_16x16x32_bf16 v[68:71], v[36:39], v[212:215], v[68:71]
  s_waitcnt lgkmcnt(4)
  v_mfma_f32_16x16x32_bf16 v[64:67], v[40:43], v[200:203], v[64:67]
  ds_read_b128 v[32:35], v24 offset:8192
  v_mfma_f32_16x16x32_bf16 v[68:71], v[40:43], v[216:219], v[68:71]
  v_mfma_f32_16x16x32_bf16 v[64:67], v[44:47], v[204:207], v[64:67]
  ds_read_b128 v[36:39], v24 offset:9216
  v_mfma_f32_16x16x32_bf16 v[68:71], v[44:47], v[220:223], v[68:71]
  s_waitcnt lgkmcnt(4)
  v_mfma_f32_16x16x32_bf16 v[72:75], v[48:51], v[192:195], v[112:115]
  ds_read_b128 v[40:43], v24 offset:10240
  v_mfma_f32_16x16x32_bf16 v[76:79], v[48:51], v[208:211], v[116:119]
  v_mfma_f32_16x16x32_bf16 v[72:75], v[52:55], v[196:199], v[72:75]
  ds_read_b128 v[44:47], v24 offset:11264
  v_mfma_f32_16x16x32_bf16 v[76:79], v[52:55], v[212:215], v[76:79]
  v_exp_f32 v64, v64
  s_waitcnt lgkmcnt(4)
  v_mfma_f32_16x16x32_bf16 v[72:75], v[56:59], v[200:203], v[72:75]
  ds_read_b128 v[48:51], v24 offset:12288
  v_add_f32 v228, v228, v64
  v_mfma_f32_16x16x32_bf16 v[76:79], v[56:59], v[216:219], v[76:79]
  v_exp_f32 v65, v65
  v_mfma_f32_16x16x32_bf16 v[72:75], v[60:63], v[204:207], v[72:75]
  ds_read_b128 v[52:55], v24 offset:13312
  v_add_f32 v228, v228, v65
  v_cvt_pk_bf16_f32 v96, v64, v65
  v_mfma_f32_16x16x32_bf16 v[76:79], v[60:63], v[220:223], v[76:79]
  v_exp_f32 v66, v66
  s_waitcnt lgkmcnt(4)
  v_mfma_f32_16x16x32_bf16 v[80:83], v[32:35], v[192:195], v[112:115]
  ds_read_b128 v[56:59], v24 offset:14336
  v_add_f32 v228, v228, v66
  v_mfma_f32_16x16x32_bf16 v[84:87], v[32:35], v[208:211], v[116:119]
  v_exp_f32 v67, v67
  v_mfma_f32_16x16x32_bf16 v[80:83], v[36:39], v[196:199], v[80:83]
  ds_read_b128 v[60:63], v24 offset:15360
  v_add_u32 v24, s85, v16
  v_add_f32 v228, v228, v67
  v_cvt_pk_bf16_f32 v97, v66, v67
  v_mfma_f32_16x16x32_bf16 v[84:87], v[36:39], v[212:215], v[84:87]
  v_exp_f32 v68, v68
  s_waitcnt lgkmcnt(4)
  v_mfma_f32_16x16x32_bf16 v[80:83], v[40:43], v[200:203], v[80:83]
  ds_read_b128 v[32:35], v25 offset:16384
  s_add_u32 s85, s85, 32768
  s_sub_u32 s33, s85, 163840
  s_cselect_b32 s85, s85, s33
  v_add_f32 v229, v229, v68
  v_mfma_f32_16x16x32_bf16 v[84:87], v[40:43], v[216:219], v[84:87]
  v_exp_f32 v69, v69
  v_mfma_f32_16x16x32_bf16 v[80:83], v[44:47], v[204:207], v[80:83]
  ds_read_b128 v[36:39], v25 offset:17408
  v_add_f32 v229, v229, v69
  v_cvt_pk_bf16_f32 v100, v68, v69
  v_mfma_f32_16x16x32_bf16 v[84:87], v[44:47], v[220:223], v[84:87]
  v_exp_f32 v70, v70
  s_waitcnt lgkmcnt(4)
  v_mfma_f32_16x16x32_bf16 v[88:91], v[48:51], v[192:195], v[112:115]
  ds_read_b128 v[40:43], v25 offset:18432
  v_add_f32 v229, v229, v70
  v_mfma_f32_16x16x32_bf16 v[92:95], v[48:51], v[208:211], v[116:119]
  v_exp_f32 v71, v71
  v_mfma_f32_16x16x32_bf16 v[88:91], v[52:55], v[196:199], v[88:91]
  ds_read_b128 v[44:47], v25 offset:19456
  v_add_f32 v229, v229, v71
  v_cvt_pk_bf16_f32 v101, v70, v71
  v_mfma_f32_16x16x32_bf16 v[92:95], v[52:55], v[212:215], v[92:95]
  v_exp_f32 v72, v72
  s_waitcnt lgkmcnt(4)
  v_mfma_f32_16x16x32_bf16 v[88:91], v[56:59], v[200:203], v[88:91]
  ds_read_b128 v[48:51], v25 offset:20480
  v_add_f32 v228, v228, v72
  v_mfma_f32_16x16x32_bf16 v[92:95], v[56:59], v[216:219], v[92:95]
  v_exp_f32 v73, v73
  v_mfma_f32_16x16x32_bf16 v[88:91], v[60:63], v[204:207], v[88:91]
  ds_read_b128 v[52:55], v25 offset:21504
  v_add_f32 v228, v228, v73
  v_cvt_pk_bf16_f32 v98, v72, v73
  v_mfma_f32_16x16x32_bf16 v[92:95], v[60:63], v[220:223], v[92:95]
  s_barrier
  v_exp_f32 v74, v74
  s_waitcnt lgkmcnt(4)
  v_exp_f32 v75, v75
  v_add_f32 v228, v228, v74
  v_add_f32 v228, v228, v75
  v_cvt_pk_bf16_f32 v99, v74, v75
  s_nop 1
  v_mfma_f32_16x16x32_bf16 v[128:131], v[32:35], v[96:99], 0
  ds_read_b128 v[56:59], v25 offset:22528
  v_exp_f32 v76, v76
  v_exp_f32 v77, v77
  v_add_f32 v229, v229, v76
  v_add_f32 v229, v229, v77
  v_cvt_pk_bf16_f32 v102, v76, v77
  v_exp_f32 v78, v78
  v_exp_f32 v79, v79
  v_add_f32 v229, v229, v78
  v_add_f32 v229, v229, v79
  v_cvt_pk_bf16_f32 v103, v78, v79
  s_nop 1
  v_mfma_f32_16x16x32_bf16 v[160:163], v[32:35], v[100:103], 0
  v_exp_f32 v80, v80
  v_mfma_f32_16x16x32_bf16 v[164:167], v[36:39], v[100:103], 0
  ds_read_b128 v[60:63], v25 offset:23552
  v_add_f32 v228, v228, v80
  v_mfma_f32_16x16x32_bf16 v[132:135], v[36:39], v[96:99], 0
  v_exp_f32 v81, v81
  s_waitcnt lgkmcnt(4)
  v_mfma_f32_16x16x32_bf16 v[136:139], v[40:43], v[96:99], 0
  ds_read_b128 v[32:35], v24 offset:0
  v_add_f32 v228, v228, v81
  v_cvt_pk_bf16_f32 v104, v80, v81
  v_mfma_f32_16x16x32_bf16 v[168:171], v[40:43], v[100:103], 0
  v_exp_f32 v82, v82
  v_mfma_f32_16x16x32_bf16 v[172:175], v[44:47], v[100:103], 0
  ds_read_b128 v[36:39], v24 offset:1024
  v_add_f32 v228, v228, v82
  v_mfma_f32_16x16x32_bf16 v[140:143], v[44:47], v[96:99], 0
  v_exp_f32 v83, v83
  s_waitcnt lgkmcnt(4)
  v_mfma_f32_16x16x32_bf16 v[144:147], v[48:51], v[96:99], 0
  ds_read_b128 v[40:43], v24 offset:2048
  v_add_f32 v228, v228, v83
  v_cvt_pk_bf16_f32 v105, v82, v83
  v_mfma_f32_16x16x32_bf16 v[176:179], v[48:51], v[100:103], 0
  v_exp_f32 v84, v84
  v_mfma_f32_16x16x32_bf16 v[180:183], v[52:55], v[100:103], 0
  ds_read_b128 v[44:47], v24 offset:3072
  v_add_f32 v229, v229, v84
  v_mfma_f32_16x16x32_bf16 v[148:151], v[52:55], v[96:99], 0
  v_exp_f32 v85, v85
  s_waitcnt lgkmcnt(4)
  v_mfma_f32_16x16x32_bf16 v[152:155], v[56:59], v[96:99], 0
  ds_read_b128 v[48:51], v24 offset:4096
  v_add_f32 v229, v229, v85
  v_cvt_pk_bf16_f32 v108, v84, v85
  v_mfma_f32_16x16x32_bf16 v[184:187], v[56:59], v[100:103], 0
  v_exp_f32 v86, v86
  v_mfma_f32_16x16x32_bf16 v[188:191], v[60:63], v[100:103], 0
  ds_read_b128 v[52:55], v24 offset:5120
  v_add_f32 v229, v229, v86
  v_mfma_f32_16x16x32_bf16 v[156:159], v[60:63], v[96:99], 0
  v_exp_f32 v87, v87
  v_exp_f32 v88, v88
  v_exp_f32 v89, v89
  v_exp_f32 v90, v90
  v_add_f32 v229, v229, v87
  v_cvt_pk_bf16_f32 v109, v86, v87
  v_add_f32 v228, v228, v88
  v_add_f32 v228, v228, v89
  v_cvt_pk_bf16_f32 v106, v88, v89
  s_sub_u32 s84, s84, 1
  buffer_store_dwordx4 v[224:227], v16, s[12:15], s93 offen sc1
  .p2align 6
F_LOOPA:
  s_waitcnt lgkmcnt(4)
  v_mfma_f32_16x16x32_bf16 v[64:67], v[32:35], v[192:195], v[112:115]
  ds_read_b128 v[56:59], v24 offset:6144
  v_add_f32 v228, v228, v90
  v_mfma_f32_16x16x32_bf16 v[68:71], v[32:35], v[208:211], v[116:119]
  v_exp_f32 v91, v91
  v_mfma_f32_16x16x32_bf16 v[64:67], v[36:39], v[196:199], v[64:67]
  ds_read_b128 v[60:63], v24 offset:7168
  v_add_f32 v228, v228, v91
  v_cvt_pk_bf16_f32 v107, v90, v91
  v_mfma_f32_16x16x32_bf16 v[68:71], v[36:39], v[212:215], v[68:71]
  v_exp_f32 v92, v92
  s_waitcnt lgkmcnt(4)
  v_mfma_f32_16x16x32_bf16 v[64:67], v[40:43], v[200:203], v[64:67]
  ds_read_b128 v[32:35], v25 offset:24576
  v_add_f32 v229, v229, v92
  v_mfma_f32_16x16x32_bf16 v[68:71], v[40:43], v[216:219], v[68:71]
  v_exp_f32 v93, v93
  v_mfma_f32_16x16x32_bf16 v[64:67], v[44:47], v[204:207], v[64:67]
  ds_read_b128 v[36:39], v25 offset:25600
  v_add_f32 v229, v229, v93
  v_cvt_pk_bf16_f32 v110, v92, v93
  v_mfma_f32_16x16x32_bf16 v[68:71], v[44:47], v[220:223], v[68:71]
  v_exp_f32 v94, v94
  s_waitcnt lgkmcnt(4)
  v_mfma_f32_16x16x32_bf16 v[72:75], v[48:51], v[192:195], v[112:115]
  ds_read_b128 v[40:43], v25 offset:26624
  v_add_f32 v229, v229, v94
  v_mfma_f32_16x16x32_bf16 v[76:79], v[48:51], v[208:211], v[116:119]
  v_exp_f32 v95, v95
  v_mfma_f32_16x16x32_bf16 v[72:75], v[52:55], v[196:199], v[72:75]
  ds_read_b128 v[44:47], v25 offset:27648
  v_add_f32 v229, v229, v95
  v_cvt_pk_bf16_f32 v111, v94, v95
  v_mfma_f32_16x16x32_bf16 v[76:79], v[52:55], v[212:215], v[76:79]
  v_exp_f32 v64, v64
  s_waitcnt lgkmcnt(4)
  v_mfma_f32_16x16x32_bf16 v[72:75], v[56:59], v[200:203], v[72:75]
  ds_read_b128 v[48:51], v25 offset:28672
  v_add_f32 v228, v228, v64
  v_mfma_f32_16x16x32_bf16 v[76:79], v[56:59], v[216:219], v[76:79]
  v_exp_f32 v65, v65
  v_mfma_f32_16x16x32_bf16 v[72:75], v[60:63], v[204:207], v[72:75]
  ds_read_b128 v[52:55], v25 offset:29696
  v_add_f32 v228, v228, v65
  v_cvt_pk_bf16_f32 v96, v64, v65
  v_mfma_f32_16x16x32_bf16 v[76:79], v[60:63], v[220:223], v[76:79]
  v_exp_f32 v66, v66
  s_waitcnt lgkmcnt(4)
  v_mfma_f32_16x16x32_bf16 v[128:131], v[32:35], v[104:107], v[128:131]
  ds_read_b128 v[56:59], v25 offset:30720
  v_add_f32 v228, v228, v66
  v_mfma_f32_16x16x32_bf16 v[160:163], v[32:35], v[108:111], v[160:163]
  v_exp_f32 v67, v67
  v_mfma_f32_16x16x32_bf16 v[164:167], v[36:39], v[108:111], v[164:167]
  ds_read_b128 v[60:63], v25 offset:31744
  v_mov_b32 v25, v24
  v_add_f32 v228, v228, v67
  v_cvt_pk_bf16_f32 v97, v66, v67
  v_mfma_f32_16x16x32_bf16 v[132:135], v[36:39], v[104:107], v[132:135]
  v_exp_f32 v68, v68
  s_waitcnt lgkmcnt(4)
  v_mfma_f32_16x16x32_bf16 v[136:139], v[40:43], v[104:107], v[136:139]
  ds_read_b128 v[32:35], v24 offset:8192
  v_add_f32 v229, v229, v68
  v_mfma_f32_16x16x32_bf16 v[168:171], v[40:43], v[108:111], v[168:171]
  v_exp_f32 v69, v69
  v_mfma_f32_16x16x32_bf16 v[172:175], v[44:47], v[108:111], v[172:175]
  ds_read_b128 v[36:39], v24 offset:9216
  v_add_f32 v229, v229, v69
  v_cvt_pk_bf16_f32 v100, v68, v69
  v_mfma_f32_16x16x32_bf16 v[140:143], v[44:47], v[104:107], v[140:143]
  v_exp_f32 v70, v70
  s_waitcnt lgkmcnt(4)
  v_mfma_f32_16x16x32_bf16 v[144:147], v[48:51], v[104:107], v[144:147]
  ds_read_b128 v[40:43], v24 offset:10240
  v_add_f32 v229, v229, v70
  v_mfma_f32_16x16x32_bf16 v[176:179], v[48:51], v[108:111], v[176:179]
  v_exp_f32 v71, v71
  v_mfma_f32_16x16x32_bf16 v[180:183], v[52:55], v[108:111], v[180:183]
  ds_read_b128 v[44:47], v24 offset:11264
  v_add_f32 v229, v229, v71
  v_cvt_pk_bf16_f32 v101, v70, v71
  v_mfma_f32_16x16x32_bf16 v[148:151], v[52:55], v[104:107], v[148:151]
  v_exp_f32 v72, v72
  s_waitcnt lgkmcnt(4)
  v_mfma_f32_16x16x32_bf16 v[152:155], v[56:59], v[104:107], v[152:155]
  ds_read_b128 v[48:51], v24 offset:12288
  v_add_f32 v228, v228, v72
  v_mfma_f32_16x16x32_bf16 v[184:187], v[56:59], v[108:111], v[184:187]
  v_exp_f32 v73, v73
  v_mfma_f32_16x16x32_bf16 v[188:191], v[60:63], v[108:111], v[188:191]
  ds_read_b128 v[52:55], v24 offset:13312
  v_add_f32 v228, v228, v73
  v_cvt_pk_bf16_f32 v98, v72, v73
  v_mfma_f32_16x16x32_bf16 v[156:159], v[60:63], v[104:107], v[156:159]
  s_barrier
  v_exp_f32 v74, v74
  s_waitcnt lgkmcnt(4)
  v_mfma_f32_16x16x32_bf16 v[80:83], v[32:35], v[192:195], v[112:115]
  ds_read_b128 v[56:59], v24 offset:14336
  v_add_f32 v228, v228, v74
  v_mfma_f32_16x16x32_bf16 v[84:87], v[32:35], v[208:211], v[116:119]
  v_exp_f32 v75, v75
  v_mfma_f32_16x16x32_bf16 v[80:83], v[36:39], v[196:199], v[80:83]
  ds_read_b128 v[60:63], v24 offset:15360
  v_add_u32 v24, s85, v16
  v_add_f32 v228, v228, v75
  v_cvt_pk_bf16_f32 v99, v74, v75
  v_mfma_f32_16x16x32_bf16 v[84:87], v[36:39], v[212:215], v[84:87]
  v_exp_f32 v76, v76
  s_waitcnt lgkmcnt(4)
  v_mfma_f32_16x16x32_bf16 v[80:83], v[40:43], v[200:203], v[80:83]
  ds_read_b128 v[32:35], v25 offset:16384
  s_add_u32 s85, s85, 32768
  s_sub_u32 s33, s85, 163840
  s_cselect_b32 s85, s85, s33
  v_add_f32 v229, v229, v76
  v_mfma_f32_16x16x32_bf16 v[84:87], v[40:43], v[216:219], v[84:87]
  v_exp_f32 v77, v77
  v_mfma_f32_16x16x32_bf16 v[80:83], v[44:47], v[204:207], v[80:83]
  ds_read_b128 v[36:39], v25 offset:17408
  v_add_f32 v229, v229, v77
  v_cvt_pk_bf16_f32 v102, v76, v77
  v_mfma_f32_16x16x32_bf16 v[84:87], v[44:47], v[220:223], v[84:87]
  v_exp_f32 v78, v78
  s_waitcnt lgkmcnt(4)
  v_mfma_f32_16x16x32_bf16 v[88:91], v[48:51], v[192:195], v[112:115]
  ds_read_b128 v[40:43], v25 offset:18432
  v_add_f32 v229, v229, v78
  v_mfma_f32_16x16x32_bf16 v[92:95], v[48:51], v[208:211], v[116:119]
  v_exp_f32 v79, v79
  v_mfma_f32_16x16x32_bf16 v[88:91], v[52:55], v[196:199], v[88:91]
  ds_read_b128 v[44:47], v25 offset:19456
  v_add_f32 v229, v229, v79
  v_cvt_pk_bf16_f32 v103, v78, v79
  v_mfma_f32_16x16x32_bf16 v[92:95], v[52:55], v[212:215], v[92:95]
  v_exp_f32 v80, v80
  s_waitcnt lgkmcnt(4)
  v_mfma_f32_16x16x32_bf16 v[88:91], v[56:59], v[200:203], v[88:91]
  ds_read_b128 v[48:51], v25 offset:20480
  v_add_f32 v228, v228, v80
  v_mfma_f32_16x16x32_bf16 v[92:95], v[56:59], v[216:219], v[92:95]
  v_exp_f32 v81, v81
  v_mfma_f32_16x16x32_bf16 v[88:91], v[60:63], v[204:207], v[88:91]
  ds_read_b128 v[52:55], v25 offset:21504
  v_add_f32 v228, v228, v81
  v_cvt_pk_bf16_f32 v104, v80, v81
  v_mfma_f32_16x16x32_bf16 v[92:95], v[60:63], v[220:223], v[92:95]
  v_exp_f32 v82, v82
  s_waitcnt lgkmcnt(4)
  v_mfma_f32_16x16x32_bf16 v[128:131], v[32:35], v[96:99], v[128:131]
  ds_read_b128 v[56:59], v25 offset:22528
  v_add_f32 v228, v228, v82
  v_mfma_f32_16x16x32_bf16 v[160:163], v[32:35], v[100:103], v[160:163]
  v_exp_f32 v83, v83
  v_mfma_f32_16x16x32_bf16 v[164:167], v[36:39], v[100:103], v[164:167]
  ds_read_b128 v[60:63], v25 offset:23552
  v_add_f32 v228, v228, v83
  v_cvt_pk_bf16_f32 v105, v82, v83
  v_mfma_f32_16x16x32_bf16 v[132:135], v[36:39], v[96:99], v[132:135]
  v_exp_f32 v84, v84
  s_waitcnt lgkmcnt(4)
  v_mfma_f32_16x16x32_bf16 v[136:139], v[40:43], v[96:99], v[136:139]
  ds_read_b128 v[32:35], v24 offset:0
  v_add_f32 v229, v229, v84
  v_mfma_f32_16x16x32_bf16 v[168:171], v[40:43], v[100:103], v[168:171]
  v_exp_f32 v85, v85
  v_mfma_f32_16x16x32_bf16 v[172:175], v[44:47], v[100:103], v[172:175]
  ds_read_b128 v[36:39], v24 offset:1024
  v_add_f32 v229, v229, v85
  v_cvt_pk_bf16_f32 v108, v84, v85
  v_mfma_f32_16x16x32_bf16 v[140:143], v[44:47], v[96:99], v[140:143]
  s_sub_u32 s84, s84, 1
  v_exp_f32 v86, v86
  s_waitcnt lgkmcnt(4)
  v_mfma_f32_16x16x32_bf16 v[144:147], v[48:51], v[96:99], v[144:147]
  ds_read_b128 v[40:43], v24 offset:2048
  v_add_f32 v229, v229, v86
  v_mfma_f32_16x16x32_bf16 v[176:179], v[48:51], v[100:103], v[176:179]
  v_exp_f32 v87, v87
  v_mfma_f32_16x16x32_bf16 v[180:183], v[52:55], v[100:103], v[180:183]
  ds_read_b128 v[44:47], v24 offset:3072
  v_add_f32 v229, v229, v87
  v_cvt_pk_bf16_f32 v109, v86, v87
  v_mfma_f32_16x16x32_bf16 v[148:151], v[52:55], v[96:99], v[148:151]
  v_exp_f32 v88, v88
  s_waitcnt lgkmcnt(4)
  v_mfma_f32_16x16x32_bf16 v[152:155], v[56:59], v[96:99], v[152:155]
  ds_read_b128 v[48:51], v24 offset:4096
  v_add_f32 v228, v228, v88
  v_mfma_f32_16x16x32_bf16 v[184:187], v[56:59], v[100:103], v[184:187]
  v_exp_f32 v89, v89
  v_mfma_f32_16x16x32_bf16 v[188:191], v[60:63], v[100:103], v[188:191]
  ds_read_b128 v[52:55], v24 offset:5120
  v_add_f32 v228, v228, v89
  v_cvt_pk_bf16_f32 v106, v88, v89
  v_mfma_f32_16x16x32_bf16 v[156:159], v[60:63], v[96:99], v[156:159]
  v_exp_f32 v90, v90
  s_cmp_eq_u32 s84, s92
  s_cbranch_scc1 F_HOOK
F_BACK:
  s_cmp_lg_u32 s84, 0
  s_cbranch_scc1 F_LOOPA
F_DIAGA:
  s_cmp_eq_u32 s81, 0
  s_cbranch_scc1 F_DA0
  s_cmp_eq_u32 s81, 1
  s_cbranch_scc1 F_DA1
  s_cmp_eq_u32 s81, 2
  s_cbranch_scc1 F_DA2
F_DA3:
  s_waitcnt lgkmcnt(4)
  v_mfma_f32_16x16x32_bf16 v[64:67], v[32:35], v[192:195], v[112:115]
  ds_read_b128 v[56:59], v24 offset:6144
  v_add_f32 v228, v228, v90
  v_mfma_f32_16x16x32_bf16 v[68:71], v[32:35], v[208:211], v[116:119]
  v_exp_f32 v91, v91
  v_mfma_f32_16x16x32_bf16 v[64:67], v[36:39], v[196:199], v[64:67]
  ds_read_b128 v[60:63], v24 offset:7168
  v_add_f32 v228, v228, v91
  v_cvt_pk_bf16_f32 v107, v90, v91
  v_mfma_f32_16x16x32_bf16 v[68:71], v[36:39], v[212:215], v[68:71]
  v_exp_f32 v92, v92
  s_waitcnt lgkmcnt(4)
  v_mfma_f32_16x16x32_bf16 v[64:67], v[40:43], v[200:203], v[64:67]
  ds_read_b128 v[32:35], v25 offset:24576
  v_add_f32 v229, v229, v92
  v_mfma_f32_16x16x32_bf16 v[68:71], v[40:43], v[216:219], v[68:71]
  v_exp_f32 v93, v93
  v_mfma_f32_16x16x32_bf16 v[64:67], v[44:47], v[204:207], v[64:67]
  ds_read_b128 v[36:39], v25 offset:25600
  v_add_f32 v229, v229, v93
  v_cvt_pk_bf16_f32 v110, v92, v93
  v_mfma_f32_16x16x32_bf16 v[68:71], v[44:47], v[220:223], v[68:71]
  v_exp_f32 v94, v94
  s_waitcnt lgkmcnt(4)
  v_mfma_f32_16x16x32_bf16 v[72:75], v[48:51], v[192:195], v[112:115]
  ds_read_b128 v[40:43], v25 offset:26624
  v_add_f32 v229, v229, v94
  v_mfma_f32_16x16x32_bf16 v[76:79], v[48:51], v[208:211], v[116:119]
  v_exp_f32 v95, v95
  v_mfma_f32_16x16x32_bf16 v[72:75], v[52:55], v[196:199], v[72:75]
  ds_read_b128 v[44:47], v25 offset:27648
  v_add_f32 v229, v229, v95
  v_cvt_pk_bf16_f32 v111, v94, v95
  v_mfma_f32_16x16x32_bf16 v[76:79], v[52:55], v[212:215], v[76:79]
  v_exp_f32 v64, v64
  s_waitcnt lgkmcnt(4)
  v_mfma_f32_16x16x32_bf16 v[72:75], v[56:59], v[200:203], v[72:75]
  ds_read_b128 v[48:51], v25 offset:28672
  v_add_f32 v228, v228, v64
  v_mfma_f32_16x16x32_bf16 v[76:79], v[56:59], v[216:219], v[76:79]
  v_exp_f32 v65, v65
  v_mfma_f32_16x16x32_bf16 v[72:75], v[60:63], v[204:207], v[72:75]
  ds_read_b128 v[52:55], v25 offset:29696
  v_add_f32 v228, v228, v65
  v_cvt_pk_bf16_f32 v96, v64, v65
  v_mfma_f32_16x16x32_bf16 v[76:79], v[60:63], v[220:223], v[76:79]
  v_exp_f32 v66, v66
  s_waitcnt lgkmcnt(4)
  v_mfma_f32_16x16x32_bf16 v[128:131], v[32:35], v[104:107], v[128:131]
  ds_read_b128 v[56:59], v25 offset:30720
  v_add_f32 v228, v228, v66
  v_mfma_f32_16x16x32_bf16 v[160:163], v[32:35], v[108:111], v[160:163]
  v_exp_f32 v67, v67
  v_mfma_f32_16x16x32_bf16 v[164:167], v[36:39], v[108:111], v[164:167]
  ds_read_b128 v[60:63], v25 offset:31744
  v_mov_b32 v25, v24
  v_add_f32 v228, v228, v67
  v_cvt_pk_bf16_f32 v97, v66, v67
  v_mfma_f32_16x16x32_bf16 v[132:135], v[36:39], v[104:107], v[132:135]
  v_exp_f32 v68, v68
  s_waitcnt lgkmcnt(4)
  v_mfma_f32_16x16x32_bf16 v[136:139], v[40:43], v[104:107], v[136:139]
  ds_read_b128 v[32:35], v24 offset:8192
  v_add_f32 v229, v229, v68
  v_mfma_f32_16x16x32_bf16 v[168:171], v[40:43], v[108:111], v[168:171]
  v_exp_f32 v69, v69
  v_mfma_f32_16x16x32_bf16 v[172:175], v[44:47], v[108:111], v[172:175]
  ds_read_b128 v[36:39], v24 offset:9216
  v_add_f32 v229, v229, v69
  v_cvt_pk_bf16_f32 v100, v68, v69
  v_mfma_f32_16x16x32_bf16 v[140:143], v[44:47], v[104:107], v[140:143]
  v_exp_f32 v70, v70
  s_waitcnt lgkmcnt(4)
  v_mfma_f32_16x16x32_bf16 v[144:147], v[48:51], v[104:107], v[144:147]
  ds_read_b128 v[40:43], v24 offset:10240
  v_add_f32 v229, v229, v70
  v_mfma_f32_16x16x32_bf16 v[176:179], v[48:51], v[108:111], v[176:179]
  v_exp_f32 v71, v71
  v_mfma_f32_16x16x32_bf16 v[180:183], v[52:55], v[108:111], v[180:183]
  ds_read_b128 v[44:47], v24 offset:11264
  v_add_f32 v229, v229, v71
  v_cvt_pk_bf16_f32 v101, v70, v71
  v_mfma_f32_16x16x32_bf16 v[148:151], v[52:55], v[104:107], v[148:151]
  v_exp_f32 v72, v72
  s_waitcnt lgkmcnt(4)
  v_mfma_f32_16x16x32_bf16 v[152:155], v[56:59], v[104:107], v[152:155]
  ds_read_b128 v[48:51], v24 offset:12288
  v_add_f32 v228, v228, v72
  v_mfma_f32_16x16x32_bf16 v[184:187], v[56:59], v[108:111], v[184:187]
  v_exp_f32 v73, v73
  v_mfma_f32_16x16x32_bf16 v[188:191], v[60:63], v[108:111], v[188:191]
  ds_read_b128 v[52:55], v24 offset:13312
  v_add_f32 v228, v228, v73
  v_cvt_pk_bf16_f32 v98, v72, v73
  v_mfma_f32_16x16x32_bf16 v[156:159], v[60:63], v[104:107], v[156:159]
  s_barrier
  v_exp_f32 v74, v74
  s_waitcnt lgkmcnt(4)
  v_mfma_f32_16x16x32_bf16 v[80:83], v[32:35], v[192:195], v[112:115]
  ds_read_b128 v[56:59], v24 offset:14336
  v_add_f32 v228, v228, v74
  v_mfma_f32_16x16x32_bf16 v[84:87], v[32:35], v[208:211], v[116:119]
  v_exp_f32 v75, v75
  v_mfma_f32_16x16x32_bf16 v[80:83], v[36:39], v[196:199], v[80:83]
  ds_read_b128 v[60:63], v24 offset:15360
  v_add_u32 v24, s85, v16
  v_add_f32 v228, v228, v75
  v_cvt_pk_bf16_f32 v99, v74, v75
  v_mfma_f32_16x16x32_bf16 v[84:87], v[36:39], v[212:215], v[84:87]
  v_exp_f32 v76, v76
  s_waitcnt lgkmcnt(4)
  v_mfma_f32_16x16x32_bf16 v[80:83], v[40:43], v[200:203], v[80:83]
  ds_read_b128 v[32:35], v25 offset:16384
  s_add_u32 s85, s85, 32768
  s_sub_u32 s33, s85, 163840
  s_cselect_b32 s85, s85, s33
  v_add_f32 v229, v229, v76
  v_mfma_f32_16x16x32_bf16 v[84:87], v[40:43], v[216:219], v[84:87]
  v_exp_f32 v77, v77
  v_mfma_f32_16x16x32_bf16 v[80:83], v[44:47], v[204:207], v[80:83]
  ds_read_b128 v[36:39], v25 offset:17408
  v_add_f32 v229, v229, v77
  v_cvt_pk_bf16_f32 v102, v76, v77
  v_mfma_f32_16x16x32_bf16 v[84:87], v[44:47], v[220:223], v[84:87]
  v_exp_f32 v78, v78
  s_waitcnt lgkmcnt(4)
  v_mfma_f32_16x16x32_bf16 v[88:91], v[48:51], v[192:195], v[120:123]
  ds_read_b128 v[40:43], v25 offset:18432
  v_add_f32 v229, v229, v78
  v_mfma_f32_16x16x32_bf16 v[92:95], v[48:51], v[208:211], v[116:119]
  v_exp_f32 v79, v79
  v_mfma_f32_16x16x32_bf16 v[88:91], v[52:55], v[196:199], v[88:91]
  ds_read_b128 v[44:47], v25 offset:19456
  v_add_f32 v229, v229, v79
  v_cvt_pk_bf16_f32 v103, v78, v79
  v_mfma_f32_16x16x32_bf16 v[92:95], v[52:55], v[212:215], v[92:95]
  v_exp_f32 v80, v80
  s_waitcnt lgkmcnt(4)
  v_mfma_f32_16x16x32_bf16 v[88:91], v[56:59], v[200:203], v[88:91]
  ds_read_b128 v[48:51], v25 offset:20480
  v_add_f32 v228, v228, v80
  v_mfma_f32_16x16x32_bf16 v[92:95], v[56:59], v[216:219], v[92:95]
  v_exp_f32 v81, v81
  v_mfma_f32_16x16x32_bf16 v[88:91], v[60:63], v[204:207], v[88:91]
  ds_read_b128 v[52:55], v25 offset:21504
  v_add_f32 v228, v228, v81
  v_cvt_pk_bf16_f32 v104, v80, v81
  v_mfma_f32_16x16x32_bf16 v[92:95], v[60:63], v[220:223], v[92:95]
  v_exp_f32 v82, v82
  s_waitcnt lgkmcnt(4)
  v_mfma_f32_16x16x32_bf16 v[128:131], v[32:35], v[96:99], v[128:131]
  ds_read_b128 v[56:59], v25 offset:22528
  buffer_load_dwordx4 v[232:235], v16, s[12:15], s72 offen offset:0 sc1
  v_add_f32 v228, v228, v82
  v_mfma_f32_16x16x32_bf16 v[160:163], v[32:35], v[100:103], v[160:163]
  buffer_load_dwordx4 v[236:239], v16, s[12:15], s73 offen offset:0 sc1
  v_exp_f32 v83, v83
  v_mfma_f32_16x16x32_bf16 v[164:167], v[36:39], v[100:103], v[164:167]
  ds_read_b128 v[60:63], v25 offset:23552
  buffer_load_dwordx4 v[240:243], v16, s[12:15], s72 offen offset:2048 sc1
  v_add_f32 v228, v228, v83
  v_cvt_pk_bf16_f32 v105, v82, v83
  v_mfma_f32_16x16x32_bf16 v[132:135], v[36:39], v[96:99], v[132:135]
  buffer_load_dwordx4 v[244:247], v16, s[12:15], s73 offen offset:2048 sc1
  s_add_u32 s72, s72, 4096
  s_add_u32 s73, s73, 4096
  v_exp_f32 v84, v84
  s_waitcnt lgkmcnt(4)
  v_mfma_f32_16x16x32_bf16 v[136:139], v[40:43], v[96:99], v[136:139]
  ds_read_b128 v[32:35], v24 offset:0
  buffer_load_dwordx4 v[248:251], v16, s[12:15], s72 offen offset:0 sc1
  v_add_f32 v229, v229, v84
  v_mfma_f32_16x16x32_bf16 v[168:171], v[40:43], v[100:103], v[168:171]
  buffer_load_dwordx4 v[252:255], v16, s[12:15], s73 offen offset:0 sc1
  v_exp_f32 v85, v85
  v_mfma_f32_16x16x32_bf16 v[172:175], v[44:47], v[100:103], v[172:175]
  ds_read_b128 v[36:39], v24 offset:1024
  buffer_load_dword v8, v11, s[12:15], s76 offen offset:4 sc1
  s_xor_b32 s76, s76, 128
  v_add_f32 v229, v229, v85
  v_cvt_pk_bf16_f32 v108, v84, v85
  v_mfma_f32_16x16x32_bf16 v[140:143], v[44:47], v[96:99], v[140:143]
  buffer_load_dword v9, v11, s[12:15], s76 offen offset:4 sc1
  v_exp_f32 v86, v86
  s_waitcnt lgkmcnt(4)
  v_mfma_f32_16x16x32_bf16 v[144:147], v[48:51], v[96:99], v[144:147]
  ds_read_b128 v[40:43], v24 offset:2048
  s_add_u32 s70, s70, 327680
  v_add_f32 v229, v229, v86
  v_mfma_f32_16x16x32_bf16 v[176:179], v[48:51], v[100:103], v[176:179]
  v_exp_f32 v87, v87
  v_mfma_f32_16x16x32_bf16 v[180:183], v[52:55], v[100:103], v[180:183]
  ds_read_b128 v[44:47], v24 offset:3072
  v_add_f32 v229, v229, v87
  v_cvt_pk_bf16_f32 v109, v86, v87
  v_mfma_f32_16x16x32_bf16 v[148:151], v[52:55], v[96:99], v[148:151]
  v_exp_f32 v88, v88
  s_waitcnt lgkmcnt(4)
  v_mfma_f32_16x16x32_bf16 v[152:155], v[56:59], v[96:99], v[152:155]
  ds_read_b128 v[48:51], v25 offset:24576
  v_add_f32 v228, v228, v88
  v_mfma_f32_16x16x32_bf16 v[184:187], v[56:59], v[100:103], v[184:187]
  v_exp_f32 v89, v89
  v_mfma_f32_16x16x32_bf16 v[188:191], v[60:63], v[100:103], v[188:191]
  ds_read_b128 v[52:55], v25 offset:25600
  v_add_f32 v228, v228, v89
  v_cvt_pk_bf16_f32 v106, v88, v89
  v_mfma_f32_16x16x32_bf16 v[156:159], v[60:63], v[96:99], v[156:159]
  v_exp_f32 v90, v90
  s_waitcnt lgkmcnt(4)
  v_mfma_f32_16x16x32_bf16 v[68:71], v[32:35], v[208:211], v[124:127]
  ds_read_b128 v[56:59], v25 offset:26624
  v_exp_f32 v91, v91
  v_mfma_f32_16x16x32_bf16 v[68:71], v[36:39], v[212:215], v[68:71]
  ds_read_b128 v[60:63], v25 offset:27648
  v_exp_f32 v92, v92
  s_waitcnt lgkmcnt(4)
  v_mfma_f32_16x16x32_bf16 v[68:71], v[40:43], v[216:219], v[68:71]
  ds_read_b128 v[32:35], v25 offset:28672
  v_exp_f32 v93, v93
  v_mfma_f32_16x16x32_bf16 v[68:71], v[44:47], v[220:223], v[68:71]
  ds_read_b128 v[36:39], v25 offset:29696
  v_exp_f32 v94, v94
  s_waitcnt lgkmcnt(4)
  v_add_f32 v228, v228, v90
  v_add_f32 v228, v228, v91
  v_cvt_pk_bf16_f32 v107, v90, v91
  s_nop 1
  v_mfma_f32_16x16x32_bf16 v[128:131], v[48:51], v[104:107], v[128:131]
  ds_read_b128 v[40:43], v25 offset:30720
  v_add_f32 v229, v229, v92
  v_add_f32 v229, v229, v93
  v_cvt_pk_bf16_f32 v110, v92, v93
  v_exp_f32 v95, v95
  v_add_f32 v229, v229, v94
  v_add_f32 v229, v229, v95
  v_cvt_pk_bf16_f32 v111, v94, v95
  s_nop 1
  v_mfma_f32_16x16x32_bf16 v[160:163], v[48:51], v[108:111], v[160:163]
  v_mov_b32 v102, 0
  v_mov_b32 v103, 0
  v_mfma_f32_16x16x32_bf16 v[164:167], v[52:55], v[108:111], v[164:167]
  ds_read_b128 v[44:47], v25 offset:31744
  v_mov_b32 v25, v24
  v_mfma_f32_16x16x32_bf16 v[132:135], v[52:55], v[104:107], v[132:135]
  v_exp_f32 v68, v68
  s_waitcnt lgkmcnt(4)
  v_mfma_f32_16x16x32_bf16 v[136:139], v[56:59], v[104:107], v[136:139]
  ds_read_b128 v[48:51], v25 offset:16384
  v_add_f32 v229, v229, v68
  v_mfma_f32_16x16x32_bf16 v[168:171], v[56:59], v[108:111], v[168:171]
  v_exp_f32 v69, v69
  v_mfma_f32_16x16x32_bf16 v[172:175], v[60:63], v[108:111], v[172:175]
  ds_read_b128 v[52:55], v25 offset:17408
  v_add_f32 v229, v229, v69
  v_cvt_pk_bf16_f32 v100, v68, v69
  v_mfma_f32_16x16x32_bf16 v[140:143], v[60:63], v[104:107], v[140:143]
  v_exp_f32 v70, v70
  s_waitcnt lgkmcnt(4)
  v_mfma_f32_16x16x32_bf16 v[144:147], v[32:35], v[104:107], v[144:147]
  ds_read_b128 v[56:59], v25 offset:18432
  v_add_f32 v229, v229, v70
  v_mfma_f32_16x16x32_bf16 v[176:179], v[32:35], v[108:111], v[176:179]
  v_exp_f32 v71, v71
  v_mfma_f32_16x16x32_bf16 v[180:183], v[36:39], v[108:111], v[180:183]
  ds_read_b128 v[60:63], v25 offset:19456
  v_add_f32 v229, v229, v71
  v_cvt_pk_bf16_f32 v101, v70, v71
  v_mfma_f32_16x16x32_bf16 v[148:151], v[36:39], v[104:107], v[148:151]
  s_waitcnt lgkmcnt(4)
  v_mfma_f32_16x16x32_bf16 v[152:155], v[40:43], v[104:107], v[152:155]
  ds_read_b128 v[32:35], v25 offset:20480
  v_mfma_f32_16x16x32_bf16 v[184:187], v[40:43], v[108:111], v[184:187]
  v_mfma_f32_16x16x32_bf16 v[188:191], v[44:47], v[108:111], v[188:191]
  ds_read_b128 v[36:39], v25 offset:21504
  v_mfma_f32_16x16x32_bf16 v[156:159], v[44:47], v[104:107], v[156:159]
  s_waitcnt lgkmcnt(4)
  v_mfma_f32_16x16x32_bf16 v[160:163], v[48:51], v[100:103], v[160:163]
  ds_read_b128 v[40:43], v25 offset:22528
  v_mfma_f32_16x16x32_bf16 v[164:167], v[52:55], v[100:103], v[164:167]
  ds_read_b128 v[44:47], v25 offset:23552
  s_waitcnt lgkmcnt(4)
  v_mfma_f32_16x16x32_bf16 v[168:171], v[56:59], v[100:103], v[168:171]
  v_mfma_f32_16x16x32_bf16 v[172:175], v[60:63], v[100:103], v[172:175]
  s_waitcnt lgkmcnt(2)
  v_mfma_f32_16x16x32_bf16 v[176:179], v[32:35], v[100:103], v[176:179]
  v_mfma_f32_16x16x32_bf16 v[180:183], v[36:39], v[100:103], v[180:183]
  s_waitcnt lgkmcnt(0)
  v_mfma_f32_16x16x32_bf16 v[184:187], v[40:43], v[100:103], v[184:187]
  v_mfma_f32_16x16x32_bf16 v[188:191], v[44:47], v[100:103], v[188:191]
  s_branch F_CHK
F_DA0:
  s_waitcnt lgkmcnt(4)
  v_mfma_f32_16x16x32_bf16 v[64:67], v[32:35], v[192:195], v[120:123]
  ds_read_b128 v[56:59], v24 offset:6144
  v_add_f32 v228, v228, v90
  v_mov_b32 v98, 0
  v_mfma_f32_16x16x32_bf16 v[68:71], v[32:35], v[208:211], v[116:119]
  v_exp_f32 v91, v91
  v_mfma_f32_16x16x32_bf16 v[64:67], v[36:39], v[196:199], v[64:67]
  ds_read_b128 v[60:63], v24 offset:7168
  v_add_f32 v228, v228, v91
  v_cvt_pk_bf16_f32 v107, v90, v91
  v_mfma_f32_16x16x32_bf16 v[68:71], v[36:39], v[212:215], v[68:71]
  v_exp_f32 v92, v92
  s_waitcnt lgkmcnt(4)
  v_mfma_f32_16x16x32_bf16 v[64:67], v[40:43], v[200:203], v[64:67]
  ds_read_b128 v[32:35], v25 offset:24576
  v_add_f32 v229, v229, v92
  v_mov_b32 v99, 0
  v_mfma_f32_16x16x32_bf16 v[68:71], v[40:43], v[216:219], v[68:71]
  v_exp_f32 v93, v93
  v_mfma_f32_16x16x32_bf16 v[64:67], v[44:47], v[204:207], v[64:67]
  ds_read_b128 v[36:39], v25 offset:25600
  v_add_f32 v229, v229, v93
  v_cvt_pk_bf16_f32 v110, v92, v93
  v_mfma_f32_16x16x32_bf16 v[68:71], v[44:47], v[220:223], v[68:71]
  v_exp_f32 v94, v94
  s_waitcnt lgkmcnt(4)
  v_mfma_f32_16x16x32_bf16 v[76:79], v[48:51], v[208:211], v[116:119]
  ds_read_b128 v[40:43], v25 offset:26624
  v_exp_f32 v95, v95
  v_mfma_f32_16x16x32_bf16 v[76:79], v[52:55], v[212:215], v[76:79]
  ds_read_b128 v[44:47], v25 offset:27648
  v_add_f32 v229, v229, v94
  v_add_f32 v229, v229, v95
  s_waitcnt lgkmcnt(4)
  v_mfma_f32_16x16x32_bf16 v[76:79], v[56:59], v[216:219], v[76:79]
  ds_read_b128 v[48:51], v25 offset:28672
  v_exp_f32 v64, v64
  v_mfma_f32_16x16x32_bf16 v[76:79], v[60:63], v[220:223], v[76:79]
  ds_read_b128 v[52:55], v25 offset:29696
  v_exp_f32 v65, v65
  s_waitcnt lgkmcnt(4)
  v_mfma_f32_16x16x32_bf16 v[128:131], v[32:35], v[104:107], v[128:131]
  ds_read_b128 v[56:59], v25 offset:30720
  v_cvt_pk_bf16_f32 v111, v94, v95
  v_add_f32 v228, v228, v64
  s_nop 0
  v_mfma_f32_16x16x32_bf16 v[160:163], v[32:35], v[108:111], v[160:163]
  v_exp_f32 v66, v66
  v_mfma_f32_16x16x32_bf16 v[164:167], v[36:39], v[108:111], v[164:167]
  ds_read_b128 v[60:63], v25 offset:31744
  v_mov_b32 v25, v24
  v_add_f32 v228, v228, v65
  v_cvt_pk_bf16_f32 v96, v64, v65
  v_mfma_f32_16x16x32_bf16 v[132:135], v[36:39], v[104:107], v[132:135]
  v_exp_f32 v67, v67
  s_waitcnt lgkmcnt(4)
  v_mfma_f32_16x16x32_bf16 v[136:139], v[40:43], v[104:107], v[136:139]
  ds_read_b128 v[32:35], v24 offset:8192
  v_add_f32 v228, v228, v66
  v_add_f32 v228, v228, v67
  v_mfma_f32_16x16x32_bf16 v[168:171], v[40:43], v[108:111], v[168:171]
  v_exp_f32 v68, v68
  v_mfma_f32_16x16x32_bf16 v[172:175], v[44:47], v[108:111], v[172:175]
  ds_read_b128 v[36:39], v24 offset:9216
  v_cvt_pk_bf16_f32 v97, v66, v67
  v_add_f32 v229, v229, v68
  v_mfma_f32_16x16x32_bf16 v[140:143], v[44:47], v[104:107], v[140:143]
  v_exp_f32 v69, v69
  s_waitcnt lgkmcnt(4)
  v_mfma_f32_16x16x32_bf16 v[144:147], v[48:51], v[104:107], v[144:147]
  ds_read_b128 v[40:43], v24 offset:10240
  v_add_f32 v229, v229, v69
  v_cvt_pk_bf16_f32 v100, v68, v69
  v_mfma_f32_16x16x32_bf16 v[176:179], v[48:51], v[108:111], v[176:179]
  v_exp_f32 v70, v70
  v_mfma_f32_16x16x32_bf16 v[180:183], v[52:55], v[108:111], v[180:183]
  ds_read_b128 v[44:47], v24 offset:11264
  v_add_f32 v229, v229, v70
  v_mfma_f32_16x16x32_bf16 v[148:151], v[52:55], v[104:107], v[148:151]
  v_exp_f32 v71, v71
  s_waitcnt lgkmcnt(4)
  v_mfma_f32_16x16x32_bf16 v[152:155], v[56:59], v[104:107], v[152:155]
  ds_read_b128 v[48:51], v24 offset:12288
  v_add_f32 v229, v229, v71
  v_cvt_pk_bf16_f32 v101, v70, v71
  v_mfma_f32_16x16x32_bf16 v[184:187], v[56:59], v[108:111], v[184:187]
  v_exp_f32 v76, v76
  v_mfma_f32_16x16x32_bf16 v[188:191], v[60:63], v[108:111], v[188:191]
  ds_read_b128 v[52:55], v24 offset:13312
  v_add_f32 v229, v229, v76
  v_mfma_f32_16x16x32_bf16 v[156:159], v[60:63], v[104:107], v[156:159]
  s_barrier
  v_exp_f32 v77, v77
  s_waitcnt lgkmcnt(4)
  v_mfma_f32_16x16x32_bf16 v[84:87], v[32:35], v[208:211], v[116:119]
  ds_read_b128 v[56:59], v24 offset:14336
  v_exp_f32 v78, v78
  v_mfma_f32_16x16x32_bf16 v[84:87], v[36:39], v[212:215], v[84:87]
  ds_read_b128 v[60:63], v24 offset:15360
  v_add_u32 v24, s85, v16
  v_exp_f32 v79, v79
  s_waitcnt lgkmcnt(4)
  v_mfma_f32_16x16x32_bf16 v[84:87], v[40:43], v[216:219], v[84:87]
  ds_read_b128 v[32:35], v25 offset:16384
  v_add_f32 v229, v229, v77
  v_cvt_pk_bf16_f32 v102, v76, v77
  v_mfma_f32_16x16x32_bf16 v[84:87], v[44:47], v[220:223], v[84:87]
  ds_read_b128 v[36:39], v25 offset:17408
  s_add_u32 s85, s85, 32768
  s_sub_u32 s33, s85, 163840
  s_cselect_b32 s85, s85, s33
  v_add_f32 v229, v229, v78
  v_add_f32 v229, v229, v79
  s_waitcnt lgkmcnt(4)
  v_mfma_f32_16x16x32_bf16 v[92:95], v[48:51], v[208:211], v[116:119]
  ds_read_b128 v[40:43], v25 offset:18432
  v_cvt_pk_bf16_f32 v103, v78, v79
  v_mfma_f32_16x16x32_bf16 v[92:95], v[52:55], v[212:215], v[92:95]
  ds_read_b128 v[44:47], v25 offset:19456
  s_waitcnt lgkmcnt(4)
  v_mfma_f32_16x16x32_bf16 v[92:95], v[56:59], v[216:219], v[92:95]
  ds_read_b128 v[48:51], v25 offset:20480
  v_mfma_f32_16x16x32_bf16 v[92:95], v[60:63], v[220:223], v[92:95]
  ds_read_b128 v[52:55], v25 offset:21504
  v_exp_f32 v84, v84
  s_waitcnt lgkmcnt(4)
  v_mfma_f32_16x16x32_bf16 v[128:131], v[32:35], v[96:99], v[128:131]
  ds_read_b128 v[56:59], v25 offset:22528
  buffer_load_dwordx4 v[232:235], v16, s[12:15], s72 offen offset:0 sc1
  v_add_f32 v229, v229, v84
  v_mfma_f32_16x16x32_bf16 v[160:163], v[32:35], v[100:103], v[160:163]
  buffer_load_dwordx4 v[236:239], v16, s[12:15], s73 offen offset:0 sc1
  v_exp_f32 v85, v85
  v_mfma_f32_16x16x32_bf16 v[164:167], v[36:39], v[100:103], v[164:167]
  ds_read_b128 v[60:63], v25 offset:23552
  buffer_load_dwordx4 v[240:243], v16, s[12:15], s72 offen offset:2048 sc1
  v_add_f32 v229, v229, v85
  v_cvt_pk_bf16_f32 v108, v84, v85
  v_mfma_f32_16x16x32_bf16 v[132:135], v[36:39], v[96:99], v[132:135]
  buffer_load_dwordx4 v[244:247], v16, s[12:15], s73 offen offset:2048 sc1
  s_add_u32 s72, s72, 4096
  s_add_u32 s73, s73, 4096
  v_exp_f32 v86, v86
  s_waitcnt lgkmcnt(4)
  v_mfma_f32_16x16x32_bf16 v[136:139], v[40:43], v[96:99], v[136:139]
  ds_read_b128 v[32:35], v24 offset:0
  buffer_load_dwordx4 v[248:251], v16, s[12:15], s72 offen offset:0 sc1
  v_add_f32 v229, v229, v86
  v_mfma_f32_16x16x32_bf16 v[168:171], v[40:43], v[100:103], v[168:171]
  buffer_load_dwordx4 v[252:255], v16, s[12:15], s73 offen offset:0 sc1
  v_exp_f32 v87, v87
  v_mfma_f32_16x16x32_bf16 v[172:175], v[44:47], v[100:103], v[172:175]
  ds_read_b128 v[36:39], v24 offset:1024
  buffer_load_dword v8, v11, s[12:15], s76 offen offset:4 sc1
  s_xor_b32 s76, s76, 128
  v_add_f32 v229, v229, v87
  v_cvt_pk_bf16_f32 v109, v86, v87
  v_mfma_f32_16x16x32_bf16 v[140:143], v[44:47], v[96:99], v[140:143]
  buffer_load_dword v9, v11, s[12:15], s76 offen offset:4 sc1
  v_exp_f32 v92, v92
  s_waitcnt lgkmcnt(4)
  v_mfma_f32_16x16x32_bf16 v[144:147], v[48:51], v[96:99], v[144:147]
  ds_read_b128 v[40:43], v24 offset:2048
  s_add_u32 s70, s70, 327680
  v_add_f32 v229, v229, v92
  v_mfma_f32_16x16x32_bf16 v[176:179], v[48:51], v[100:103], v[176:179]
  v_exp_f32 v93, v93
  v_mfma_f32_16x16x32_bf16 v[180:183], v[52:55], v[100:103], v[180:183]
  ds_read_b128 v[44:47], v24 offset:3072
  v_add_f32 v229, v229, v93
  v_cvt_pk_bf16_f32 v110, v92, v93
  v_mfma_f32_16x16x32_bf16 v[148:151], v[52:55], v[96:99], v[148:151]
  v_exp_f32 v94, v94
  s_waitcnt lgkmcnt(4)
  v_mfma_f32_16x16x32_bf16 v[152:155], v[56:59], v[96:99], v[152:155]
  ds_read_b128 v[48:51], v24 offset:4096
  v_add_f32 v229, v229, v94
  v_mfma_f32_16x16x32_bf16 v[184:187], v[56:59], v[100:103], v[184:187]
  v_exp_f32 v95, v95
  v_mfma_f32_16x16x32_bf16 v[188:191], v[60:63], v[100:103], v[188:191]
  ds_read_b128 v[52:55], v24 offset:5120
  v_add_f32 v229, v229, v95
  v_cvt_pk_bf16_f32 v111, v94, v95
  v_mfma_f32_16x16x32_bf16 v[156:159], v[60:63], v[96:99], v[156:159]
  s_waitcnt lgkmcnt(4)
  v_mfma_f32_16x16x32_bf16 v[68:71], v[32:35], v[208:211], v[116:119]
  ds_read_b128 v[56:59], v24 offset:6144
  v_mfma_f32_16x16x32_bf16 v[68:71], v[36:39], v[212:215], v[68:71]
  ds_read_b128 v[60:63], v24 offset:7168
  s_waitcnt lgkmcnt(4)
  v_mfma_f32_16x16x32_bf16 v[68:71], v[40:43], v[216:219], v[68:71]
  ds_read_b128 v[32:35], v25 offset:24576
  v_mfma_f32_16x16x32_bf16 v[68:71], v[44:47], v[220:223], v[68:71]
  ds_read_b128 v[36:39], v25 offset:25600
  s_waitcnt lgkmcnt(4)
  v_mfma_f32_16x16x32_bf16 v[76:79], v[48:51], v[208:211], v[116:119]
  ds_read_b128 v[40:43], v25 offset:26624
  v_mfma_f32_16x16x32_bf16 v[76:79], v[52:55], v[212:215], v[76:79]
  ds_read_b128 v[44:47], v25 offset:27648
  s_waitcnt lgkmcnt(4)
  v_mfma_f32_16x16x32_bf16 v[76:79], v[56:59], v[216:219], v[76:79]
  ds_read_b128 v[48:51], v25 offset:28672
  v_mfma_f32_16x16x32_bf16 v[76:79], v[60:63], v[220:223], v[76:79]
  ds_read_b128 v[52:55], v25 offset:29696
  v_exp_f32 v68, v68
  s_waitcnt lgkmcnt(4)
  v_mfma_f32_16x16x32_bf16 v[160:163], v[32:35], v[108:111], v[160:163]
  ds_read_b128 v[56:59], v25 offset:30720
  v_exp_f32 v69, v69
  v_mfma_f32_16x16x32_bf16 v[164:167], v[36:39], v[108:111], v[164:167]
  ds_read_b128 v[60:63], v25 offset:31744
  v_mov_b32 v25, v24
  v_exp_f32 v70, v70
  s_waitcnt lgkmcnt(4)
  v_mfma_f32_16x16x32_bf16 v[168:171], v[40:43], v[108:111], v[168:171]
  ds_read_b128 v[32:35], v24 offset:8192
  v_exp_f32 v71, v71
  v_mfma_f32_16x16x32_bf16 v[172:175], v[44:47], v[108:111], v[172:175]
  ds_read_b128 v[36:39], v24 offset:9216
  v_exp_f32 v76, v76
  s_waitcnt lgkmcnt(4)
  v_mfma_f32_16x16x32_bf16 v[176:179], v[48:51], v[108:111], v[176:179]
  ds_read_b128 v[40:43], v24 offset:10240
  v_exp_f32 v77, v77
  v_mfma_f32_16x16x32_bf16 v[180:183], v[52:55], v[108:111], v[180:183]
  ds_read_b128 v[44:47], v24 offset:11264
  v_exp_f32 v78, v78
  s_waitcnt lgkmcnt(4)
  v_mfma_f32_16x16x32_bf16 v[184:187], v[56:59], v[108:111], v[184:187]
  ds_read_b128 v[48:51], v24 offset:12288
  v_exp_f32 v79, v79
  v_mfma_f32_16x16x32_bf16 v[188:191], v[60:63], v[108:111], v[188:191]
  ds_read_b128 v[52:55], v24 offset:13312
  v_add_f32 v229, v229, v68
  v_add_f32 v229, v229, v69
  s_waitcnt lgkmcnt(4)
  v_mfma_f32_16x16x32_bf16 v[84:87], v[32:35], v[208:211], v[116:119]
  ds_read_b128 v[56:59], v24 offset:14336
  v_cvt_pk_bf16_f32 v100, v68, v69
  v_add_f32 v229, v229, v70
  v_mfma_f32_16x16x32_bf16 v[84:87], v[36:39], v[212:215], v[84:87]
  ds_read_b128 v[60:63], v24 offset:15360
  v_add_f32 v229, v229, v71
  v_cvt_pk_bf16_f32 v101, v70, v71
  s_waitcnt lgkmcnt(4)
  v_mfma_f32_16x16x32_bf16 v[84:87], v[40:43], v[216:219], v[84:87]
  ds_read_b128 v[32:35], v25 offset:16384
  v_add_f32 v229, v229, v76
  v_add_f32 v229, v229, v77
  v_mfma_f32_16x16x32_bf16 v[84:87], v[44:47], v[220:223], v[84:87]
  ds_read_b128 v[36:39], v25 offset:17408
  v_cvt_pk_bf16_f32 v102, v76, v77
  v_add_f32 v229, v229, v78
  s_waitcnt lgkmcnt(4)
  v_mfma_f32_16x16x32_bf16 v[92:95], v[48:51], v[208:211], v[124:127]
  ds_read_b128 v[40:43], v25 offset:18432
  v_add_f32 v229, v229, v79
  v_cvt_pk_bf16_f32 v103, v78, v79
  v_mfma_f32_16x16x32_bf16 v[92:95], v[52:55], v[212:215], v[92:95]
  ds_read_b128 v[44:47], v25 offset:19456
  s_waitcnt lgkmcnt(4)
  v_mfma_f32_16x16x32_bf16 v[92:95], v[56:59], v[216:219], v[92:95]
  ds_read_b128 v[48:51], v25 offset:20480
  v_mfma_f32_16x16x32_bf16 v[92:95], v[60:63], v[220:223], v[92:95]
  ds_read_b128 v[52:55], v25 offset:21504
  v_exp_f32 v84, v84
  s_waitcnt lgkmcnt(4)
  v_mfma_f32_16x16x32_bf16 v[160:163], v[32:35], v[100:103], v[160:163]
  ds_read_b128 v[56:59], v25 offset:22528
  v_exp_f32 v85, v85
  v_mfma_f32_16x16x32_bf16 v[164:167], v[36:39], v[100:103], v[164:167]
  ds_read_b128 v[60:63], v25 offset:23552
  v_exp_f32 v86, v86
  s_waitcnt lgkmcnt(4)
  v_mfma_f32_16x16x32_bf16 v[168:171], v[40:43], v[100:103], v[168:171]
  ds_read_b128 v[32:35], v25 offset:24576
  v_exp_f32 v87, v87
  v_mfma_f32_16x16x32_bf16 v[172:175], v[44:47], v[100:103], v[172:175]
  ds_read_b128 v[36:39], v25 offset:25600
  v_exp_f32 v92, v92
  s_waitcnt lgkmcnt(4)
  v_mfma_f32_16x16x32_bf16 v[176:179], v[48:51], v[100:103], v[176:179]
  ds_read_b128 v[40:43], v25 offset:26624
  v_exp_f32 v93, v93
  v_mfma_f32_16x16x32_bf16 v[180:183], v[52:55], v[100:103], v[180:183]
  ds_read_b128 v[44:47], v25 offset:27648
  v_exp_f32 v94, v94
  s_waitcnt lgkmcnt(4)
  v_mfma_f32_16x16x32_bf16 v[184:187], v[56:59], v[100:103], v[184:187]
  ds_read_b128 v[48:51], v25 offset:28672
  v_exp_f32 v95, v95
  v_mfma_f32_16x16x32_bf16 v[188:191], v[60:63], v[100:103], v[188:191]
  ds_read_b128 v[52:55], v25 offset:29696
  v_add_f32 v229, v229, v84
  v_add_f32 v229, v229, v85
  s_waitcnt lgkmcnt(4)
  v_cvt_pk_bf16_f32 v108, v84, v85
  v_add_f32 v229, v229, v86
  v_add_f32 v229, v229, v87
  v_cvt_pk_bf16_f32 v109, v86, v87
  v_add_f32 v229, v229, v92
  v_add_f32 v229, v229, v93
  v_cvt_pk_bf16_f32 v110, v92, v93
  v_add_f32 v229, v229, v94
  v_add_f32 v229, v229, v95
  v_cvt_pk_bf16_f32 v111, v94, v95
  s_nop 1
  v_mfma_f32_16x16x32_bf16 v[160:163], v[32:35], v[108:111], v[160:163]
  ds_read_b128 v[56:59], v25 offset:30720
  v_mfma_f32_16x16x32_bf16 v[164:167], v[36:39], v[108:111], v[164:167]
  ds_read_b128 v[60:63], v25 offset:31744
  s_waitcnt lgkmcnt(4)
  v_mfma_f32_16x16x32_bf16 v[168:171], v[40:43], v[108:111], v[168:171]
  v_mfma_f32_16x16x32_bf16 v[172:175], v[44:47], v[108:111], v[172:175]
  s_waitcnt lgkmcnt(2)
  v_mfma_f32_16x16x32_bf16 v[176:179], v[48:51], v[108:111], v[176:179]
  v_mfma_f32_16x16x32_bf16 v[180:183], v[52:55], v[108:111], v[180:183]
  s_waitcnt lgkmcnt(0)
  v_mfma_f32_16x16x32_bf16 v[184:187], v[56:59], v[108:111], v[184:187]
  v_mfma_f32_16x16x32_bf16 v[188:191], v[60:63], v[108:111], v[188:191]
  s_branch F_CHK
F_DA1:
  s_waitcnt lgkmcnt(4)
  v_mfma_f32_16x16x32_bf16 v[64:67], v[32:35], v[192:195], v[112:115]
  ds_read_b128 v[56:59], v24 offset:6144
  v_add_f32 v228, v228, v90
  v_mfma_f32_16x16x32_bf16 v[68:71], v[32:35], v[208:211], v[116:119]
  v_exp_f32 v91, v91
  v_mfma_f32_16x16x32_bf16 v[64:67], v[36:39], v[196:199], v[64:67]
  ds_read_b128 v[60:63], v24 offset:7168
  v_add_f32 v228, v228, v91
  v_cvt_pk_bf16_f32 v107, v90, v91
  v_mfma_f32_16x16x32_bf16 v[68:71], v[36:39], v[212:215], v[68:71]
  v_exp_f32 v92, v92
  s_waitcnt lgkmcnt(4)
  v_mfma_f32_16x16x32_bf16 v[64:67], v[40:43], v[200:203], v[64:67]
  ds_read_b128 v[32:35], v25 offset:24576
  v_add_f32 v229, v229, v92
  v_mfma_f32_16x16x32_bf16 v[68:71], v[40:43], v[216:219], v[68:71]
  v_exp_f32 v93, v93
  v_mfma_f32_16x16x32_bf16 v[64:67], v[44:47], v[204:207], v[64:67]
  ds_read_b128 v[36:39], v25 offset:25600
  v_add_f32 v229, v229, v93
  v_cvt_pk_bf16_f32 v110, v92, v93
  v_mfma_f32_16x16x32_bf16 v[68:71], v[44:47], v[220:223], v[68:71]
  v_exp_f32 v94, v94
  s_waitcnt lgkmcnt(4)
  v_mfma_f32_16x16x32_bf16 v[72:75], v[48:51], v[192:195], v[120:123]
  ds_read_b128 v[40:43], v25 offset:26624
  v_add_f32 v229, v229, v94
  v_mfma_f32_16x16x32_bf16 v[76:79], v[48:51], v[208:211], v[116:119]
  v_exp_f32 v95, v95
  v_mfma_f32_16x16x32_bf16 v[72:75], v[52:55], v[196:199], v[72:75]
  ds_read_b128 v[44:47], v25 offset:27648
  v_add_f32 v229, v229, v95
  v_cvt_pk_bf16_f32 v111, v94, v95
  v_mfma_f32_16x16x32_bf16 v[76:79], v[52:55], v[212:215], v[76:79]
  v_exp_f32 v64, v64
  s_waitcnt lgkmcnt(4)
  v_mfma_f32_16x16x32_bf16 v[72:75], v[56:59], v[200:203], v[72:75]
  ds_read_b128 v[48:51], v25 offset:28672
  v_add_f32 v228, v228, v64
  v_mfma_f32_16x16x32_bf16 v[76:79], v[56:59], v[216:219], v[76:79]
  v_exp_f32 v65, v65
  v_mfma_f32_16x16x32_bf16 v[72:75], v[60:63], v[204:207], v[72:75]
  ds_read_b128 v[52:55], v25 offset:29696
  v_add_f32 v228, v228, v65
  v_cvt_pk_bf16_f32 v96, v64, v65
  v_mfma_f32_16x16x32_bf16 v[76:79], v[60:63], v[220:223], v[76:79]
  v_exp_f32 v66, v66
  s_waitcnt lgkmcnt(4)
  v_mfma_f32_16x16x32_bf16 v[128:131], v[32:35], v[104:107], v[128:131]
  ds_read_b128 v[56:59], v25 offset:30720
  v_add_f32 v228, v228, v66
  v_mfma_f32_16x16x32_bf16 v[160:163], v[32:35], v[108:111], v[160:163]
  v_exp_f32 v67, v67
  v_mfma_f32_16x16x32_bf16 v[164:167], v[36:39], v[108:111], v[164:167]
  ds_read_b128 v[60:63], v25 offset:31744
  v_mov_b32 v25, v24
  v_add_f32 v228, v228, v67
  v_cvt_pk_bf16_f32 v97, v66, v67
  v_mfma_f32_16x16x32_bf16 v[132:135], v[36:39], v[104:107], v[132:135]
  v_exp_f32 v68, v68
  s_waitcnt lgkmcnt(4)
  v_mfma_f32_16x16x32_bf16 v[136:139], v[40:43], v[104:107], v[136:139]
  ds_read_b128 v[32:35], v24 offset:8192
  v_add_f32 v229, v229, v68
  v_mfma_f32_16x16x32_bf16 v[168:171], v[40:43], v[108:111], v[168:171]
  v_exp_f32 v69, v69
  v_mfma_f32_16x16x32_bf16 v[172:175], v[44:47], v[108:111], v[172:175]
  ds_read_b128 v[36:39], v24 offset:9216
  v_add_f32 v229, v229, v69
  v_cvt_pk_bf16_f32 v100, v68, v69
  v_mfma_f32_16x16x32_bf16 v[140:143], v[44:47], v[104:107], v[140:143]
  v_exp_f32 v70, v70
  s_waitcnt lgkmcnt(4)
  v_mfma_f32_16x16x32_bf16 v[144:147], v[48:51], v[104:107], v[144:147]
  ds_read_b128 v[40:43], v24 offset:10240
  v_add_f32 v229, v229, v70
  v_mfma_f32_16x16x32_bf16 v[176:179], v[48:51], v[108:111], v[176:179]
  v_exp_f32 v71, v71
  v_mfma_f32_16x16x32_bf16 v[180:183], v[52:55], v[108:111], v[180:183]
  ds_read_b128 v[44:47], v24 offset:11264
  v_add_f32 v229, v229, v71
  v_cvt_pk_bf16_f32 v101, v70, v71
  v_mfma_f32_16x16x32_bf16 v[148:151], v[52:55], v[104:107], v[148:151]
  v_exp_f32 v72, v72
  s_waitcnt lgkmcnt(4)
  v_mfma_f32_16x16x32_bf16 v[152:155], v[56:59], v[104:107], v[152:155]
  ds_read_b128 v[48:51], v24 offset:12288
  v_add_f32 v228, v228, v72
  v_mfma_f32_16x16x32_bf16 v[184:187], v[56:59], v[108:111], v[184:187]
  v_exp_f32 v73, v73
  v_mfma_f32_16x16x32_bf16 v[188:191], v[60:63], v[108:111], v[188:191]
  ds_read_b128 v[52:55], v24 offset:13312
  v_add_f32 v228, v228, v73
  v_cvt_pk_bf16_f32 v98, v72, v73
  v_mfma_f32_16x16x32_bf16 v[156:159], v[60:63], v[104:107], v[156:159]
  s_barrier
  v_exp_f32 v74, v74
  s_waitcnt lgkmcnt(4)
  v_mfma_f32_16x16x32_bf16 v[84:87], v[32:35], v[208:211], v[116:119]
  ds_read_b128 v[56:59], v24 offset:14336
  v_exp_f32 v75, v75
  v_mfma_f32_16x16x32_bf16 v[84:87], v[36:39], v[212:215], v[84:87]
  ds_read_b128 v[60:63], v24 offset:15360
  v_add_u32 v24, s85, v16
  v_exp_f32 v76, v76
  s_waitcnt lgkmcnt(4)
  v_mfma_f32_16x16x32_bf16 v[84:87], v[40:43], v[216:219], v[84:87]
  ds_read_b128 v[32:35], v25 offset:16384
  v_exp_f32 v77, v77
  v_mfma_f32_16x16x32_bf16 v[84:87], v[44:47], v[220:223], v[84:87]
  ds_read_b128 v[36:39], v25 offset:17408
  s_add_u32 s85, s85, 32768
  s_sub_u32 s33, s85, 163840
  s_cselect_b32 s85, s85, s33
  v_exp_f32 v78, v78
  s_waitcnt lgkmcnt(4)
  v_mfma_f32_16x16x32_bf16 v[92:95], v[48:51], v[208:211], v[116:119]
  ds_read_b128 v[40:43], v25 offset:18432
  v_exp_f32 v79, v79
  v_mfma_f32_16x16x32_bf16 v[92:95], v[52:55], v[212:215], v[92:95]
  ds_read_b128 v[44:47], v25 offset:19456
  v_add_f32 v228, v228, v74
  v_add_f32 v228, v228, v75
  s_waitcnt lgkmcnt(4)
  v_mfma_f32_16x16x32_bf16 v[92:95], v[56:59], v[216:219], v[92:95]
  ds_read_b128 v[48:51], v25 offset:20480
  v_cvt_pk_bf16_f32 v99, v74, v75
  v_add_f32 v229, v229, v76
  v_mfma_f32_16x16x32_bf16 v[92:95], v[60:63], v[220:223], v[92:95]
  ds_read_b128 v[52:55], v25 offset:21504
  v_exp_f32 v84, v84
  s_waitcnt lgkmcnt(4)
  v_mfma_f32_16x16x32_bf16 v[128:131], v[32:35], v[96:99], v[128:131]
  ds_read_b128 v[56:59], v25 offset:22528
  buffer_load_dwordx4 v[232:235], v16, s[12:15], s72 offen offset:0 sc1
  v_add_f32 v229, v229, v77
  v_cvt_pk_bf16_f32 v102, v76, v77
  v_add_f32 v229, v229, v78
  v_add_f32 v229, v229, v79
  v_cvt_pk_bf16_f32 v103, v78, v79
  s_nop 1
  v_mfma_f32_16x16x32_bf16 v[160:163], v[32:35], v[100:103], v[160:163]
  buffer_load_dwordx4 v[236:239], v16, s[12:15], s73 offen offset:0 sc1
  v_exp_f32 v85, v85
  v_mfma_f32_16x16x32_bf16 v[164:167], v[36:39], v[100:103], v[164:167]
  ds_read_b128 v[60:63], v25 offset:23552
  buffer_load_dwordx4 v[240:243], v16, s[12:15], s72 offen offset:2048 sc1
  v_add_f32 v229, v229, v84
  v_add_f32 v229, v229, v85
  v_mfma_f32_16x16x32_bf16 v[132:135], v[36:39], v[96:99], v[132:135]
  buffer_load_dwordx4 v[244:247], v16, s[12:15], s73 offen offset:2048 sc1
  s_add_u32 s72, s72, 4096
  s_add_u32 s73, s73, 4096
  v_exp_f32 v86, v86
  s_waitcnt lgkmcnt(4)
  v_mfma_f32_16x16x32_bf16 v[136:139], v[40:43], v[96:99], v[136:139]
  ds_read_b128 v[32:35], v24 offset:0
  buffer_load_dwordx4 v[248:251], v16, s[12:15], s72 offen offset:0 sc1
  v_cvt_pk_bf16_f32 v108, v84, v85
  v_add_f32 v229, v229, v86
  v_mfma_f32_16x16x32_bf16 v[168:171], v[40:43], v[100:103], v[168:171]
  buffer_load_dwordx4 v[252:255], v16, s[12:15], s73 offen offset:0 sc1
  v_exp_f32 v87, v87
  v_mfma_f32_16x16x32_bf16 v[172:175], v[44:47], v[100:103], v[172:175]
  ds_read_b128 v[36:39], v24 offset:1024
  buffer_load_dword v8, v11, s[12:15], s76 offen offset:4 sc1
  s_xor_b32 s76, s76, 128
  v_add_f32 v229, v229, v87
  v_cvt_pk_bf16_f32 v109, v86, v87
  v_mfma_f32_16x16x32_bf16 v[140:143], v[44:47], v[96:99], v[140:143]
  buffer_load_dword v9, v11, s[12:15], s76 offen offset:4 sc1
  v_exp_f32 v92, v92
  s_waitcnt lgkmcnt(4)
  v_mfma_f32_16x16x32_bf16 v[144:147], v[48:51], v[96:99], v[144:147]
  ds_read_b128 v[40:43], v24 offset:2048
  s_add_u32 s70, s70, 327680
  v_add_f32 v229, v229, v92
  v_mfma_f32_16x16x32_bf16 v[176:179], v[48:51], v[100:103], v[176:179]
  v_exp_f32 v93, v93
  v_mfma_f32_16x16x32_bf16 v[180:183], v[52:55], v[100:103], v[180:183]
  ds_read_b128 v[44:47], v24 offset:3072
  v_add_f32 v229, v229, v93
  v_cvt_pk_bf16_f32 v110, v92, v93
  v_mfma_f32_16x16x32_bf16 v[148:151], v[52:55], v[96:99], v[148:151]
  v_exp_f32 v94, v94
  s_waitcnt lgkmcnt(4)
  v_mfma_f32_16x16x32_bf16 v[152:155], v[56:59], v[96:99], v[152:155]
  ds_read_b128 v[48:51], v24 offset:4096
  v_add_f32 v229, v229, v94
  v_mfma_f32_16x16x32_bf16 v[184:187], v[56:59], v[100:103], v[184:187]
  v_exp_f32 v95, v95
  v_mfma_f32_16x16x32_bf16 v[188:191], v[60:63], v[100:103], v[188:191]
  ds_read_b128 v[52:55], v24 offset:5120
  v_add_f32 v229, v229, v95
  v_cvt_pk_bf16_f32 v111, v94, v95
  v_mfma_f32_16x16x32_bf16 v[156:159], v[60:63], v[96:99], v[156:159]
  s_waitcnt lgkmcnt(4)
  v_mfma_f32_16x16x32_bf16 v[68:71], v[32:35], v[208:211], v[116:119]
  ds_read_b128 v[56:59], v24 offset:6144
  v_mfma_f32_16x16x32_bf16 v[68:71], v[36:39], v[212:215], v[68:71]
  ds_read_b128 v[60:63], v24 offset:7168
  s_waitcnt lgkmcnt(4)
  v_mfma_f32_16x16x32_bf16 v[68:71], v[40:43], v[216:219], v[68:71]
  ds_read_b128 v[32:35], v25 offset:24576
  v_mfma_f32_16x16x32_bf16 v[68:71], v[44:47], v[220:223], v[68:71]
  ds_read_b128 v[36:39], v25 offset:25600
  s_waitcnt lgkmcnt(4)
  v_mfma_f32_16x16x32_bf16 v[76:79], v[48:51], v[208:211], v[116:119]
  ds_read_b128 v[40:43], v25 offset:26624
  v_mfma_f32_16x16x32_bf16 v[76:79], v[52:55], v[212:215], v[76:79]
  ds_read_b128 v[44:47], v25 offset:27648
  s_waitcnt lgkmcnt(4)
  v_mfma_f32_16x16x32_bf16 v[76:79], v[56:59], v[216:219], v[76:79]
  ds_read_b128 v[48:51], v25 offset:28672
  v_mfma_f32_16x16x32_bf16 v[76:79], v[60:63], v[220:223], v[76:79]
  ds_read_b128 v[52:55], v25 offset:29696
  v_exp_f32 v68, v68
  s_waitcnt lgkmcnt(4)
  v_mfma_f32_16x16x32_bf16 v[160:163], v[32:35], v[108:111], v[160:163]
  ds_read_b128 v[56:59], v25 offset:30720
  v_exp_f32 v69, v69
  v_mfma_f32_16x16x32_bf16 v[164:167], v[36:39], v[108:111], v[164:167]
  ds_read_b128 v[60:63], v25 offset:31744
  v_mov_b32 v25, v24
  v_exp_f32 v70, v70
  s_waitcnt lgkmcnt(4)
  v_mfma_f32_16x16x32_bf16 v[168:171], v[40:43], v[108:111], v[168:171]
  ds_read_b128 v[32:35], v24 offset:8192
  v_exp_f32 v71, v71
  v_mfma_f32_16x16x32_bf16 v[172:175], v[44:47], v[108:111], v[172:175]
  ds_read_b128 v[36:39], v24 offset:9216
  v_exp_f32 v76, v76
  s_waitcnt lgkmcnt(4)
  v_mfma_f32_16x16x32_bf16 v[176:179], v[48:51], v[108:111], v[176:179]
  ds_read_b128 v[40:43], v24 offset:10240
  v_exp_f32 v77, v77
  v_mfma_f32_16x16x32_bf16 v[180:183], v[52:55], v[108:111], v[180:183]
  ds_read_b128 v[44:47], v24 offset:11264
  v_exp_f32 v78, v78
  s_waitcnt lgkmcnt(4)
  v_mfma_f32_16x16x32_bf16 v[184:187], v[56:59], v[108:111], v[184:187]
  ds_read_b128 v[48:51], v25 offset:16384
  v_exp_f32 v79, v79
  v_mfma_f32_16x16x32_bf16 v[188:191], v[60:63], v[108:111], v[188:191]
  ds_read_b128 v[52:55], v25 offset:17408
  v_add_f32 v229, v229, v68
  v_add_f32 v229, v229, v69
  s_waitcnt lgkmcnt(4)
  v_mfma_f32_16x16x32_bf16 v[84:87], v[32:35], v[208:211], v[124:127]
  ds_read_b128 v[56:59], v25 offset:18432
  v_cvt_pk_bf16_f32 v100, v68, v69
  v_add_f32 v229, v229, v70
  v_mfma_f32_16x16x32_bf16 v[84:87], v[36:39], v[212:215], v[84:87]
  ds_read_b128 v[60:63], v25 offset:19456
  v_add_f32 v229, v229, v71
  v_cvt_pk_bf16_f32 v101, v70, v71
  s_waitcnt lgkmcnt(4)
  v_mfma_f32_16x16x32_bf16 v[84:87], v[40:43], v[216:219], v[84:87]
  ds_read_b128 v[32:35], v25 offset:20480
  v_add_f32 v229, v229, v76
  v_add_f32 v229, v229, v77
  v_mfma_f32_16x16x32_bf16 v[84:87], v[44:47], v[220:223], v[84:87]
  ds_read_b128 v[36:39], v25 offset:21504
  v_cvt_pk_bf16_f32 v102, v76, v77
  v_add_f32 v229, v229, v78
  s_waitcnt lgkmcnt(4)
  v_add_f32 v229, v229, v79
  v_cvt_pk_bf16_f32 v103, v78, v79
  s_nop 1
  v_mfma_f32_16x16x32_bf16 v[160:163], v[48:51], v[100:103], v[160:163]
  ds_read_b128 v[40:43], v25 offset:22528
  v_mov_b32 v110, 0
  v_mov_b32 v111, 0
  v_mfma_f32_16x16x32_bf16 v[164:167], v[52:55], v[100:103], v[164:167]
  ds_read_b128 v[44:47], v25 offset:23552
  s_waitcnt lgkmcnt(4)
  v_mfma_f32_16x16x32_bf16 v[168:171], v[56:59], v[100:103], v[168:171]
  ds_read_b128 v[48:51], v25 offset:24576
  v_mfma_f32_16x16x32_bf16 v[172:175], v[60:63], v[100:103], v[172:175]
  ds_read_b128 v[52:55], v25 offset:25600
  v_exp_f32 v84, v84
  s_waitcnt lgkmcnt(4)
  v_mfma_f32_16x16x32_bf16 v[176:179], v[32:35], v[100:103], v[176:179]
  ds_read_b128 v[56:59], v25 offset:26624
  v_exp_f32 v85, v85
  v_mfma_f32_16x16x32_bf16 v[180:183], v[36:39], v[100:103], v[180:183]
  ds_read_b128 v[60:63], v25 offset:27648
  v_exp_f32 v86, v86
  s_waitcnt lgkmcnt(4)
  v_mfma_f32_16x16x32_bf16 v[184:187], v[40:43], v[100:103], v[184:187]
  ds_read_b128 v[32:35], v25 offset:28672
  v_exp_f32 v87, v87
  v_mfma_f32_16x16x32_bf16 v[188:191], v[44:47], v[100:103], v[188:191]
  ds_read_b128 v[36:39], v25 offset:29696
  v_add_f32 v229, v229, v84
  v_add_f32 v229, v229, v85
  s_waitcnt lgkmcnt(4)
  v_cvt_pk_bf16_f32 v108, v84, v85
  v_add_f32 v229, v229, v86
  v_add_f32 v229, v229, v87
  v_cvt_pk_bf16_f32 v109, v86, v87
  s_nop 1
  v_mfma_f32_16x16x32_bf16 v[160:163], v[48:51], v[108:111], v[160:163]
  ds_read_b128 v[40:43], v25 offset:30720
  v_mfma_f32_16x16x32_bf16 v[164:167], v[52:55], v[108:111], v[164:167]
  ds_read_b128 v[44:47], v25 offset:31744
  s_waitcnt lgkmcnt(4)
  v_mfma_f32_16x16x32_bf16 v[168:171], v[56:59], v[108:111], v[168:171]
  v_mfma_f32_16x16x32_bf16 v[172:175], v[60:63], v[108:111], v[172:175]
  s_waitcnt lgkmcnt(2)
  v_mfma_f32_16x16x32_bf16 v[176:179], v[32:35], v[108:111], v[176:179]
  v_mfma_f32_16x16x32_bf16 v[180:183], v[36:39], v[108:111], v[180:183]
  s_waitcnt lgkmcnt(0)
  v_mfma_f32_16x16x32_bf16 v[184:187], v[40:43], v[108:111], v[184:187]
  v_mfma_f32_16x16x32_bf16 v[188:191], v[44:47], v[108:111], v[188:191]
  s_branch F_CHK
F_DA2:
  s_waitcnt lgkmcnt(4)
  v_mfma_f32_16x16x32_bf16 v[64:67], v[32:35], v[192:195], v[112:115]
  ds_read_b128 v[56:59], v24 offset:6144
  v_add_f32 v228, v228, v90
  v_mfma_f32_16x16x32_bf16 v[68:71], v[32:35], v[208:211], v[116:119]
  v_exp_f32 v91, v91
  v_mfma_f32_16x16x32_bf16 v[64:67], v[36:39], v[196:199], v[64:67]
  ds_read_b128 v[60:63], v24 offset:7168
  v_add_f32 v228, v228, v91
  v_cvt_pk_bf16_f32 v107, v90, v91
  v_mfma_f32_16x16x32_bf16 v[68:71], v[36:39], v[212:215], v[68:71]
  v_exp_f32 v92, v92
  s_waitcnt lgkmcnt(4)
  v_mfma_f32_16x16x32_bf16 v[64:67], v[40:43], v[200:203], v[64:67]
  ds_read_b128 v[32:35], v25 offset:24576
  v_add_f32 v229, v229, v92
  v_mfma_f32_16x16x32_bf16 v[68:71], v[40:43], v[216:219], v[68:71]
  v_exp_f32 v93, v93
  v_mfma_f32_16x16x32_bf16 v[64:67], v[44:47], v[204:207], v[64:67]
  ds_read_b128 v[36:39], v25 offset:25600
  v_add_f32 v229, v229, v93
  v_cvt_pk_bf16_f32 v110, v92, v93
  v_mfma_f32_16x16x32_bf16 v[68:71], v[44:47], v[220:223], v[68:71]
  v_exp_f32 v94, v94
  s_waitcnt lgkmcnt(4)
  v_mfma_f32_16x16x32_bf16 v[72:75], v[48:51], v[192:195], v[112:115]
  ds_read_b128 v[40:43], v25 offset:26624
  v_add_f32 v229, v229, v94
  v_mfma_f32_16x16x32_bf16 v[76:79], v[48:51], v[208:211], v[116:119]
  v_exp_f32 v95, v95
  v_mfma_f32_16x16x32_bf16 v[72:75], v[52:55], v[196:199], v[72:75]
  ds_read_b128 v[44:47], v25 offset:27648
  v_add_f32 v229, v229, v95
  v_cvt_pk_bf16_f32 v111, v94, v95
  v_mfma_f32_16x16x32_bf16 v[76:79], v[52:55], v[212:215], v[76:79]
  v_exp_f32 v64, v64
  s_waitcnt lgkmcnt(4)
  v_mfma_f32_16x16x32_bf16 v[72:75], v[56:59], v[200:203], v[72:75]
  ds_read_b128 v[48:51], v25 offset:28672
  v_add_f32 v228, v228, v64
  v_mfma_f32_16x16x32_bf16 v[76:79], v[56:59], v[216:219], v[76:79]
  v_exp_f32 v65, v65
  v_mfma_f32_16x16x32_bf16 v[72:75], v[60:63], v[204:207], v[72:75]
  ds_read_b128 v[52:55], v25 offset:29696
  v_add_f32 v228, v228, v65
  v_cvt_pk_bf16_f32 v96, v64, v65
  v_mfma_f32_16x16x32_bf16 v[76:79], v[60:63], v[220:223], v[76:79]
  v_exp_f32 v66, v66
  s_waitcnt lgkmcnt(4)
  v_mfma_f32_16x16x32_bf16 v[128:131], v[32:35], v[104:107], v[128:131]
  ds_read_b128 v[56:59], v25 offset:30720
  v_add_f32 v228, v228, v66
  v_mfma_f32_16x16x32_bf16 v[160:163], v[32:35], v[108:111], v[160:163]
  v_exp_f32 v67, v67
  v_mfma_f32_16x16x32_bf16 v[164:167], v[36:39], v[108:111], v[164:167]
  ds_read_b128 v[60:63], v25 offset:31744
  v_mov_b32 v25, v24
  v_add_f32 v228, v228, v67
  v_cvt_pk_bf16_f32 v97, v66, v67
  v_mfma_f32_16x16x32_bf16 v[132:135], v[36:39], v[104:107], v[132:135]
  v_exp_f32 v68, v68
  s_waitcnt lgkmcnt(4)
  v_mfma_f32_16x16x32_bf16 v[136:139], v[40:43], v[104:107], v[136:139]
  ds_read_b128 v[32:35], v24 offset:8192
  v_add_f32 v229, v229, v68
  v_mfma_f32_16x16x32_bf16 v[168:171], v[40:43], v[108:111], v[168:171]
  v_exp_f32 v69, v69
  v_mfma_f32_16x16x32_bf16 v[172:175], v[44:47], v[108:111], v[172:175]
  ds_read_b128 v[36:39], v24 offset:9216
  v_add_f32 v229, v229, v69
  v_cvt_pk_bf16_f32 v100, v68, v69
  v_mfma_f32_16x16x32_bf16 v[140:143], v[44:47], v[104:107], v[140:143]
  v_exp_f32 v70, v70
  s_waitcnt lgkmcnt(4)
  v_mfma_f32_16x16x32_bf16 v[144:147], v[48:51], v[104:107], v[144:147]
  ds_read_b128 v[40:43], v24 offset:10240
  v_add_f32 v229, v229, v70
  v_mfma_f32_16x16x32_bf16 v[176:179], v[48:51], v[108:111], v[176:179]
  v_exp_f32 v71, v71
  v_mfma_f32_16x16x32_bf16 v[180:183], v[52:55], v[108:111], v[180:183]
  ds_read_b128 v[44:47], v24 offset:11264
  v_add_f32 v229, v229, v71
  v_cvt_pk_bf16_f32 v101, v70, v71
  v_mfma_f32_16x16x32_bf16 v[148:151], v[52:55], v[104:107], v[148:151]
  v_exp_f32 v72, v72
  s_waitcnt lgkmcnt(4)
  v_mfma_f32_16x16x32_bf16 v[152:155], v[56:59], v[104:107], v[152:155]
  ds_read_b128 v[48:51], v24 offset:12288
  v_add_f32 v228, v228, v72
  v_mfma_f32_16x16x32_bf16 v[184:187], v[56:59], v[108:111], v[184:187]
  v_exp_f32 v73, v73
  v_mfma_f32_16x16x32_bf16 v[188:191], v[60:63], v[108:111], v[188:191]
  ds_read_b128 v[52:55], v24 offset:13312
  v_add_f32 v228, v228, v73
  v_cvt_pk_bf16_f32 v98, v72, v73
  v_mfma_f32_16x16x32_bf16 v[156:159], v[60:63], v[104:107], v[156:159]
  s_barrier
  v_exp_f32 v74, v74
  s_waitcnt lgkmcnt(4)
  v_mfma_f32_16x16x32_bf16 v[80:83], v[32:35], v[192:195], v[120:123]
  ds_read_b128 v[56:59], v24 offset:14336
  v_add_f32 v228, v228, v74
  v_mov_b32 v106, 0
  v_mfma_f32_16x16x32_bf16 v[84:87], v[32:35], v[208:211], v[116:119]
  v_exp_f32 v75, v75
  v_mfma_f32_16x16x32_bf16 v[80:83], v[36:39], v[196:199], v[80:83]
  ds_read_b128 v[60:63], v24 offset:15360
  v_add_u32 v24, s85, v16
  v_add_f32 v228, v228, v75
  v_cvt_pk_bf16_f32 v99, v74, v75
  v_mfma_f32_16x16x32_bf16 v[84:87], v[36:39], v[212:215], v[84:87]
  v_exp_f32 v76, v76
  s_waitcnt lgkmcnt(4)
  v_mfma_f32_16x16x32_bf16 v[80:83], v[40:43], v[200:203], v[80:83]
  ds_read_b128 v[32:35], v25 offset:16384
  s_add_u32 s85, s85, 32768
  s_sub_u32 s33, s85, 163840
  s_cselect_b32 s85, s85, s33
  v_add_f32 v229, v229, v76
  v_mov_b32 v107, 0
  v_mfma_f32_16x16x32_bf16 v[84:87], v[40:43], v[216:219], v[84:87]
  v_exp_f32 v77, v77
  v_mfma_f32_16x16x32_bf16 v[80:83], v[44:47], v[204:207], v[80:83]
  ds_read_b128 v[36:39], v25 offset:17408
  v_add_f32 v229, v229, v77
  v_cvt_pk_bf16_f32 v102, v76, v77
  v_mfma_f32_16x16x32_bf16 v[84:87], v[44:47], v[220:223], v[84:87]
  v_exp_f32 v78, v78
  s_waitcnt lgkmcnt(4)
  v_mfma_f32_16x16x32_bf16 v[92:95], v[48:51], v[208:211], v[116:119]
  ds_read_b128 v[40:43], v25 offset:18432
  v_exp_f32 v79, v79
  v_mfma_f32_16x16x32_bf16 v[92:95], v[52:55], v[212:215], v[92:95]
  ds_read_b128 v[44:47], v25 offset:19456
  v_add_f32 v229, v229, v78
  v_add_f32 v229, v229, v79
  s_waitcnt lgkmcnt(4)
  v_mfma_f32_16x16x32_bf16 v[92:95], v[56:59], v[216:219], v[92:95]
  ds_read_b128 v[48:51], v25 offset:20480
  v_exp_f32 v80, v80
  v_mfma_f32_16x16x32_bf16 v[92:95], v[60:63], v[220:223], v[92:95]
  ds_read_b128 v[52:55], v25 offset:21504
  v_exp_f32 v81, v81
  s_waitcnt lgkmcnt(4)
  v_mfma_f32_16x16x32_bf16 v[128:131], v[32:35], v[96:99], v[128:131]
  ds_read_b128 v[56:59], v25 offset:22528
  buffer_load_dwordx4 v[232:235], v16, s[12:15], s72 offen offset:0 sc1
  v_cvt_pk_bf16_f32 v103, v78, v79
  v_add_f32 v228, v228, v80
  s_nop 0
  v_mfma_f32_16x16x32_bf16 v[160:163], v[32:35], v[100:103], v[160:163]
  buffer_load_dwordx4 v[236:239], v16, s[12:15], s73 offen offset:0 sc1
  v_exp_f32 v82, v82
  v_mfma_f32_16x16x32_bf16 v[164:167], v[36:39], v[100:103], v[164:167]
  ds_read_b128 v[60:63], v25 offset:23552
  buffer_load_dwordx4 v[240:243], v16, s[12:15], s72 offen offset:2048 sc1
  v_add_f32 v228, v228, v81
  v_cvt_pk_bf16_f32 v104, v80, v81
  v_mfma_f32_16x16x32_bf16 v[132:135], v[36:39], v[96:99], v[132:135]
  buffer_load_dwordx4 v[244:247], v16, s[12:15], s73 offen offset:2048 sc1
  s_add_u32 s72, s72, 4096
  s_add_u32 s73, s73, 4096
  v_exp_f32 v83, v83
  s_waitcnt lgkmcnt(4)
  v_mfma_f32_16x16x32_bf16 v[136:139], v[40:43], v[96:99], v[136:139]
  ds_read_b128 v[32:35], v24 offset:0
  buffer_load_dwordx4 v[248:251], v16, s[12:15], s72 offen offset:0 sc1
  v_add_f32 v228, v228, v82
  v_add_f32 v228, v228, v83
  v_mfma_f32_16x16x32_bf16 v[168:171], v[40:43], v[100:103], v[168:171]
  buffer_load_dwordx4 v[252:255], v16, s[12:15], s73 offen offset:0 sc1
  v_exp_f32 v84, v84
  v_mfma_f32_16x16x32_bf16 v[172:175], v[44:47], v[100:103], v[172:175]
  ds_read_b128 v[36:39], v24 offset:1024
  buffer_load_dword v8, v11, s[12:15], s76 offen offset:4 sc1
  s_xor_b32 s76, s76, 128
  v_cvt_pk_bf16_f32 v105, v82, v83
  v_add_f32 v229, v229, v84
  v_mfma_f32_16x16x32_bf16 v[140:143], v[44:47], v[96:99], v[140:143]
  buffer_load_dword v9, v11, s[12:15], s76 offen offset:4 sc1
  v_exp_f32 v85, v85
  s_waitcnt lgkmcnt(4)
  v_mfma_f32_16x16x32_bf16 v[144:147], v[48:51], v[96:99], v[144:147]
  ds_read_b128 v[40:43], v24 offset:2048
  s_add_u32 s70, s70, 327680
  v_add_f32 v229, v229, v85
  v_cvt_pk_bf16_f32 v108, v84, v85
  v_mfma_f32_16x16x32_bf16 v[176:179], v[48:51], v[100:103], v[176:179]
  v_exp_f32 v86, v86
  v_mfma_f32_16x16x32_bf16 v[180:183], v[52:55], v[100:103], v[180:183]
  ds_read_b128 v[44:47], v24 offset:3072
  v_add_f32 v229, v229, v86
  v_mfma_f32_16x16x32_bf16 v[148:151], v[52:55], v[96:99], v[148:151]
  v_exp_f32 v87, v87
  s_waitcnt lgkmcnt(4)
  v_mfma_f32_16x16x32_bf16 v[152:155], v[56:59], v[96:99], v[152:155]
  ds_read_b128 v[48:51], v24 offset:4096
  v_add_f32 v229, v229, v87
  v_cvt_pk_bf16_f32 v109, v86, v87
  v_mfma_f32_16x16x32_bf16 v[184:187], v[56:59], v[100:103], v[184:187]
  v_exp_f32 v92, v92
  v_mfma_f32_16x16x32_bf16 v[188:191], v[60:63], v[100:103], v[188:191]
  ds_read_b128 v[52:55], v24 offset:5120
  v_add_f32 v229, v229, v92
  v_mfma_f32_16x16x32_bf16 v[156:159], v[60:63], v[96:99], v[156:159]
  v_exp_f32 v93, v93
  s_waitcnt lgkmcnt(4)
  v_mfma_f32_16x16x32_bf16 v[68:71], v[32:35], v[208:211], v[116:119]
  ds_read_b128 v[56:59], v24 offset:6144
  v_exp_f32 v94, v94
  v_mfma_f32_16x16x32_bf16 v[68:71], v[36:39], v[212:215], v[68:71]
  ds_read_b128 v[60:63], v24 offset:7168
  v_exp_f32 v95, v95
  s_waitcnt lgkmcnt(4)
  v_mfma_f32_16x16x32_bf16 v[68:71], v[40:43], v[216:219], v[68:71]
  ds_read_b128 v[32:35], v25 offset:24576
  v_add_f32 v229, v229, v93
  v_cvt_pk_bf16_f32 v110, v92, v93
  v_mfma_f32_16x16x32_bf16 v[68:71], v[44:47], v[220:223], v[68:71]
  ds_read_b128 v[36:39], v25 offset:25600
  v_add_f32 v229, v229, v94
  v_add_f32 v229, v229, v95
  s_waitcnt lgkmcnt(4)
  v_mfma_f32_16x16x32_bf16 v[76:79], v[48:51], v[208:211], v[124:127]
  ds_read_b128 v[40:43], v25 offset:26624
  v_cvt_pk_bf16_f32 v111, v94, v95
  v_mfma_f32_16x16x32_bf16 v[76:79], v[52:55], v[212:215], v[76:79]
  ds_read_b128 v[44:47], v25 offset:27648
  s_waitcnt lgkmcnt(4)
  v_mfma_f32_16x16x32_bf16 v[76:79], v[56:59], v[216:219], v[76:79]
  ds_read_b128 v[48:51], v25 offset:28672
  v_mfma_f32_16x16x32_bf16 v[76:79], v[60:63], v[220:223], v[76:79]
  ds_read_b128 v[52:55], v25 offset:29696
  v_exp_f32 v68, v68
  s_waitcnt lgkmcnt(4)
  v_mfma_f32_16x16x32_bf16 v[128:131], v[32:35], v[104:107], v[128:131]
  ds_read_b128 v[56:59], v25 offset:30720
  v_add_f32 v229, v229, v68
  v_mfma_f32_16x16x32_bf16 v[160:163], v[32:35], v[108:111], v[160:163]
  v_exp_f32 v69, v69
  v_mfma_f32_16x16x32_bf16 v[164:167], v[36:39], v[108:111], v[164:167]
  ds_read_b128 v[60:63], v25 offset:31744
  v_mov_b32 v25, v24
  v_add_f32 v229, v229, v69
  v_cvt_pk_bf16_f32 v100, v68, v69
  v_mfma_f32_16x16x32_bf16 v[132:135], v[36:39], v[104:107], v[132:135]
  v_exp_f32 v70, v70
  s_waitcnt lgkmcnt(4)
  v_mfma_f32_16x16x32_bf16 v[136:139], v[40:43], v[104:107], v[136:139]
  ds_read_b128 v[32:35], v25 offset:16384
  v_add_f32 v229, v229, v70
  v_mfma_f32_16x16x32_bf16 v[168:171], v[40:43], v[108:111], v[168:171]
  v_exp_f32 v71, v71
  v_mfma_f32_16x16x32_bf16 v[172:175], v[44:47], v[108:111], v[172:175]
  ds_read_b128 v[36:39], v25 offset:17408
  v_add_f32 v229, v229, v71
  v_cvt_pk_bf16_f32 v101, v70, v71
  v_mfma_f32_16x16x32_bf16 v[140:143], v[44:47], v[104:107], v[140:143]
  v_exp_f32 v76, v76
  s_waitcnt lgkmcnt(4)
  v_mfma_f32_16x16x32_bf16 v[144:147], v[48:51], v[104:107], v[144:147]
  ds_read_b128 v[40:43], v25 offset:18432
  v_add_f32 v229, v229, v76
  v_mfma_f32_16x16x32_bf16 v[176:179], v[48:51], v[108:111], v[176:179]
  v_exp_f32 v77, v77
  v_mfma_f32_16x16x32_bf16 v[180:183], v[52:55], v[108:111], v[180:183]
  ds_read_b128 v[44:47], v25 offset:19456
  v_add_f32 v229, v229, v77
  v_cvt_pk_bf16_f32 v102, v76, v77
  v_mfma_f32_16x16x32_bf16 v[148:151], v[52:55], v[104:107], v[148:151]
  v_exp_f32 v78, v78
  s_waitcnt lgkmcnt(4)
  v_mfma_f32_16x16x32_bf16 v[152:155], v[56:59], v[104:107], v[152:155]
  ds_read_b128 v[48:51], v25 offset:20480
  v_add_f32 v229, v229, v78
  v_mfma_f32_16x16x32_bf16 v[184:187], v[56:59], v[108:111], v[184:187]
  v_exp_f32 v79, v79
  v_mfma_f32_16x16x32_bf16 v[188:191], v[60:63], v[108:111], v[188:191]
  ds_read_b128 v[52:55], v25 offset:21504
  v_add_f32 v229, v229, v79
  v_cvt_pk_bf16_f32 v103, v78, v79
  v_mfma_f32_16x16x32_bf16 v[156:159], v[60:63], v[104:107], v[156:159]
  s_waitcnt lgkmcnt(4)
  v_mfma_f32_16x16x32_bf16 v[160:163], v[32:35], v[100:103], v[160:163]
  ds_read_b128 v[56:59], v25 offset:22528
  v_mfma_f32_16x16x32_bf16 v[164:167], v[36:39], v[100:103], v[164:167]
  ds_read_b128 v[60:63], v25 offset:23552
  s_waitcnt lgkmcnt(4)
  v_mfma_f32_16x16x32_bf16 v[168:171], v[40:43], v[100:103], v[168:171]
  v_mfma_f32_16x16x32_bf16 v[172:175], v[44:47], v[100:103], v[172:175]
  s_waitcnt lgkmcnt(2)
  v_mfma_f32_16x16x32_bf16 v[176:179], v[48:51], v[100:103], v[176:179]
  v_mfma_f32_16x16x32_bf16 v[180:183], v[52:55], v[100:103], v[180:183]
  s_waitcnt lgkmcnt(0)
  v_mfma_f32_16x16x32_bf16 v[184:187], v[56:59], v[100:103], v[184:187]
  v_mfma_f32_16x16x32_bf16 v[188:191], v[60:63], v[100:103], v[188:191]
  s_branch F_CHK
F_HOOK:
  s_cmp_eq_u32 s92, 5
  s_cbranch_scc1 F_HOOK2
  s_sub_u32 s35, s82, s92
  s_cmp_eq_u32 s35, 9
  s_cbranch_scc1 F_HOOK1
  s_sub_u32 s92, s92, 1
  s_cmp_eq_u32 s35, 4
  s_cbranch_scc0 F_HA1
  s_add_u32 s34, s93, 186368
  s_waitcnt vmcnt(7)
  buffer_store_dwordx4 v[232:235], v16, s[12:15], s34 offen sc1
  s_branch F_BACK
F_HA1:
  s_cmp_eq_u32 s35, 5
  s_cbranch_scc0 F_HA2
  s_and_b32 s34, s28, 2
  s_mul_i32 s34, s34, 372736
  s_sub_u32 s34, 1118208, s34
  s_add_u32 s34, s34, s93
  s_waitcnt vmcnt(6)
  buffer_store_dwordx4 v[240:243], v16, s[12:15], s34 offen sc1
  s_branch F_BACK
F_HA2:
  s_cmp_eq_u32 s35, 6
  s_cbranch_scc0 F_HA3
  s_and_b32 s34, s28, 2
  s_mul_i32 s34, s34, 372736
  s_sub_u32 s34, 1304576, s34
  s_add_u32 s34, s34, s93
  s_waitcnt vmcnt(5)
  buffer_store_dwordx4 v[248:251], v16, s[12:15], s34 offen sc1
  s_branch F_BACK
F_HA3:
  s_waitcnt vmcnt(0)
  s_branch F_BACK
F_HOOK1:
  s_mov_b32 s92, 5
  s_cmp_eq_u32 s28, 0
  s_cbranch_scc0 F_BACK
  s_lshl_b32 s34, s31, 7
  s_add_u32 s34, s34, 87051264
  v_mov_b32 v12, 1
  s_mov_b64 exec, 1
  buffer_atomic_add v12, off, s[12:15], s34 sc1
  s_mov_b64 exec, -1
  s_branch F_BACK
F_HOOK2:
  s_lshl_b32 s34, s30, 2
  s_add_u32 s34, s34, s28
  s_lshl_b32 s35, s64, 7
  s_add_u32 s34, s34, s35
  s_mul_i32 s35, s34, 4480
  v_lshlrev_b32 v12, 3, v16
  v_min_u32 v14, 4352, v12
  v_add_u32 v14, s35, v14
  v_min_u32 v14, 2211712, v14
  buffer_load_dword v13, v14, s[4:7], 0 offen
  s_mul_i32 s35, s34, 10240
  buffer_load_dword v13, v12, s[8:11], s35 offen
  v_min_u32 v14, 1920, v12
  s_add_u32 s35, s35, 8192
  buffer_load_dword v13, v14, s[8:11], s35 offen
  s_getpc_b64 s[34:35]
F_PC1:
  s_sub_u32 s34, s34, F_PC1-gated_mix__compressed_kv_cla__geglu_ffn__prompt_kernel
  s_subb_u32 s35, s35, 0
  s_lshl_b32 s33, s30, 9
  s_add_u32 s33, s33, F_DIAGA-gated_mix__compressed_kv_cla__geglu_ffn__prompt_kernel
  v_bfe_u32 v14, v16, 4, 2
  v_lshlrev_b32 v14, 7, v14
  v_add_u32 v14, s33, v14
  v_min_u32 v14, F_END-gated_mix__compressed_kv_cla__geglu_ffn__prompt_kernel, v14
  global_load_dword v13, v14, s[34:35]
  s_getpc_b64 s[34:35]
F_PC2:
  s_sub_u32 s34, s34, F_PC2-gated_mix__compressed_kv_cla__geglu_ffn__prompt_kernel
  s_subb_u32 s35, s35, 0
  s_lshl_b32 s33, s30, 10
  s_add_u32 s33, s33, F_CHK-gated_mix__compressed_kv_cla__geglu_ffn__prompt_kernel
  v_bfe_u32 v14, v16, 4, 3
  v_lshlrev_b32 v14, 7, v14
  v_add_u32 v14, s33, v14
  v_min_u32 v14, F_END-gated_mix__compressed_kv_cla__geglu_ffn__prompt_kernel, v14
  global_load_dword v13, v14, s[34:35]
  s_branch F_BACK
F_B:
  v_and_b32 v48, 15, v44
  v_lshlrev_b32 v48, 10, v48
  v_and_b32 v49, 1, v47
  v_lshl_add_u32 v2, v49, 7, v48
  v_and_b32 v48, 1, v45
  v_lshlrev_b32 v48, 19, v48
  v_bfe_u32 v49, v44, 2, 1
  v_lshl_add_u32 v48, v49, 13, v48
  v_and_b32 v49, 3, v44
  v_lshl_add_u32 v3, v49, 7, v48
  s_lshl_b32 s74, s31, 2
  s_add_u32 s74, s74, s32
  s_lshl_b32 s74, s74, 2
  s_add_u32 s74, s74, s28
  s_sub_u32 s74, s74, 4
  s_lshl_b32 s74, s74, 14
  s_lshl_b32 s75, s31, 2
  s_add_u32 s75, s75, s28
  s_sub_u32 s75, s75, 4
  s_lshl_b32 s75, s75, 14
  s_lshl_b32 s33, s96, 9
  s_add_u32 s75, s75, s33
  s_waitcnt lgkmcnt(0)
  s_mov_b32 s4, s38
  s_mov_b32 s5, s39
  s_mov_b32 s6, 2097152
  s_mov_b32 s7, 0x20000
  s_cmp_eq_u32 s97, 0
  s_cselect_b32 s8, s42, s44
  s_cselect_b32 s9, s43, s45
  s_mov_b32 s10, 4194304
  s_mov_b32 s11, 0x20000
  buffer_load_dword v13, v2, s[4:7], s74 offen offset:0
  buffer_load_dword v13, v3, s[8:11], s75 offen
  s_add_u32 s75, s75, 1048576
  buffer_load_dword v13, v2, s[4:7], s74 offen offset:256
  buffer_load_dword v13, v3, s[8:11], s75 offen
  s_mov_b32 s12, s62
  s_mov_b32 s13, s63
  s_mov_b32 s14, 100663296
  s_mov_b32 s15, 0x20000
  s_mov_b32 s16, s36
  s_mov_b32 s17, s37
  s_mov_b32 s18, 2621440
  s_mov_b32 s19, 0x20000
  s_lshl_b32 s80, s29, 2
  s_add_u32 s80, s80, s32
  s_mul_i32 s79, s29, 3
  s_add_u32 s79, s79, s32
  s_add_u32 s33, s29, 24
  s_cmp_lt_u32 s32, 3
  s_cselect_b32 s79, s79, s33
  s_cmp_lt_u32 s79, 27
  s_cselect_b32 s73, 1, 0
  s_cselect_b32 s79, s79, 0
  s_and_b32 s81, s28, 3
  s_cmp_eq_u32 s81, 2
  s_cselect_b32 s20, s50, s52
  s_cselect_b32 s21, s51, s53
  s_mul_i32 s33, s73, 2211840
  s_cmp_lt_u32 s81, 2
  s_cselect_b32 s20, s40, s20
  s_cselect_b32 s21, s41, s21
  s_cselect_b32 s22, 5242880, s33
  s_mov_b32 s23, 0x20000
  s_mov_b32 s33, 3456
  s_cselect_b32 s35, 8192, s33
  s_lshl_b32 s33, s80, 8
  s_lshl_b32 s34, s79, 7
  s_cmp_lt_u32 s81, 2
  s_cselect_b32 s68, s33, s34
  s_cselect_b32 s33, 7, 15
  s_cselect_b32 s34, 128, 0
  v_and_b32 v48, s33, v44
  v_mul_u32_u24 v48, s35, v48
  v_and_b32 v49, 1, v45
  v_mul_u32_u24 v49, s34, v49
  v_add_u32 v5, v48, v49
  s_cselect_b32 s33, s81, 0
  s_lshl_b32 s33, s33, 3
  s_lshl_b32 s34, s31, 4
  s_add_u32 s33, s33, s34
  s_mul_i32 s33, s33, s35
  s_add_u32 s77, s68, s33
  s_lshl_b32 s78, s35, 7
  v_and_b32 v48, 15, v44
  v_mul_u32_u24 v48, 1280, v48
  v_and_b32 v49, 1, v47
  v_lshl_add_u32 v4, v49, 7, v48
  s_sub_u32 s33, 15, s31
  s_cmp_lt_u32 s32, 2
  s_cselect_b32 s33, s33, s31
  s_lshl_b32 s33, s33, 1
  s_and_b32 s34, s32, 1
  s_add_u32 s33, s33, s34
  s_lshl_b32 s33, s33, 2
  s_add_u32 s33, s33, s81
  s_mul_i32 s76, s33, 20480
  v_and_b32 v48, 15, v44
  v_lshrrev_b32 v49, 1, v48
  v_xor_b32 v49, v49, v47
  v_lshlrev_b32 v49, 4, v49
  v_lshl_add_u32 v54, v48, 7, v49
  v_bfe_u32 v48, v44, 2, 2
  v_lshl_add_u32 v49, v47, 3, v48
  v_lshlrev_b32 v49, 7, v49
  v_lshrrev_b32 v48, 1, v48
  v_and_b32 v50, 1, v47
  v_lshl_or_b32 v48, v50, 1, v48
  v_lshlrev_b32 v48, 5, v48
  v_and_b32 v50, 3, v44
  v_lshlrev_b32 v50, 3, v50
  v_add3_u32 v55, v49, v48, v50
  s_and_b32 s33, s28, 1
  s_lshl_b32 s34, s33, 14
  v_add_u32 v40, s34, v54
  v_xor_b32 v41, 64, v40
  s_lshr_b32 s34, s28, 1
  s_lshl_b32 s34, s34, 13
  s_add_u32 s34, s34, 65536
  v_add_u32 v42, s34, v55
  v_xor_b32 v43, 32, v42
  v_xor_b32 v44, 64, v42
  v_xor_b32 v45, 96, v42
  s_lshl_b32 s34, s33, 13
  s_add_u32 s34, s34, 65536
  v_add_u32 v27, s34, v55
  v_xor_b32 v28, 32, v27
  v_xor_b32 v29, 64, v27
  v_xor_b32 v30, 96, v27
  s_lshl_b32 s34, s33, 6
  s_add_u32 s34, s34, 81920
  v_xor_b32 v31, s34, v55
  v_xor_b32 v14, 32, v31
  s_bfe_u32 s33, s28, 0x10001
  s_lshl_b32 s33, s33, 12
  s_add_u32 s34, s33, 16384
  v_add_u32 v23, s34, v54
  v_xor_b32 v24, 64, v23
  s_sub_u32 s34, 28672, s33
  v_add_u32 v25, s34, v54
  v_xor_b32 v26, 64, v25
  s_lshl_b32 s33, s96, 1
  s_add_u32 s33, s33, 1
  s_lshl_b32 s70, s33, 19
  s_lshl_b32 s33, s31, 16
  s_add_u32 s70, s70, s33
  s_and_b32 s33, s28, 1
  s_lshl_b32 s33, s33, 15
  s_add_u32 s70, s70, s33
  s_bfe_u32 s33, s28, 0x10001
  s_add_u32 s34, s97, 11
  s_lshl_b32 s33, s33, s34
  s_add_u32 s70, s70, s33
  s_lshl_b32 s33, s97, 24
  s_add_u32 s70, s70, s33
  s_lshr_b32 s33, 4096, s97
  s_add_u32 s71, s70, s33
  s_mov_b32 s91, s31
  s_lshl_b32 s33, s91, 3
  s_add_u32 s89, s33, s81
  s_add_u32 s90, s33, 7
  s_sub_u32 s90, s90, s81
  s_and_b32 s34, s28, 2
  s_add_u32 s33, s33, s34
  s_mul_i32 s33, s33, 182
  s_lshl_b32 s34, s79, 1
  s_add_u32 s33, s33, s34
  s_and_b32 s34, s28, 1
  s_add_u32 s33, s33, s34
  s_add_u32 s33, s33, 32896
  s_lshl_b32 s72, s33, 10
  s_cmp_eq_u32 s73, 1
  s_cselect_b32 s72, s72, 92274688
  s_lshl_b32 s82, s91, 1
  s_add_u32 s82, s82, 2
  s_lshl_b32 s83, s31, 1
  s_sub_u32 s83, 32, s83
  s_mov_b32 s95, 1
  v_lshrrev_b32 v52, 4, v16
  v_add_u32 v48, 0, v52
  v_mul_u32_u24 v49, 3277, v48
  v_lshrrev_b32 v49, 16, v49
  v_mul_u32_u24 v50, 20, v49
  v_sub_u32 v50, v48, v50
  v_bfe_u32 v51, v49, 2, 1
  v_lshlrev_b32 v51, 1, v51
  v_xor_b32 v50, v50, v51
  v_lshlrev_b32 v50, 4, v50
  v_mul_u32_u24 v49, 1280, v49
  v_add_u32 v17, v49, v50
  v_add_u32 v48, 64, v52
  v_mul_u32_u24 v49, 3277, v48
  v_lshrrev_b32 v49, 16, v49
  v_mul_u32_u24 v50, 20, v49
  v_sub_u32 v50, v48, v50
  v_bfe_u32 v51, v49, 2, 1
  v_lshlrev_b32 v51, 1, v51
  v_xor_b32 v50, v50, v51
  v_lshlrev_b32 v50, 4, v50
  v_mul_u32_u24 v49, 1280, v49
  v_add_u32 v18, v49, v50
  v_subrev_u32 v18, 1024, v18
  v_add_u32 v48, 128, v52
  v_mul_u32_u24 v49, 3277, v48
  v_lshrrev_b32 v49, 16, v49
  v_mul_u32_u24 v50, 20, v49
  v_sub_u32 v50, v48, v50
  v_bfe_u32 v51, v49, 2, 1
  v_lshlrev_b32 v51, 1, v51
  v_xor_b32 v50, v50, v51
  v_lshlrev_b32 v50, 4, v50
  v_mul_u32_u24 v49, 1280, v49
  v_add_u32 v19, v49, v50
  v_subrev_u32 v19, 2048, v19
  v_add_u32 v48, 192, v52
  v_mul_u32_u24 v49, 3277, v48
  v_lshrrev_b32 v49, 16, v49
  v_mul_u32_u24 v50, 20, v49
  v_sub_u32 v50, v48, v50
  v_bfe_u32 v51, v49, 2, 1
  v_lshlrev_b32 v51, 1, v51
  v_xor_b32 v50, v50, v51
  v_lshlrev_b32 v50, 4, v50
  v_mul_u32_u24 v49, 1280, v49
  v_add_u32 v20, v49, v50
  v_subrev_u32 v20, 3072, v20
  v_add_u32 v48, 256, v52
  v_mul_u32_u24 v49, 3277, v48
  v_lshrrev_b32 v49, 16, v49
  v_mul_u32_u24 v50, 20, v49
  v_sub_u32 v50, v48, v50
  v_bfe_u32 v51, v49, 2, 1
  v_lshlrev_b32 v51, 1, v51
  v_xor_b32 v50, v50, v51
  v_lshlrev_b32 v50, 4, v50
  v_mul_u32_u24 v49, 1280, v49
  v_add_u32 v21, v49, v50
  v_bfe_u32 v49, v52, 2, 2
  v_lshl_add_u32 v49, v47, 2, v49
  v_mul_u32_u24 v49, 320, v49
  v_and_b32 v50, 3, v52
  v_lshl_add_u32 v49, v50, 3, v49
  v_add_u32 v49, 10240, v49
  v_and_b32 v50, 1, v47
  v_lshl_add_u32 v22, v50, 5, v49
  s_cmp_eq_u32 s97, 0
  s_cbranch_scc0 F_VB
  s_waitcnt lgkmcnt(0)
  s_barrier
  ds_read_b128 v[80:83], v40 offset:0
  ds_read_b64_tr_b16 v[96:97], v42 offset:0
  ds_read_b64_tr_b16 v[98:99], v42 offset:512
  ds_read_b64_tr_b16 v[100:101], v43 offset:0
  ds_read_b64_tr_b16 v[102:103], v43 offset:512
  ds_read_b64_tr_b16 v[104:105], v44 offset:0
  ds_read_b64_tr_b16 v[106:107], v44 offset:512
  ds_read_b64_tr_b16 v[108:109], v45 offset:0
  ds_read_b64_tr_b16 v[110:111], v45 offset:512
  ds_read_b128 v[84:87], v40 offset:2048
  s_waitcnt lgkmcnt(7)
  v_mfma_f32_16x16x32_bf16 v[128:131], v[96:99], v[80:83], 0
  ds_read_b128 v[88:91], v40 offset:4096
  s_waitcnt lgkmcnt(6)
  v_mfma_f32_16x16x32_bf16 v[132:135], v[100:103], v[80:83], 0
  s_waitcnt lgkmcnt(4)
  v_mfma_f32_16x16x32_bf16 v[136:139], v[104:107], v[80:83], 0
  s_getpc_b64 s[34:35]
F_PC3:
  s_sub_u32 s34, s34, F_PC3-gated_mix__compressed_kv_cla__geglu_ffn__prompt_kernel
  s_subb_u32 s35, s35, 0
  s_lshl_b32 s33, s30, 12
  v_bfe_u32 v12, v16, 4, 5
  v_lshlrev_b32 v12, 7, v12
  v_add_u32 v12, s33, v12
  v_min_u32 v12, F_END-gated_mix__compressed_kv_cla__geglu_ffn__prompt_kernel, v12
  global_load_dword v13, v12, s[34:35]
  s_waitcnt lgkmcnt(2)
  v_mfma_f32_16x16x32_bf16 v[140:143], v[108:111], v[80:83], 0
  s_waitcnt lgkmcnt(1)
  v_mfma_f32_16x16x32_bf16 v[156:159], v[108:111], v[84:87], 0
  ds_read_b128 v[92:95], v40 offset:6144
  s_cmp_lt_u32 s2, 7
  s_cbranch_scc0 F_NZx0
  s_cmp_eq_u32 s28, 4
  s_cbranch_scc0 F_NZx0
  s_lshl_b32 s33, s2, 13
  s_add_u32 s33, s33, 87031808
  v_lshlrev_b32 v6, 3, v16
  v_mov_b32 v7, 0
  buffer_store_dword v7, v6, s[12:15], s33 offen sc1
F_NZx0:
  s_mov_b32 s24, s56
  s_mov_b32 s25, s57
  s_mov_b32 s26, 1280
  s_mov_b32 s27, 0x20000
  v_mfma_f32_16x16x32_bf16 v[152:155], v[104:107], v[84:87], 0
  v_mfma_f32_16x16x32_bf16 v[148:151], v[100:103], v[84:87], 0
  s_lshl_b32 s33, s29, 2
  s_add_u32 s33, s33, s32
  s_sub_u32 s34, 15, s31
  s_sub_u32 s35, s31, 1
  s_cmp_lt_u32 s33, 16
  s_cselect_b32 s34, s34, s35
  s_lshl_b32 s34, s34, 4
  s_add_u32 s34, s34, s33
  s_lshl_b32 s34, s34, 2
  s_add_u32 s34, s34, s28
  s_sub_u32 s34, s34, 4
  s_lshl_b32 s92, s34, 1
  s_mul_i32 s93, s92, 1280
  v_bfe_u32 v6, v16, 4, 5
  v_lshrrev_b32 v7, 9, v16
  v_lshlrev_b32 v8, 4, v6
  v_mul_u32_u24 v9, 1280, v7
  v_min_u32 v10, 15, v6
  v_lshlrev_b32 v10, 4, v10
  v_add_u32 v11, v9, v10
  v_add_u32 v9, v9, v8
  s_lshl_b32 s92, s92, 3
  s_add_u32 s92, s92, 58720256
  v_mfma_f32_16x16x32_bf16 v[144:147], v[96:99], v[84:87], 0
  s_waitcnt lgkmcnt(1)
  v_mfma_f32_16x16x32_bf16 v[160:163], v[96:99], v[88:91], 0
  ds_read_b128 v[80:83], v40 offset:8192
  buffer_load_dwordx4 v[56:59], v9, s[16:19], s93 offen offset:0
  v_mfma_f32_16x16x32_bf16 v[164:167], v[100:103], v[88:91], 0
  ds_read_b64_tr_b16 v[112:113], v42 offset:4096
  v_mfma_f32_16x16x32_bf16 v[168:171], v[104:107], v[88:91], 0
  buffer_load_dwordx4 v[68:71], v8, s[24:27], 0 offen offset:0
  v_mfma_f32_16x16x32_bf16 v[172:175], v[108:111], v[88:91], 0
  ds_read_b64_tr_b16 v[114:115], v42 offset:4608
  s_waitcnt lgkmcnt(3)
  v_mfma_f32_16x16x32_bf16 v[188:191], v[108:111], v[92:95], 0
  ds_read_b128 v[84:87], v40 offset:10240
  buffer_load_dwordx4 v[60:63], v9, s[16:19], s93 offen offset:512
  v_mfma_f32_16x16x32_bf16 v[184:187], v[104:107], v[92:95], 0
  ds_read_b64_tr_b16 v[116:117], v43 offset:4096
  v_mfma_f32_16x16x32_bf16 v[180:183], v[100:103], v[92:95], 0
  buffer_load_dwordx4 v[72:75], v8, s[24:27], 0 offen offset:512
  v_mfma_f32_16x16x32_bf16 v[176:179], v[96:99], v[92:95], 0
  ds_read_b64_tr_b16 v[118:119], v43 offset:4608
  s_waitcnt lgkmcnt(5)
  v_mfma_f32_16x16x32_bf16 v[192:195], v[96:99], v[80:83], 0
  ds_read_b128 v[88:91], v40 offset:12288
  buffer_load_dwordx4 v[64:67], v11, s[16:19], s93 offen offset:1024
  v_mfma_f32_16x16x32_bf16 v[196:199], v[100:103], v[80:83], 0
  ds_read_b64_tr_b16 v[120:121], v44 offset:4096
  v_mfma_f32_16x16x32_bf16 v[200:203], v[104:107], v[80:83], 0
  buffer_load_dwordx4 v[76:79], v10, s[24:27], 0 offen offset:1024
  v_mfma_f32_16x16x32_bf16 v[204:207], v[108:111], v[80:83], 0
  ds_read_b64_tr_b16 v[122:123], v44 offset:4608
  s_waitcnt lgkmcnt(5)
  v_mfma_f32_16x16x32_bf16 v[220:223], v[108:111], v[84:87], 0
  ds_read_b128 v[92:95], v40 offset:14336
  s_mov_b32 s24, s60
  s_mov_b32 s25, s61
  s_mov_b32 s26, 256
  s_mov_b32 s27, 0x20000
  v_mfma_f32_16x16x32_bf16 v[216:219], v[104:107], v[84:87], 0
  ds_read_b64_tr_b16 v[124:125], v45 offset:4096
  v_mfma_f32_16x16x32_bf16 v[212:215], v[100:103], v[84:87], 0
  v_mfma_f32_16x16x32_bf16 v[208:211], v[96:99], v[84:87], 0
  ds_read_b64_tr_b16 v[126:127], v45 offset:4608
  s_waitcnt lgkmcnt(5)
  v_mfma_f32_16x16x32_bf16 v[224:227], v[96:99], v[88:91], 0
  ds_read_b128 v[80:83], v41 offset:0
  v_mfma_f32_16x16x32_bf16 v[228:231], v[100:103], v[88:91], 0
  v_mfma_f32_16x16x32_bf16 v[232:235], v[104:107], v[88:91], 0
  v_mfma_f32_16x16x32_bf16 v[236:239], v[108:111], v[88:91], 0
  s_waitcnt lgkmcnt(3)
  v_mfma_f32_16x16x32_bf16 v[252:255], v[108:111], v[92:95], 0
  ds_read_b128 v[84:87], v41 offset:2048
  v_mfma_f32_16x16x32_bf16 v[248:251], v[104:107], v[92:95], 0
  v_mfma_f32_16x16x32_bf16 v[244:247], v[100:103], v[92:95], 0
  v_mfma_f32_16x16x32_bf16 v[240:243], v[96:99], v[92:95], 0
  s_waitcnt lgkmcnt(1)
  v_mfma_f32_16x16x32_bf16 v[128:131], v[112:115], v[80:83], v[128:131]
  ds_read_b128 v[88:91], v41 offset:4096
  v_mfma_f32_16x16x32_bf16 v[132:135], v[116:119], v[80:83], v[132:135]
  v_mfma_f32_16x16x32_bf16 v[136:139], v[120:123], v[80:83], v[136:139]
  v_mfma_f32_16x16x32_bf16 v[140:143], v[124:127], v[80:83], v[140:143]
  s_waitcnt lgkmcnt(1)
  v_mfma_f32_16x16x32_bf16 v[156:159], v[124:127], v[84:87], v[156:159]
  ds_read_b128 v[92:95], v41 offset:6144
  v_mfma_f32_16x16x32_bf16 v[152:155], v[120:123], v[84:87], v[152:155]
  v_mfma_f32_16x16x32_bf16 v[148:151], v[116:119], v[84:87], v[148:151]
  v_mfma_f32_16x16x32_bf16 v[144:147], v[112:115], v[84:87], v[144:147]
  s_waitcnt lgkmcnt(1)
  v_mfma_f32_16x16x32_bf16 v[160:163], v[112:115], v[88:91], v[160:163]
  ds_read_b128 v[80:83], v41 offset:8192
  v_mfma_f32_16x16x32_bf16 v[164:167], v[116:119], v[88:91], v[164:167]
  v_mfma_f32_16x16x32_bf16 v[168:171], v[120:123], v[88:91], v[168:171]
  v_mfma_f32_16x16x32_bf16 v[172:175], v[124:127], v[88:91], v[172:175]
  s_waitcnt lgkmcnt(1)
  v_mfma_f32_16x16x32_bf16 v[188:191], v[124:127], v[92:95], v[188:191]
  ds_read_b128 v[84:87], v41 offset:10240
  s_add_u32 s75, s75, 1048576
  v_mfma_f32_16x16x32_bf16 v[184:187], v[120:123], v[92:95], v[184:187]
  buffer_load_dword v13, v2, s[4:7], s74 offen offset:512
  v_mfma_f32_16x16x32_bf16 v[180:183], v[116:119], v[92:95], v[180:183]
  v_mfma_f32_16x16x32_bf16 v[176:179], v[112:115], v[92:95], v[176:179]
  buffer_load_dword v13, v3, s[8:11], s75 offen
  s_waitcnt lgkmcnt(1)
  v_mfma_f32_16x16x32_bf16 v[192:195], v[112:115], v[80:83], v[192:195]
  ds_read_b128 v[88:91], v41 offset:12288
  v_mfma_f32_16x16x32_bf16 v[196:199], v[116:119], v[80:83], v[196:199]
  v_mfma_f32_16x16x32_bf16 v[200:203], v[120:123], v[80:83], v[200:203]
  s_mov_b32 s94, 0xffff0000
  v_cmp_gt_u32 vcc, 16, v6
  v_mfma_f32_16x16x32_bf16 v[204:207], v[124:127], v[80:83], v[204:207]
  s_waitcnt vmcnt(2)
  v_cndmask_b32 v76, 0, v76, vcc
  s_waitcnt lgkmcnt(1)
  v_mfma_f32_16x16x32_bf16 v[220:223], v[124:127], v[84:87], v[220:223]
  ds_read_b128 v[92:95], v41 offset:14336
  v_cndmask_b32 v77, 0, v77, vcc
  v_mfma_f32_16x16x32_bf16 v[216:219], v[120:123], v[84:87], v[216:219]
  v_cndmask_b32 v78, 0, v78, vcc
  v_mfma_f32_16x16x32_bf16 v[212:215], v[116:119], v[84:87], v[212:215]
  v_cndmask_b32 v79, 0, v79, vcc
  v_mfma_f32_16x16x32_bf16 v[208:211], v[112:115], v[84:87], v[208:211]
  v_lshlrev_b32 v8, 16, v56
  s_waitcnt lgkmcnt(0)
  s_barrier
  v_mfma_f32_16x16x32_bf16 v[224:227], v[112:115], v[88:91], v[224:227]
  ds_read_b128 v[80:83], v40 offset:32768
  ds_read_b64_tr_b16 v[96:97], v42 offset:32768
  v_lshlrev_b32 v9, 16, v68
  v_mfma_f32_16x16x32_bf16 v[228:231], v[116:119], v[88:91], v[228:231]
  ds_read_b64_tr_b16 v[98:99], v42 offset:33280
  ds_read_b64_tr_b16 v[100:101], v43 offset:32768
  v_and_b32 v56, s94, v56
  v_mfma_f32_16x16x32_bf16 v[232:235], v[120:123], v[88:91], v[232:235]
  ds_read_b64_tr_b16 v[102:103], v43 offset:33280
  ds_read_b64_tr_b16 v[104:105], v44 offset:32768
  v_and_b32 v68, s94, v68
  v_mfma_f32_16x16x32_bf16 v[236:239], v[124:127], v[88:91], v[236:239]
  ds_read_b64_tr_b16 v[106:107], v44 offset:33280
  ds_read_b64_tr_b16 v[108:109], v45 offset:32768
  v_mul_f32 v8, v8, v9
  v_mfma_f32_16x16x32_bf16 v[252:255], v[124:127], v[92:95], v[252:255]
  ds_read_b64_tr_b16 v[110:111], v45 offset:33280
  ds_read_b128 v[84:87], v40 offset:34816
  v_mul_f32 v9, v56, v68
  v_mfma_f32_16x16x32_bf16 v[248:251], v[120:123], v[92:95], v[248:251]
  v_cvt_pk_bf16_f32 v8, v8, v9
  v_mfma_f32_16x16x32_bf16 v[244:247], v[116:119], v[92:95], v[244:247]
  v_lshlrev_b32 v10, 16, v8
  v_mfma_f32_16x16x32_bf16 v[240:243], v[112:115], v[92:95], v[240:243]
  v_and_b32 v11, s94, v8
  s_waitcnt lgkmcnt(7)
  v_mfma_f32_16x16x32_bf16 v[128:131], v[96:99], v[80:83], v[128:131]
  ds_read_b128 v[88:91], v40 offset:36864
  v_lshlrev_b32 v8, 16, v57
  s_waitcnt lgkmcnt(6)
  v_mfma_f32_16x16x32_bf16 v[132:135], v[100:103], v[80:83], v[132:135]
  v_lshlrev_b32 v9, 16, v69
  s_waitcnt lgkmcnt(4)
  v_mfma_f32_16x16x32_bf16 v[136:139], v[104:107], v[80:83], v[136:139]
  v_and_b32 v57, s94, v57
  s_waitcnt lgkmcnt(2)
  v_mfma_f32_16x16x32_bf16 v[140:143], v[108:111], v[80:83], v[140:143]
  v_and_b32 v69, s94, v69
  s_waitcnt lgkmcnt(1)
  v_mfma_f32_16x16x32_bf16 v[156:159], v[108:111], v[84:87], v[156:159]
  ds_read_b128 v[92:95], v40 offset:38912
  v_mul_f32 v8, v8, v9
  v_mfma_f32_16x16x32_bf16 v[152:155], v[104:107], v[84:87], v[152:155]
  v_mul_f32 v9, v57, v69
  v_mfma_f32_16x16x32_bf16 v[148:151], v[100:103], v[84:87], v[148:151]
  v_cvt_pk_bf16_f32 v8, v8, v9
  v_mfma_f32_16x16x32_bf16 v[144:147], v[96:99], v[84:87], v[144:147]
  v_lshlrev_b32 v9, 16, v8
  s_waitcnt lgkmcnt(1)
  v_mfma_f32_16x16x32_bf16 v[160:163], v[96:99], v[88:91], v[160:163]
  ds_read_b128 v[80:83], v40 offset:40960
  v_and_b32 v8, s94, v8
  v_mfma_f32_16x16x32_bf16 v[164:167], v[100:103], v[88:91], v[164:167]
  ds_read_b64_tr_b16 v[112:113], v42 offset:36864
  v_add_f32 v10, v10, v9
  v_mfma_f32_16x16x32_bf16 v[168:171], v[104:107], v[88:91], v[168:171]
  v_add_f32 v11, v11, v8
  v_mfma_f32_16x16x32_bf16 v[172:175], v[108:111], v[88:91], v[172:175]
  ds_read_b64_tr_b16 v[114:115], v42 offset:37376
  v_lshlrev_b32 v8, 16, v58
  s_waitcnt lgkmcnt(3)
  v_mfma_f32_16x16x32_bf16 v[188:191], v[108:111], v[92:95], v[188:191]
  ds_read_b128 v[84:87], v40 offset:43008
  v_lshlrev_b32 v9, 16, v70
  v_mfma_f32_16x16x32_bf16 v[184:187], v[104:107], v[92:95], v[184:187]
  ds_read_b64_tr_b16 v[116:117], v43 offset:36864
  v_and_b32 v58, s94, v58
  v_mfma_f32_16x16x32_bf16 v[180:183], v[100:103], v[92:95], v[180:183]
  v_and_b32 v70, s94, v70
  v_mfma_f32_16x16x32_bf16 v[176:179], v[96:99], v[92:95], v[176:179]
  ds_read_b64_tr_b16 v[118:119], v43 offset:37376
  v_mul_f32 v8, v8, v9
  s_waitcnt lgkmcnt(5)
  v_mfma_f32_16x16x32_bf16 v[192:195], v[96:99], v[80:83], v[192:195]
  ds_read_b128 v[88:91], v40 offset:45056
  v_mul_f32 v9, v58, v70
  v_mfma_f32_16x16x32_bf16 v[196:199], v[100:103], v[80:83], v[196:199]
  ds_read_b64_tr_b16 v[120:121], v44 offset:36864
  v_cvt_pk_bf16_f32 v8, v8, v9
  v_mfma_f32_16x16x32_bf16 v[200:203], v[104:107], v[80:83], v[200:203]
  v_lshlrev_b32 v9, 16, v8
  v_mfma_f32_16x16x32_bf16 v[204:207], v[108:111], v[80:83], v[204:207]
  ds_read_b64_tr_b16 v[122:123], v44 offset:37376
  v_and_b32 v8, s94, v8
  s_waitcnt lgkmcnt(5)
  v_mfma_f32_16x16x32_bf16 v[220:223], v[108:111], v[84:87], v[220:223]
  ds_read_b128 v[92:95], v40 offset:47104
  v_add_f32 v10, v10, v9
  v_mfma_f32_16x16x32_bf16 v[216:219], v[104:107], v[84:87], v[216:219]
  ds_read_b64_tr_b16 v[124:125], v45 offset:36864
  v_add_f32 v11, v11, v8
  v_mfma_f32_16x16x32_bf16 v[212:215], v[100:103], v[84:87], v[212:215]
  v_lshlrev_b32 v8, 16, v59
  v_mfma_f32_16x16x32_bf16 v[208:211], v[96:99], v[84:87], v[208:211]
  ds_read_b64_tr_b16 v[126:127], v45 offset:37376
  v_lshlrev_b32 v9, 16, v71
  s_waitcnt lgkmcnt(5)
  v_mfma_f32_16x16x32_bf16 v[224:227], v[96:99], v[88:91], v[224:227]
  ds_read_b128 v[80:83], v41 offset:32768
  v_and_b32 v59, s94, v59
  v_mfma_f32_16x16x32_bf16 v[228:231], v[100:103], v[88:91], v[228:231]
  v_and_b32 v71, s94, v71
  v_mfma_f32_16x16x32_bf16 v[232:235], v[104:107], v[88:91], v[232:235]
  v_mul_f32 v8, v8, v9
  v_mfma_f32_16x16x32_bf16 v[236:239], v[108:111], v[88:91], v[236:239]
  v_mul_f32 v9, v59, v71
  s_waitcnt lgkmcnt(3)
  v_mfma_f32_16x16x32_bf16 v[252:255], v[108:111], v[92:95], v[252:255]
  ds_read_b128 v[84:87], v41 offset:34816
  v_cvt_pk_bf16_f32 v8, v8, v9
  v_mfma_f32_16x16x32_bf16 v[248:251], v[104:107], v[92:95], v[248:251]
  v_lshlrev_b32 v9, 16, v8
  v_mfma_f32_16x16x32_bf16 v[244:247], v[100:103], v[92:95], v[244:247]
  v_and_b32 v8, s94, v8
  v_mfma_f32_16x16x32_bf16 v[240:243], v[96:99], v[92:95], v[240:243]
  v_add_f32 v10, v10, v9
  s_waitcnt lgkmcnt(1)
  v_mfma_f32_16x16x32_bf16 v[128:131], v[112:115], v[80:83], v[128:131]
  ds_read_b128 v[88:91], v41 offset:36864
  v_add_f32 v11, v11, v8
  v_mfma_f32_16x16x32_bf16 v[132:135], v[116:119], v[80:83], v[132:135]
  v_lshlrev_b32 v8, 16, v60
  v_mfma_f32_16x16x32_bf16 v[136:139], v[120:123], v[80:83], v[136:139]
  v_lshlrev_b32 v9, 16, v72
  v_mfma_f32_16x16x32_bf16 v[140:143], v[124:127], v[80:83], v[140:143]
  v_and_b32 v60, s94, v60
  s_waitcnt lgkmcnt(1)
  v_mfma_f32_16x16x32_bf16 v[156:159], v[124:127], v[84:87], v[156:159]
  ds_read_b128 v[92:95], v41 offset:38912
  v_and_b32 v72, s94, v72
  v_mfma_f32_16x16x32_bf16 v[152:155], v[120:123], v[84:87], v[152:155]
  v_mul_f32 v8, v8, v9
  v_mfma_f32_16x16x32_bf16 v[148:151], v[116:119], v[84:87], v[148:151]
  v_mul_f32 v9, v60, v72
  v_mfma_f32_16x16x32_bf16 v[144:147], v[112:115], v[84:87], v[144:147]
  v_cvt_pk_bf16_f32 v8, v8, v9
  s_waitcnt lgkmcnt(1)
  v_mfma_f32_16x16x32_bf16 v[160:163], v[112:115], v[88:91], v[160:163]
  ds_read_b128 v[80:83], v41 offset:40960
  v_lshlrev_b32 v9, 16, v8
  v_mfma_f32_16x16x32_bf16 v[164:167], v[116:119], v[88:91], v[164:167]
  v_and_b32 v8, s94, v8
  v_mfma_f32_16x16x32_bf16 v[168:171], v[120:123], v[88:91], v[168:171]
  v_add_f32 v10, v10, v9
  v_mfma_f32_16x16x32_bf16 v[172:175], v[124:127], v[88:91], v[172:175]
  v_add_f32 v11, v11, v8
  s_waitcnt lgkmcnt(1)
  v_mfma_f32_16x16x32_bf16 v[188:191], v[124:127], v[92:95], v[188:191]
  ds_read_b128 v[84:87], v41 offset:43008
  s_add_u32 s75, s75, 1048576
  v_lshlrev_b32 v8, 16, v61
  v_mfma_f32_16x16x32_bf16 v[184:187], v[120:123], v[92:95], v[184:187]
  buffer_load_dword v13, v2, s[4:7], s74 offen offset:768
  v_mfma_f32_16x16x32_bf16 v[180:183], v[116:119], v[92:95], v[180:183]
  v_lshlrev_b32 v9, 16, v73
  v_and_b32 v61, s94, v61
  v_mfma_f32_16x16x32_bf16 v[176:179], v[112:115], v[92:95], v[176:179]
  buffer_load_dword v13, v3, s[8:11], s75 offen
  s_waitcnt lgkmcnt(1)
  v_mfma_f32_16x16x32_bf16 v[192:195], v[112:115], v[80:83], v[192:195]
  ds_read_b128 v[88:91], v41 offset:45056
  v_and_b32 v73, s94, v73
  v_mfma_f32_16x16x32_bf16 v[196:199], v[116:119], v[80:83], v[196:199]
  v_mul_f32 v8, v8, v9
  v_mul_f32 v9, v61, v73
  v_mfma_f32_16x16x32_bf16 v[200:203], v[120:123], v[80:83], v[200:203]
  v_cvt_pk_bf16_f32 v8, v8, v9
  v_mfma_f32_16x16x32_bf16 v[204:207], v[124:127], v[80:83], v[204:207]
  v_lshlrev_b32 v9, 16, v8
  s_waitcnt lgkmcnt(1)
  v_mfma_f32_16x16x32_bf16 v[220:223], v[124:127], v[84:87], v[220:223]
  ds_read_b128 v[92:95], v41 offset:47104
  v_and_b32 v8, s94, v8
  v_mfma_f32_16x16x32_bf16 v[216:219], v[120:123], v[84:87], v[216:219]
  v_add_f32 v10, v10, v9
  v_mfma_f32_16x16x32_bf16 v[212:215], v[116:119], v[84:87], v[212:215]
  v_add_f32 v11, v11, v8
  v_mfma_f32_16x16x32_bf16 v[208:211], v[112:115], v[84:87], v[208:211]
  v_lshlrev_b32 v8, 16, v62
  s_waitcnt lgkmcnt(0)
  s_barrier
  v_mfma_f32_16x16x32_bf16 v[224:227], v[112:115], v[88:91], v[224:227]
  ds_read_b128 v[80:83], v40 offset:0
  ds_read_b64_tr_b16 v[96:97], v42 offset:0
  v_lshlrev_b32 v9, 16, v74
  v_mfma_f32_16x16x32_bf16 v[228:231], v[116:119], v[88:91], v[228:231]
  ds_read_b64_tr_b16 v[98:99], v42 offset:512
  ds_read_b64_tr_b16 v[100:101], v43 offset:0
  v_and_b32 v62, s94, v62
  v_mfma_f32_16x16x32_bf16 v[232:235], v[120:123], v[88:91], v[232:235]
  ds_read_b64_tr_b16 v[102:103], v43 offset:512
  ds_read_b64_tr_b16 v[104:105], v44 offset:0
  v_and_b32 v74, s94, v74
  v_mfma_f32_16x16x32_bf16 v[236:239], v[124:127], v[88:91], v[236:239]
  ds_read_b64_tr_b16 v[106:107], v44 offset:512
  ds_read_b64_tr_b16 v[108:109], v45 offset:0
  v_mul_f32 v8, v8, v9
  v_mfma_f32_16x16x32_bf16 v[252:255], v[124:127], v[92:95], v[252:255]
  ds_read_b64_tr_b16 v[110:111], v45 offset:512
  ds_read_b128 v[84:87], v40 offset:2048
  v_mul_f32 v9, v62, v74
  v_mfma_f32_16x16x32_bf16 v[248:251], v[120:123], v[92:95], v[248:251]
  v_cvt_pk_bf16_f32 v8, v8, v9
  v_mfma_f32_16x16x32_bf16 v[244:247], v[116:119], v[92:95], v[244:247]
  v_lshlrev_b32 v9, 16, v8
  v_mfma_f32_16x16x32_bf16 v[240:243], v[112:115], v[92:95], v[240:243]
  v_and_b32 v8, s94, v8
  s_waitcnt lgkmcnt(7)
  v_mfma_f32_16x16x32_bf16 v[128:131], v[96:99], v[80:83], v[128:131]
  ds_read_b128 v[88:91], v40 offset:4096
  v_add_f32 v10, v10, v9
  s_waitcnt lgkmcnt(6)
  v_mfma_f32_16x16x32_bf16 v[132:135], v[100:103], v[80:83], v[132:135]
  v_add_f32 v11, v11, v8
  s_waitcnt lgkmcnt(4)
  v_mfma_f32_16x16x32_bf16 v[136:139], v[104:107], v[80:83], v[136:139]
  v_lshlrev_b32 v8, 16, v63
  s_waitcnt lgkmcnt(2)
  v_mfma_f32_16x16x32_bf16 v[140:143], v[108:111], v[80:83], v[140:143]
  v_lshlrev_b32 v9, 16, v75
  s_waitcnt lgkmcnt(1)
  v_mfma_f32_16x16x32_bf16 v[156:159], v[108:111], v[84:87], v[156:159]
  ds_read_b128 v[92:95], v40 offset:6144
  v_and_b32 v63, s94, v63
  v_mfma_f32_16x16x32_bf16 v[152:155], v[104:107], v[84:87], v[152:155]
  v_and_b32 v75, s94, v75
  v_mfma_f32_16x16x32_bf16 v[148:151], v[100:103], v[84:87], v[148:151]
  v_mul_f32 v8, v8, v9
  v_mfma_f32_16x16x32_bf16 v[144:147], v[96:99], v[84:87], v[144:147]
  v_mul_f32 v9, v63, v75
  s_waitcnt lgkmcnt(1)
  v_mfma_f32_16x16x32_bf16 v[160:163], v[96:99], v[88:91], v[160:163]
  ds_read_b128 v[80:83], v40 offset:8192
  v_cvt_pk_bf16_f32 v8, v8, v9
  v_mfma_f32_16x16x32_bf16 v[164:167], v[100:103], v[88:91], v[164:167]
  ds_read_b64_tr_b16 v[112:113], v42 offset:4096
  v_lshlrev_b32 v9, 16, v8
  v_mfma_f32_16x16x32_bf16 v[168:171], v[104:107], v[88:91], v[168:171]
  v_and_b32 v8, s94, v8
  v_mfma_f32_16x16x32_bf16 v[172:175], v[108:111], v[88:91], v[172:175]
  ds_read_b64_tr_b16 v[114:115], v42 offset:4608
  v_add_f32 v10, v10, v9
  s_waitcnt lgkmcnt(3)
  v_mfma_f32_16x16x32_bf16 v[188:191], v[108:111], v[92:95], v[188:191]
  ds_read_b128 v[84:87], v40 offset:10240
  v_add_f32 v11, v11, v8
  v_mfma_f32_16x16x32_bf16 v[184:187], v[104:107], v[92:95], v[184:187]
  ds_read_b64_tr_b16 v[116:117], v43 offset:4096
  v_lshlrev_b32 v8, 16, v64
  v_mfma_f32_16x16x32_bf16 v[180:183], v[100:103], v[92:95], v[180:183]
  v_lshlrev_b32 v9, 16, v76
  v_mfma_f32_16x16x32_bf16 v[176:179], v[96:99], v[92:95], v[176:179]
  ds_read_b64_tr_b16 v[118:119], v43 offset:4608
  v_and_b32 v64, s94, v64
  s_waitcnt lgkmcnt(5)
  v_mfma_f32_16x16x32_bf16 v[192:195], v[96:99], v[80:83], v[192:195]
  ds_read_b128 v[88:91], v40 offset:12288
  v_and_b32 v76, s94, v76
  v_mfma_f32_16x16x32_bf16 v[196:199], v[100:103], v[80:83], v[196:199]
  ds_read_b64_tr_b16 v[120:121], v44 offset:4096
  v_mul_f32 v8, v8, v9
  v_mfma_f32_16x16x32_bf16 v[200:203], v[104:107], v[80:83], v[200:203]
  v_mul_f32 v9, v64, v76
  v_mfma_f32_16x16x32_bf16 v[204:207], v[108:111], v[80:83], v[204:207]
  ds_read_b64_tr_b16 v[122:123], v44 offset:4608
  v_cvt_pk_bf16_f32 v8, v8, v9
  s_waitcnt lgkmcnt(5)
  v_mfma_f32_16x16x32_bf16 v[220:223], v[108:111], v[84:87], v[220:223]
  ds_read_b128 v[92:95], v40 offset:14336
  v_lshlrev_b32 v9, 16, v8
  v_mfma_f32_16x16x32_bf16 v[216:219], v[104:107], v[84:87], v[216:219]
  ds_read_b64_tr_b16 v[124:125], v45 offset:4096
  v_and_b32 v8, s94, v8
  v_mfma_f32_16x16x32_bf16 v[212:215], v[100:103], v[84:87], v[212:215]
  v_add_f32 v10, v10, v9
  v_mfma_f32_16x16x32_bf16 v[208:211], v[96:99], v[84:87], v[208:211]
  ds_read_b64_tr_b16 v[126:127], v45 offset:4608
  v_add_f32 v11, v11, v8
  s_waitcnt lgkmcnt(5)
  v_mfma_f32_16x16x32_bf16 v[224:227], v[96:99], v[88:91], v[224:227]
  ds_read_b128 v[80:83], v41 offset:0
  v_lshlrev_b32 v8, 16, v65
  v_mfma_f32_16x16x32_bf16 v[228:231], v[100:103], v[88:91], v[228:231]
  v_lshlrev_b32 v9, 16, v77
  v_mfma_f32_16x16x32_bf16 v[232:235], v[104:107], v[88:91], v[232:235]
  v_and_b32 v65, s94, v65
  v_mfma_f32_16x16x32_bf16 v[236:239], v[108:111], v[88:91], v[236:239]
  v_and_b32 v77, s94, v77
  s_waitcnt lgkmcnt(3)
  v_mfma_f32_16x16x32_bf16 v[252:255], v[108:111], v[92:95], v[252:255]
  ds_read_b128 v[84:87], v41 offset:2048
  v_mul_f32 v8, v8, v9
  v_mfma_f32_16x16x32_bf16 v[248:251], v[104:107], v[92:95], v[248:251]
  v_mul_f32 v9, v65, v77
  v_mfma_f32_16x16x32_bf16 v[244:247], v[100:103], v[92:95], v[244:247]
  v_cvt_pk_bf16_f32 v8, v8, v9
  v_mfma_f32_16x16x32_bf16 v[240:243], v[96:99], v[92:95], v[240:243]
  v_lshlrev_b32 v9, 16, v8
  s_waitcnt lgkmcnt(1)
  v_mfma_f32_16x16x32_bf16 v[128:131], v[112:115], v[80:83], v[128:131]
  ds_read_b128 v[88:91], v41 offset:4096
  v_and_b32 v8, s94, v8
  v_mfma_f32_16x16x32_bf16 v[132:135], v[116:119], v[80:83], v[132:135]
  v_add_f32 v10, v10, v9
  v_mfma_f32_16x16x32_bf16 v[136:139], v[120:123], v[80:83], v[136:139]
  v_add_f32 v11, v11, v8
  v_mfma_f32_16x16x32_bf16 v[140:143], v[124:127], v[80:83], v[140:143]
  v_lshlrev_b32 v8, 16, v66
  s_waitcnt lgkmcnt(1)
  v_mfma_f32_16x16x32_bf16 v[156:159], v[124:127], v[84:87], v[156:159]
  ds_read_b128 v[92:95], v41 offset:6144
  v_lshlrev_b32 v9, 16, v78
  v_mfma_f32_16x16x32_bf16 v[152:155], v[120:123], v[84:87], v[152:155]
  v_and_b32 v66, s94, v66
  v_mfma_f32_16x16x32_bf16 v[148:151], v[116:119], v[84:87], v[148:151]
  v_and_b32 v78, s94, v78
  v_mfma_f32_16x16x32_bf16 v[144:147], v[112:115], v[84:87], v[144:147]
  v_mul_f32 v8, v8, v9
  s_waitcnt lgkmcnt(1)
  v_mfma_f32_16x16x32_bf16 v[160:163], v[112:115], v[88:91], v[160:163]
  ds_read_b128 v[80:83], v41 offset:8192
  v_mul_f32 v9, v66, v78
  v_mfma_f32_16x16x32_bf16 v[164:167], v[116:119], v[88:91], v[164:167]
  v_cvt_pk_bf16_f32 v8, v8, v9
  v_mfma_f32_16x16x32_bf16 v[168:171], v[120:123], v[88:91], v[168:171]
  v_lshlrev_b32 v9, 16, v8
  v_mfma_f32_16x16x32_bf16 v[172:175], v[124:127], v[88:91], v[172:175]
  v_and_b32 v8, s94, v8
  s_waitcnt lgkmcnt(1)
  v_mfma_f32_16x16x32_bf16 v[188:191], v[124:127], v[92:95], v[188:191]
  ds_read_b128 v[84:87], v41 offset:10240
  v_add_f32 v10, v10, v9
  v_mfma_f32_16x16x32_bf16 v[184:187], v[120:123], v[92:95], v[184:187]
  v_add_f32 v11, v11, v8
  v_mfma_f32_16x16x32_bf16 v[180:183], v[116:119], v[92:95], v[180:183]
  v_lshlrev_b32 v8, 16, v67
  v_mfma_f32_16x16x32_bf16 v[176:179], v[112:115], v[92:95], v[176:179]
  v_lshlrev_b32 v9, 16, v79
  s_waitcnt lgkmcnt(1)
  v_mfma_f32_16x16x32_bf16 v[192:195], v[112:115], v[80:83], v[192:195]
  ds_read_b128 v[88:91], v41 offset:12288
  v_and_b32 v67, s94, v67
  v_mfma_f32_16x16x32_bf16 v[196:199], v[116:119], v[80:83], v[196:199]
  v_and_b32 v79, s94, v79
  v_mfma_f32_16x16x32_bf16 v[200:203], v[120:123], v[80:83], v[200:203]
  v_mul_f32 v8, v8, v9
  v_mfma_f32_16x16x32_bf16 v[204:207], v[124:127], v[80:83], v[204:207]
  v_mul_f32 v9, v67, v79
  s_waitcnt lgkmcnt(1)
  v_mfma_f32_16x16x32_bf16 v[220:223], v[124:127], v[84:87], v[220:223]
  ds_read_b128 v[92:95], v41 offset:14336
  v_cvt_pk_bf16_f32 v8, v8, v9
  v_mfma_f32_16x16x32_bf16 v[216:219], v[120:123], v[84:87], v[216:219]
  v_lshlrev_b32 v9, 16, v8
  v_mfma_f32_16x16x32_bf16 v[212:215], v[116:119], v[84:87], v[212:215]
  v_and_b32 v8, s94, v8
  v_mfma_f32_16x16x32_bf16 v[208:211], v[112:115], v[84:87], v[208:211]
  v_add_f32 v10, v10, v9
  s_waitcnt lgkmcnt(0)
  s_barrier
  v_mfma_f32_16x16x32_bf16 v[224:227], v[112:115], v[88:91], v[224:227]
  ds_read_b128 v[80:83], v40 offset:32768
  ds_read_b64_tr_b16 v[96:97], v42 offset:32768
  v_add_f32 v11, v11, v8
  v_mfma_f32_16x16x32_bf16 v[228:231], v[116:119], v[88:91], v[228:231]
  ds_read_b64_tr_b16 v[98:99], v42 offset:33280
  ds_read_b64_tr_b16 v[100:101], v43 offset:32768
  v_add_f32 v10, v10, v11
  v_mfma_f32_16x16x32_bf16 v[232:235], v[120:123], v[88:91], v[232:235]
  ds_read_b64_tr_b16 v[102:103], v43 offset:33280
  ds_read_b64_tr_b16 v[104:105], v44 offset:32768
  v_add_f32_dpp v10, v10, v10 quad_perm:[1,0,3,2] row_mask:0xf bank_mask:0xf
  v_mfma_f32_16x16x32_bf16 v[236:239], v[124:127], v[88:91], v[236:239]
  ds_read_b64_tr_b16 v[106:107], v44 offset:33280
  ds_read_b64_tr_b16 v[108:109], v45 offset:32768
  v_add_f32_dpp v10, v10, v10 quad_perm:[2,3,0,1] row_mask:0xf bank_mask:0xf
  v_mfma_f32_16x16x32_bf16 v[252:255], v[124:127], v[92:95], v[252:255]
  ds_read_b64_tr_b16 v[110:111], v45 offset:33280
  ds_read_b128 v[84:87], v40 offset:34816
  v_add_f32_dpp v10, v10, v10 row_half_mirror row_mask:0xf bank_mask:0xf
  v_mfma_f32_16x16x32_bf16 v[248:251], v[120:123], v[92:95], v[248:251]
  s_nop 0
  v_add_f32_dpp v10, v10, v10 row_mirror row_mask:0xf bank_mask:0xf
  v_mfma_f32_16x16x32_bf16 v[244:247], v[116:119], v[92:95], v[244:247]
  v_mov_b32 v11, v10
  v_mfma_f32_16x16x32_bf16 v[240:243], v[112:115], v[92:95], v[240:243]
  s_nop 0
  v_permlane16_swap_b32 v10, v11
  s_waitcnt lgkmcnt(7)
  v_mfma_f32_16x16x32_bf16 v[128:131], v[96:99], v[80:83], v[128:131]
  ds_read_b128 v[88:91], v40 offset:36864
  v_add_f32 v10, v10, v11
  s_waitcnt lgkmcnt(6)
  v_mfma_f32_16x16x32_bf16 v[132:135], v[100:103], v[80:83], v[132:135]
  v_cvt_pk_bf16_f32 v10, v10, v10
  s_waitcnt lgkmcnt(4)
  v_mfma_f32_16x16x32_bf16 v[136:139], v[104:107], v[80:83], v[136:139]
  v_lshlrev_b32 v10, 16, v10
  s_waitcnt lgkmcnt(2)
  v_mfma_f32_16x16x32_bf16 v[140:143], v[108:111], v[80:83], v[140:143]
  v_mul_f32 v10, 0xbfb8aa3b, v10
  s_waitcnt lgkmcnt(1)
  v_mfma_f32_16x16x32_bf16 v[156:159], v[108:111], v[84:87], v[156:159]
  ds_read_b128 v[92:95], v40 offset:38912
  v_exp_f32 v10, v10
  v_mfma_f32_16x16x32_bf16 v[152:155], v[104:107], v[84:87], v[152:155]
  v_add_f32 v10, 1.0, v10
  v_mfma_f32_16x16x32_bf16 v[148:151], v[100:103], v[84:87], v[148:151]
  v_rcp_f32 v10, v10
  v_mfma_f32_16x16x32_bf16 v[144:147], v[96:99], v[84:87], v[144:147]
  v_cvt_pk_bf16_f32 v10, v10, v10
  s_waitcnt lgkmcnt(1)
  v_mfma_f32_16x16x32_bf16 v[160:163], v[96:99], v[88:91], v[160:163]
  ds_read_b128 v[80:83], v40 offset:40960
  v_lshlrev_b32 v10, 16, v10
  v_mfma_f32_16x16x32_bf16 v[164:167], v[100:103], v[88:91], v[164:167]
  ds_read_b64_tr_b16 v[112:113], v42 offset:36864
  v_sub_f32 v11, 1.0, v10
  v_mfma_f32_16x16x32_bf16 v[168:171], v[104:107], v[88:91], v[168:171]
  v_cvt_pk_bf16_f32 v11, v11, v11
  v_mfma_f32_16x16x32_bf16 v[172:175], v[108:111], v[88:91], v[172:175]
  ds_read_b64_tr_b16 v[114:115], v42 offset:37376
  v_lshlrev_b32 v11, 16, v11
  s_waitcnt lgkmcnt(3)
  v_mfma_f32_16x16x32_bf16 v[188:191], v[108:111], v[92:95], v[188:191]
  ds_read_b128 v[84:87], v40 offset:43008
  v_lshlrev_b32 v7, 3, v7
  v_mfma_f32_16x16x32_bf16 v[184:187], v[104:107], v[92:95], v[184:187]
  ds_read_b64_tr_b16 v[116:117], v43 offset:36864
  v_mov_b32 v9, 1
  v_mfma_f32_16x16x32_bf16 v[180:183], v[100:103], v[92:95], v[180:183]
  v_cmp_eq_u32 vcc, 0, v6
  v_mfma_f32_16x16x32_bf16 v[176:179], v[96:99], v[92:95], v[176:179]
  ds_read_b64_tr_b16 v[118:119], v43 offset:37376
  s_waitcnt lgkmcnt(5)
  v_mfma_f32_16x16x32_bf16 v[192:195], v[96:99], v[80:83], v[192:195]
  ds_read_b128 v[88:91], v40 offset:45056
  s_mov_b64 exec, vcc
  buffer_store_dwordx2 v[10:11], v7, s[12:15], s92 offen sc1
  s_mov_b64 exec, -1
  s_lshl_b32 s93, s2, 3
  s_add_u32 s93, s93, s28
  s_and_b32 s94, s93, 3
  s_cmp_lt_u32 s93, 56
  s_cselect_b32 s94, s94, 1
  s_cmp_eq_u32 s94, 0
  s_cbranch_scc0 F_NZ0
  s_mov_b64 exec, 1
  buffer_atomic_add v9, off, s[24:27], 0 sc1
  s_mov_b64 exec, -1
F_NZ0:
  v_mfma_f32_16x16x32_bf16 v[196:199], v[100:103], v[80:83], v[196:199]
  ds_read_b64_tr_b16 v[120:121], v44 offset:36864
  v_mfma_f32_16x16x32_bf16 v[200:203], v[104:107], v[80:83], v[200:203]
  v_mfma_f32_16x16x32_bf16 v[204:207], v[108:111], v[80:83], v[204:207]
  ds_read_b64_tr_b16 v[122:123], v44 offset:37376
  s_waitcnt lgkmcnt(5)
  v_mfma_f32_16x16x32_bf16 v[220:223], v[108:111], v[84:87], v[220:223]
  ds_read_b128 v[92:95], v40 offset:47104
  v_mfma_f32_16x16x32_bf16 v[216:219], v[104:107], v[84:87], v[216:219]
  ds_read_b64_tr_b16 v[124:125], v45 offset:36864
  v_mfma_f32_16x16x32_bf16 v[212:215], v[100:103], v[84:87], v[212:215]
  v_mfma_f32_16x16x32_bf16 v[208:211], v[96:99], v[84:87], v[208:211]
  ds_read_b64_tr_b16 v[126:127], v45 offset:37376
  s_waitcnt lgkmcnt(5)
  v_mfma_f32_16x16x32_bf16 v[224:227], v[96:99], v[88:91], v[224:227]
  ds_read_b128 v[80:83], v41 offset:32768
  v_mfma_f32_16x16x32_bf16 v[228:231], v[100:103], v[88:91], v[228:231]
  v_mfma_f32_16x16x32_bf16 v[232:235], v[104:107], v[88:91], v[232:235]
  v_mfma_f32_16x16x32_bf16 v[236:239], v[108:111], v[88:91], v[236:239]
  s_waitcnt lgkmcnt(3)
  v_mfma_f32_16x16x32_bf16 v[252:255], v[108:111], v[92:95], v[252:255]
  ds_read_b128 v[84:87], v41 offset:34816
  v_mfma_f32_16x16x32_bf16 v[248:251], v[104:107], v[92:95], v[248:251]
  v_mfma_f32_16x16x32_bf16 v[244:247], v[100:103], v[92:95], v[244:247]
  v_mfma_f32_16x16x32_bf16 v[240:243], v[96:99], v[92:95], v[240:243]
  s_waitcnt lgkmcnt(1)
  v_mfma_f32_16x16x32_bf16 v[128:131], v[112:115], v[80:83], v[128:131]
  ds_read_b128 v[88:91], v41 offset:36864
  v_mfma_f32_16x16x32_bf16 v[132:135], v[116:119], v[80:83], v[132:135]
  v_mfma_f32_16x16x32_bf16 v[136:139], v[120:123], v[80:83], v[136:139]
  v_mfma_f32_16x16x32_bf16 v[140:143], v[124:127], v[80:83], v[140:143]
  s_waitcnt lgkmcnt(1)
  v_mfma_f32_16x16x32_bf16 v[156:159], v[124:127], v[84:87], v[156:159]
  ds_read_b128 v[92:95], v41 offset:38912
  v_mfma_f32_16x16x32_bf16 v[152:155], v[120:123], v[84:87], v[152:155]
  v_mfma_f32_16x16x32_bf16 v[148:151], v[116:119], v[84:87], v[148:151]
  v_mfma_f32_16x16x32_bf16 v[144:147], v[112:115], v[84:87], v[144:147]
  s_waitcnt lgkmcnt(1)
  v_mfma_f32_16x16x32_bf16 v[160:163], v[112:115], v[88:91], v[160:163]
  ds_read_b128 v[80:83], v41 offset:40960
  v_mfma_f32_16x16x32_bf16 v[164:167], v[116:119], v[88:91], v[164:167]
  v_mfma_f32_16x16x32_bf16 v[168:171], v[120:123], v[88:91], v[168:171]
  v_mfma_f32_16x16x32_bf16 v[172:175], v[124:127], v[88:91], v[172:175]
  s_waitcnt lgkmcnt(1)
  v_mfma_f32_16x16x32_bf16 v[188:191], v[124:127], v[92:95], v[188:191]
  ds_read_b128 v[84:87], v41 offset:43008
  buffer_load_dword v13, v5, s[20:23], s77 offen
  s_add_u32 s77, s77, s78
  v_mfma_f32_16x16x32_bf16 v[184:187], v[120:123], v[92:95], v[184:187]
  v_mfma_f32_16x16x32_bf16 v[180:183], v[116:119], v[92:95], v[180:183]
  v_mfma_f32_16x16x32_bf16 v[176:179], v[112:115], v[92:95], v[176:179]
  s_waitcnt lgkmcnt(1)
  v_mfma_f32_16x16x32_bf16 v[192:195], v[112:115], v[80:83], v[192:195]
  ds_read_b128 v[88:91], v41 offset:45056
  v_mfma_f32_16x16x32_bf16 v[196:199], v[116:119], v[80:83], v[196:199]
  v_mfma_f32_16x16x32_bf16 v[200:203], v[120:123], v[80:83], v[200:203]
  v_mfma_f32_16x16x32_bf16 v[204:207], v[124:127], v[80:83], v[204:207]
  s_waitcnt lgkmcnt(1)
  v_mfma_f32_16x16x32_bf16 v[220:223], v[124:127], v[84:87], v[220:223]
  ds_read_b128 v[92:95], v41 offset:47104
  v_mfma_f32_16x16x32_bf16 v[216:219], v[120:123], v[84:87], v[216:219]
  v_mfma_f32_16x16x32_bf16 v[212:215], v[116:119], v[84:87], v[212:215]
  v_mfma_f32_16x16x32_bf16 v[208:211], v[112:115], v[84:87], v[208:211]
  s_waitcnt lgkmcnt(0)
  s_barrier
  v_mfma_f32_16x16x32_bf16 v[224:227], v[112:115], v[88:91], v[224:227]
  ds_read_b128 v[80:83], v40 offset:0
  ds_read_b64_tr_b16 v[96:97], v42 offset:0
  v_mfma_f32_16x16x32_bf16 v[228:231], v[116:119], v[88:91], v[228:231]
  ds_read_b64_tr_b16 v[98:99], v42 offset:512
  ds_read_b64_tr_b16 v[100:101], v43 offset:0
  v_mfma_f32_16x16x32_bf16 v[232:235], v[120:123], v[88:91], v[232:235]
  ds_read_b64_tr_b16 v[102:103], v43 offset:512
  ds_read_b64_tr_b16 v[104:105], v44 offset:0
  v_mfma_f32_16x16x32_bf16 v[236:239], v[124:127], v[88:91], v[236:239]
  ds_read_b64_tr_b16 v[106:107], v44 offset:512
  ds_read_b64_tr_b16 v[108:109], v45 offset:0
  v_mfma_f32_16x16x32_bf16 v[252:255], v[124:127], v[92:95], v[252:255]
  ds_read_b64_tr_b16 v[110:111], v45 offset:512
  ds_read_b128 v[84:87], v40 offset:2048
  v_mfma_f32_16x16x32_bf16 v[248:251], v[120:123], v[92:95], v[248:251]
  v_mfma_f32_16x16x32_bf16 v[244:247], v[116:119], v[92:95], v[244:247]
  v_mfma_f32_16x16x32_bf16 v[240:243], v[112:115], v[92:95], v[240:243]
  s_waitcnt lgkmcnt(7)
  v_mfma_f32_16x16x32_bf16 v[128:131], v[96:99], v[80:83], v[128:131]
  ds_read_b128 v[88:91], v40 offset:4096
  s_waitcnt lgkmcnt(6)
  v_mfma_f32_16x16x32_bf16 v[132:135], v[100:103], v[80:83], v[132:135]
  s_waitcnt lgkmcnt(4)
  v_mfma_f32_16x16x32_bf16 v[136:139], v[104:107], v[80:83], v[136:139]
  s_waitcnt lgkmcnt(2)
  v_mfma_f32_16x16x32_bf16 v[140:143], v[108:111], v[80:83], v[140:143]
  s_waitcnt lgkmcnt(1)
  v_mfma_f32_16x16x32_bf16 v[156:159], v[108:111], v[84:87], v[156:159]
  ds_read_b128 v[92:95], v40 offset:6144
  v_mfma_f32_16x16x32_bf16 v[152:155], v[104:107], v[84:87], v[152:155]
  v_mfma_f32_16x16x32_bf16 v[148:151], v[100:103], v[84:87], v[148:151]
  v_mfma_f32_16x16x32_bf16 v[144:147], v[96:99], v[84:87], v[144:147]
  s_waitcnt lgkmcnt(1)
  v_mfma_f32_16x16x32_bf16 v[160:163], v[96:99], v[88:91], v[160:163]
  ds_read_b128 v[80:83], v40 offset:8192
  v_mfma_f32_16x16x32_bf16 v[164:167], v[100:103], v[88:91], v[164:167]
  ds_read_b64_tr_b16 v[112:113], v42 offset:4096
  v_mfma_f32_16x16x32_bf16 v[168:171], v[104:107], v[88:91], v[168:171]
  v_mfma_f32_16x16x32_bf16 v[172:175], v[108:111], v[88:91], v[172:175]
  ds_read_b64_tr_b16 v[114:115], v42 offset:4608
  s_waitcnt lgkmcnt(3)
  v_mfma_f32_16x16x32_bf16 v[188:191], v[108:111], v[92:95], v[188:191]
  ds_read_b128 v[84:87], v40 offset:10240
  v_mfma_f32_16x16x32_bf16 v[184:187], v[104:107], v[92:95], v[184:187]
  ds_read_b64_tr_b16 v[116:117], v43 offset:4096
  v_mfma_f32_16x16x32_bf16 v[180:183], v[100:103], v[92:95], v[180:183]
  v_mfma_f32_16x16x32_bf16 v[176:179], v[96:99], v[92:95], v[176:179]
  ds_read_b64_tr_b16 v[118:119], v43 offset:4608
  s_waitcnt lgkmcnt(5)
  v_mfma_f32_16x16x32_bf16 v[192:195], v[96:99], v[80:83], v[192:195]
  ds_read_b128 v[88:91], v40 offset:12288
  v_mfma_f32_16x16x32_bf16 v[196:199], v[100:103], v[80:83], v[196:199]
  ds_read_b64_tr_b16 v[120:121], v44 offset:4096
  v_mfma_f32_16x16x32_bf16 v[200:203], v[104:107], v[80:83], v[200:203]
  v_mfma_f32_16x16x32_bf16 v[204:207], v[108:111], v[80:83], v[204:207]
  ds_read_b64_tr_b16 v[122:123], v44 offset:4608
  s_waitcnt lgkmcnt(5)
  v_mfma_f32_16x16x32_bf16 v[220:223], v[108:111], v[84:87], v[220:223]
  ds_read_b128 v[92:95], v40 offset:14336
  v_mfma_f32_16x16x32_bf16 v[216:219], v[104:107], v[84:87], v[216:219]
  ds_read_b64_tr_b16 v[124:125], v45 offset:4096
  v_mfma_f32_16x16x32_bf16 v[212:215], v[100:103], v[84:87], v[212:215]
  v_mfma_f32_16x16x32_bf16 v[208:211], v[96:99], v[84:87], v[208:211]
  ds_read_b64_tr_b16 v[126:127], v45 offset:4608
  s_waitcnt lgkmcnt(5)
  v_mfma_f32_16x16x32_bf16 v[224:227], v[96:99], v[88:91], v[224:227]
  ds_read_b128 v[80:83], v41 offset:0
  v_mfma_f32_16x16x32_bf16 v[228:231], v[100:103], v[88:91], v[228:231]
  v_mfma_f32_16x16x32_bf16 v[232:235], v[104:107], v[88:91], v[232:235]
  v_mfma_f32_16x16x32_bf16 v[236:239], v[108:111], v[88:91], v[236:239]
  s_waitcnt lgkmcnt(3)
  v_mfma_f32_16x16x32_bf16 v[252:255], v[108:111], v[92:95], v[252:255]
  ds_read_b128 v[84:87], v41 offset:2048
  v_mfma_f32_16x16x32_bf16 v[248:251], v[104:107], v[92:95], v[248:251]
  v_mfma_f32_16x16x32_bf16 v[244:247], v[100:103], v[92:95], v[244:247]
  v_mfma_f32_16x16x32_bf16 v[240:243], v[96:99], v[92:95], v[240:243]
  s_waitcnt lgkmcnt(1)
  v_mfma_f32_16x16x32_bf16 v[128:131], v[112:115], v[80:83], v[128:131]
  ds_read_b128 v[88:91], v41 offset:4096
  v_mfma_f32_16x16x32_bf16 v[132:135], v[116:119], v[80:83], v[132:135]
  v_mfma_f32_16x16x32_bf16 v[136:139], v[120:123], v[80:83], v[136:139]
  v_mfma_f32_16x16x32_bf16 v[140:143], v[124:127], v[80:83], v[140:143]
  s_waitcnt lgkmcnt(1)
  v_mfma_f32_16x16x32_bf16 v[156:159], v[124:127], v[84:87], v[156:159]
  ds_read_b128 v[92:95], v41 offset:6144
  v_mfma_f32_16x16x32_bf16 v[152:155], v[120:123], v[84:87], v[152:155]
  v_mfma_f32_16x16x32_bf16 v[148:151], v[116:119], v[84:87], v[148:151]
  v_mfma_f32_16x16x32_bf16 v[144:147], v[112:115], v[84:87], v[144:147]
  s_waitcnt lgkmcnt(1)
  v_mfma_f32_16x16x32_bf16 v[160:163], v[112:115], v[88:91], v[160:163]
  ds_read_b128 v[80:83], v41 offset:8192
  v_mfma_f32_16x16x32_bf16 v[164:167], v[116:119], v[88:91], v[164:167]
  v_mfma_f32_16x16x32_bf16 v[168:171], v[120:123], v[88:91], v[168:171]
  v_mfma_f32_16x16x32_bf16 v[172:175], v[124:127], v[88:91], v[172:175]
  s_waitcnt lgkmcnt(1)
  v_mfma_f32_16x16x32_bf16 v[188:191], v[124:127], v[92:95], v[188:191]
  ds_read_b128 v[84:87], v41 offset:10240
  buffer_load_dword v13, v4, s[16:19], s76 offen offset:0
  v_mfma_f32_16x16x32_bf16 v[184:187], v[120:123], v[92:95], v[184:187]
  v_mfma_f32_16x16x32_bf16 v[180:183], v[116:119], v[92:95], v[180:183]
  v_mfma_f32_16x16x32_bf16 v[176:179], v[112:115], v[92:95], v[176:179]
  s_waitcnt lgkmcnt(1)
  v_mfma_f32_16x16x32_bf16 v[192:195], v[112:115], v[80:83], v[192:195]
  ds_read_b128 v[88:91], v41 offset:12288
  v_mfma_f32_16x16x32_bf16 v[196:199], v[116:119], v[80:83], v[196:199]
  v_mfma_f32_16x16x32_bf16 v[200:203], v[120:123], v[80:83], v[200:203]
  v_mfma_f32_16x16x32_bf16 v[204:207], v[124:127], v[80:83], v[204:207]
  s_waitcnt lgkmcnt(1)
  v_mfma_f32_16x16x32_bf16 v[220:223], v[124:127], v[84:87], v[220:223]
  ds_read_b128 v[92:95], v41 offset:14336
  v_mfma_f32_16x16x32_bf16 v[216:219], v[120:123], v[84:87], v[216:219]
  v_mfma_f32_16x16x32_bf16 v[212:215], v[116:119], v[84:87], v[212:215]
  v_mfma_f32_16x16x32_bf16 v[208:211], v[112:115], v[84:87], v[208:211]
  s_waitcnt lgkmcnt(0)
  s_barrier
  v_mfma_f32_16x16x32_bf16 v[224:227], v[112:115], v[88:91], v[224:227]
  ds_read_b128 v[80:83], v40 offset:32768
  ds_read_b64_tr_b16 v[96:97], v42 offset:32768
  v_mfma_f32_16x16x32_bf16 v[228:231], v[116:119], v[88:91], v[228:231]
  ds_read_b64_tr_b16 v[98:99], v42 offset:33280
  ds_read_b64_tr_b16 v[100:101], v43 offset:32768
  v_mfma_f32_16x16x32_bf16 v[232:235], v[120:123], v[88:91], v[232:235]
  ds_read_b64_tr_b16 v[102:103], v43 offset:33280
  ds_read_b64_tr_b16 v[104:105], v44 offset:32768
  v_mfma_f32_16x16x32_bf16 v[236:239], v[124:127], v[88:91], v[236:239]
  ds_read_b64_tr_b16 v[106:107], v44 offset:33280
  ds_read_b64_tr_b16 v[108:109], v45 offset:32768
  v_mfma_f32_16x16x32_bf16 v[252:255], v[124:127], v[92:95], v[252:255]
  ds_read_b64_tr_b16 v[110:111], v45 offset:33280
  ds_read_b128 v[84:87], v40 offset:34816
  v_mfma_f32_16x16x32_bf16 v[248:251], v[120:123], v[92:95], v[248:251]
  v_mfma_f32_16x16x32_bf16 v[244:247], v[116:119], v[92:95], v[244:247]
  v_mfma_f32_16x16x32_bf16 v[240:243], v[112:115], v[92:95], v[240:243]
  s_waitcnt lgkmcnt(7)
  v_mfma_f32_16x16x32_bf16 v[128:131], v[96:99], v[80:83], v[128:131]
  ds_read_b128 v[88:91], v40 offset:36864
  s_waitcnt lgkmcnt(6)
  v_mfma_f32_16x16x32_bf16 v[132:135], v[100:103], v[80:83], v[132:135]
  s_waitcnt lgkmcnt(4)
  v_mfma_f32_16x16x32_bf16 v[136:139], v[104:107], v[80:83], v[136:139]
  s_waitcnt lgkmcnt(2)
  v_mfma_f32_16x16x32_bf16 v[140:143], v[108:111], v[80:83], v[140:143]
  s_waitcnt lgkmcnt(1)
  v_mfma_f32_16x16x32_bf16 v[156:159], v[108:111], v[84:87], v[156:159]
  ds_read_b128 v[92:95], v40 offset:38912
  v_mfma_f32_16x16x32_bf16 v[152:155], v[104:107], v[84:87], v[152:155]
  v_mfma_f32_16x16x32_bf16 v[148:151], v[100:103], v[84:87], v[148:151]
  v_mfma_f32_16x16x32_bf16 v[144:147], v[96:99], v[84:87], v[144:147]
  s_waitcnt lgkmcnt(1)
  v_mfma_f32_16x16x32_bf16 v[160:163], v[96:99], v[88:91], v[160:163]
  ds_read_b128 v[80:83], v40 offset:40960
  v_mfma_f32_16x16x32_bf16 v[164:167], v[100:103], v[88:91], v[164:167]
  ds_read_b64_tr_b16 v[112:113], v42 offset:36864
  v_mfma_f32_16x16x32_bf16 v[168:171], v[104:107], v[88:91], v[168:171]
  v_mfma_f32_16x16x32_bf16 v[172:175], v[108:111], v[88:91], v[172:175]
  ds_read_b64_tr_b16 v[114:115], v42 offset:37376
  s_waitcnt lgkmcnt(3)
  v_mfma_f32_16x16x32_bf16 v[188:191], v[108:111], v[92:95], v[188:191]
  ds_read_b128 v[84:87], v40 offset:43008
  v_mfma_f32_16x16x32_bf16 v[184:187], v[104:107], v[92:95], v[184:187]
  ds_read_b64_tr_b16 v[116:117], v43 offset:36864
  v_mfma_f32_16x16x32_bf16 v[180:183], v[100:103], v[92:95], v[180:183]
  v_mfma_f32_16x16x32_bf16 v[176:179], v[96:99], v[92:95], v[176:179]
  ds_read_b64_tr_b16 v[118:119], v43 offset:37376
  s_waitcnt lgkmcnt(5)
  v_mfma_f32_16x16x32_bf16 v[192:195], v[96:99], v[80:83], v[192:195]
  ds_read_b128 v[88:91], v40 offset:45056
  v_mfma_f32_16x16x32_bf16 v[196:199], v[100:103], v[80:83], v[196:199]
  ds_read_b64_tr_b16 v[120:121], v44 offset:36864
  v_mfma_f32_16x16x32_bf16 v[200:203], v[104:107], v[80:83], v[200:203]
  v_mfma_f32_16x16x32_bf16 v[204:207], v[108:111], v[80:83], v[204:207]
  ds_read_b64_tr_b16 v[122:123], v44 offset:37376
  s_waitcnt lgkmcnt(5)
  v_mfma_f32_16x16x32_bf16 v[220:223], v[108:111], v[84:87], v[220:223]
  ds_read_b128 v[92:95], v40 offset:47104
  v_mfma_f32_16x16x32_bf16 v[216:219], v[104:107], v[84:87], v[216:219]
  ds_read_b64_tr_b16 v[124:125], v45 offset:36864
  v_mfma_f32_16x16x32_bf16 v[212:215], v[100:103], v[84:87], v[212:215]
  v_mfma_f32_16x16x32_bf16 v[208:211], v[96:99], v[84:87], v[208:211]
  ds_read_b64_tr_b16 v[126:127], v45 offset:37376
  s_waitcnt lgkmcnt(5)
  v_mfma_f32_16x16x32_bf16 v[224:227], v[96:99], v[88:91], v[224:227]
  ds_read_b128 v[80:83], v41 offset:32768
  v_mfma_f32_16x16x32_bf16 v[228:231], v[100:103], v[88:91], v[228:231]
  v_mfma_f32_16x16x32_bf16 v[232:235], v[104:107], v[88:91], v[232:235]
  v_mfma_f32_16x16x32_bf16 v[236:239], v[108:111], v[88:91], v[236:239]
  s_waitcnt lgkmcnt(3)
  v_mfma_f32_16x16x32_bf16 v[252:255], v[108:111], v[92:95], v[252:255]
  ds_read_b128 v[84:87], v41 offset:34816
  v_mfma_f32_16x16x32_bf16 v[248:251], v[104:107], v[92:95], v[248:251]
  v_mfma_f32_16x16x32_bf16 v[244:247], v[100:103], v[92:95], v[244:247]
  v_mfma_f32_16x16x32_bf16 v[240:243], v[96:99], v[92:95], v[240:243]
  s_waitcnt lgkmcnt(1)
  v_mfma_f32_16x16x32_bf16 v[128:131], v[112:115], v[80:83], v[128:131]
  ds_read_b128 v[88:91], v41 offset:36864
  v_mfma_f32_16x16x32_bf16 v[132:135], v[116:119], v[80:83], v[132:135]
  v_mfma_f32_16x16x32_bf16 v[136:139], v[120:123], v[80:83], v[136:139]
  v_mfma_f32_16x16x32_bf16 v[140:143], v[124:127], v[80:83], v[140:143]
  s_waitcnt lgkmcnt(1)
  v_mfma_f32_16x16x32_bf16 v[156:159], v[124:127], v[84:87], v[156:159]
  ds_read_b128 v[92:95], v41 offset:38912
  v_mfma_f32_16x16x32_bf16 v[152:155], v[120:123], v[84:87], v[152:155]
  v_mfma_f32_16x16x32_bf16 v[148:151], v[116:119], v[84:87], v[148:151]
  v_mfma_f32_16x16x32_bf16 v[144:147], v[112:115], v[84:87], v[144:147]
  s_waitcnt lgkmcnt(1)
  v_mfma_f32_16x16x32_bf16 v[160:163], v[112:115], v[88:91], v[160:163]
  ds_read_b128 v[80:83], v41 offset:40960
  v_mfma_f32_16x16x32_bf16 v[164:167], v[116:119], v[88:91], v[164:167]
  v_mfma_f32_16x16x32_bf16 v[168:171], v[120:123], v[88:91], v[168:171]
  v_mfma_f32_16x16x32_bf16 v[172:175], v[124:127], v[88:91], v[172:175]
  s_waitcnt lgkmcnt(1)
  v_mfma_f32_16x16x32_bf16 v[188:191], v[124:127], v[92:95], v[188:191]
  ds_read_b128 v[84:87], v41 offset:43008
  buffer_load_dword v13, v5, s[20:23], s77 offen
  s_add_u32 s77, s77, s78
  v_mfma_f32_16x16x32_bf16 v[184:187], v[120:123], v[92:95], v[184:187]
  v_mfma_f32_16x16x32_bf16 v[180:183], v[116:119], v[92:95], v[180:183]
  v_mfma_f32_16x16x32_bf16 v[176:179], v[112:115], v[92:95], v[176:179]
  s_waitcnt lgkmcnt(1)
  v_mfma_f32_16x16x32_bf16 v[192:195], v[112:115], v[80:83], v[192:195]
  ds_read_b128 v[88:91], v41 offset:45056
  v_mfma_f32_16x16x32_bf16 v[196:199], v[116:119], v[80:83], v[196:199]
  v_mfma_f32_16x16x32_bf16 v[200:203], v[120:123], v[80:83], v[200:203]
  v_mfma_f32_16x16x32_bf16 v[204:207], v[124:127], v[80:83], v[204:207]
  s_waitcnt lgkmcnt(1)
  v_mfma_f32_16x16x32_bf16 v[220:223], v[124:127], v[84:87], v[220:223]
  ds_read_b128 v[92:95], v41 offset:47104
  v_mfma_f32_16x16x32_bf16 v[216:219], v[120:123], v[84:87], v[216:219]
  v_mfma_f32_16x16x32_bf16 v[212:215], v[116:119], v[84:87], v[212:215]
  v_mfma_f32_16x16x32_bf16 v[208:211], v[112:115], v[84:87], v[208:211]
  s_waitcnt lgkmcnt(0)
  s_barrier
  v_mfma_f32_16x16x32_bf16 v[224:227], v[112:115], v[88:91], v[224:227]
  ds_read_b128 v[80:83], v40 offset:0
  ds_read_b64_tr_b16 v[96:97], v42 offset:0
  v_mfma_f32_16x16x32_bf16 v[228:231], v[116:119], v[88:91], v[228:231]
  ds_read_b64_tr_b16 v[98:99], v42 offset:512
  ds_read_b64_tr_b16 v[100:101], v43 offset:0
  v_mfma_f32_16x16x32_bf16 v[232:235], v[120:123], v[88:91], v[232:235]
  ds_read_b64_tr_b16 v[102:103], v43 offset:512
  ds_read_b64_tr_b16 v[104:105], v44 offset:0
  v_mfma_f32_16x16x32_bf16 v[236:239], v[124:127], v[88:91], v[236:239]
  ds_read_b64_tr_b16 v[106:107], v44 offset:512
  ds_read_b64_tr_b16 v[108:109], v45 offset:0
  v_mfma_f32_16x16x32_bf16 v[252:255], v[124:127], v[92:95], v[252:255]
  ds_read_b64_tr_b16 v[110:111], v45 offset:512
  ds_read_b128 v[84:87], v40 offset:2048
  v_mfma_f32_16x16x32_bf16 v[248:251], v[120:123], v[92:95], v[248:251]
  v_mfma_f32_16x16x32_bf16 v[244:247], v[116:119], v[92:95], v[244:247]
  v_mfma_f32_16x16x32_bf16 v[240:243], v[112:115], v[92:95], v[240:243]
  s_waitcnt lgkmcnt(7)
  v_mfma_f32_16x16x32_bf16 v[128:131], v[96:99], v[80:83], v[128:131]
  ds_read_b128 v[88:91], v40 offset:4096
  s_waitcnt lgkmcnt(6)
  v_mfma_f32_16x16x32_bf16 v[132:135], v[100:103], v[80:83], v[132:135]
  s_waitcnt lgkmcnt(4)
  v_mfma_f32_16x16x32_bf16 v[136:139], v[104:107], v[80:83], v[136:139]
  s_waitcnt lgkmcnt(2)
  v_mfma_f32_16x16x32_bf16 v[140:143], v[108:111], v[80:83], v[140:143]
  s_waitcnt lgkmcnt(1)
  v_mfma_f32_16x16x32_bf16 v[156:159], v[108:111], v[84:87], v[156:159]
  ds_read_b128 v[92:95], v40 offset:6144
  v_mfma_f32_16x16x32_bf16 v[152:155], v[104:107], v[84:87], v[152:155]
  v_mfma_f32_16x16x32_bf16 v[148:151], v[100:103], v[84:87], v[148:151]
  v_mfma_f32_16x16x32_bf16 v[144:147], v[96:99], v[84:87], v[144:147]
  s_waitcnt lgkmcnt(1)
  v_mfma_f32_16x16x32_bf16 v[160:163], v[96:99], v[88:91], v[160:163]
  ds_read_b128 v[80:83], v40 offset:8192
  v_mfma_f32_16x16x32_bf16 v[164:167], v[100:103], v[88:91], v[164:167]
  ds_read_b64_tr_b16 v[112:113], v42 offset:4096
  v_mfma_f32_16x16x32_bf16 v[168:171], v[104:107], v[88:91], v[168:171]
  v_mfma_f32_16x16x32_bf16 v[172:175], v[108:111], v[88:91], v[172:175]
  ds_read_b64_tr_b16 v[114:115], v42 offset:4608
  s_waitcnt lgkmcnt(3)
  v_mfma_f32_16x16x32_bf16 v[188:191], v[108:111], v[92:95], v[188:191]
  ds_read_b128 v[84:87], v40 offset:10240
  v_mfma_f32_16x16x32_bf16 v[184:187], v[104:107], v[92:95], v[184:187]
  ds_read_b64_tr_b16 v[116:117], v43 offset:4096
  v_mfma_f32_16x16x32_bf16 v[180:183], v[100:103], v[92:95], v[180:183]
  v_mfma_f32_16x16x32_bf16 v[176:179], v[96:99], v[92:95], v[176:179]
  ds_read_b64_tr_b16 v[118:119], v43 offset:4608
  s_waitcnt lgkmcnt(5)
  v_mfma_f32_16x16x32_bf16 v[192:195], v[96:99], v[80:83], v[192:195]
  ds_read_b128 v[88:91], v40 offset:12288
  v_mfma_f32_16x16x32_bf16 v[196:199], v[100:103], v[80:83], v[196:199]
  ds_read_b64_tr_b16 v[120:121], v44 offset:4096
  v_mfma_f32_16x16x32_bf16 v[200:203], v[104:107], v[80:83], v[200:203]
  v_mfma_f32_16x16x32_bf16 v[204:207], v[108:111], v[80:83], v[204:207]
  ds_read_b64_tr_b16 v[122:123], v44 offset:4608
  s_waitcnt lgkmcnt(5)
  v_mfma_f32_16x16x32_bf16 v[220:223], v[108:111], v[84:87], v[220:223]
  ds_read_b128 v[92:95], v40 offset:14336
  v_mfma_f32_16x16x32_bf16 v[216:219], v[104:107], v[84:87], v[216:219]
  ds_read_b64_tr_b16 v[124:125], v45 offset:4096
  v_mfma_f32_16x16x32_bf16 v[212:215], v[100:103], v[84:87], v[212:215]
  v_mfma_f32_16x16x32_bf16 v[208:211], v[96:99], v[84:87], v[208:211]
  ds_read_b64_tr_b16 v[126:127], v45 offset:4608
  s_waitcnt lgkmcnt(5)
  v_mfma_f32_16x16x32_bf16 v[224:227], v[96:99], v[88:91], v[224:227]
  ds_read_b128 v[80:83], v41 offset:0
  v_mfma_f32_16x16x32_bf16 v[228:231], v[100:103], v[88:91], v[228:231]
  v_mfma_f32_16x16x32_bf16 v[232:235], v[104:107], v[88:91], v[232:235]
  v_mfma_f32_16x16x32_bf16 v[236:239], v[108:111], v[88:91], v[236:239]
  s_waitcnt lgkmcnt(3)
  v_mfma_f32_16x16x32_bf16 v[252:255], v[108:111], v[92:95], v[252:255]
  ds_read_b128 v[84:87], v41 offset:2048
  v_mfma_f32_16x16x32_bf16 v[248:251], v[104:107], v[92:95], v[248:251]
  v_mfma_f32_16x16x32_bf16 v[244:247], v[100:103], v[92:95], v[244:247]
  v_mfma_f32_16x16x32_bf16 v[240:243], v[96:99], v[92:95], v[240:243]
  s_waitcnt lgkmcnt(1)
  v_mfma_f32_16x16x32_bf16 v[128:131], v[112:115], v[80:83], v[128:131]
  ds_read_b128 v[88:91], v41 offset:4096
  v_mfma_f32_16x16x32_bf16 v[132:135], v[116:119], v[80:83], v[132:135]
  v_mfma_f32_16x16x32_bf16 v[136:139], v[120:123], v[80:83], v[136:139]
  v_mfma_f32_16x16x32_bf16 v[140:143], v[124:127], v[80:83], v[140:143]
  s_waitcnt lgkmcnt(1)
  v_mfma_f32_16x16x32_bf16 v[156:159], v[124:127], v[84:87], v[156:159]
  ds_read_b128 v[92:95], v41 offset:6144
  v_mfma_f32_16x16x32_bf16 v[152:155], v[120:123], v[84:87], v[152:155]
  v_mfma_f32_16x16x32_bf16 v[148:151], v[116:119], v[84:87], v[148:151]
  v_mfma_f32_16x16x32_bf16 v[144:147], v[112:115], v[84:87], v[144:147]
  s_waitcnt lgkmcnt(1)
  v_mfma_f32_16x16x32_bf16 v[160:163], v[112:115], v[88:91], v[160:163]
  ds_read_b128 v[80:83], v41 offset:8192
  v_mfma_f32_16x16x32_bf16 v[164:167], v[116:119], v[88:91], v[164:167]
  v_mfma_f32_16x16x32_bf16 v[168:171], v[120:123], v[88:91], v[168:171]
  v_mfma_f32_16x16x32_bf16 v[172:175], v[124:127], v[88:91], v[172:175]
  s_waitcnt lgkmcnt(1)
  v_mfma_f32_16x16x32_bf16 v[188:191], v[124:127], v[92:95], v[188:191]
  ds_read_b128 v[84:87], v41 offset:10240
  buffer_load_dword v13, v4, s[16:19], s76 offen offset:256
  v_mfma_f32_16x16x32_bf16 v[184:187], v[120:123], v[92:95], v[184:187]
  v_mfma_f32_16x16x32_bf16 v[180:183], v[116:119], v[92:95], v[180:183]
  v_mfma_f32_16x16x32_bf16 v[176:179], v[112:115], v[92:95], v[176:179]
  s_waitcnt lgkmcnt(1)
  v_mfma_f32_16x16x32_bf16 v[192:195], v[112:115], v[80:83], v[192:195]
  ds_read_b128 v[88:91], v41 offset:12288
  v_mfma_f32_16x16x32_bf16 v[196:199], v[116:119], v[80:83], v[196:199]
  v_mfma_f32_16x16x32_bf16 v[200:203], v[120:123], v[80:83], v[200:203]
  v_mfma_f32_16x16x32_bf16 v[204:207], v[124:127], v[80:83], v[204:207]
  s_waitcnt lgkmcnt(1)
  v_mfma_f32_16x16x32_bf16 v[220:223], v[124:127], v[84:87], v[220:223]
  ds_read_b128 v[92:95], v41 offset:14336
  v_mfma_f32_16x16x32_bf16 v[216:219], v[120:123], v[84:87], v[216:219]
  v_mfma_f32_16x16x32_bf16 v[212:215], v[116:119], v[84:87], v[212:215]
  v_mfma_f32_16x16x32_bf16 v[208:211], v[112:115], v[84:87], v[208:211]
  s_waitcnt lgkmcnt(0)
  s_barrier
  v_mfma_f32_16x16x32_bf16 v[224:227], v[112:115], v[88:91], v[224:227]
  ds_read_b128 v[80:83], v40 offset:32768
  ds_read_b64_tr_b16 v[96:97], v42 offset:32768
  v_mfma_f32_16x16x32_bf16 v[228:231], v[116:119], v[88:91], v[228:231]
  ds_read_b64_tr_b16 v[98:99], v42 offset:33280
  ds_read_b64_tr_b16 v[100:101], v43 offset:32768
  v_mfma_f32_16x16x32_bf16 v[232:235], v[120:123], v[88:91], v[232:235]
  ds_read_b64_tr_b16 v[102:103], v43 offset:33280
  ds_read_b64_tr_b16 v[104:105], v44 offset:32768
  v_mfma_f32_16x16x32_bf16 v[236:239], v[124:127], v[88:91], v[236:239]
  ds_read_b64_tr_b16 v[106:107], v44 offset:33280
  ds_read_b64_tr_b16 v[108:109], v45 offset:32768
  v_mfma_f32_16x16x32_bf16 v[252:255], v[124:127], v[92:95], v[252:255]
  ds_read_b64_tr_b16 v[110:111], v45 offset:33280
  ds_read_b128 v[84:87], v40 offset:34816
  v_mfma_f32_16x16x32_bf16 v[248:251], v[120:123], v[92:95], v[248:251]
  v_mfma_f32_16x16x32_bf16 v[244:247], v[116:119], v[92:95], v[244:247]
  v_mfma_f32_16x16x32_bf16 v[240:243], v[112:115], v[92:95], v[240:243]
  s_waitcnt lgkmcnt(7)
  v_mfma_f32_16x16x32_bf16 v[128:131], v[96:99], v[80:83], v[128:131]
  ds_read_b128 v[88:91], v40 offset:36864
  s_waitcnt lgkmcnt(6)
  v_mfma_f32_16x16x32_bf16 v[132:135], v[100:103], v[80:83], v[132:135]
  s_waitcnt lgkmcnt(4)
  v_mfma_f32_16x16x32_bf16 v[136:139], v[104:107], v[80:83], v[136:139]
  s_waitcnt lgkmcnt(2)
  v_mfma_f32_16x16x32_bf16 v[140:143], v[108:111], v[80:83], v[140:143]
  s_waitcnt lgkmcnt(1)
  v_mfma_f32_16x16x32_bf16 v[156:159], v[108:111], v[84:87], v[156:159]
  ds_read_b128 v[92:95], v40 offset:38912
  v_mfma_f32_16x16x32_bf16 v[152:155], v[104:107], v[84:87], v[152:155]
  v_mfma_f32_16x16x32_bf16 v[148:151], v[100:103], v[84:87], v[148:151]
  v_mfma_f32_16x16x32_bf16 v[144:147], v[96:99], v[84:87], v[144:147]
  s_waitcnt lgkmcnt(1)
  v_mfma_f32_16x16x32_bf16 v[160:163], v[96:99], v[88:91], v[160:163]
  ds_read_b128 v[80:83], v40 offset:40960
  v_mfma_f32_16x16x32_bf16 v[164:167], v[100:103], v[88:91], v[164:167]
  ds_read_b64_tr_b16 v[112:113], v42 offset:36864
  v_mfma_f32_16x16x32_bf16 v[168:171], v[104:107], v[88:91], v[168:171]
  v_mfma_f32_16x16x32_bf16 v[172:175], v[108:111], v[88:91], v[172:175]
  ds_read_b64_tr_b16 v[114:115], v42 offset:37376
  s_waitcnt lgkmcnt(3)
  v_mfma_f32_16x16x32_bf16 v[188:191], v[108:111], v[92:95], v[188:191]
  ds_read_b128 v[84:87], v40 offset:43008
  v_mfma_f32_16x16x32_bf16 v[184:187], v[104:107], v[92:95], v[184:187]
  ds_read_b64_tr_b16 v[116:117], v43 offset:36864
  v_mfma_f32_16x16x32_bf16 v[180:183], v[100:103], v[92:95], v[180:183]
  v_mfma_f32_16x16x32_bf16 v[176:179], v[96:99], v[92:95], v[176:179]
  ds_read_b64_tr_b16 v[118:119], v43 offset:37376
  s_waitcnt lgkmcnt(5)
  v_mfma_f32_16x16x32_bf16 v[192:195], v[96:99], v[80:83], v[192:195]
  ds_read_b128 v[88:91], v40 offset:45056
  v_mfma_f32_16x16x32_bf16 v[196:199], v[100:103], v[80:83], v[196:199]
  ds_read_b64_tr_b16 v[120:121], v44 offset:36864
  v_mfma_f32_16x16x32_bf16 v[200:203], v[104:107], v[80:83], v[200:203]
  v_mfma_f32_16x16x32_bf16 v[204:207], v[108:111], v[80:83], v[204:207]
  ds_read_b64_tr_b16 v[122:123], v44 offset:37376
  s_waitcnt lgkmcnt(5)
  v_mfma_f32_16x16x32_bf16 v[220:223], v[108:111], v[84:87], v[220:223]
  ds_read_b128 v[92:95], v40 offset:47104
  v_mfma_f32_16x16x32_bf16 v[216:219], v[104:107], v[84:87], v[216:219]
  ds_read_b64_tr_b16 v[124:125], v45 offset:36864
  v_mfma_f32_16x16x32_bf16 v[212:215], v[100:103], v[84:87], v[212:215]
  v_mfma_f32_16x16x32_bf16 v[208:211], v[96:99], v[84:87], v[208:211]
  ds_read_b64_tr_b16 v[126:127], v45 offset:37376
  s_waitcnt lgkmcnt(5)
  v_mfma_f32_16x16x32_bf16 v[224:227], v[96:99], v[88:91], v[224:227]
  ds_read_b128 v[80:83], v41 offset:32768
  v_mfma_f32_16x16x32_bf16 v[228:231], v[100:103], v[88:91], v[228:231]
  v_mfma_f32_16x16x32_bf16 v[232:235], v[104:107], v[88:91], v[232:235]
  v_mfma_f32_16x16x32_bf16 v[236:239], v[108:111], v[88:91], v[236:239]
  s_waitcnt lgkmcnt(3)
  v_mfma_f32_16x16x32_bf16 v[252:255], v[108:111], v[92:95], v[252:255]
  ds_read_b128 v[84:87], v41 offset:34816
  v_mfma_f32_16x16x32_bf16 v[248:251], v[104:107], v[92:95], v[248:251]
  v_mfma_f32_16x16x32_bf16 v[244:247], v[100:103], v[92:95], v[244:247]
  v_mfma_f32_16x16x32_bf16 v[240:243], v[96:99], v[92:95], v[240:243]
  s_waitcnt lgkmcnt(1)
  v_mfma_f32_16x16x32_bf16 v[128:131], v[112:115], v[80:83], v[128:131]
  ds_read_b128 v[88:91], v41 offset:36864
  v_mfma_f32_16x16x32_bf16 v[132:135], v[116:119], v[80:83], v[132:135]
  v_mfma_f32_16x16x32_bf16 v[136:139], v[120:123], v[80:83], v[136:139]
  v_mfma_f32_16x16x32_bf16 v[140:143], v[124:127], v[80:83], v[140:143]
  s_waitcnt lgkmcnt(1)
  v_mfma_f32_16x16x32_bf16 v[156:159], v[124:127], v[84:87], v[156:159]
  ds_read_b128 v[92:95], v41 offset:38912
  v_mfma_f32_16x16x32_bf16 v[152:155], v[120:123], v[84:87], v[152:155]
  v_mfma_f32_16x16x32_bf16 v[148:151], v[116:119], v[84:87], v[148:151]
  v_mfma_f32_16x16x32_bf16 v[144:147], v[112:115], v[84:87], v[144:147]
  v_cvt_pk_bf16_f32 v128, v128, v129
  v_cvt_pk_bf16_f32 v129, v130, v131
  s_waitcnt lgkmcnt(1)
  v_mfma_f32_16x16x32_bf16 v[160:163], v[112:115], v[88:91], v[160:163]
  ds_read_b128 v[80:83], v41 offset:40960
  v_cvt_pk_bf16_f32 v130, v132, v133
  v_mfma_f32_16x16x32_bf16 v[164:167], v[116:119], v[88:91], v[164:167]
  v_cvt_pk_bf16_f32 v131, v134, v135
  buffer_store_dwordx4 v[128:131], v16, s[12:15], s70 offen offset:0 sc1
  v_mfma_f32_16x16x32_bf16 v[168:171], v[120:123], v[88:91], v[168:171]
  v_cvt_pk_bf16_f32 v136, v136, v137
  v_cvt_pk_bf16_f32 v137, v138, v139
  v_mfma_f32_16x16x32_bf16 v[172:175], v[124:127], v[88:91], v[172:175]
  v_cvt_pk_bf16_f32 v138, v140, v141
  v_cvt_pk_bf16_f32 v139, v142, v143
  s_waitcnt lgkmcnt(1)
  v_mfma_f32_16x16x32_bf16 v[188:191], v[124:127], v[92:95], v[188:191]
  ds_read_b128 v[84:87], v41 offset:43008
  buffer_store_dwordx4 v[136:139], v16, s[12:15], s70 offen offset:1024 sc1
  s_add_u32 s70, s70, 8192
  v_mfma_f32_16x16x32_bf16 v[184:187], v[120:123], v[92:95], v[184:187]
  v_cvt_pk_bf16_f32 v144, v144, v145
  v_cvt_pk_bf16_f32 v145, v146, v147
  v_mfma_f32_16x16x32_bf16 v[180:183], v[116:119], v[92:95], v[180:183]
  v_cvt_pk_bf16_f32 v146, v148, v149
  v_cvt_pk_bf16_f32 v147, v150, v151
  v_mfma_f32_16x16x32_bf16 v[176:179], v[112:115], v[92:95], v[176:179]
  buffer_store_dwordx4 v[144:147], v16, s[12:15], s71 offen offset:0 sc1
  v_cvt_pk_bf16_f32 v152, v152, v153
  s_waitcnt lgkmcnt(1)
  v_mfma_f32_16x16x32_bf16 v[192:195], v[112:115], v[80:83], v[192:195]
  ds_read_b128 v[88:91], v41 offset:45056
  v_cvt_pk_bf16_f32 v153, v154, v155
  v_mfma_f32_16x16x32_bf16 v[196:199], v[116:119], v[80:83], v[196:199]
  v_cvt_pk_bf16_f32 v154, v156, v157
  v_cvt_pk_bf16_f32 v155, v158, v159
  v_mfma_f32_16x16x32_bf16 v[200:203], v[120:123], v[80:83], v[200:203]
  buffer_store_dwordx4 v[152:155], v16, s[12:15], s71 offen offset:1024 sc1
  s_add_u32 s71, s71, 8192
  v_cvt_pk_bf16_f32 v160, v160, v161
  v_mfma_f32_16x16x32_bf16 v[204:207], v[124:127], v[80:83], v[204:207]
  v_cvt_pk_bf16_f32 v161, v162, v163
  v_cvt_pk_bf16_f32 v162, v164, v165
  s_waitcnt lgkmcnt(1)
  v_mfma_f32_16x16x32_bf16 v[220:223], v[124:127], v[84:87], v[220:223]
  ds_read_b128 v[92:95], v41 offset:47104
  v_cvt_pk_bf16_f32 v163, v166, v167
  v_mfma_f32_16x16x32_bf16 v[216:219], v[120:123], v[84:87], v[216:219]
  v_cvt_pk_bf16_f32 v168, v168, v169
  v_cvt_pk_bf16_f32 v169, v170, v171
  v_mfma_f32_16x16x32_bf16 v[212:215], v[116:119], v[84:87], v[212:215]
  v_cvt_pk_bf16_f32 v170, v172, v173
  v_cvt_pk_bf16_f32 v171, v174, v175
  v_mfma_f32_16x16x32_bf16 v[208:211], v[112:115], v[84:87], v[208:211]
  v_cvt_pk_bf16_f32 v176, v176, v177
  v_cvt_pk_bf16_f32 v177, v178, v179
  s_waitcnt lgkmcnt(0)
  s_barrier
  v_mfma_f32_16x16x32_bf16 v[224:227], v[112:115], v[88:91], v[224:227]
  ds_read_b64_tr_b16 v[80:81], v27 offset:0
  ds_read_b64_tr_b16 v[82:83], v27 offset:512
  v_cvt_pk_bf16_f32 v178, v180, v181
  v_mfma_f32_16x16x32_bf16 v[228:231], v[116:119], v[88:91], v[228:231]
  ds_read_b128 v[96:99], v23 offset:0
  ds_read_b128 v[100:103], v23 offset:2048
  v_cvt_pk_bf16_f32 v179, v182, v183
  v_mfma_f32_16x16x32_bf16 v[232:235], v[120:123], v[88:91], v[232:235]
  ds_read_b128 v[104:107], v25 offset:0
  ds_read_b128 v[108:111], v25 offset:2048
  v_cvt_pk_bf16_f32 v184, v184, v185
  v_mfma_f32_16x16x32_bf16 v[236:239], v[124:127], v[88:91], v[236:239]
  ds_read_b64_tr_b16 v[84:85], v28 offset:0
  ds_read_b64_tr_b16 v[86:87], v28 offset:512
  v_cvt_pk_bf16_f32 v185, v186, v187
  v_mfma_f32_16x16x32_bf16 v[252:255], v[124:127], v[92:95], v[252:255]
  v_cvt_pk_bf16_f32 v186, v188, v189
  v_cvt_pk_bf16_f32 v187, v190, v191
  v_mfma_f32_16x16x32_bf16 v[248:251], v[120:123], v[92:95], v[248:251]
  v_mfma_f32_16x16x32_bf16 v[244:247], v[116:119], v[92:95], v[244:247]
  v_mfma_f32_16x16x32_bf16 v[240:243], v[112:115], v[92:95], v[240:243]
  s_branch F_QB
F_VB:
  s_waitcnt lgkmcnt(0)
  s_barrier
  ds_read_b128 v[80:83], v40 offset:0
  ds_read_b64_tr_b16 v[96:97], v42 offset:0
  ds_read_b64_tr_b16 v[98:99], v42 offset:512
  ds_read_b64_tr_b16 v[100:101], v43 offset:0
  ds_read_b64_tr_b16 v[102:103], v43 offset:512
  ds_read_b64_tr_b16 v[104:105], v44 offset:0
  ds_read_b64_tr_b16 v[106:107], v44 offset:512
  ds_read_b64_tr_b16 v[108:109], v45 offset:0
  ds_read_b64_tr_b16 v[110:111], v45 offset:512
  ds_read_b128 v[84:87], v40 offset:2048
  s_waitcnt lgkmcnt(7)
  v_mfma_f32_16x16x32_bf16 v[128:131], v[80:83], v[96:99], 0
  ds_read_b128 v[88:91], v40 offset:4096
  s_waitcnt lgkmcnt(6)
  v_mfma_f32_16x16x32_bf16 v[136:139], v[80:83], v[100:103], 0
  s_waitcnt lgkmcnt(4)
  v_mfma_f32_16x16x32_bf16 v[144:147], v[80:83], v[104:107], 0
  s_getpc_b64 s[34:35]
F_PC4:
  s_sub_u32 s34, s34, F_PC4-gated_mix__compressed_kv_cla__geglu_ffn__prompt_kernel
  s_subb_u32 s35, s35, 0
  s_lshl_b32 s33, s30, 12
  v_bfe_u32 v12, v16, 4, 5
  v_lshlrev_b32 v12, 7, v12
  v_add_u32 v12, s33, v12
  v_min_u32 v12, F_END-gated_mix__compressed_kv_cla__geglu_ffn__prompt_kernel, v12
  global_load_dword v13, v12, s[34:35]
  s_waitcnt lgkmcnt(2)
  v_mfma_f32_16x16x32_bf16 v[152:155], v[80:83], v[108:111], 0
  s_waitcnt lgkmcnt(1)
  v_mfma_f32_16x16x32_bf16 v[156:159], v[84:87], v[108:111], 0
  ds_read_b128 v[92:95], v40 offset:6144
  s_cmp_lt_u32 s2, 7
  s_cbranch_scc0 F_NZx1
  s_cmp_eq_u32 s28, 4
  s_cbranch_scc0 F_NZx1
  s_lshl_b32 s33, s2, 13
  s_add_u32 s33, s33, 87031808
  v_lshlrev_b32 v6, 3, v16
  v_mov_b32 v7, 0
  buffer_store_dword v7, v6, s[12:15], s33 offen sc1
F_NZx1:
  s_mov_b32 s24, s56
  s_mov_b32 s25, s57
  s_mov_b32 s26, 1280
  s_mov_b32 s27, 0x20000
  v_mfma_f32_16x16x32_bf16 v[148:151], v[84:87], v[104:107], 0
  v_mfma_f32_16x16x32_bf16 v[140:143], v[84:87], v[100:103], 0
  s_lshl_b32 s33, s29, 2
  s_add_u32 s33, s33, s32
  s_sub_u32 s34, 15, s31
  s_sub_u32 s35, s31, 1
  s_cmp_lt_u32 s33, 16
  s_cselect_b32 s34, s34, s35
  s_lshl_b32 s34, s34, 4
  s_add_u32 s34, s34, s33
  s_lshl_b32 s34, s34, 2
  s_add_u32 s34, s34, s28
  s_sub_u32 s34, s34, 4
  s_lshl_b32 s92, s34, 1
  s_mul_i32 s93, s92, 1280
  v_bfe_u32 v6, v16, 4, 5
  v_lshrrev_b32 v7, 9, v16
  v_lshlrev_b32 v8, 4, v6
  v_mul_u32_u24 v9, 1280, v7
  v_min_u32 v10, 15, v6
  v_lshlrev_b32 v10, 4, v10
  v_add_u32 v11, v9, v10
  v_add_u32 v9, v9, v8
  s_lshl_b32 s92, s92, 3
  s_add_u32 s92, s92, 58720256
  v_mfma_f32_16x16x32_bf16 v[132:135], v[84:87], v[96:99], 0
  s_waitcnt lgkmcnt(1)
  v_mfma_f32_16x16x32_bf16 v[160:163], v[88:91], v[96:99], 0
  ds_read_b128 v[80:83], v40 offset:8192
  buffer_load_dwordx4 v[56:59], v9, s[16:19], s93 offen offset:0
  v_mfma_f32_16x16x32_bf16 v[168:171], v[88:91], v[100:103], 0
  ds_read_b64_tr_b16 v[112:113], v42 offset:4096
  v_mfma_f32_16x16x32_bf16 v[176:179], v[88:91], v[104:107], 0
  buffer_load_dwordx4 v[68:71], v8, s[24:27], 0 offen offset:0
  v_mfma_f32_16x16x32_bf16 v[184:187], v[88:91], v[108:111], 0
  ds_read_b64_tr_b16 v[114:115], v42 offset:4608
  s_waitcnt lgkmcnt(3)
  v_mfma_f32_16x16x32_bf16 v[188:191], v[92:95], v[108:111], 0
  ds_read_b128 v[84:87], v40 offset:10240
  buffer_load_dwordx4 v[60:63], v9, s[16:19], s93 offen offset:512
  v_mfma_f32_16x16x32_bf16 v[180:183], v[92:95], v[104:107], 0
  ds_read_b64_tr_b16 v[116:117], v43 offset:4096
  v_mfma_f32_16x16x32_bf16 v[172:175], v[92:95], v[100:103], 0
  buffer_load_dwordx4 v[72:75], v8, s[24:27], 0 offen offset:512
  v_mfma_f32_16x16x32_bf16 v[164:167], v[92:95], v[96:99], 0
  ds_read_b64_tr_b16 v[118:119], v43 offset:4608
  s_waitcnt lgkmcnt(5)
  v_mfma_f32_16x16x32_bf16 v[192:195], v[80:83], v[96:99], 0
  ds_read_b128 v[88:91], v40 offset:12288
  buffer_load_dwordx4 v[64:67], v11, s[16:19], s93 offen offset:1024
  v_mfma_f32_16x16x32_bf16 v[200:203], v[80:83], v[100:103], 0
  ds_read_b64_tr_b16 v[120:121], v44 offset:4096
  v_mfma_f32_16x16x32_bf16 v[208:211], v[80:83], v[104:107], 0
  buffer_load_dwordx4 v[76:79], v10, s[24:27], 0 offen offset:1024
  v_mfma_f32_16x16x32_bf16 v[216:219], v[80:83], v[108:111], 0
  ds_read_b64_tr_b16 v[122:123], v44 offset:4608
  s_waitcnt lgkmcnt(5)
  v_mfma_f32_16x16x32_bf16 v[220:223], v[84:87], v[108:111], 0
  ds_read_b128 v[92:95], v40 offset:14336
  s_mov_b32 s24, s60
  s_mov_b32 s25, s61
  s_mov_b32 s26, 256
  s_mov_b32 s27, 0x20000
  v_mfma_f32_16x16x32_bf16 v[212:215], v[84:87], v[104:107], 0
  ds_read_b64_tr_b16 v[124:125], v45 offset:4096
  v_mfma_f32_16x16x32_bf16 v[204:207], v[84:87], v[100:103], 0
  v_mfma_f32_16x16x32_bf16 v[196:199], v[84:87], v[96:99], 0
  ds_read_b64_tr_b16 v[126:127], v45 offset:4608
  s_waitcnt lgkmcnt(5)
  v_mfma_f32_16x16x32_bf16 v[224:227], v[88:91], v[96:99], 0
  ds_read_b128 v[80:83], v41 offset:0
  v_mfma_f32_16x16x32_bf16 v[232:235], v[88:91], v[100:103], 0
  v_mfma_f32_16x16x32_bf16 v[240:243], v[88:91], v[104:107], 0
  v_mfma_f32_16x16x32_bf16 v[248:251], v[88:91], v[108:111], 0
  s_waitcnt lgkmcnt(3)
  v_mfma_f32_16x16x32_bf16 v[252:255], v[92:95], v[108:111], 0
  ds_read_b128 v[84:87], v41 offset:2048
  v_mfma_f32_16x16x32_bf16 v[244:247], v[92:95], v[104:107], 0
  v_mfma_f32_16x16x32_bf16 v[236:239], v[92:95], v[100:103], 0
  v_mfma_f32_16x16x32_bf16 v[228:231], v[92:95], v[96:99], 0
  s_waitcnt lgkmcnt(1)
  v_mfma_f32_16x16x32_bf16 v[128:131], v[80:83], v[112:115], v[128:131]
  ds_read_b128 v[88:91], v41 offset:4096
  v_mfma_f32_16x16x32_bf16 v[136:139], v[80:83], v[116:119], v[136:139]
  v_mfma_f32_16x16x32_bf16 v[144:147], v[80:83], v[120:123], v[144:147]
  v_mfma_f32_16x16x32_bf16 v[152:155], v[80:83], v[124:127], v[152:155]
  s_waitcnt lgkmcnt(1)
  v_mfma_f32_16x16x32_bf16 v[156:159], v[84:87], v[124:127], v[156:159]
  ds_read_b128 v[92:95], v41 offset:6144
  v_mfma_f32_16x16x32_bf16 v[148:151], v[84:87], v[120:123], v[148:151]
  v_mfma_f32_16x16x32_bf16 v[140:143], v[84:87], v[116:119], v[140:143]
  v_mfma_f32_16x16x32_bf16 v[132:135], v[84:87], v[112:115], v[132:135]
  s_waitcnt lgkmcnt(1)
  v_mfma_f32_16x16x32_bf16 v[160:163], v[88:91], v[112:115], v[160:163]
  ds_read_b128 v[80:83], v41 offset:8192
  v_mfma_f32_16x16x32_bf16 v[168:171], v[88:91], v[116:119], v[168:171]
  v_mfma_f32_16x16x32_bf16 v[176:179], v[88:91], v[120:123], v[176:179]
  v_mfma_f32_16x16x32_bf16 v[184:187], v[88:91], v[124:127], v[184:187]
  s_waitcnt lgkmcnt(1)
  v_mfma_f32_16x16x32_bf16 v[188:191], v[92:95], v[124:127], v[188:191]
  ds_read_b128 v[84:87], v41 offset:10240
  s_add_u32 s75, s75, 1048576
  v_mfma_f32_16x16x32_bf16 v[180:183], v[92:95], v[120:123], v[180:183]
  buffer_load_dword v13, v2, s[4:7], s74 offen offset:512
  v_mfma_f32_16x16x32_bf16 v[172:175], v[92:95], v[116:119], v[172:175]
  v_mfma_f32_16x16x32_bf16 v[164:167], v[92:95], v[112:115], v[164:167]
  buffer_load_dword v13, v3, s[8:11], s75 offen
  s_waitcnt lgkmcnt(1)
  v_mfma_f32_16x16x32_bf16 v[192:195], v[80:83], v[112:115], v[192:195]
  ds_read_b128 v[88:91], v41 offset:12288
  v_mfma_f32_16x16x32_bf16 v[200:203], v[80:83], v[116:119], v[200:203]
  v_mfma_f32_16x16x32_bf16 v[208:211], v[80:83], v[120:123], v[208:211]
  s_mov_b32 s94, 0xffff0000
  v_cmp_gt_u32 vcc, 16, v6
  v_mfma_f32_16x16x32_bf16 v[216:219], v[80:83], v[124:127], v[216:219]
  s_waitcnt vmcnt(2)
  v_cndmask_b32 v76, 0, v76, vcc
  s_waitcnt lgkmcnt(1)
  v_mfma_f32_16x16x32_bf16 v[220:223], v[84:87], v[124:127], v[220:223]
  ds_read_b128 v[92:95], v41 offset:14336
  v_cndmask_b32 v77, 0, v77, vcc
  v_mfma_f32_16x16x32_bf16 v[212:215], v[84:87], v[120:123], v[212:215]
  v_cndmask_b32 v78, 0, v78, vcc
  v_mfma_f32_16x16x32_bf16 v[204:207], v[84:87], v[116:119], v[204:207]
  v_cndmask_b32 v79, 0, v79, vcc
  v_mfma_f32_16x16x32_bf16 v[196:199], v[84:87], v[112:115], v[196:199]
  v_lshlrev_b32 v8, 16, v56
  s_waitcnt lgkmcnt(0)
  s_barrier
  v_mfma_f32_16x16x32_bf16 v[224:227], v[88:91], v[112:115], v[224:227]
  ds_read_b128 v[80:83], v40 offset:32768
  ds_read_b64_tr_b16 v[96:97], v42 offset:32768
  v_lshlrev_b32 v9, 16, v68
  v_mfma_f32_16x16x32_bf16 v[232:235], v[88:91], v[116:119], v[232:235]
  ds_read_b64_tr_b16 v[98:99], v42 offset:33280
  ds_read_b64_tr_b16 v[100:101], v43 offset:32768
  v_and_b32 v56, s94, v56
  v_mfma_f32_16x16x32_bf16 v[240:243], v[88:91], v[120:123], v[240:243]
  ds_read_b64_tr_b16 v[102:103], v43 offset:33280
  ds_read_b64_tr_b16 v[104:105], v44 offset:32768
  v_and_b32 v68, s94, v68
  v_mfma_f32_16x16x32_bf16 v[248:251], v[88:91], v[124:127], v[248:251]
  ds_read_b64_tr_b16 v[106:107], v44 offset:33280
  ds_read_b64_tr_b16 v[108:109], v45 offset:32768
  v_mul_f32 v8, v8, v9
  v_mfma_f32_16x16x32_bf16 v[252:255], v[92:95], v[124:127], v[252:255]
  ds_read_b64_tr_b16 v[110:111], v45 offset:33280
  ds_read_b128 v[84:87], v40 offset:34816
  v_mul_f32 v9, v56, v68
  v_mfma_f32_16x16x32_bf16 v[244:247], v[92:95], v[120:123], v[244:247]
  v_cvt_pk_bf16_f32 v8, v8, v9
  v_mfma_f32_16x16x32_bf16 v[236:239], v[92:95], v[116:119], v[236:239]
  v_lshlrev_b32 v10, 16, v8
  v_mfma_f32_16x16x32_bf16 v[228:231], v[92:95], v[112:115], v[228:231]
  v_and_b32 v11, s94, v8
  s_waitcnt lgkmcnt(7)
  v_mfma_f32_16x16x32_bf16 v[128:131], v[80:83], v[96:99], v[128:131]
  ds_read_b128 v[88:91], v40 offset:36864
  v_lshlrev_b32 v8, 16, v57
  s_waitcnt lgkmcnt(6)
  v_mfma_f32_16x16x32_bf16 v[136:139], v[80:83], v[100:103], v[136:139]
  v_lshlrev_b32 v9, 16, v69
  s_waitcnt lgkmcnt(4)
  v_mfma_f32_16x16x32_bf16 v[144:147], v[80:83], v[104:107], v[144:147]
  v_and_b32 v57, s94, v57
  s_waitcnt lgkmcnt(2)
  v_mfma_f32_16x16x32_bf16 v[152:155], v[80:83], v[108:111], v[152:155]
  v_and_b32 v69, s94, v69
  s_waitcnt lgkmcnt(1)
  v_mfma_f32_16x16x32_bf16 v[156:159], v[84:87], v[108:111], v[156:159]
  ds_read_b128 v[92:95], v40 offset:38912
  v_mul_f32 v8, v8, v9
  v_mfma_f32_16x16x32_bf16 v[148:151], v[84:87], v[104:107], v[148:151]
  v_mul_f32 v9, v57, v69
  v_mfma_f32_16x16x32_bf16 v[140:143], v[84:87], v[100:103], v[140:143]
  v_cvt_pk_bf16_f32 v8, v8, v9
  v_mfma_f32_16x16x32_bf16 v[132:135], v[84:87], v[96:99], v[132:135]
  v_lshlrev_b32 v9, 16, v8
  s_waitcnt lgkmcnt(1)
  v_mfma_f32_16x16x32_bf16 v[160:163], v[88:91], v[96:99], v[160:163]
  ds_read_b128 v[80:83], v40 offset:40960
  v_and_b32 v8, s94, v8
  v_mfma_f32_16x16x32_bf16 v[168:171], v[88:91], v[100:103], v[168:171]
  ds_read_b64_tr_b16 v[112:113], v42 offset:36864
  v_add_f32 v10, v10, v9
  v_mfma_f32_16x16x32_bf16 v[176:179], v[88:91], v[104:107], v[176:179]
  v_add_f32 v11, v11, v8
  v_mfma_f32_16x16x32_bf16 v[184:187], v[88:91], v[108:111], v[184:187]
  ds_read_b64_tr_b16 v[114:115], v42 offset:37376
  v_lshlrev_b32 v8, 16, v58
  s_waitcnt lgkmcnt(3)
  v_mfma_f32_16x16x32_bf16 v[188:191], v[92:95], v[108:111], v[188:191]
  ds_read_b128 v[84:87], v40 offset:43008
  v_lshlrev_b32 v9, 16, v70
  v_mfma_f32_16x16x32_bf16 v[180:183], v[92:95], v[104:107], v[180:183]
  ds_read_b64_tr_b16 v[116:117], v43 offset:36864
  v_and_b32 v58, s94, v58
  v_mfma_f32_16x16x32_bf16 v[172:175], v[92:95], v[100:103], v[172:175]
  v_and_b32 v70, s94, v70
  v_mfma_f32_16x16x32_bf16 v[164:167], v[92:95], v[96:99], v[164:167]
  ds_read_b64_tr_b16 v[118:119], v43 offset:37376
  v_mul_f32 v8, v8, v9
  s_waitcnt lgkmcnt(5)
  v_mfma_f32_16x16x32_bf16 v[192:195], v[80:83], v[96:99], v[192:195]
  ds_read_b128 v[88:91], v40 offset:45056
  v_mul_f32 v9, v58, v70
  v_mfma_f32_16x16x32_bf16 v[200:203], v[80:83], v[100:103], v[200:203]
  ds_read_b64_tr_b16 v[120:121], v44 offset:36864
  v_cvt_pk_bf16_f32 v8, v8, v9
  v_mfma_f32_16x16x32_bf16 v[208:211], v[80:83], v[104:107], v[208:211]
  v_lshlrev_b32 v9, 16, v8
  v_mfma_f32_16x16x32_bf16 v[216:219], v[80:83], v[108:111], v[216:219]
  ds_read_b64_tr_b16 v[122:123], v44 offset:37376
  v_and_b32 v8, s94, v8
  s_waitcnt lgkmcnt(5)
  v_mfma_f32_16x16x32_bf16 v[220:223], v[84:87], v[108:111], v[220:223]
  ds_read_b128 v[92:95], v40 offset:47104
  v_add_f32 v10, v10, v9
  v_mfma_f32_16x16x32_bf16 v[212:215], v[84:87], v[104:107], v[212:215]
  ds_read_b64_tr_b16 v[124:125], v45 offset:36864
  v_add_f32 v11, v11, v8
  v_mfma_f32_16x16x32_bf16 v[204:207], v[84:87], v[100:103], v[204:207]
  v_lshlrev_b32 v8, 16, v59
  v_mfma_f32_16x16x32_bf16 v[196:199], v[84:87], v[96:99], v[196:199]
  ds_read_b64_tr_b16 v[126:127], v45 offset:37376
  v_lshlrev_b32 v9, 16, v71
  s_waitcnt lgkmcnt(5)
  v_mfma_f32_16x16x32_bf16 v[224:227], v[88:91], v[96:99], v[224:227]
  ds_read_b128 v[80:83], v41 offset:32768
  v_and_b32 v59, s94, v59
  v_mfma_f32_16x16x32_bf16 v[232:235], v[88:91], v[100:103], v[232:235]
  v_and_b32 v71, s94, v71
  v_mfma_f32_16x16x32_bf16 v[240:243], v[88:91], v[104:107], v[240:243]
  v_mul_f32 v8, v8, v9
  v_mfma_f32_16x16x32_bf16 v[248:251], v[88:91], v[108:111], v[248:251]
  v_mul_f32 v9, v59, v71
  s_waitcnt lgkmcnt(3)
  v_mfma_f32_16x16x32_bf16 v[252:255], v[92:95], v[108:111], v[252:255]
  ds_read_b128 v[84:87], v41 offset:34816
  v_cvt_pk_bf16_f32 v8, v8, v9
  v_mfma_f32_16x16x32_bf16 v[244:247], v[92:95], v[104:107], v[244:247]
  v_lshlrev_b32 v9, 16, v8
  v_mfma_f32_16x16x32_bf16 v[236:239], v[92:95], v[100:103], v[236:239]
  v_and_b32 v8, s94, v8
  v_mfma_f32_16x16x32_bf16 v[228:231], v[92:95], v[96:99], v[228:231]
  v_add_f32 v10, v10, v9
  s_waitcnt lgkmcnt(1)
  v_mfma_f32_16x16x32_bf16 v[128:131], v[80:83], v[112:115], v[128:131]
  ds_read_b128 v[88:91], v41 offset:36864
  v_add_f32 v11, v11, v8
  v_mfma_f32_16x16x32_bf16 v[136:139], v[80:83], v[116:119], v[136:139]
  v_lshlrev_b32 v8, 16, v60
  v_mfma_f32_16x16x32_bf16 v[144:147], v[80:83], v[120:123], v[144:147]
  v_lshlrev_b32 v9, 16, v72
  v_mfma_f32_16x16x32_bf16 v[152:155], v[80:83], v[124:127], v[152:155]
  v_and_b32 v60, s94, v60
  s_waitcnt lgkmcnt(1)
  v_mfma_f32_16x16x32_bf16 v[156:159], v[84:87], v[124:127], v[156:159]
  ds_read_b128 v[92:95], v41 offset:38912
  v_and_b32 v72, s94, v72
  v_mfma_f32_16x16x32_bf16 v[148:151], v[84:87], v[120:123], v[148:151]
  v_mul_f32 v8, v8, v9
  v_mfma_f32_16x16x32_bf16 v[140:143], v[84:87], v[116:119], v[140:143]
  v_mul_f32 v9, v60, v72
  v_mfma_f32_16x16x32_bf16 v[132:135], v[84:87], v[112:115], v[132:135]
  v_cvt_pk_bf16_f32 v8, v8, v9
  s_waitcnt lgkmcnt(1)
  v_mfma_f32_16x16x32_bf16 v[160:163], v[88:91], v[112:115], v[160:163]
  ds_read_b128 v[80:83], v41 offset:40960
  v_lshlrev_b32 v9, 16, v8
  v_mfma_f32_16x16x32_bf16 v[168:171], v[88:91], v[116:119], v[168:171]
  v_and_b32 v8, s94, v8
  v_mfma_f32_16x16x32_bf16 v[176:179], v[88:91], v[120:123], v[176:179]
  v_add_f32 v10, v10, v9
  v_mfma_f32_16x16x32_bf16 v[184:187], v[88:91], v[124:127], v[184:187]
  v_add_f32 v11, v11, v8
  s_waitcnt lgkmcnt(1)
  v_mfma_f32_16x16x32_bf16 v[188:191], v[92:95], v[124:127], v[188:191]
  ds_read_b128 v[84:87], v41 offset:43008
  s_add_u32 s75, s75, 1048576
  v_lshlrev_b32 v8, 16, v61
  v_mfma_f32_16x16x32_bf16 v[180:183], v[92:95], v[120:123], v[180:183]
  buffer_load_dword v13, v2, s[4:7], s74 offen offset:768
  v_mfma_f32_16x16x32_bf16 v[172:175], v[92:95], v[116:119], v[172:175]
  v_lshlrev_b32 v9, 16, v73
  v_and_b32 v61, s94, v61
  v_mfma_f32_16x16x32_bf16 v[164:167], v[92:95], v[112:115], v[164:167]
  buffer_load_dword v13, v3, s[8:11], s75 offen
  s_waitcnt lgkmcnt(1)
  v_mfma_f32_16x16x32_bf16 v[192:195], v[80:83], v[112:115], v[192:195]
  ds_read_b128 v[88:91], v41 offset:45056
  v_and_b32 v73, s94, v73
  v_mfma_f32_16x16x32_bf16 v[200:203], v[80:83], v[116:119], v[200:203]
  v_mul_f32 v8, v8, v9
  v_mul_f32 v9, v61, v73
  v_mfma_f32_16x16x32_bf16 v[208:211], v[80:83], v[120:123], v[208:211]
  v_cvt_pk_bf16_f32 v8, v8, v9
  v_mfma_f32_16x16x32_bf16 v[216:219], v[80:83], v[124:127], v[216:219]
  v_lshlrev_b32 v9, 16, v8
  s_waitcnt lgkmcnt(1)
  v_mfma_f32_16x16x32_bf16 v[220:223], v[84:87], v[124:127], v[220:223]
  ds_read_b128 v[92:95], v41 offset:47104
  v_and_b32 v8, s94, v8
  v_mfma_f32_16x16x32_bf16 v[212:215], v[84:87], v[120:123], v[212:215]
  v_add_f32 v10, v10, v9
  v_mfma_f32_16x16x32_bf16 v[204:207], v[84:87], v[116:119], v[204:207]
  v_add_f32 v11, v11, v8
  v_mfma_f32_16x16x32_bf16 v[196:199], v[84:87], v[112:115], v[196:199]
  v_lshlrev_b32 v8, 16, v62
  s_waitcnt lgkmcnt(0)
  s_barrier
  v_mfma_f32_16x16x32_bf16 v[224:227], v[88:91], v[112:115], v[224:227]
  ds_read_b128 v[80:83], v40 offset:0
  ds_read_b64_tr_b16 v[96:97], v42 offset:0
  v_lshlrev_b32 v9, 16, v74
  v_mfma_f32_16x16x32_bf16 v[232:235], v[88:91], v[116:119], v[232:235]
  ds_read_b64_tr_b16 v[98:99], v42 offset:512
  ds_read_b64_tr_b16 v[100:101], v43 offset:0
  v_and_b32 v62, s94, v62
  v_mfma_f32_16x16x32_bf16 v[240:243], v[88:91], v[120:123], v[240:243]
  ds_read_b64_tr_b16 v[102:103], v43 offset:512
  ds_read_b64_tr_b16 v[104:105], v44 offset:0
  v_and_b32 v74, s94, v74
  v_mfma_f32_16x16x32_bf16 v[248:251], v[88:91], v[124:127], v[248:251]
  ds_read_b64_tr_b16 v[106:107], v44 offset:512
  ds_read_b64_tr_b16 v[108:109], v45 offset:0
  v_mul_f32 v8, v8, v9
  v_mfma_f32_16x16x32_bf16 v[252:255], v[92:95], v[124:127], v[252:255]
  ds_read_b64_tr_b16 v[110:111], v45 offset:512
  ds_read_b128 v[84:87], v40 offset:2048
  v_mul_f32 v9, v62, v74
  v_mfma_f32_16x16x32_bf16 v[244:247], v[92:95], v[120:123], v[244:247]
  v_cvt_pk_bf16_f32 v8, v8, v9
  v_mfma_f32_16x16x32_bf16 v[236:239], v[92:95], v[116:119], v[236:239]
  v_lshlrev_b32 v9, 16, v8
  v_mfma_f32_16x16x32_bf16 v[228:231], v[92:95], v[112:115], v[228:231]
  v_and_b32 v8, s94, v8
  s_waitcnt lgkmcnt(7)
  v_mfma_f32_16x16x32_bf16 v[128:131], v[80:83], v[96:99], v[128:131]
  ds_read_b128 v[88:91], v40 offset:4096
  v_add_f32 v10, v10, v9
  s_waitcnt lgkmcnt(6)
  v_mfma_f32_16x16x32_bf16 v[136:139], v[80:83], v[100:103], v[136:139]
  v_add_f32 v11, v11, v8
  s_waitcnt lgkmcnt(4)
  v_mfma_f32_16x16x32_bf16 v[144:147], v[80:83], v[104:107], v[144:147]
  v_lshlrev_b32 v8, 16, v63
  s_waitcnt lgkmcnt(2)
  v_mfma_f32_16x16x32_bf16 v[152:155], v[80:83], v[108:111], v[152:155]
  v_lshlrev_b32 v9, 16, v75
  s_waitcnt lgkmcnt(1)
  v_mfma_f32_16x16x32_bf16 v[156:159], v[84:87], v[108:111], v[156:159]
  ds_read_b128 v[92:95], v40 offset:6144
  v_and_b32 v63, s94, v63
  v_mfma_f32_16x16x32_bf16 v[148:151], v[84:87], v[104:107], v[148:151]
  v_and_b32 v75, s94, v75
  v_mfma_f32_16x16x32_bf16 v[140:143], v[84:87], v[100:103], v[140:143]
  v_mul_f32 v8, v8, v9
  v_mfma_f32_16x16x32_bf16 v[132:135], v[84:87], v[96:99], v[132:135]
  v_mul_f32 v9, v63, v75
  s_waitcnt lgkmcnt(1)
  v_mfma_f32_16x16x32_bf16 v[160:163], v[88:91], v[96:99], v[160:163]
  ds_read_b128 v[80:83], v40 offset:8192
  v_cvt_pk_bf16_f32 v8, v8, v9
  v_mfma_f32_16x16x32_bf16 v[168:171], v[88:91], v[100:103], v[168:171]
  ds_read_b64_tr_b16 v[112:113], v42 offset:4096
  v_lshlrev_b32 v9, 16, v8
  v_mfma_f32_16x16x32_bf16 v[176:179], v[88:91], v[104:107], v[176:179]
  v_and_b32 v8, s94, v8
  v_mfma_f32_16x16x32_bf16 v[184:187], v[88:91], v[108:111], v[184:187]
  ds_read_b64_tr_b16 v[114:115], v42 offset:4608
  v_add_f32 v10, v10, v9
  s_waitcnt lgkmcnt(3)
  v_mfma_f32_16x16x32_bf16 v[188:191], v[92:95], v[108:111], v[188:191]
  ds_read_b128 v[84:87], v40 offset:10240
  v_add_f32 v11, v11, v8
  v_mfma_f32_16x16x32_bf16 v[180:183], v[92:95], v[104:107], v[180:183]
  ds_read_b64_tr_b16 v[116:117], v43 offset:4096
  v_lshlrev_b32 v8, 16, v64
  v_mfma_f32_16x16x32_bf16 v[172:175], v[92:95], v[100:103], v[172:175]
  v_lshlrev_b32 v9, 16, v76
  v_mfma_f32_16x16x32_bf16 v[164:167], v[92:95], v[96:99], v[164:167]
  ds_read_b64_tr_b16 v[118:119], v43 offset:4608
  v_and_b32 v64, s94, v64
  s_waitcnt lgkmcnt(5)
  v_mfma_f32_16x16x32_bf16 v[192:195], v[80:83], v[96:99], v[192:195]
  ds_read_b128 v[88:91], v40 offset:12288
  v_and_b32 v76, s94, v76
  v_mfma_f32_16x16x32_bf16 v[200:203], v[80:83], v[100:103], v[200:203]
  ds_read_b64_tr_b16 v[120:121], v44 offset:4096
  v_mul_f32 v8, v8, v9
  v_mfma_f32_16x16x32_bf16 v[208:211], v[80:83], v[104:107], v[208:211]
  v_mul_f32 v9, v64, v76
  v_mfma_f32_16x16x32_bf16 v[216:219], v[80:83], v[108:111], v[216:219]
  ds_read_b64_tr_b16 v[122:123], v44 offset:4608
  v_cvt_pk_bf16_f32 v8, v8, v9
  s_waitcnt lgkmcnt(5)
  v_mfma_f32_16x16x32_bf16 v[220:223], v[84:87], v[108:111], v[220:223]
  ds_read_b128 v[92:95], v40 offset:14336
  v_lshlrev_b32 v9, 16, v8
  v_mfma_f32_16x16x32_bf16 v[212:215], v[84:87], v[104:107], v[212:215]
  ds_read_b64_tr_b16 v[124:125], v45 offset:4096
  v_and_b32 v8, s94, v8
  v_mfma_f32_16x16x32_bf16 v[204:207], v[84:87], v[100:103], v[204:207]
  v_add_f32 v10, v10, v9
  v_mfma_f32_16x16x32_bf16 v[196:199], v[84:87], v[96:99], v[196:199]
  ds_read_b64_tr_b16 v[126:127], v45 offset:4608
  v_add_f32 v11, v11, v8
  s_waitcnt lgkmcnt(5)
  v_mfma_f32_16x16x32_bf16 v[224:227], v[88:91], v[96:99], v[224:227]
  ds_read_b128 v[80:83], v41 offset:0
  v_lshlrev_b32 v8, 16, v65
  v_mfma_f32_16x16x32_bf16 v[232:235], v[88:91], v[100:103], v[232:235]
  v_lshlrev_b32 v9, 16, v77
  v_mfma_f32_16x16x32_bf16 v[240:243], v[88:91], v[104:107], v[240:243]
  v_and_b32 v65, s94, v65
  v_mfma_f32_16x16x32_bf16 v[248:251], v[88:91], v[108:111], v[248:251]
  v_and_b32 v77, s94, v77
  s_waitcnt lgkmcnt(3)
  v_mfma_f32_16x16x32_bf16 v[252:255], v[92:95], v[108:111], v[252:255]
  ds_read_b128 v[84:87], v41 offset:2048
  v_mul_f32 v8, v8, v9
  v_mfma_f32_16x16x32_bf16 v[244:247], v[92:95], v[104:107], v[244:247]
  v_mul_f32 v9, v65, v77
  v_mfma_f32_16x16x32_bf16 v[236:239], v[92:95], v[100:103], v[236:239]
  v_cvt_pk_bf16_f32 v8, v8, v9
  v_mfma_f32_16x16x32_bf16 v[228:231], v[92:95], v[96:99], v[228:231]
  v_lshlrev_b32 v9, 16, v8
  s_waitcnt lgkmcnt(1)
  v_mfma_f32_16x16x32_bf16 v[128:131], v[80:83], v[112:115], v[128:131]
  ds_read_b128 v[88:91], v41 offset:4096
  v_and_b32 v8, s94, v8
  v_mfma_f32_16x16x32_bf16 v[136:139], v[80:83], v[116:119], v[136:139]
  v_add_f32 v10, v10, v9
  v_mfma_f32_16x16x32_bf16 v[144:147], v[80:83], v[120:123], v[144:147]
  v_add_f32 v11, v11, v8
  v_mfma_f32_16x16x32_bf16 v[152:155], v[80:83], v[124:127], v[152:155]
  v_lshlrev_b32 v8, 16, v66
  s_waitcnt lgkmcnt(1)
  v_mfma_f32_16x16x32_bf16 v[156:159], v[84:87], v[124:127], v[156:159]
  ds_read_b128 v[92:95], v41 offset:6144
  v_lshlrev_b32 v9, 16, v78
  v_mfma_f32_16x16x32_bf16 v[148:151], v[84:87], v[120:123], v[148:151]
  v_and_b32 v66, s94, v66
  v_mfma_f32_16x16x32_bf16 v[140:143], v[84:87], v[116:119], v[140:143]
  v_and_b32 v78, s94, v78
  v_mfma_f32_16x16x32_bf16 v[132:135], v[84:87], v[112:115], v[132:135]
  v_mul_f32 v8, v8, v9
  s_waitcnt lgkmcnt(1)
  v_mfma_f32_16x16x32_bf16 v[160:163], v[88:91], v[112:115], v[160:163]
  ds_read_b128 v[80:83], v41 offset:8192
  v_mul_f32 v9, v66, v78
  v_mfma_f32_16x16x32_bf16 v[168:171], v[88:91], v[116:119], v[168:171]
  v_cvt_pk_bf16_f32 v8, v8, v9
  v_mfma_f32_16x16x32_bf16 v[176:179], v[88:91], v[120:123], v[176:179]
  v_lshlrev_b32 v9, 16, v8
  v_mfma_f32_16x16x32_bf16 v[184:187], v[88:91], v[124:127], v[184:187]
  v_and_b32 v8, s94, v8
  s_waitcnt lgkmcnt(1)
  v_mfma_f32_16x16x32_bf16 v[188:191], v[92:95], v[124:127], v[188:191]
  ds_read_b128 v[84:87], v41 offset:10240
  v_add_f32 v10, v10, v9
  v_mfma_f32_16x16x32_bf16 v[180:183], v[92:95], v[120:123], v[180:183]
  v_add_f32 v11, v11, v8
  v_mfma_f32_16x16x32_bf16 v[172:175], v[92:95], v[116:119], v[172:175]
  v_lshlrev_b32 v8, 16, v67
  v_mfma_f32_16x16x32_bf16 v[164:167], v[92:95], v[112:115], v[164:167]
  v_lshlrev_b32 v9, 16, v79
  s_waitcnt lgkmcnt(1)
  v_mfma_f32_16x16x32_bf16 v[192:195], v[80:83], v[112:115], v[192:195]
  ds_read_b128 v[88:91], v41 offset:12288
  v_and_b32 v67, s94, v67
  v_mfma_f32_16x16x32_bf16 v[200:203], v[80:83], v[116:119], v[200:203]
  v_and_b32 v79, s94, v79
  v_mfma_f32_16x16x32_bf16 v[208:211], v[80:83], v[120:123], v[208:211]
  v_mul_f32 v8, v8, v9
  v_mfma_f32_16x16x32_bf16 v[216:219], v[80:83], v[124:127], v[216:219]
  v_mul_f32 v9, v67, v79
  s_waitcnt lgkmcnt(1)
  v_mfma_f32_16x16x32_bf16 v[220:223], v[84:87], v[124:127], v[220:223]
  ds_read_b128 v[92:95], v41 offset:14336
  v_cvt_pk_bf16_f32 v8, v8, v9
  v_mfma_f32_16x16x32_bf16 v[212:215], v[84:87], v[120:123], v[212:215]
  v_lshlrev_b32 v9, 16, v8
  v_mfma_f32_16x16x32_bf16 v[204:207], v[84:87], v[116:119], v[204:207]
  v_and_b32 v8, s94, v8
  v_mfma_f32_16x16x32_bf16 v[196:199], v[84:87], v[112:115], v[196:199]
  v_add_f32 v10, v10, v9
  s_waitcnt lgkmcnt(0)
  s_barrier
  v_mfma_f32_16x16x32_bf16 v[224:227], v[88:91], v[112:115], v[224:227]
  ds_read_b128 v[80:83], v40 offset:32768
  ds_read_b64_tr_b16 v[96:97], v42 offset:32768
  v_add_f32 v11, v11, v8
  v_mfma_f32_16x16x32_bf16 v[232:235], v[88:91], v[116:119], v[232:235]
  ds_read_b64_tr_b16 v[98:99], v42 offset:33280
  ds_read_b64_tr_b16 v[100:101], v43 offset:32768
  v_add_f32 v10, v10, v11
  v_mfma_f32_16x16x32_bf16 v[240:243], v[88:91], v[120:123], v[240:243]
  ds_read_b64_tr_b16 v[102:103], v43 offset:33280
  ds_read_b64_tr_b16 v[104:105], v44 offset:32768
  v_add_f32_dpp v10, v10, v10 quad_perm:[1,0,3,2] row_mask:0xf bank_mask:0xf
  v_mfma_f32_16x16x32_bf16 v[248:251], v[88:91], v[124:127], v[248:251]
  ds_read_b64_tr_b16 v[106:107], v44 offset:33280
  ds_read_b64_tr_b16 v[108:109], v45 offset:32768
  v_add_f32_dpp v10, v10, v10 quad_perm:[2,3,0,1] row_mask:0xf bank_mask:0xf
  v_mfma_f32_16x16x32_bf16 v[252:255], v[92:95], v[124:127], v[252:255]
  ds_read_b64_tr_b16 v[110:111], v45 offset:33280
  ds_read_b128 v[84:87], v40 offset:34816
  v_add_f32_dpp v10, v10, v10 row_half_mirror row_mask:0xf bank_mask:0xf
  v_mfma_f32_16x16x32_bf16 v[244:247], v[92:95], v[120:123], v[244:247]
  s_nop 0
  v_add_f32_dpp v10, v10, v10 row_mirror row_mask:0xf bank_mask:0xf
  v_mfma_f32_16x16x32_bf16 v[236:239], v[92:95], v[116:119], v[236:239]
  v_mov_b32 v11, v10
  v_mfma_f32_16x16x32_bf16 v[228:231], v[92:95], v[112:115], v[228:231]
  s_nop 0
  v_permlane16_swap_b32 v10, v11
  s_waitcnt lgkmcnt(7)
  v_mfma_f32_16x16x32_bf16 v[128:131], v[80:83], v[96:99], v[128:131]
  ds_read_b128 v[88:91], v40 offset:36864
  v_add_f32 v10, v10, v11
  s_waitcnt lgkmcnt(6)
  v_mfma_f32_16x16x32_bf16 v[136:139], v[80:83], v[100:103], v[136:139]
  v_cvt_pk_bf16_f32 v10, v10, v10
  s_waitcnt lgkmcnt(4)
  v_mfma_f32_16x16x32_bf16 v[144:147], v[80:83], v[104:107], v[144:147]
  v_lshlrev_b32 v10, 16, v10
  s_waitcnt lgkmcnt(2)
  v_mfma_f32_16x16x32_bf16 v[152:155], v[80:83], v[108:111], v[152:155]
  v_mul_f32 v10, 0xbfb8aa3b, v10
  s_waitcnt lgkmcnt(1)
  v_mfma_f32_16x16x32_bf16 v[156:159], v[84:87], v[108:111], v[156:159]
  ds_read_b128 v[92:95], v40 offset:38912
  v_exp_f32 v10, v10
  v_mfma_f32_16x16x32_bf16 v[148:151], v[84:87], v[104:107], v[148:151]
  v_add_f32 v10, 1.0, v10
  v_mfma_f32_16x16x32_bf16 v[140:143], v[84:87], v[100:103], v[140:143]
  v_rcp_f32 v10, v10
  v_mfma_f32_16x16x32_bf16 v[132:135], v[84:87], v[96:99], v[132:135]
  v_cvt_pk_bf16_f32 v10, v10, v10
  s_waitcnt lgkmcnt(1)
  v_mfma_f32_16x16x32_bf16 v[160:163], v[88:91], v[96:99], v[160:163]
  ds_read_b128 v[80:83], v40 offset:40960
  v_lshlrev_b32 v10, 16, v10
  v_mfma_f32_16x16x32_bf16 v[168:171], v[88:91], v[100:103], v[168:171]
  ds_read_b64_tr_b16 v[112:113], v42 offset:36864
  v_sub_f32 v11, 1.0, v10
  v_mfma_f32_16x16x32_bf16 v[176:179], v[88:91], v[104:107], v[176:179]
  v_cvt_pk_bf16_f32 v11, v11, v11
  v_mfma_f32_16x16x32_bf16 v[184:187], v[88:91], v[108:111], v[184:187]
  ds_read_b64_tr_b16 v[114:115], v42 offset:37376
  v_lshlrev_b32 v11, 16, v11
  s_waitcnt lgkmcnt(3)
  v_mfma_f32_16x16x32_bf16 v[188:191], v[92:95], v[108:111], v[188:191]
  ds_read_b128 v[84:87], v40 offset:43008
  v_lshlrev_b32 v7, 3, v7
  v_mfma_f32_16x16x32_bf16 v[180:183], v[92:95], v[104:107], v[180:183]
  ds_read_b64_tr_b16 v[116:117], v43 offset:36864
  v_mov_b32 v9, 1
  v_mfma_f32_16x16x32_bf16 v[172:175], v[92:95], v[100:103], v[172:175]
  v_cmp_eq_u32 vcc, 0, v6
  v_mfma_f32_16x16x32_bf16 v[164:167], v[92:95], v[96:99], v[164:167]
  ds_read_b64_tr_b16 v[118:119], v43 offset:37376
  s_waitcnt lgkmcnt(5)
  v_mfma_f32_16x16x32_bf16 v[192:195], v[80:83], v[96:99], v[192:195]
  ds_read_b128 v[88:91], v40 offset:45056
  s_mov_b64 exec, vcc
  buffer_store_dwordx2 v[10:11], v7, s[12:15], s92 offen sc1
  s_mov_b64 exec, -1
  s_lshl_b32 s93, s2, 3
  s_add_u32 s93, s93, s28
  s_and_b32 s94, s93, 3
  s_cmp_lt_u32 s93, 56
  s_cselect_b32 s94, s94, 1
  s_cmp_eq_u32 s94, 0
  s_cbranch_scc0 F_NZ1
  s_mov_b64 exec, 1
  buffer_atomic_add v9, off, s[24:27], 0 sc1
  s_mov_b64 exec, -1
F_NZ1:
  v_mfma_f32_16x16x32_bf16 v[200:203], v[80:83], v[100:103], v[200:203]
  ds_read_b64_tr_b16 v[120:121], v44 offset:36864
  v_mfma_f32_16x16x32_bf16 v[208:211], v[80:83], v[104:107], v[208:211]
  v_mfma_f32_16x16x32_bf16 v[216:219], v[80:83], v[108:111], v[216:219]
  ds_read_b64_tr_b16 v[122:123], v44 offset:37376
  s_waitcnt lgkmcnt(5)
  v_mfma_f32_16x16x32_bf16 v[220:223], v[84:87], v[108:111], v[220:223]
  ds_read_b128 v[92:95], v40 offset:47104
  v_mfma_f32_16x16x32_bf16 v[212:215], v[84:87], v[104:107], v[212:215]
  ds_read_b64_tr_b16 v[124:125], v45 offset:36864
  v_mfma_f32_16x16x32_bf16 v[204:207], v[84:87], v[100:103], v[204:207]
  v_mfma_f32_16x16x32_bf16 v[196:199], v[84:87], v[96:99], v[196:199]
  ds_read_b64_tr_b16 v[126:127], v45 offset:37376
  s_waitcnt lgkmcnt(5)
  v_mfma_f32_16x16x32_bf16 v[224:227], v[88:91], v[96:99], v[224:227]
  ds_read_b128 v[80:83], v41 offset:32768
  v_mfma_f32_16x16x32_bf16 v[232:235], v[88:91], v[100:103], v[232:235]
  v_mfma_f32_16x16x32_bf16 v[240:243], v[88:91], v[104:107], v[240:243]
  v_mfma_f32_16x16x32_bf16 v[248:251], v[88:91], v[108:111], v[248:251]
  s_waitcnt lgkmcnt(3)
  v_mfma_f32_16x16x32_bf16 v[252:255], v[92:95], v[108:111], v[252:255]
  ds_read_b128 v[84:87], v41 offset:34816
  v_mfma_f32_16x16x32_bf16 v[244:247], v[92:95], v[104:107], v[244:247]
  v_mfma_f32_16x16x32_bf16 v[236:239], v[92:95], v[100:103], v[236:239]
  v_mfma_f32_16x16x32_bf16 v[228:231], v[92:95], v[96:99], v[228:231]
  s_waitcnt lgkmcnt(1)
  v_mfma_f32_16x16x32_bf16 v[128:131], v[80:83], v[112:115], v[128:131]
  ds_read_b128 v[88:91], v41 offset:36864
  v_mfma_f32_16x16x32_bf16 v[136:139], v[80:83], v[116:119], v[136:139]
  v_mfma_f32_16x16x32_bf16 v[144:147], v[80:83], v[120:123], v[144:147]
  v_mfma_f32_16x16x32_bf16 v[152:155], v[80:83], v[124:127], v[152:155]
  s_waitcnt lgkmcnt(1)
  v_mfma_f32_16x16x32_bf16 v[156:159], v[84:87], v[124:127], v[156:159]
  ds_read_b128 v[92:95], v41 offset:38912
  v_mfma_f32_16x16x32_bf16 v[148:151], v[84:87], v[120:123], v[148:151]
  v_mfma_f32_16x16x32_bf16 v[140:143], v[84:87], v[116:119], v[140:143]
  v_mfma_f32_16x16x32_bf16 v[132:135], v[84:87], v[112:115], v[132:135]
  s_waitcnt lgkmcnt(1)
  v_mfma_f32_16x16x32_bf16 v[160:163], v[88:91], v[112:115], v[160:163]
  ds_read_b128 v[80:83], v41 offset:40960
  v_mfma_f32_16x16x32_bf16 v[168:171], v[88:91], v[116:119], v[168:171]
  v_mfma_f32_16x16x32_bf16 v[176:179], v[88:91], v[120:123], v[176:179]
  v_mfma_f32_16x16x32_bf16 v[184:187], v[88:91], v[124:127], v[184:187]
  s_waitcnt lgkmcnt(1)
  v_mfma_f32_16x16x32_bf16 v[188:191], v[92:95], v[124:127], v[188:191]
  ds_read_b128 v[84:87], v41 offset:43008
  buffer_load_dword v13, v5, s[20:23], s77 offen
  s_add_u32 s77, s77, s78
  v_mfma_f32_16x16x32_bf16 v[180:183], v[92:95], v[120:123], v[180:183]
  v_mfma_f32_16x16x32_bf16 v[172:175], v[92:95], v[116:119], v[172:175]
  v_mfma_f32_16x16x32_bf16 v[164:167], v[92:95], v[112:115], v[164:167]
  s_waitcnt lgkmcnt(1)
  v_mfma_f32_16x16x32_bf16 v[192:195], v[80:83], v[112:115], v[192:195]
  ds_read_b128 v[88:91], v41 offset:45056
  v_mfma_f32_16x16x32_bf16 v[200:203], v[80:83], v[116:119], v[200:203]
  v_mfma_f32_16x16x32_bf16 v[208:211], v[80:83], v[120:123], v[208:211]
  v_mfma_f32_16x16x32_bf16 v[216:219], v[80:83], v[124:127], v[216:219]
  s_waitcnt lgkmcnt(1)
  v_mfma_f32_16x16x32_bf16 v[220:223], v[84:87], v[124:127], v[220:223]
  ds_read_b128 v[92:95], v41 offset:47104
  v_mfma_f32_16x16x32_bf16 v[212:215], v[84:87], v[120:123], v[212:215]
  v_mfma_f32_16x16x32_bf16 v[204:207], v[84:87], v[116:119], v[204:207]
  v_mfma_f32_16x16x32_bf16 v[196:199], v[84:87], v[112:115], v[196:199]
  s_waitcnt lgkmcnt(0)
  s_barrier
  v_mfma_f32_16x16x32_bf16 v[224:227], v[88:91], v[112:115], v[224:227]
  ds_read_b128 v[80:83], v40 offset:0
  ds_read_b64_tr_b16 v[96:97], v42 offset:0
  v_mfma_f32_16x16x32_bf16 v[232:235], v[88:91], v[116:119], v[232:235]
  ds_read_b64_tr_b16 v[98:99], v42 offset:512
  ds_read_b64_tr_b16 v[100:101], v43 offset:0
  v_mfma_f32_16x16x32_bf16 v[240:243], v[88:91], v[120:123], v[240:243]
  ds_read_b64_tr_b16 v[102:103], v43 offset:512
  ds_read_b64_tr_b16 v[104:105], v44 offset:0
  v_mfma_f32_16x16x32_bf16 v[248:251], v[88:91], v[124:127], v[248:251]
  ds_read_b64_tr_b16 v[106:107], v44 offset:512
  ds_read_b64_tr_b16 v[108:109], v45 offset:0
  v_mfma_f32_16x16x32_bf16 v[252:255], v[92:95], v[124:127], v[252:255]
  ds_read_b64_tr_b16 v[110:111], v45 offset:512
  ds_read_b128 v[84:87], v40 offset:2048
  v_mfma_f32_16x16x32_bf16 v[244:247], v[92:95], v[120:123], v[244:247]
  v_mfma_f32_16x16x32_bf16 v[236:239], v[92:95], v[116:119], v[236:239]
  v_mfma_f32_16x16x32_bf16 v[228:231], v[92:95], v[112:115], v[228:231]
  s_waitcnt lgkmcnt(7)
  v_mfma_f32_16x16x32_bf16 v[128:131], v[80:83], v[96:99], v[128:131]
  ds_read_b128 v[88:91], v40 offset:4096
  s_waitcnt lgkmcnt(6)
  v_mfma_f32_16x16x32_bf16 v[136:139], v[80:83], v[100:103], v[136:139]
  s_waitcnt lgkmcnt(4)
  v_mfma_f32_16x16x32_bf16 v[144:147], v[80:83], v[104:107], v[144:147]
  s_waitcnt lgkmcnt(2)
  v_mfma_f32_16x16x32_bf16 v[152:155], v[80:83], v[108:111], v[152:155]
  s_waitcnt lgkmcnt(1)
  v_mfma_f32_16x16x32_bf16 v[156:159], v[84:87], v[108:111], v[156:159]
  ds_read_b128 v[92:95], v40 offset:6144
  v_mfma_f32_16x16x32_bf16 v[148:151], v[84:87], v[104:107], v[148:151]
  v_mfma_f32_16x16x32_bf16 v[140:143], v[84:87], v[100:103], v[140:143]
  v_mfma_f32_16x16x32_bf16 v[132:135], v[84:87], v[96:99], v[132:135]
  s_waitcnt lgkmcnt(1)
  v_mfma_f32_16x16x32_bf16 v[160:163], v[88:91], v[96:99], v[160:163]
  ds_read_b128 v[80:83], v40 offset:8192
  v_mfma_f32_16x16x32_bf16 v[168:171], v[88:91], v[100:103], v[168:171]
  ds_read_b64_tr_b16 v[112:113], v42 offset:4096
  v_mfma_f32_16x16x32_bf16 v[176:179], v[88:91], v[104:107], v[176:179]
  v_mfma_f32_16x16x32_bf16 v[184:187], v[88:91], v[108:111], v[184:187]
  ds_read_b64_tr_b16 v[114:115], v42 offset:4608
  s_waitcnt lgkmcnt(3)
  v_mfma_f32_16x16x32_bf16 v[188:191], v[92:95], v[108:111], v[188:191]
  ds_read_b128 v[84:87], v40 offset:10240
  v_mfma_f32_16x16x32_bf16 v[180:183], v[92:95], v[104:107], v[180:183]
  ds_read_b64_tr_b16 v[116:117], v43 offset:4096
  v_mfma_f32_16x16x32_bf16 v[172:175], v[92:95], v[100:103], v[172:175]
  v_mfma_f32_16x16x32_bf16 v[164:167], v[92:95], v[96:99], v[164:167]
  ds_read_b64_tr_b16 v[118:119], v43 offset:4608
  s_waitcnt lgkmcnt(5)
  v_mfma_f32_16x16x32_bf16 v[192:195], v[80:83], v[96:99], v[192:195]
  ds_read_b128 v[88:91], v40 offset:12288
  v_mfma_f32_16x16x32_bf16 v[200:203], v[80:83], v[100:103], v[200:203]
  ds_read_b64_tr_b16 v[120:121], v44 offset:4096
  v_mfma_f32_16x16x32_bf16 v[208:211], v[80:83], v[104:107], v[208:211]
  v_mfma_f32_16x16x32_bf16 v[216:219], v[80:83], v[108:111], v[216:219]
  ds_read_b64_tr_b16 v[122:123], v44 offset:4608
  s_waitcnt lgkmcnt(5)
  v_mfma_f32_16x16x32_bf16 v[220:223], v[84:87], v[108:111], v[220:223]
  ds_read_b128 v[92:95], v40 offset:14336
  v_mfma_f32_16x16x32_bf16 v[212:215], v[84:87], v[104:107], v[212:215]
  ds_read_b64_tr_b16 v[124:125], v45 offset:4096
  v_mfma_f32_16x16x32_bf16 v[204:207], v[84:87], v[100:103], v[204:207]
  v_mfma_f32_16x16x32_bf16 v[196:199], v[84:87], v[96:99], v[196:199]
  ds_read_b64_tr_b16 v[126:127], v45 offset:4608
  s_waitcnt lgkmcnt(5)
  v_mfma_f32_16x16x32_bf16 v[224:227], v[88:91], v[96:99], v[224:227]
  ds_read_b128 v[80:83], v41 offset:0
  v_mfma_f32_16x16x32_bf16 v[232:235], v[88:91], v[100:103], v[232:235]
  v_mfma_f32_16x16x32_bf16 v[240:243], v[88:91], v[104:107], v[240:243]
  v_mfma_f32_16x16x32_bf16 v[248:251], v[88:91], v[108:111], v[248:251]
  s_waitcnt lgkmcnt(3)
  v_mfma_f32_16x16x32_bf16 v[252:255], v[92:95], v[108:111], v[252:255]
  ds_read_b128 v[84:87], v41 offset:2048
  v_mfma_f32_16x16x32_bf16 v[244:247], v[92:95], v[104:107], v[244:247]
  v_mfma_f32_16x16x32_bf16 v[236:239], v[92:95], v[100:103], v[236:239]
  v_mfma_f32_16x16x32_bf16 v[228:231], v[92:95], v[96:99], v[228:231]
  s_waitcnt lgkmcnt(1)
  v_mfma_f32_16x16x32_bf16 v[128:131], v[80:83], v[112:115], v[128:131]
  ds_read_b128 v[88:91], v41 offset:4096
  v_mfma_f32_16x16x32_bf16 v[136:139], v[80:83], v[116:119], v[136:139]
  v_mfma_f32_16x16x32_bf16 v[144:147], v[80:83], v[120:123], v[144:147]
  v_mfma_f32_16x16x32_bf16 v[152:155], v[80:83], v[124:127], v[152:155]
  s_waitcnt lgkmcnt(1)
  v_mfma_f32_16x16x32_bf16 v[156:159], v[84:87], v[124:127], v[156:159]
  ds_read_b128 v[92:95], v41 offset:6144
  v_mfma_f32_16x16x32_bf16 v[148:151], v[84:87], v[120:123], v[148:151]
  v_mfma_f32_16x16x32_bf16 v[140:143], v[84:87], v[116:119], v[140:143]
  v_mfma_f32_16x16x32_bf16 v[132:135], v[84:87], v[112:115], v[132:135]
  s_waitcnt lgkmcnt(1)
  v_mfma_f32_16x16x32_bf16 v[160:163], v[88:91], v[112:115], v[160:163]
  ds_read_b128 v[80:83], v41 offset:8192
  v_mfma_f32_16x16x32_bf16 v[168:171], v[88:91], v[116:119], v[168:171]
  v_mfma_f32_16x16x32_bf16 v[176:179], v[88:91], v[120:123], v[176:179]
  v_mfma_f32_16x16x32_bf16 v[184:187], v[88:91], v[124:127], v[184:187]
  s_waitcnt lgkmcnt(1)
  v_mfma_f32_16x16x32_bf16 v[188:191], v[92:95], v[124:127], v[188:191]
  ds_read_b128 v[84:87], v41 offset:10240
  buffer_load_dword v13, v4, s[16:19], s76 offen offset:0
  v_mfma_f32_16x16x32_bf16 v[180:183], v[92:95], v[120:123], v[180:183]
  v_mfma_f32_16x16x32_bf16 v[172:175], v[92:95], v[116:119], v[172:175]
  v_mfma_f32_16x16x32_bf16 v[164:167], v[92:95], v[112:115], v[164:167]
  s_waitcnt lgkmcnt(1)
  v_mfma_f32_16x16x32_bf16 v[192:195], v[80:83], v[112:115], v[192:195]
  ds_read_b128 v[88:91], v41 offset:12288
  v_mfma_f32_16x16x32_bf16 v[200:203], v[80:83], v[116:119], v[200:203]
  v_mfma_f32_16x16x32_bf16 v[208:211], v[80:83], v[120:123], v[208:211]
  v_mfma_f32_16x16x32_bf16 v[216:219], v[80:83], v[124:127], v[216:219]
  s_waitcnt lgkmcnt(1)
  v_mfma_f32_16x16x32_bf16 v[220:223], v[84:87], v[124:127], v[220:223]
  ds_read_b128 v[92:95], v41 offset:14336
  v_mfma_f32_16x16x32_bf16 v[212:215], v[84:87], v[120:123], v[212:215]
  v_mfma_f32_16x16x32_bf16 v[204:207], v[84:87], v[116:119], v[204:207]
  v_mfma_f32_16x16x32_bf16 v[196:199], v[84:87], v[112:115], v[196:199]
  s_waitcnt lgkmcnt(0)
  s_barrier
  v_mfma_f32_16x16x32_bf16 v[224:227], v[88:91], v[112:115], v[224:227]
  ds_read_b128 v[80:83], v40 offset:32768
  ds_read_b64_tr_b16 v[96:97], v42 offset:32768
  v_mfma_f32_16x16x32_bf16 v[232:235], v[88:91], v[116:119], v[232:235]
  ds_read_b64_tr_b16 v[98:99], v42 offset:33280
  ds_read_b64_tr_b16 v[100:101], v43 offset:32768
  v_mfma_f32_16x16x32_bf16 v[240:243], v[88:91], v[120:123], v[240:243]
  ds_read_b64_tr_b16 v[102:103], v43 offset:33280
  ds_read_b64_tr_b16 v[104:105], v44 offset:32768
  v_mfma_f32_16x16x32_bf16 v[248:251], v[88:91], v[124:127], v[248:251]
  ds_read_b64_tr_b16 v[106:107], v44 offset:33280
  ds_read_b64_tr_b16 v[108:109], v45 offset:32768
  v_mfma_f32_16x16x32_bf16 v[252:255], v[92:95], v[124:127], v[252:255]
  ds_read_b64_tr_b16 v[110:111], v45 offset:33280
  ds_read_b128 v[84:87], v40 offset:34816
  v_mfma_f32_16x16x32_bf16 v[244:247], v[92:95], v[120:123], v[244:247]
  v_mfma_f32_16x16x32_bf16 v[236:239], v[92:95], v[116:119], v[236:239]
  v_mfma_f32_16x16x32_bf16 v[228:231], v[92:95], v[112:115], v[228:231]
  s_waitcnt lgkmcnt(7)
  v_mfma_f32_16x16x32_bf16 v[128:131], v[80:83], v[96:99], v[128:131]
  ds_read_b128 v[88:91], v40 offset:36864
  s_waitcnt lgkmcnt(6)
  v_mfma_f32_16x16x32_bf16 v[136:139], v[80:83], v[100:103], v[136:139]
  s_waitcnt lgkmcnt(4)
  v_mfma_f32_16x16x32_bf16 v[144:147], v[80:83], v[104:107], v[144:147]
  s_waitcnt lgkmcnt(2)
  v_mfma_f32_16x16x32_bf16 v[152:155], v[80:83], v[108:111], v[152:155]
  s_waitcnt lgkmcnt(1)
  v_mfma_f32_16x16x32_bf16 v[156:159], v[84:87], v[108:111], v[156:159]
  ds_read_b128 v[92:95], v40 offset:38912
  v_mfma_f32_16x16x32_bf16 v[148:151], v[84:87], v[104:107], v[148:151]
  v_mfma_f32_16x16x32_bf16 v[140:143], v[84:87], v[100:103], v[140:143]
  v_mfma_f32_16x16x32_bf16 v[132:135], v[84:87], v[96:99], v[132:135]
  s_waitcnt lgkmcnt(1)
  v_mfma_f32_16x16x32_bf16 v[160:163], v[88:91], v[96:99], v[160:163]
  ds_read_b128 v[80:83], v40 offset:40960
  v_mfma_f32_16x16x32_bf16 v[168:171], v[88:91], v[100:103], v[168:171]
  ds_read_b64_tr_b16 v[112:113], v42 offset:36864
  v_mfma_f32_16x16x32_bf16 v[176:179], v[88:91], v[104:107], v[176:179]
  v_mfma_f32_16x16x32_bf16 v[184:187], v[88:91], v[108:111], v[184:187]
  ds_read_b64_tr_b16 v[114:115], v42 offset:37376
  s_waitcnt lgkmcnt(3)
  v_mfma_f32_16x16x32_bf16 v[188:191], v[92:95], v[108:111], v[188:191]
  ds_read_b128 v[84:87], v40 offset:43008
  v_mfma_f32_16x16x32_bf16 v[180:183], v[92:95], v[104:107], v[180:183]
  ds_read_b64_tr_b16 v[116:117], v43 offset:36864
  v_mfma_f32_16x16x32_bf16 v[172:175], v[92:95], v[100:103], v[172:175]
  v_mfma_f32_16x16x32_bf16 v[164:167], v[92:95], v[96:99], v[164:167]
  ds_read_b64_tr_b16 v[118:119], v43 offset:37376
  s_waitcnt lgkmcnt(5)
  v_mfma_f32_16x16x32_bf16 v[192:195], v[80:83], v[96:99], v[192:195]
  ds_read_b128 v[88:91], v40 offset:45056
  v_mfma_f32_16x16x32_bf16 v[200:203], v[80:83], v[100:103], v[200:203]
  ds_read_b64_tr_b16 v[120:121], v44 offset:36864
  v_mfma_f32_16x16x32_bf16 v[208:211], v[80:83], v[104:107], v[208:211]
  v_mfma_f32_16x16x32_bf16 v[216:219], v[80:83], v[108:111], v[216:219]
  ds_read_b64_tr_b16 v[122:123], v44 offset:37376
  s_waitcnt lgkmcnt(5)
  v_mfma_f32_16x16x32_bf16 v[220:223], v[84:87], v[108:111], v[220:223]
  ds_read_b128 v[92:95], v40 offset:47104
  v_mfma_f32_16x16x32_bf16 v[212:215], v[84:87], v[104:107], v[212:215]
  ds_read_b64_tr_b16 v[124:125], v45 offset:36864
  v_mfma_f32_16x16x32_bf16 v[204:207], v[84:87], v[100:103], v[204:207]
  v_mfma_f32_16x16x32_bf16 v[196:199], v[84:87], v[96:99], v[196:199]
  ds_read_b64_tr_b16 v[126:127], v45 offset:37376
  s_waitcnt lgkmcnt(5)
  v_mfma_f32_16x16x32_bf16 v[224:227], v[88:91], v[96:99], v[224:227]
  ds_read_b128 v[80:83], v41 offset:32768
  v_mfma_f32_16x16x32_bf16 v[232:235], v[88:91], v[100:103], v[232:235]
  v_mfma_f32_16x16x32_bf16 v[240:243], v[88:91], v[104:107], v[240:243]
  v_mfma_f32_16x16x32_bf16 v[248:251], v[88:91], v[108:111], v[248:251]
  s_waitcnt lgkmcnt(3)
  v_mfma_f32_16x16x32_bf16 v[252:255], v[92:95], v[108:111], v[252:255]
  ds_read_b128 v[84:87], v41 offset:34816
  v_mfma_f32_16x16x32_bf16 v[244:247], v[92:95], v[104:107], v[244:247]
  v_mfma_f32_16x16x32_bf16 v[236:239], v[92:95], v[100:103], v[236:239]
  v_mfma_f32_16x16x32_bf16 v[228:231], v[92:95], v[96:99], v[228:231]
  s_waitcnt lgkmcnt(1)
  v_mfma_f32_16x16x32_bf16 v[128:131], v[80:83], v[112:115], v[128:131]
  ds_read_b128 v[88:91], v41 offset:36864
  v_mfma_f32_16x16x32_bf16 v[136:139], v[80:83], v[116:119], v[136:139]
  v_mfma_f32_16x16x32_bf16 v[144:147], v[80:83], v[120:123], v[144:147]
  v_mfma_f32_16x16x32_bf16 v[152:155], v[80:83], v[124:127], v[152:155]
  s_waitcnt lgkmcnt(1)
  v_mfma_f32_16x16x32_bf16 v[156:159], v[84:87], v[124:127], v[156:159]
  ds_read_b128 v[92:95], v41 offset:38912
  v_mfma_f32_16x16x32_bf16 v[148:151], v[84:87], v[120:123], v[148:151]
  v_mfma_f32_16x16x32_bf16 v[140:143], v[84:87], v[116:119], v[140:143]
  v_mfma_f32_16x16x32_bf16 v[132:135], v[84:87], v[112:115], v[132:135]
  s_waitcnt lgkmcnt(1)
  v_mfma_f32_16x16x32_bf16 v[160:163], v[88:91], v[112:115], v[160:163]
  ds_read_b128 v[80:83], v41 offset:40960
  v_mfma_f32_16x16x32_bf16 v[168:171], v[88:91], v[116:119], v[168:171]
  v_mfma_f32_16x16x32_bf16 v[176:179], v[88:91], v[120:123], v[176:179]
  v_mfma_f32_16x16x32_bf16 v[184:187], v[88:91], v[124:127], v[184:187]
  s_waitcnt lgkmcnt(1)
  v_mfma_f32_16x16x32_bf16 v[188:191], v[92:95], v[124:127], v[188:191]
  ds_read_b128 v[84:87], v41 offset:43008
  buffer_load_dword v13, v5, s[20:23], s77 offen
  s_add_u32 s77, s77, s78
  v_mfma_f32_16x16x32_bf16 v[180:183], v[92:95], v[120:123], v[180:183]
  v_mfma_f32_16x16x32_bf16 v[172:175], v[92:95], v[116:119], v[172:175]
  v_mfma_f32_16x16x32_bf16 v[164:167], v[92:95], v[112:115], v[164:167]
  s_waitcnt lgkmcnt(1)
  v_mfma_f32_16x16x32_bf16 v[192:195], v[80:83], v[112:115], v[192:195]
  ds_read_b128 v[88:91], v41 offset:45056
  v_mfma_f32_16x16x32_bf16 v[200:203], v[80:83], v[116:119], v[200:203]
  v_mfma_f32_16x16x32_bf16 v[208:211], v[80:83], v[120:123], v[208:211]
  v_mfma_f32_16x16x32_bf16 v[216:219], v[80:83], v[124:127], v[216:219]
  s_waitcnt lgkmcnt(1)
  v_mfma_f32_16x16x32_bf16 v[220:223], v[84:87], v[124:127], v[220:223]
  ds_read_b128 v[92:95], v41 offset:47104
  v_mfma_f32_16x16x32_bf16 v[212:215], v[84:87], v[120:123], v[212:215]
  v_mfma_f32_16x16x32_bf16 v[204:207], v[84:87], v[116:119], v[204:207]
  v_mfma_f32_16x16x32_bf16 v[196:199], v[84:87], v[112:115], v[196:199]
  s_waitcnt lgkmcnt(0)
  s_barrier
  v_mfma_f32_16x16x32_bf16 v[224:227], v[88:91], v[112:115], v[224:227]
  ds_read_b128 v[80:83], v40 offset:0
  ds_read_b64_tr_b16 v[96:97], v42 offset:0
  v_mfma_f32_16x16x32_bf16 v[232:235], v[88:91], v[116:119], v[232:235]
  ds_read_b64_tr_b16 v[98:99], v42 offset:512
  ds_read_b64_tr_b16 v[100:101], v43 offset:0
  v_mfma_f32_16x16x32_bf16 v[240:243], v[88:91], v[120:123], v[240:243]
  ds_read_b64_tr_b16 v[102:103], v43 offset:512
  ds_read_b64_tr_b16 v[104:105], v44 offset:0
  v_mfma_f32_16x16x32_bf16 v[248:251], v[88:91], v[124:127], v[248:251]
  ds_read_b64_tr_b16 v[106:107], v44 offset:512
  ds_read_b64_tr_b16 v[108:109], v45 offset:0
  v_mfma_f32_16x16x32_bf16 v[252:255], v[92:95], v[124:127], v[252:255]
  ds_read_b64_tr_b16 v[110:111], v45 offset:512
  ds_read_b128 v[84:87], v40 offset:2048
  v_mfma_f32_16x16x32_bf16 v[244:247], v[92:95], v[120:123], v[244:247]
  v_mfma_f32_16x16x32_bf16 v[236:239], v[92:95], v[116:119], v[236:239]
  v_mfma_f32_16x16x32_bf16 v[228:231], v[92:95], v[112:115], v[228:231]
  s_waitcnt lgkmcnt(7)
  v_mfma_f32_16x16x32_bf16 v[128:131], v[80:83], v[96:99], v[128:131]
  ds_read_b128 v[88:91], v40 offset:4096
  s_waitcnt lgkmcnt(6)
  v_mfma_f32_16x16x32_bf16 v[136:139], v[80:83], v[100:103], v[136:139]
  s_waitcnt lgkmcnt(4)
  v_mfma_f32_16x16x32_bf16 v[144:147], v[80:83], v[104:107], v[144:147]
  s_waitcnt lgkmcnt(2)
  v_mfma_f32_16x16x32_bf16 v[152:155], v[80:83], v[108:111], v[152:155]
  s_waitcnt lgkmcnt(1)
  v_mfma_f32_16x16x32_bf16 v[156:159], v[84:87], v[108:111], v[156:159]
  ds_read_b128 v[92:95], v40 offset:6144
  v_mfma_f32_16x16x32_bf16 v[148:151], v[84:87], v[104:107], v[148:151]
  v_mfma_f32_16x16x32_bf16 v[140:143], v[84:87], v[100:103], v[140:143]
  v_mfma_f32_16x16x32_bf16 v[132:135], v[84:87], v[96:99], v[132:135]
  s_waitcnt lgkmcnt(1)
  v_mfma_f32_16x16x32_bf16 v[160:163], v[88:91], v[96:99], v[160:163]
  ds_read_b128 v[80:83], v40 offset:8192
  v_mfma_f32_16x16x32_bf16 v[168:171], v[88:91], v[100:103], v[168:171]
  ds_read_b64_tr_b16 v[112:113], v42 offset:4096
  v_mfma_f32_16x16x32_bf16 v[176:179], v[88:91], v[104:107], v[176:179]
  v_mfma_f32_16x16x32_bf16 v[184:187], v[88:91], v[108:111], v[184:187]
  ds_read_b64_tr_b16 v[114:115], v42 offset:4608
  s_waitcnt lgkmcnt(3)
  v_mfma_f32_16x16x32_bf16 v[188:191], v[92:95], v[108:111], v[188:191]
  ds_read_b128 v[84:87], v40 offset:10240
  v_mfma_f32_16x16x32_bf16 v[180:183], v[92:95], v[104:107], v[180:183]
  ds_read_b64_tr_b16 v[116:117], v43 offset:4096
  v_mfma_f32_16x16x32_bf16 v[172:175], v[92:95], v[100:103], v[172:175]
  v_mfma_f32_16x16x32_bf16 v[164:167], v[92:95], v[96:99], v[164:167]
  ds_read_b64_tr_b16 v[118:119], v43 offset:4608
  s_waitcnt lgkmcnt(5)
  v_mfma_f32_16x16x32_bf16 v[192:195], v[80:83], v[96:99], v[192:195]
  ds_read_b128 v[88:91], v40 offset:12288
  v_mfma_f32_16x16x32_bf16 v[200:203], v[80:83], v[100:103], v[200:203]
  ds_read_b64_tr_b16 v[120:121], v44 offset:4096
  v_mfma_f32_16x16x32_bf16 v[208:211], v[80:83], v[104:107], v[208:211]
  v_mfma_f32_16x16x32_bf16 v[216:219], v[80:83], v[108:111], v[216:219]
  ds_read_b64_tr_b16 v[122:123], v44 offset:4608
  s_waitcnt lgkmcnt(5)
  v_mfma_f32_16x16x32_bf16 v[220:223], v[84:87], v[108:111], v[220:223]
  ds_read_b128 v[92:95], v40 offset:14336
  v_mfma_f32_16x16x32_bf16 v[212:215], v[84:87], v[104:107], v[212:215]
  ds_read_b64_tr_b16 v[124:125], v45 offset:4096
  v_mfma_f32_16x16x32_bf16 v[204:207], v[84:87], v[100:103], v[204:207]
  v_mfma_f32_16x16x32_bf16 v[196:199], v[84:87], v[96:99], v[196:199]
  ds_read_b64_tr_b16 v[126:127], v45 offset:4608
  s_waitcnt lgkmcnt(5)
  v_mfma_f32_16x16x32_bf16 v[224:227], v[88:91], v[96:99], v[224:227]
  ds_read_b128 v[80:83], v41 offset:0
  v_mfma_f32_16x16x32_bf16 v[232:235], v[88:91], v[100:103], v[232:235]
  v_mfma_f32_16x16x32_bf16 v[240:243], v[88:91], v[104:107], v[240:243]
  v_mfma_f32_16x16x32_bf16 v[248:251], v[88:91], v[108:111], v[248:251]
  s_waitcnt lgkmcnt(3)
  v_mfma_f32_16x16x32_bf16 v[252:255], v[92:95], v[108:111], v[252:255]
  ds_read_b128 v[84:87], v41 offset:2048
  v_mfma_f32_16x16x32_bf16 v[244:247], v[92:95], v[104:107], v[244:247]
  v_mfma_f32_16x16x32_bf16 v[236:239], v[92:95], v[100:103], v[236:239]
  v_mfma_f32_16x16x32_bf16 v[228:231], v[92:95], v[96:99], v[228:231]
  s_waitcnt lgkmcnt(1)
  v_mfma_f32_16x16x32_bf16 v[128:131], v[80:83], v[112:115], v[128:131]
  ds_read_b128 v[88:91], v41 offset:4096
  v_mfma_f32_16x16x32_bf16 v[136:139], v[80:83], v[116:119], v[136:139]
  v_mfma_f32_16x16x32_bf16 v[144:147], v[80:83], v[120:123], v[144:147]
  v_mfma_f32_16x16x32_bf16 v[152:155], v[80:83], v[124:127], v[152:155]
  s_waitcnt lgkmcnt(1)
  v_mfma_f32_16x16x32_bf16 v[156:159], v[84:87], v[124:127], v[156:159]
  ds_read_b128 v[92:95], v41 offset:6144
  v_mfma_f32_16x16x32_bf16 v[148:151], v[84:87], v[120:123], v[148:151]
  v_mfma_f32_16x16x32_bf16 v[140:143], v[84:87], v[116:119], v[140:143]
  v_mfma_f32_16x16x32_bf16 v[132:135], v[84:87], v[112:115], v[132:135]
  s_waitcnt lgkmcnt(1)
  v_mfma_f32_16x16x32_bf16 v[160:163], v[88:91], v[112:115], v[160:163]
  ds_read_b128 v[80:83], v41 offset:8192
  v_mfma_f32_16x16x32_bf16 v[168:171], v[88:91], v[116:119], v[168:171]
  v_mfma_f32_16x16x32_bf16 v[176:179], v[88:91], v[120:123], v[176:179]
  v_mfma_f32_16x16x32_bf16 v[184:187], v[88:91], v[124:127], v[184:187]
  s_waitcnt lgkmcnt(1)
  v_mfma_f32_16x16x32_bf16 v[188:191], v[92:95], v[124:127], v[188:191]
  ds_read_b128 v[84:87], v41 offset:10240
  buffer_load_dword v13, v4, s[16:19], s76 offen offset:256
  v_mfma_f32_16x16x32_bf16 v[180:183], v[92:95], v[120:123], v[180:183]
  v_mfma_f32_16x16x32_bf16 v[172:175], v[92:95], v[116:119], v[172:175]
  v_mfma_f32_16x16x32_bf16 v[164:167], v[92:95], v[112:115], v[164:167]
  s_waitcnt lgkmcnt(1)
  v_mfma_f32_16x16x32_bf16 v[192:195], v[80:83], v[112:115], v[192:195]
  ds_read_b128 v[88:91], v41 offset:12288
  v_mfma_f32_16x16x32_bf16 v[200:203], v[80:83], v[116:119], v[200:203]
  v_mfma_f32_16x16x32_bf16 v[208:211], v[80:83], v[120:123], v[208:211]
  v_mfma_f32_16x16x32_bf16 v[216:219], v[80:83], v[124:127], v[216:219]
  s_waitcnt lgkmcnt(1)
  v_mfma_f32_16x16x32_bf16 v[220:223], v[84:87], v[124:127], v[220:223]
  ds_read_b128 v[92:95], v41 offset:14336
  v_mfma_f32_16x16x32_bf16 v[212:215], v[84:87], v[120:123], v[212:215]
  v_mfma_f32_16x16x32_bf16 v[204:207], v[84:87], v[116:119], v[204:207]
  v_mfma_f32_16x16x32_bf16 v[196:199], v[84:87], v[112:115], v[196:199]
  s_waitcnt lgkmcnt(0)
  s_barrier
  v_mfma_f32_16x16x32_bf16 v[224:227], v[88:91], v[112:115], v[224:227]
  ds_read_b128 v[80:83], v40 offset:32768
  ds_read_b64_tr_b16 v[96:97], v42 offset:32768
  v_mfma_f32_16x16x32_bf16 v[232:235], v[88:91], v[116:119], v[232:235]
  ds_read_b64_tr_b16 v[98:99], v42 offset:33280
  ds_read_b64_tr_b16 v[100:101], v43 offset:32768
  v_mfma_f32_16x16x32_bf16 v[240:243], v[88:91], v[120:123], v[240:243]
  ds_read_b64_tr_b16 v[102:103], v43 offset:33280
  ds_read_b64_tr_b16 v[104:105], v44 offset:32768
  v_mfma_f32_16x16x32_bf16 v[248:251], v[88:91], v[124:127], v[248:251]
  ds_read_b64_tr_b16 v[106:107], v44 offset:33280
  ds_read_b64_tr_b16 v[108:109], v45 offset:32768
  v_mfma_f32_16x16x32_bf16 v[252:255], v[92:95], v[124:127], v[252:255]
  ds_read_b64_tr_b16 v[110:111], v45 offset:33280
  ds_read_b128 v[84:87], v40 offset:34816
  v_mfma_f32_16x16x32_bf16 v[244:247], v[92:95], v[120:123], v[244:247]
  v_mfma_f32_16x16x32_bf16 v[236:239], v[92:95], v[116:119], v[236:239]
  v_mfma_f32_16x16x32_bf16 v[228:231], v[92:95], v[112:115], v[228:231]
  s_waitcnt lgkmcnt(7)
  v_mfma_f32_16x16x32_bf16 v[128:131], v[80:83], v[96:99], v[128:131]
  ds_read_b128 v[88:91], v40 offset:36864
  s_waitcnt lgkmcnt(6)
  v_mfma_f32_16x16x32_bf16 v[136:139], v[80:83], v[100:103], v[136:139]
  s_waitcnt lgkmcnt(4)
  v_mfma_f32_16x16x32_bf16 v[144:147], v[80:83], v[104:107], v[144:147]
  s_waitcnt lgkmcnt(2)
  v_mfma_f32_16x16x32_bf16 v[152:155], v[80:83], v[108:111], v[152:155]
  s_waitcnt lgkmcnt(1)
  v_mfma_f32_16x16x32_bf16 v[156:159], v[84:87], v[108:111], v[156:159]
  ds_read_b128 v[92:95], v40 offset:38912
  v_mfma_f32_16x16x32_bf16 v[148:151], v[84:87], v[104:107], v[148:151]
  v_mfma_f32_16x16x32_bf16 v[140:143], v[84:87], v[100:103], v[140:143]
  v_mfma_f32_16x16x32_bf16 v[132:135], v[84:87], v[96:99], v[132:135]
  s_waitcnt lgkmcnt(1)
  v_mfma_f32_16x16x32_bf16 v[160:163], v[88:91], v[96:99], v[160:163]
  ds_read_b128 v[80:83], v40 offset:40960
  v_mfma_f32_16x16x32_bf16 v[168:171], v[88:91], v[100:103], v[168:171]
  ds_read_b64_tr_b16 v[112:113], v42 offset:36864
  v_mfma_f32_16x16x32_bf16 v[176:179], v[88:91], v[104:107], v[176:179]
  v_mfma_f32_16x16x32_bf16 v[184:187], v[88:91], v[108:111], v[184:187]
  ds_read_b64_tr_b16 v[114:115], v42 offset:37376
  s_waitcnt lgkmcnt(3)
  v_mfma_f32_16x16x32_bf16 v[188:191], v[92:95], v[108:111], v[188:191]
  ds_read_b128 v[84:87], v40 offset:43008
  v_mfma_f32_16x16x32_bf16 v[180:183], v[92:95], v[104:107], v[180:183]
  ds_read_b64_tr_b16 v[116:117], v43 offset:36864
  v_mfma_f32_16x16x32_bf16 v[172:175], v[92:95], v[100:103], v[172:175]
  v_mfma_f32_16x16x32_bf16 v[164:167], v[92:95], v[96:99], v[164:167]
  ds_read_b64_tr_b16 v[118:119], v43 offset:37376
  s_waitcnt lgkmcnt(5)
  v_mfma_f32_16x16x32_bf16 v[192:195], v[80:83], v[96:99], v[192:195]
  ds_read_b128 v[88:91], v40 offset:45056
  v_mfma_f32_16x16x32_bf16 v[200:203], v[80:83], v[100:103], v[200:203]
  ds_read_b64_tr_b16 v[120:121], v44 offset:36864
  v_mfma_f32_16x16x32_bf16 v[208:211], v[80:83], v[104:107], v[208:211]
  v_mfma_f32_16x16x32_bf16 v[216:219], v[80:83], v[108:111], v[216:219]
  ds_read_b64_tr_b16 v[122:123], v44 offset:37376
  s_waitcnt lgkmcnt(5)
  v_mfma_f32_16x16x32_bf16 v[220:223], v[84:87], v[108:111], v[220:223]
  ds_read_b128 v[92:95], v40 offset:47104
  v_mfma_f32_16x16x32_bf16 v[212:215], v[84:87], v[104:107], v[212:215]
  ds_read_b64_tr_b16 v[124:125], v45 offset:36864
  v_mfma_f32_16x16x32_bf16 v[204:207], v[84:87], v[100:103], v[204:207]
  v_mfma_f32_16x16x32_bf16 v[196:199], v[84:87], v[96:99], v[196:199]
  ds_read_b64_tr_b16 v[126:127], v45 offset:37376
  s_waitcnt lgkmcnt(5)
  v_mfma_f32_16x16x32_bf16 v[224:227], v[88:91], v[96:99], v[224:227]
  ds_read_b128 v[80:83], v41 offset:32768
  v_mfma_f32_16x16x32_bf16 v[232:235], v[88:91], v[100:103], v[232:235]
  v_mfma_f32_16x16x32_bf16 v[240:243], v[88:91], v[104:107], v[240:243]
  v_mfma_f32_16x16x32_bf16 v[248:251], v[88:91], v[108:111], v[248:251]
  s_waitcnt lgkmcnt(3)
  v_mfma_f32_16x16x32_bf16 v[252:255], v[92:95], v[108:111], v[252:255]
  ds_read_b128 v[84:87], v41 offset:34816
  v_mfma_f32_16x16x32_bf16 v[244:247], v[92:95], v[104:107], v[244:247]
  v_mfma_f32_16x16x32_bf16 v[236:239], v[92:95], v[100:103], v[236:239]
  v_mfma_f32_16x16x32_bf16 v[228:231], v[92:95], v[96:99], v[228:231]
  s_waitcnt lgkmcnt(1)
  v_mfma_f32_16x16x32_bf16 v[128:131], v[80:83], v[112:115], v[128:131]
  ds_read_b128 v[88:91], v41 offset:36864
  v_mfma_f32_16x16x32_bf16 v[136:139], v[80:83], v[116:119], v[136:139]
  v_mfma_f32_16x16x32_bf16 v[144:147], v[80:83], v[120:123], v[144:147]
  v_mfma_f32_16x16x32_bf16 v[152:155], v[80:83], v[124:127], v[152:155]
  s_waitcnt lgkmcnt(1)
  v_mfma_f32_16x16x32_bf16 v[156:159], v[84:87], v[124:127], v[156:159]
  ds_read_b128 v[92:95], v41 offset:38912
  v_mfma_f32_16x16x32_bf16 v[148:151], v[84:87], v[120:123], v[148:151]
  v_mfma_f32_16x16x32_bf16 v[140:143], v[84:87], v[116:119], v[140:143]
  v_mfma_f32_16x16x32_bf16 v[132:135], v[84:87], v[112:115], v[132:135]
  s_waitcnt lgkmcnt(1)
  v_mfma_f32_16x16x32_bf16 v[160:163], v[88:91], v[112:115], v[160:163]
  ds_read_b128 v[80:83], v41 offset:40960
  v_mfma_f32_16x16x32_bf16 v[168:171], v[88:91], v[116:119], v[168:171]
  v_mfma_f32_16x16x32_bf16 v[176:179], v[88:91], v[120:123], v[176:179]
  v_mfma_f32_16x16x32_bf16 v[184:187], v[88:91], v[124:127], v[184:187]
  v_cvt_pk_bf16_f32 v128, v128, v129
  v_cvt_pk_bf16_f32 v129, v130, v131
  s_waitcnt lgkmcnt(1)
  v_mfma_f32_16x16x32_bf16 v[188:191], v[92:95], v[124:127], v[188:191]
  ds_read_b128 v[84:87], v41 offset:43008
  v_cvt_pk_bf16_f32 v130, v132, v133
  v_mfma_f32_16x16x32_bf16 v[180:183], v[92:95], v[120:123], v[180:183]
  v_cvt_pk_bf16_f32 v131, v134, v135
  buffer_store_dwordx4 v[128:131], v16, s[12:15], s70 offen offset:0 sc1
  v_mfma_f32_16x16x32_bf16 v[172:175], v[92:95], v[116:119], v[172:175]
  v_cvt_pk_bf16_f32 v136, v136, v137
  v_cvt_pk_bf16_f32 v137, v138, v139
  v_mfma_f32_16x16x32_bf16 v[164:167], v[92:95], v[112:115], v[164:167]
  v_cvt_pk_bf16_f32 v138, v140, v141
  v_cvt_pk_bf16_f32 v139, v142, v143
  s_waitcnt lgkmcnt(1)
  v_mfma_f32_16x16x32_bf16 v[192:195], v[80:83], v[112:115], v[192:195]
  ds_read_b128 v[88:91], v41 offset:45056
  buffer_store_dwordx4 v[136:139], v16, s[12:15], s70 offen offset:1024 sc1
  s_add_u32 s70, s70, 8192
  v_mfma_f32_16x16x32_bf16 v[200:203], v[80:83], v[116:119], v[200:203]
  v_cvt_pk_bf16_f32 v144, v144, v145
  v_cvt_pk_bf16_f32 v145, v146, v147
  v_mfma_f32_16x16x32_bf16 v[208:211], v[80:83], v[120:123], v[208:211]
  v_cvt_pk_bf16_f32 v146, v148, v149
  v_cvt_pk_bf16_f32 v147, v150, v151
  v_mfma_f32_16x16x32_bf16 v[216:219], v[80:83], v[124:127], v[216:219]
  buffer_store_dwordx4 v[144:147], v16, s[12:15], s71 offen offset:0 sc1
  v_cvt_pk_bf16_f32 v152, v152, v153
  s_waitcnt lgkmcnt(1)
  v_mfma_f32_16x16x32_bf16 v[220:223], v[84:87], v[124:127], v[220:223]
  ds_read_b128 v[92:95], v41 offset:47104
  v_cvt_pk_bf16_f32 v153, v154, v155
  v_mfma_f32_16x16x32_bf16 v[212:215], v[84:87], v[120:123], v[212:215]
  v_cvt_pk_bf16_f32 v154, v156, v157
  v_cvt_pk_bf16_f32 v155, v158, v159
  v_mfma_f32_16x16x32_bf16 v[204:207], v[84:87], v[116:119], v[204:207]
  buffer_store_dwordx4 v[152:155], v16, s[12:15], s71 offen offset:1024 sc1
  s_add_u32 s71, s71, 8192
  v_cvt_pk_bf16_f32 v160, v160, v161
  v_mfma_f32_16x16x32_bf16 v[196:199], v[84:87], v[112:115], v[196:199]
  v_cvt_pk_bf16_f32 v161, v162, v163
  v_cvt_pk_bf16_f32 v162, v164, v165
  s_waitcnt lgkmcnt(0)
  s_barrier
  v_mfma_f32_16x16x32_bf16 v[224:227], v[88:91], v[112:115], v[224:227]
  ds_read_b64_tr_b16 v[80:81], v27 offset:0
  ds_read_b64_tr_b16 v[82:83], v27 offset:512
  v_cvt_pk_bf16_f32 v163, v166, v167
  v_mfma_f32_16x16x32_bf16 v[232:235], v[88:91], v[116:119], v[232:235]
  ds_read_b128 v[96:99], v23 offset:0
  ds_read_b128 v[100:103], v23 offset:2048
  v_cvt_pk_bf16_f32 v168, v168, v169
  v_mfma_f32_16x16x32_bf16 v[240:243], v[88:91], v[120:123], v[240:243]
  ds_read_b128 v[104:107], v25 offset:0
  ds_read_b128 v[108:111], v25 offset:2048
  v_cvt_pk_bf16_f32 v169, v170, v171
  v_mfma_f32_16x16x32_bf16 v[248:251], v[88:91], v[124:127], v[248:251]
  ds_read_b64_tr_b16 v[84:85], v28 offset:0
  ds_read_b64_tr_b16 v[86:87], v28 offset:512
  v_cvt_pk_bf16_f32 v170, v172, v173
  v_mfma_f32_16x16x32_bf16 v[252:255], v[92:95], v[124:127], v[252:255]
  v_cvt_pk_bf16_f32 v171, v174, v175
  v_cvt_pk_bf16_f32 v176, v176, v177
  v_mfma_f32_16x16x32_bf16 v[244:247], v[92:95], v[120:123], v[244:247]
  v_cvt_pk_bf16_f32 v177, v178, v179
  v_cvt_pk_bf16_f32 v178, v180, v181
  v_mfma_f32_16x16x32_bf16 v[236:239], v[92:95], v[116:119], v[236:239]
  v_cvt_pk_bf16_f32 v179, v182, v183
  v_cvt_pk_bf16_f32 v184, v184, v185
  v_mfma_f32_16x16x32_bf16 v[228:231], v[92:95], v[112:115], v[228:231]
  v_cvt_pk_bf16_f32 v185, v186, v187
  v_cvt_pk_bf16_f32 v186, v188, v189
  v_cvt_pk_bf16_f32 v187, v190, v191
F_QB:
  s_waitcnt lgkmcnt(5)
  v_mfma_f32_16x16x32_bf16 v[32:35], v[80:83], v[96:99], 0
  ds_read_b64_tr_b16 v[88:89], v29 offset:0
  s_waitcnt lgkmcnt(5)
  v_mfma_f32_16x16x32_bf16 v[36:39], v[80:83], v[100:103], 0
  ds_read_b64_tr_b16 v[90:91], v29 offset:512
  s_waitcnt lgkmcnt(5)
  v_mfma_f32_16x16x32_bf16 v[40:43], v[80:83], v[104:107], 0
  s_waitcnt lgkmcnt(4)
  v_mfma_f32_16x16x32_bf16 v[44:47], v[80:83], v[108:111], 0
  s_waitcnt lgkmcnt(2)
  v_mfma_f32_16x16x32_bf16 v[60:63], v[84:87], v[108:111], 0
  ds_read_b64_tr_b16 v[92:93], v30 offset:0
  v_cvt_pk_bf16_f32 v192, v192, v193
  v_mfma_f32_16x16x32_bf16 v[56:59], v[84:87], v[104:107], 0
  ds_read_b64_tr_b16 v[94:95], v30 offset:512
  v_cvt_pk_bf16_f32 v193, v194, v195
  v_mfma_f32_16x16x32_bf16 v[52:55], v[84:87], v[100:103], 0
  v_cvt_pk_bf16_f32 v194, v196, v197
  v_cvt_pk_bf16_f32 v195, v198, v199
  v_mfma_f32_16x16x32_bf16 v[48:51], v[84:87], v[96:99], 0
  v_cvt_pk_bf16_f32 v200, v200, v201
  v_cvt_pk_bf16_f32 v201, v202, v203
  s_waitcnt lgkmcnt(2)
  v_mfma_f32_16x16x32_bf16 v[64:67], v[88:91], v[96:99], 0
  ds_read_b64_tr_b16 v[80:81], v31 offset:0
  v_cvt_pk_bf16_f32 v202, v204, v205
  v_mfma_f32_16x16x32_bf16 v[68:71], v[88:91], v[100:103], 0
  ds_read_b64_tr_b16 v[82:83], v31 offset:512
  v_cvt_pk_bf16_f32 v203, v206, v207
  v_mfma_f32_16x16x32_bf16 v[72:75], v[88:91], v[104:107], 0
  v_cvt_pk_bf16_f32 v208, v208, v209
  v_cvt_pk_bf16_f32 v209, v210, v211
  v_mfma_f32_16x16x32_bf16 v[76:79], v[88:91], v[108:111], 0
  ds_read_b128 v[112:115], v24 offset:0
  v_cvt_pk_bf16_f32 v210, v212, v213
  s_waitcnt lgkmcnt(3)
  v_mfma_f32_16x16x32_bf16 v[152:155], v[92:95], v[108:111], 0
  ds_read_b64_tr_b16 v[84:85], v14 offset:0
  v_cvt_pk_bf16_f32 v211, v214, v215
  v_mfma_f32_16x16x32_bf16 v[144:147], v[92:95], v[104:107], 0
  ds_read_b64_tr_b16 v[86:87], v14 offset:512
  v_cvt_pk_bf16_f32 v216, v216, v217
  v_mfma_f32_16x16x32_bf16 v[136:139], v[92:95], v[100:103], 0
  v_cvt_pk_bf16_f32 v217, v218, v219
  v_cvt_pk_bf16_f32 v218, v220, v221
  v_mfma_f32_16x16x32_bf16 v[128:131], v[92:95], v[96:99], 0
  ds_read_b128 v[116:119], v24 offset:2048
  v_cvt_pk_bf16_f32 v219, v222, v223
  s_waitcnt lgkmcnt(4)
  v_mfma_f32_16x16x32_bf16 v[132:135], v[80:83], v[96:99], 0
  ds_read_b64_tr_b16 v[88:89], v31 offset:8192
  v_cvt_pk_bf16_f32 v224, v224, v225
  v_mfma_f32_16x16x32_bf16 v[140:143], v[80:83], v[100:103], 0
  ds_read_b64_tr_b16 v[90:91], v31 offset:8704
  v_cvt_pk_bf16_f32 v225, v226, v227
  v_mfma_f32_16x16x32_bf16 v[148:151], v[80:83], v[104:107], 0
  v_cvt_pk_bf16_f32 v226, v228, v229
  v_cvt_pk_bf16_f32 v227, v230, v231
  v_mfma_f32_16x16x32_bf16 v[156:159], v[80:83], v[108:111], 0
  ds_read_b128 v[120:123], v26 offset:0
  v_cvt_pk_bf16_f32 v232, v232, v233
  s_waitcnt lgkmcnt(4)
  v_mfma_f32_16x16x32_bf16 v[188:191], v[84:87], v[108:111], 0
  ds_read_b64_tr_b16 v[92:93], v14 offset:8192
  v_cvt_pk_bf16_f32 v233, v234, v235
  v_mfma_f32_16x16x32_bf16 v[180:183], v[84:87], v[104:107], 0
  ds_read_b64_tr_b16 v[94:95], v14 offset:8704
  v_cvt_pk_bf16_f32 v234, v236, v237
  v_mfma_f32_16x16x32_bf16 v[172:175], v[84:87], v[100:103], 0
  v_cvt_pk_bf16_f32 v235, v238, v239
  v_cvt_pk_bf16_f32 v240, v240, v241
  v_mfma_f32_16x16x32_bf16 v[164:167], v[84:87], v[96:99], 0
  ds_read_b128 v[124:127], v26 offset:2048
  v_cvt_pk_bf16_f32 v241, v242, v243
  s_waitcnt lgkmcnt(4)
  v_mfma_f32_16x16x32_bf16 v[196:199], v[88:91], v[96:99], 0
  ds_read_b64_tr_b16 v[80:81], v27 offset:4096
  v_cvt_pk_bf16_f32 v242, v244, v245
  v_mfma_f32_16x16x32_bf16 v[204:207], v[88:91], v[100:103], 0
  ds_read_b64_tr_b16 v[82:83], v27 offset:4608
  v_cvt_pk_bf16_f32 v243, v246, v247
  v_mfma_f32_16x16x32_bf16 v[212:215], v[88:91], v[104:107], 0
  v_cvt_pk_bf16_f32 v248, v248, v249
  v_cvt_pk_bf16_f32 v249, v250, v251
  v_mfma_f32_16x16x32_bf16 v[220:223], v[88:91], v[108:111], 0
  v_cvt_pk_bf16_f32 v250, v252, v253
  v_cvt_pk_bf16_f32 v251, v254, v255
  s_waitcnt lgkmcnt(3)
  v_mfma_f32_16x16x32_bf16 v[252:255], v[92:95], v[108:111], 0
  ds_read_b64_tr_b16 v[84:85], v28 offset:4096
  v_mfma_f32_16x16x32_bf16 v[244:247], v[92:95], v[104:107], 0
  ds_read_b64_tr_b16 v[86:87], v28 offset:4608
  v_mfma_f32_16x16x32_bf16 v[236:239], v[92:95], v[100:103], 0
  v_mfma_f32_16x16x32_bf16 v[228:231], v[92:95], v[96:99], 0
  s_waitcnt lgkmcnt(2)
  v_mfma_f32_16x16x32_bf16 v[32:35], v[80:83], v[112:115], v[32:35]
  ds_read_b64_tr_b16 v[88:89], v29 offset:4096
  v_mfma_f32_16x16x32_bf16 v[36:39], v[80:83], v[116:119], v[36:39]
  ds_read_b64_tr_b16 v[90:91], v29 offset:4608
  v_mfma_f32_16x16x32_bf16 v[40:43], v[80:83], v[120:123], v[40:43]
  v_mfma_f32_16x16x32_bf16 v[44:47], v[80:83], v[124:127], v[44:47]
  s_waitcnt lgkmcnt(2)
  v_mfma_f32_16x16x32_bf16 v[60:63], v[84:87], v[124:127], v[60:63]
  ds_read_b64_tr_b16 v[92:93], v30 offset:4096
  v_mfma_f32_16x16x32_bf16 v[56:59], v[84:87], v[120:123], v[56:59]
  ds_read_b64_tr_b16 v[94:95], v30 offset:4608
  v_mfma_f32_16x16x32_bf16 v[52:55], v[84:87], v[116:119], v[52:55]
  v_mfma_f32_16x16x32_bf16 v[48:51], v[84:87], v[112:115], v[48:51]
  s_waitcnt lgkmcnt(2)
  v_mfma_f32_16x16x32_bf16 v[64:67], v[88:91], v[112:115], v[64:67]
  ds_read_b64_tr_b16 v[80:81], v31 offset:4096
  v_mfma_f32_16x16x32_bf16 v[68:71], v[88:91], v[116:119], v[68:71]
  ds_read_b64_tr_b16 v[82:83], v31 offset:4608
  v_mfma_f32_16x16x32_bf16 v[72:75], v[88:91], v[120:123], v[72:75]
  v_mfma_f32_16x16x32_bf16 v[76:79], v[88:91], v[124:127], v[76:79]
  s_waitcnt lgkmcnt(2)
  v_mfma_f32_16x16x32_bf16 v[152:155], v[92:95], v[124:127], v[152:155]
  ds_read_b64_tr_b16 v[84:85], v14 offset:4096
  buffer_store_dwordx4 v[160:163], v16, s[12:15], s70 offen offset:0 sc1
  v_mfma_f32_16x16x32_bf16 v[144:147], v[92:95], v[120:123], v[144:147]
  ds_read_b64_tr_b16 v[86:87], v14 offset:4608
  buffer_load_dword v13, v5, s[20:23], s77 offen
  s_add_u32 s77, s77, s78
  v_mfma_f32_16x16x32_bf16 v[136:139], v[92:95], v[116:119], v[136:139]
  v_mfma_f32_16x16x32_bf16 v[128:131], v[92:95], v[112:115], v[128:131]
  s_waitcnt lgkmcnt(2)
  v_mfma_f32_16x16x32_bf16 v[132:135], v[80:83], v[112:115], v[132:135]
  ds_read_b64_tr_b16 v[88:89], v31 offset:12288
  v_mfma_f32_16x16x32_bf16 v[140:143], v[80:83], v[116:119], v[140:143]
  ds_read_b64_tr_b16 v[90:91], v31 offset:12800
  v_mfma_f32_16x16x32_bf16 v[148:151], v[80:83], v[120:123], v[148:151]
  v_mfma_f32_16x16x32_bf16 v[156:159], v[80:83], v[124:127], v[156:159]
  s_waitcnt lgkmcnt(2)
  v_mfma_f32_16x16x32_bf16 v[188:191], v[84:87], v[124:127], v[188:191]
  ds_read_b64_tr_b16 v[92:93], v14 offset:12288
  buffer_store_dwordx4 v[168:171], v16, s[12:15], s70 offen offset:1024 sc1
  s_add_u32 s70, s70, 8192
  v_mfma_f32_16x16x32_bf16 v[180:183], v[84:87], v[120:123], v[180:183]
  ds_read_b64_tr_b16 v[94:95], v14 offset:12800
  v_mfma_f32_16x16x32_bf16 v[172:175], v[84:87], v[116:119], v[172:175]
  v_mfma_f32_16x16x32_bf16 v[164:167], v[84:87], v[112:115], v[164:167]
  s_waitcnt lgkmcnt(0)
  s_barrier
  v_mfma_f32_16x16x32_bf16 v[196:199], v[88:91], v[112:115], v[196:199]
  ds_read_b64_tr_b16 v[80:81], v27 offset:32768
  ds_read_b64_tr_b16 v[82:83], v27 offset:33280
  v_mfma_f32_16x16x32_bf16 v[204:207], v[88:91], v[116:119], v[204:207]
  ds_read_b128 v[96:99], v23 offset:32768
  ds_read_b128 v[100:103], v23 offset:34816
  v_mfma_f32_16x16x32_bf16 v[212:215], v[88:91], v[120:123], v[212:215]
  ds_read_b128 v[104:107], v25 offset:32768
  ds_read_b128 v[108:111], v25 offset:34816
  v_mfma_f32_16x16x32_bf16 v[220:223], v[88:91], v[124:127], v[220:223]
  ds_read_b64_tr_b16 v[84:85], v28 offset:32768
  ds_read_b64_tr_b16 v[86:87], v28 offset:33280
  v_mfma_f32_16x16x32_bf16 v[252:255], v[92:95], v[124:127], v[252:255]
  v_mfma_f32_16x16x32_bf16 v[244:247], v[92:95], v[120:123], v[244:247]
  v_mfma_f32_16x16x32_bf16 v[236:239], v[92:95], v[116:119], v[236:239]
  v_mfma_f32_16x16x32_bf16 v[228:231], v[92:95], v[112:115], v[228:231]
  s_waitcnt lgkmcnt(5)
  v_mfma_f32_16x16x32_bf16 v[32:35], v[80:83], v[96:99], v[32:35]
  ds_read_b64_tr_b16 v[88:89], v29 offset:32768
  s_waitcnt lgkmcnt(5)
  v_mfma_f32_16x16x32_bf16 v[36:39], v[80:83], v[100:103], v[36:39]
  ds_read_b64_tr_b16 v[90:91], v29 offset:33280
  s_waitcnt lgkmcnt(5)
  v_mfma_f32_16x16x32_bf16 v[40:43], v[80:83], v[104:107], v[40:43]
  s_waitcnt lgkmcnt(4)
  v_mfma_f32_16x16x32_bf16 v[44:47], v[80:83], v[108:111], v[44:47]
  s_waitcnt lgkmcnt(2)
  v_mfma_f32_16x16x32_bf16 v[60:63], v[84:87], v[108:111], v[60:63]
  ds_read_b64_tr_b16 v[92:93], v30 offset:32768
  v_mfma_f32_16x16x32_bf16 v[56:59], v[84:87], v[104:107], v[56:59]
  ds_read_b64_tr_b16 v[94:95], v30 offset:33280
  v_mfma_f32_16x16x32_bf16 v[52:55], v[84:87], v[100:103], v[52:55]
  v_mfma_f32_16x16x32_bf16 v[48:51], v[84:87], v[96:99], v[48:51]
  s_waitcnt lgkmcnt(2)
  v_mfma_f32_16x16x32_bf16 v[64:67], v[88:91], v[96:99], v[64:67]
  ds_read_b64_tr_b16 v[80:81], v31 offset:32768
  v_mfma_f32_16x16x32_bf16 v[68:71], v[88:91], v[100:103], v[68:71]
  ds_read_b64_tr_b16 v[82:83], v31 offset:33280
  v_mfma_f32_16x16x32_bf16 v[72:75], v[88:91], v[104:107], v[72:75]
  v_mfma_f32_16x16x32_bf16 v[76:79], v[88:91], v[108:111], v[76:79]
  ds_read_b128 v[112:115], v24 offset:32768
  s_waitcnt lgkmcnt(3)
  v_mfma_f32_16x16x32_bf16 v[152:155], v[92:95], v[108:111], v[152:155]
  ds_read_b64_tr_b16 v[84:85], v14 offset:32768
  v_mfma_f32_16x16x32_bf16 v[144:147], v[92:95], v[104:107], v[144:147]
  ds_read_b64_tr_b16 v[86:87], v14 offset:33280
  v_mfma_f32_16x16x32_bf16 v[136:139], v[92:95], v[100:103], v[136:139]
  v_mfma_f32_16x16x32_bf16 v[128:131], v[92:95], v[96:99], v[128:131]
  ds_read_b128 v[116:119], v24 offset:34816
  s_waitcnt lgkmcnt(4)
  v_mfma_f32_16x16x32_bf16 v[132:135], v[80:83], v[96:99], v[132:135]
  ds_read_b64_tr_b16 v[88:89], v31 offset:40960
  v_mfma_f32_16x16x32_bf16 v[140:143], v[80:83], v[100:103], v[140:143]
  ds_read_b64_tr_b16 v[90:91], v31 offset:41472
  v_mfma_f32_16x16x32_bf16 v[148:151], v[80:83], v[104:107], v[148:151]
  v_mfma_f32_16x16x32_bf16 v[156:159], v[80:83], v[108:111], v[156:159]
  ds_read_b128 v[120:123], v26 offset:32768
  s_waitcnt lgkmcnt(4)
  v_mfma_f32_16x16x32_bf16 v[188:191], v[84:87], v[108:111], v[188:191]
  ds_read_b64_tr_b16 v[92:93], v14 offset:40960
  v_mfma_f32_16x16x32_bf16 v[180:183], v[84:87], v[104:107], v[180:183]
  ds_read_b64_tr_b16 v[94:95], v14 offset:41472
  v_mfma_f32_16x16x32_bf16 v[172:175], v[84:87], v[100:103], v[172:175]
  v_mfma_f32_16x16x32_bf16 v[164:167], v[84:87], v[96:99], v[164:167]
  ds_read_b128 v[124:127], v26 offset:34816
  s_waitcnt lgkmcnt(4)
  v_mfma_f32_16x16x32_bf16 v[196:199], v[88:91], v[96:99], v[196:199]
  ds_read_b64_tr_b16 v[80:81], v27 offset:36864
  v_mfma_f32_16x16x32_bf16 v[204:207], v[88:91], v[100:103], v[204:207]
  ds_read_b64_tr_b16 v[82:83], v27 offset:37376
  v_mfma_f32_16x16x32_bf16 v[212:215], v[88:91], v[104:107], v[212:215]
  v_mfma_f32_16x16x32_bf16 v[220:223], v[88:91], v[108:111], v[220:223]
  s_waitcnt lgkmcnt(3)
  v_mfma_f32_16x16x32_bf16 v[252:255], v[92:95], v[108:111], v[252:255]
  ds_read_b64_tr_b16 v[84:85], v28 offset:36864
  v_mfma_f32_16x16x32_bf16 v[244:247], v[92:95], v[104:107], v[244:247]
  ds_read_b64_tr_b16 v[86:87], v28 offset:37376
  v_mfma_f32_16x16x32_bf16 v[236:239], v[92:95], v[100:103], v[236:239]
  v_mfma_f32_16x16x32_bf16 v[228:231], v[92:95], v[96:99], v[228:231]
  s_waitcnt lgkmcnt(2)
  v_mfma_f32_16x16x32_bf16 v[32:35], v[80:83], v[112:115], v[32:35]
  ds_read_b64_tr_b16 v[88:89], v29 offset:36864
  v_mfma_f32_16x16x32_bf16 v[36:39], v[80:83], v[116:119], v[36:39]
  ds_read_b64_tr_b16 v[90:91], v29 offset:37376
  v_mfma_f32_16x16x32_bf16 v[40:43], v[80:83], v[120:123], v[40:43]
  v_mfma_f32_16x16x32_bf16 v[44:47], v[80:83], v[124:127], v[44:47]
  s_waitcnt lgkmcnt(2)
  v_mfma_f32_16x16x32_bf16 v[60:63], v[84:87], v[124:127], v[60:63]
  ds_read_b64_tr_b16 v[92:93], v30 offset:36864
  v_mfma_f32_16x16x32_bf16 v[56:59], v[84:87], v[120:123], v[56:59]
  ds_read_b64_tr_b16 v[94:95], v30 offset:37376
  v_mfma_f32_16x16x32_bf16 v[52:55], v[84:87], v[116:119], v[52:55]
  v_mfma_f32_16x16x32_bf16 v[48:51], v[84:87], v[112:115], v[48:51]
  s_waitcnt lgkmcnt(2)
  v_mfma_f32_16x16x32_bf16 v[64:67], v[88:91], v[112:115], v[64:67]
  ds_read_b64_tr_b16 v[80:81], v31 offset:36864
  v_mfma_f32_16x16x32_bf16 v[68:71], v[88:91], v[116:119], v[68:71]
  ds_read_b64_tr_b16 v[82:83], v31 offset:37376
  v_mfma_f32_16x16x32_bf16 v[72:75], v[88:91], v[120:123], v[72:75]
  v_mfma_f32_16x16x32_bf16 v[76:79], v[88:91], v[124:127], v[76:79]
  s_waitcnt lgkmcnt(2)
  v_mfma_f32_16x16x32_bf16 v[152:155], v[92:95], v[124:127], v[152:155]
  ds_read_b64_tr_b16 v[84:85], v14 offset:36864
  buffer_store_dwordx4 v[176:179], v16, s[12:15], s71 offen offset:0 sc1
  v_mfma_f32_16x16x32_bf16 v[144:147], v[92:95], v[120:123], v[144:147]
  ds_read_b64_tr_b16 v[86:87], v14 offset:37376
  buffer_load_dword v13, v4, s[16:19], s76 offen offset:512
  v_mfma_f32_16x16x32_bf16 v[136:139], v[92:95], v[116:119], v[136:139]
  v_mfma_f32_16x16x32_bf16 v[128:131], v[92:95], v[112:115], v[128:131]
  s_waitcnt lgkmcnt(2)
  v_mfma_f32_16x16x32_bf16 v[132:135], v[80:83], v[112:115], v[132:135]
  ds_read_b64_tr_b16 v[88:89], v31 offset:45056
  v_mfma_f32_16x16x32_bf16 v[140:143], v[80:83], v[116:119], v[140:143]
  ds_read_b64_tr_b16 v[90:91], v31 offset:45568
  v_mfma_f32_16x16x32_bf16 v[148:151], v[80:83], v[120:123], v[148:151]
  v_mfma_f32_16x16x32_bf16 v[156:159], v[80:83], v[124:127], v[156:159]
  s_waitcnt lgkmcnt(2)
  v_mfma_f32_16x16x32_bf16 v[188:191], v[84:87], v[124:127], v[188:191]
  ds_read_b64_tr_b16 v[92:93], v14 offset:45056
  buffer_store_dwordx4 v[184:187], v16, s[12:15], s71 offen offset:1024 sc1
  s_add_u32 s71, s71, 8192
  v_mfma_f32_16x16x32_bf16 v[180:183], v[84:87], v[120:123], v[180:183]
  ds_read_b64_tr_b16 v[94:95], v14 offset:45568
  v_mfma_f32_16x16x32_bf16 v[172:175], v[84:87], v[116:119], v[172:175]
  v_mfma_f32_16x16x32_bf16 v[164:167], v[84:87], v[112:115], v[164:167]
  s_waitcnt lgkmcnt(0)
  s_barrier
  v_mfma_f32_16x16x32_bf16 v[196:199], v[88:91], v[112:115], v[196:199]
  ds_read_b64_tr_b16 v[80:81], v27 offset:0
  ds_read_b64_tr_b16 v[82:83], v27 offset:512
  v_mfma_f32_16x16x32_bf16 v[204:207], v[88:91], v[116:119], v[204:207]
  ds_read_b128 v[96:99], v23 offset:0
  ds_read_b128 v[100:103], v23 offset:2048
  v_mfma_f32_16x16x32_bf16 v[212:215], v[88:91], v[120:123], v[212:215]
  ds_read_b128 v[104:107], v25 offset:0
  ds_read_b128 v[108:111], v25 offset:2048
  v_mfma_f32_16x16x32_bf16 v[220:223], v[88:91], v[124:127], v[220:223]
  ds_read_b64_tr_b16 v[84:85], v28 offset:0
  ds_read_b64_tr_b16 v[86:87], v28 offset:512
  v_mfma_f32_16x16x32_bf16 v[252:255], v[92:95], v[124:127], v[252:255]
  v_mfma_f32_16x16x32_bf16 v[244:247], v[92:95], v[120:123], v[244:247]
  v_mfma_f32_16x16x32_bf16 v[236:239], v[92:95], v[116:119], v[236:239]
  v_mfma_f32_16x16x32_bf16 v[228:231], v[92:95], v[112:115], v[228:231]
  s_waitcnt lgkmcnt(5)
  v_mfma_f32_16x16x32_bf16 v[32:35], v[80:83], v[96:99], v[32:35]
  ds_read_b64_tr_b16 v[88:89], v29 offset:0
  s_waitcnt lgkmcnt(5)
  v_mfma_f32_16x16x32_bf16 v[36:39], v[80:83], v[100:103], v[36:39]
  ds_read_b64_tr_b16 v[90:91], v29 offset:512
  s_waitcnt lgkmcnt(5)
  v_mfma_f32_16x16x32_bf16 v[40:43], v[80:83], v[104:107], v[40:43]
  s_waitcnt lgkmcnt(4)
  v_mfma_f32_16x16x32_bf16 v[44:47], v[80:83], v[108:111], v[44:47]
  s_waitcnt lgkmcnt(2)
  v_mfma_f32_16x16x32_bf16 v[60:63], v[84:87], v[108:111], v[60:63]
  ds_read_b64_tr_b16 v[92:93], v30 offset:0
  v_mfma_f32_16x16x32_bf16 v[56:59], v[84:87], v[104:107], v[56:59]
  ds_read_b64_tr_b16 v[94:95], v30 offset:512
  v_mfma_f32_16x16x32_bf16 v[52:55], v[84:87], v[100:103], v[52:55]
  v_mfma_f32_16x16x32_bf16 v[48:51], v[84:87], v[96:99], v[48:51]
  s_waitcnt lgkmcnt(2)
  v_mfma_f32_16x16x32_bf16 v[64:67], v[88:91], v[96:99], v[64:67]
  ds_read_b64_tr_b16 v[80:81], v31 offset:0
  v_mfma_f32_16x16x32_bf16 v[68:71], v[88:91], v[100:103], v[68:71]
  ds_read_b64_tr_b16 v[82:83], v31 offset:512
  v_mfma_f32_16x16x32_bf16 v[72:75], v[88:91], v[104:107], v[72:75]
  v_mfma_f32_16x16x32_bf16 v[76:79], v[88:91], v[108:111], v[76:79]
  ds_read_b128 v[112:115], v24 offset:0
  s_waitcnt lgkmcnt(3)
  v_mfma_f32_16x16x32_bf16 v[152:155], v[92:95], v[108:111], v[152:155]
  ds_read_b64_tr_b16 v[84:85], v14 offset:0
  v_mfma_f32_16x16x32_bf16 v[144:147], v[92:95], v[104:107], v[144:147]
  ds_read_b64_tr_b16 v[86:87], v14 offset:512
  v_mfma_f32_16x16x32_bf16 v[136:139], v[92:95], v[100:103], v[136:139]
  v_mfma_f32_16x16x32_bf16 v[128:131], v[92:95], v[96:99], v[128:131]
  ds_read_b128 v[116:119], v24 offset:2048
  s_waitcnt lgkmcnt(4)
  v_mfma_f32_16x16x32_bf16 v[132:135], v[80:83], v[96:99], v[132:135]
  ds_read_b64_tr_b16 v[88:89], v31 offset:8192
  v_mfma_f32_16x16x32_bf16 v[140:143], v[80:83], v[100:103], v[140:143]
  ds_read_b64_tr_b16 v[90:91], v31 offset:8704
  v_mfma_f32_16x16x32_bf16 v[148:151], v[80:83], v[104:107], v[148:151]
  v_mfma_f32_16x16x32_bf16 v[156:159], v[80:83], v[108:111], v[156:159]
  ds_read_b128 v[120:123], v26 offset:0
  s_waitcnt lgkmcnt(4)
  v_mfma_f32_16x16x32_bf16 v[188:191], v[84:87], v[108:111], v[188:191]
  ds_read_b64_tr_b16 v[92:93], v14 offset:8192
  v_mfma_f32_16x16x32_bf16 v[180:183], v[84:87], v[104:107], v[180:183]
  ds_read_b64_tr_b16 v[94:95], v14 offset:8704
  v_mfma_f32_16x16x32_bf16 v[172:175], v[84:87], v[100:103], v[172:175]
  v_mfma_f32_16x16x32_bf16 v[164:167], v[84:87], v[96:99], v[164:167]
  ds_read_b128 v[124:127], v26 offset:2048
  s_waitcnt lgkmcnt(4)
  v_mfma_f32_16x16x32_bf16 v[196:199], v[88:91], v[96:99], v[196:199]
  ds_read_b64_tr_b16 v[80:81], v27 offset:4096
  v_mfma_f32_16x16x32_bf16 v[204:207], v[88:91], v[100:103], v[204:207]
  ds_read_b64_tr_b16 v[82:83], v27 offset:4608
  v_mfma_f32_16x16x32_bf16 v[212:215], v[88:91], v[104:107], v[212:215]
  v_mfma_f32_16x16x32_bf16 v[220:223], v[88:91], v[108:111], v[220:223]
  s_waitcnt lgkmcnt(3)
  v_mfma_f32_16x16x32_bf16 v[252:255], v[92:95], v[108:111], v[252:255]
  ds_read_b64_tr_b16 v[84:85], v28 offset:4096
  v_mfma_f32_16x16x32_bf16 v[244:247], v[92:95], v[104:107], v[244:247]
  ds_read_b64_tr_b16 v[86:87], v28 offset:4608
  v_mfma_f32_16x16x32_bf16 v[236:239], v[92:95], v[100:103], v[236:239]
  v_mfma_f32_16x16x32_bf16 v[228:231], v[92:95], v[96:99], v[228:231]
  s_waitcnt lgkmcnt(2)
  v_mfma_f32_16x16x32_bf16 v[32:35], v[80:83], v[112:115], v[32:35]
  ds_read_b64_tr_b16 v[88:89], v29 offset:4096
  v_mfma_f32_16x16x32_bf16 v[36:39], v[80:83], v[116:119], v[36:39]
  ds_read_b64_tr_b16 v[90:91], v29 offset:4608
  v_mfma_f32_16x16x32_bf16 v[40:43], v[80:83], v[120:123], v[40:43]
  v_mfma_f32_16x16x32_bf16 v[44:47], v[80:83], v[124:127], v[44:47]
  s_waitcnt lgkmcnt(2)
  v_mfma_f32_16x16x32_bf16 v[60:63], v[84:87], v[124:127], v[60:63]
  ds_read_b64_tr_b16 v[92:93], v30 offset:4096
  v_mfma_f32_16x16x32_bf16 v[56:59], v[84:87], v[120:123], v[56:59]
  ds_read_b64_tr_b16 v[94:95], v30 offset:4608
  v_mfma_f32_16x16x32_bf16 v[52:55], v[84:87], v[116:119], v[52:55]
  v_mfma_f32_16x16x32_bf16 v[48:51], v[84:87], v[112:115], v[48:51]
  s_waitcnt lgkmcnt(2)
  v_mfma_f32_16x16x32_bf16 v[64:67], v[88:91], v[112:115], v[64:67]
  ds_read_b64_tr_b16 v[80:81], v31 offset:4096
  v_mfma_f32_16x16x32_bf16 v[68:71], v[88:91], v[116:119], v[68:71]
  ds_read_b64_tr_b16 v[82:83], v31 offset:4608
  v_mfma_f32_16x16x32_bf16 v[72:75], v[88:91], v[120:123], v[72:75]
  v_mfma_f32_16x16x32_bf16 v[76:79], v[88:91], v[124:127], v[76:79]
  s_waitcnt lgkmcnt(2)
  v_mfma_f32_16x16x32_bf16 v[152:155], v[92:95], v[124:127], v[152:155]
  ds_read_b64_tr_b16 v[84:85], v14 offset:4096
  buffer_store_dwordx4 v[192:195], v16, s[12:15], s70 offen offset:0 sc1
  v_mfma_f32_16x16x32_bf16 v[144:147], v[92:95], v[120:123], v[144:147]
  ds_read_b64_tr_b16 v[86:87], v14 offset:4608
  buffer_load_dword v13, v5, s[20:23], s77 offen
  s_add_u32 s77, s77, s78
  v_mfma_f32_16x16x32_bf16 v[136:139], v[92:95], v[116:119], v[136:139]
  v_mfma_f32_16x16x32_bf16 v[128:131], v[92:95], v[112:115], v[128:131]
  s_waitcnt lgkmcnt(2)
  v_mfma_f32_16x16x32_bf16 v[132:135], v[80:83], v[112:115], v[132:135]
  ds_read_b64_tr_b16 v[88:89], v31 offset:12288
  v_mfma_f32_16x16x32_bf16 v[140:143], v[80:83], v[116:119], v[140:143]
  ds_read_b64_tr_b16 v[90:91], v31 offset:12800
  v_mfma_f32_16x16x32_bf16 v[148:151], v[80:83], v[120:123], v[148:151]
  v_mfma_f32_16x16x32_bf16 v[156:159], v[80:83], v[124:127], v[156:159]
  s_waitcnt lgkmcnt(2)
  v_mfma_f32_16x16x32_bf16 v[188:191], v[84:87], v[124:127], v[188:191]
  ds_read_b64_tr_b16 v[92:93], v14 offset:12288
  buffer_store_dwordx4 v[200:203], v16, s[12:15], s70 offen offset:1024 sc1
  s_add_u32 s70, s70, 8192
  v_mfma_f32_16x16x32_bf16 v[180:183], v[84:87], v[120:123], v[180:183]
  ds_read_b64_tr_b16 v[94:95], v14 offset:12800
  v_mfma_f32_16x16x32_bf16 v[172:175], v[84:87], v[116:119], v[172:175]
  v_mfma_f32_16x16x32_bf16 v[164:167], v[84:87], v[112:115], v[164:167]
  s_waitcnt lgkmcnt(0)
  s_barrier
  v_mfma_f32_16x16x32_bf16 v[196:199], v[88:91], v[112:115], v[196:199]
  ds_read_b64_tr_b16 v[80:81], v27 offset:32768
  ds_read_b64_tr_b16 v[82:83], v27 offset:33280
  v_mfma_f32_16x16x32_bf16 v[204:207], v[88:91], v[116:119], v[204:207]
  ds_read_b128 v[96:99], v23 offset:32768
  ds_read_b128 v[100:103], v23 offset:34816
  v_mfma_f32_16x16x32_bf16 v[212:215], v[88:91], v[120:123], v[212:215]
  ds_read_b128 v[104:107], v25 offset:32768
  ds_read_b128 v[108:111], v25 offset:34816
  v_mfma_f32_16x16x32_bf16 v[220:223], v[88:91], v[124:127], v[220:223]
  ds_read_b64_tr_b16 v[84:85], v28 offset:32768
  ds_read_b64_tr_b16 v[86:87], v28 offset:33280
  v_mfma_f32_16x16x32_bf16 v[252:255], v[92:95], v[124:127], v[252:255]
  v_mfma_f32_16x16x32_bf16 v[244:247], v[92:95], v[120:123], v[244:247]
  v_mfma_f32_16x16x32_bf16 v[236:239], v[92:95], v[116:119], v[236:239]
  v_mfma_f32_16x16x32_bf16 v[228:231], v[92:95], v[112:115], v[228:231]
  s_waitcnt lgkmcnt(5)
  v_mfma_f32_16x16x32_bf16 v[32:35], v[80:83], v[96:99], v[32:35]
  ds_read_b64_tr_b16 v[88:89], v29 offset:32768
  s_waitcnt lgkmcnt(5)
  v_mfma_f32_16x16x32_bf16 v[36:39], v[80:83], v[100:103], v[36:39]
  ds_read_b64_tr_b16 v[90:91], v29 offset:33280
  s_waitcnt lgkmcnt(5)
  v_mfma_f32_16x16x32_bf16 v[40:43], v[80:83], v[104:107], v[40:43]
  s_waitcnt lgkmcnt(4)
  v_mfma_f32_16x16x32_bf16 v[44:47], v[80:83], v[108:111], v[44:47]
  s_waitcnt lgkmcnt(2)
  v_mfma_f32_16x16x32_bf16 v[60:63], v[84:87], v[108:111], v[60:63]
  ds_read_b64_tr_b16 v[92:93], v30 offset:32768
  v_mfma_f32_16x16x32_bf16 v[56:59], v[84:87], v[104:107], v[56:59]
  ds_read_b64_tr_b16 v[94:95], v30 offset:33280
  v_mfma_f32_16x16x32_bf16 v[52:55], v[84:87], v[100:103], v[52:55]
  v_mfma_f32_16x16x32_bf16 v[48:51], v[84:87], v[96:99], v[48:51]
  s_waitcnt lgkmcnt(2)
  v_mfma_f32_16x16x32_bf16 v[64:67], v[88:91], v[96:99], v[64:67]
  ds_read_b64_tr_b16 v[80:81], v31 offset:32768
  v_mfma_f32_16x16x32_bf16 v[68:71], v[88:91], v[100:103], v[68:71]
  ds_read_b64_tr_b16 v[82:83], v31 offset:33280
  v_mfma_f32_16x16x32_bf16 v[72:75], v[88:91], v[104:107], v[72:75]
  v_mfma_f32_16x16x32_bf16 v[76:79], v[88:91], v[108:111], v[76:79]
  ds_read_b128 v[112:115], v24 offset:32768
  s_waitcnt lgkmcnt(3)
  v_mfma_f32_16x16x32_bf16 v[152:155], v[92:95], v[108:111], v[152:155]
  ds_read_b64_tr_b16 v[84:85], v14 offset:32768
  v_mfma_f32_16x16x32_bf16 v[144:147], v[92:95], v[104:107], v[144:147]
  ds_read_b64_tr_b16 v[86:87], v14 offset:33280
  v_mfma_f32_16x16x32_bf16 v[136:139], v[92:95], v[100:103], v[136:139]
  v_mfma_f32_16x16x32_bf16 v[128:131], v[92:95], v[96:99], v[128:131]
  ds_read_b128 v[116:119], v24 offset:34816
  s_waitcnt lgkmcnt(4)
  v_mfma_f32_16x16x32_bf16 v[132:135], v[80:83], v[96:99], v[132:135]
  ds_read_b64_tr_b16 v[88:89], v31 offset:40960
  v_mfma_f32_16x16x32_bf16 v[140:143], v[80:83], v[100:103], v[140:143]
  ds_read_b64_tr_b16 v[90:91], v31 offset:41472
  v_mfma_f32_16x16x32_bf16 v[148:151], v[80:83], v[104:107], v[148:151]
  v_mfma_f32_16x16x32_bf16 v[156:159], v[80:83], v[108:111], v[156:159]
  ds_read_b128 v[120:123], v26 offset:32768
  s_waitcnt lgkmcnt(4)
  v_mfma_f32_16x16x32_bf16 v[188:191], v[84:87], v[108:111], v[188:191]
  ds_read_b64_tr_b16 v[92:93], v14 offset:40960
  v_mfma_f32_16x16x32_bf16 v[180:183], v[84:87], v[104:107], v[180:183]
  ds_read_b64_tr_b16 v[94:95], v14 offset:41472
  v_mfma_f32_16x16x32_bf16 v[172:175], v[84:87], v[100:103], v[172:175]
  v_mfma_f32_16x16x32_bf16 v[164:167], v[84:87], v[96:99], v[164:167]
  ds_read_b128 v[124:127], v26 offset:34816
  s_waitcnt lgkmcnt(4)
  v_mfma_f32_16x16x32_bf16 v[196:199], v[88:91], v[96:99], v[196:199]
  ds_read_b64_tr_b16 v[80:81], v27 offset:36864
  v_mfma_f32_16x16x32_bf16 v[204:207], v[88:91], v[100:103], v[204:207]
  ds_read_b64_tr_b16 v[82:83], v27 offset:37376
  v_mfma_f32_16x16x32_bf16 v[212:215], v[88:91], v[104:107], v[212:215]
  v_mfma_f32_16x16x32_bf16 v[220:223], v[88:91], v[108:111], v[220:223]
  s_waitcnt lgkmcnt(3)
  v_mfma_f32_16x16x32_bf16 v[252:255], v[92:95], v[108:111], v[252:255]
  ds_read_b64_tr_b16 v[84:85], v28 offset:36864
  v_mfma_f32_16x16x32_bf16 v[244:247], v[92:95], v[104:107], v[244:247]
  ds_read_b64_tr_b16 v[86:87], v28 offset:37376
  v_mfma_f32_16x16x32_bf16 v[236:239], v[92:95], v[100:103], v[236:239]
  v_mfma_f32_16x16x32_bf16 v[228:231], v[92:95], v[96:99], v[228:231]
  s_waitcnt lgkmcnt(2)
  v_mfma_f32_16x16x32_bf16 v[32:35], v[80:83], v[112:115], v[32:35]
  ds_read_b64_tr_b16 v[88:89], v29 offset:36864
  v_mfma_f32_16x16x32_bf16 v[36:39], v[80:83], v[116:119], v[36:39]
  ds_read_b64_tr_b16 v[90:91], v29 offset:37376
  v_mfma_f32_16x16x32_bf16 v[40:43], v[80:83], v[120:123], v[40:43]
  v_mfma_f32_16x16x32_bf16 v[44:47], v[80:83], v[124:127], v[44:47]
  s_waitcnt lgkmcnt(2)
  v_mfma_f32_16x16x32_bf16 v[60:63], v[84:87], v[124:127], v[60:63]
  ds_read_b64_tr_b16 v[92:93], v30 offset:36864
  v_mfma_f32_16x16x32_bf16 v[56:59], v[84:87], v[120:123], v[56:59]
  ds_read_b64_tr_b16 v[94:95], v30 offset:37376
  v_mfma_f32_16x16x32_bf16 v[52:55], v[84:87], v[116:119], v[52:55]
  v_mfma_f32_16x16x32_bf16 v[48:51], v[84:87], v[112:115], v[48:51]
  s_waitcnt lgkmcnt(2)
  v_mfma_f32_16x16x32_bf16 v[64:67], v[88:91], v[112:115], v[64:67]
  ds_read_b64_tr_b16 v[80:81], v31 offset:36864
  v_mfma_f32_16x16x32_bf16 v[68:71], v[88:91], v[116:119], v[68:71]
  ds_read_b64_tr_b16 v[82:83], v31 offset:37376
  v_mfma_f32_16x16x32_bf16 v[72:75], v[88:91], v[120:123], v[72:75]
  v_mfma_f32_16x16x32_bf16 v[76:79], v[88:91], v[124:127], v[76:79]
  s_waitcnt lgkmcnt(2)
  v_mfma_f32_16x16x32_bf16 v[152:155], v[92:95], v[124:127], v[152:155]
  ds_read_b64_tr_b16 v[84:85], v14 offset:36864
  buffer_store_dwordx4 v[208:211], v16, s[12:15], s71 offen offset:0 sc1
  v_mfma_f32_16x16x32_bf16 v[144:147], v[92:95], v[120:123], v[144:147]
  ds_read_b64_tr_b16 v[86:87], v14 offset:37376
  buffer_load_dword v13, v4, s[16:19], s76 offen offset:768
  v_mfma_f32_16x16x32_bf16 v[136:139], v[92:95], v[116:119], v[136:139]
  v_mfma_f32_16x16x32_bf16 v[128:131], v[92:95], v[112:115], v[128:131]
  s_waitcnt lgkmcnt(2)
  v_mfma_f32_16x16x32_bf16 v[132:135], v[80:83], v[112:115], v[132:135]
  ds_read_b64_tr_b16 v[88:89], v31 offset:45056
  v_mfma_f32_16x16x32_bf16 v[140:143], v[80:83], v[116:119], v[140:143]
  ds_read_b64_tr_b16 v[90:91], v31 offset:45568
  v_mfma_f32_16x16x32_bf16 v[148:151], v[80:83], v[120:123], v[148:151]
  v_mfma_f32_16x16x32_bf16 v[156:159], v[80:83], v[124:127], v[156:159]
  s_waitcnt lgkmcnt(2)
  v_mfma_f32_16x16x32_bf16 v[188:191], v[84:87], v[124:127], v[188:191]
  ds_read_b64_tr_b16 v[92:93], v14 offset:45056
  buffer_store_dwordx4 v[216:219], v16, s[12:15], s71 offen offset:1024 sc1
  s_add_u32 s71, s71, 8192
  v_mfma_f32_16x16x32_bf16 v[180:183], v[84:87], v[120:123], v[180:183]
  ds_read_b64_tr_b16 v[94:95], v14 offset:45568
  v_mfma_f32_16x16x32_bf16 v[172:175], v[84:87], v[116:119], v[172:175]
  v_mfma_f32_16x16x32_bf16 v[164:167], v[84:87], v[112:115], v[164:167]
  s_waitcnt lgkmcnt(0)
  s_barrier
  v_mfma_f32_16x16x32_bf16 v[196:199], v[88:91], v[112:115], v[196:199]
  ds_read_b64_tr_b16 v[80:81], v27 offset:0
  ds_read_b64_tr_b16 v[82:83], v27 offset:512
  v_mfma_f32_16x16x32_bf16 v[204:207], v[88:91], v[116:119], v[204:207]
  ds_read_b128 v[96:99], v23 offset:0
  ds_read_b128 v[100:103], v23 offset:2048
  v_mfma_f32_16x16x32_bf16 v[212:215], v[88:91], v[120:123], v[212:215]
  ds_read_b128 v[104:107], v25 offset:0
  ds_read_b128 v[108:111], v25 offset:2048
  v_mfma_f32_16x16x32_bf16 v[220:223], v[88:91], v[124:127], v[220:223]
  ds_read_b64_tr_b16 v[84:85], v28 offset:0
  ds_read_b64_tr_b16 v[86:87], v28 offset:512
  v_mfma_f32_16x16x32_bf16 v[252:255], v[92:95], v[124:127], v[252:255]
  v_mfma_f32_16x16x32_bf16 v[244:247], v[92:95], v[120:123], v[244:247]
  v_mfma_f32_16x16x32_bf16 v[236:239], v[92:95], v[116:119], v[236:239]
  v_mfma_f32_16x16x32_bf16 v[228:231], v[92:95], v[112:115], v[228:231]
  s_waitcnt lgkmcnt(5)
  v_mfma_f32_16x16x32_bf16 v[32:35], v[80:83], v[96:99], v[32:35]
  ds_read_b64_tr_b16 v[88:89], v29 offset:0
  s_waitcnt lgkmcnt(5)
  v_mfma_f32_16x16x32_bf16 v[36:39], v[80:83], v[100:103], v[36:39]
  ds_read_b64_tr_b16 v[90:91], v29 offset:512
  s_waitcnt lgkmcnt(5)
  v_mfma_f32_16x16x32_bf16 v[40:43], v[80:83], v[104:107], v[40:43]
  s_waitcnt lgkmcnt(4)
  v_mfma_f32_16x16x32_bf16 v[44:47], v[80:83], v[108:111], v[44:47]
  s_waitcnt lgkmcnt(2)
  v_mfma_f32_16x16x32_bf16 v[60:63], v[84:87], v[108:111], v[60:63]
  ds_read_b64_tr_b16 v[92:93], v30 offset:0
  v_mfma_f32_16x16x32_bf16 v[56:59], v[84:87], v[104:107], v[56:59]
  ds_read_b64_tr_b16 v[94:95], v30 offset:512
  v_mfma_f32_16x16x32_bf16 v[52:55], v[84:87], v[100:103], v[52:55]
  v_mfma_f32_16x16x32_bf16 v[48:51], v[84:87], v[96:99], v[48:51]
  s_waitcnt lgkmcnt(2)
  v_mfma_f32_16x16x32_bf16 v[64:67], v[88:91], v[96:99], v[64:67]
  ds_read_b64_tr_b16 v[80:81], v31 offset:0
  v_mfma_f32_16x16x32_bf16 v[68:71], v[88:91], v[100:103], v[68:71]
  ds_read_b64_tr_b16 v[82:83], v31 offset:512
  v_mfma_f32_16x16x32_bf16 v[72:75], v[88:91], v[104:107], v[72:75]
  v_mfma_f32_16x16x32_bf16 v[76:79], v[88:91], v[108:111], v[76:79]
  ds_read_b128 v[112:115], v24 offset:0
  s_waitcnt lgkmcnt(3)
  v_mfma_f32_16x16x32_bf16 v[152:155], v[92:95], v[108:111], v[152:155]
  ds_read_b64_tr_b16 v[84:85], v14 offset:0
  v_mfma_f32_16x16x32_bf16 v[144:147], v[92:95], v[104:107], v[144:147]
  ds_read_b64_tr_b16 v[86:87], v14 offset:512
  v_mfma_f32_16x16x32_bf16 v[136:139], v[92:95], v[100:103], v[136:139]
  v_mfma_f32_16x16x32_bf16 v[128:131], v[92:95], v[96:99], v[128:131]
  ds_read_b128 v[116:119], v24 offset:2048
  s_waitcnt lgkmcnt(4)
  v_mfma_f32_16x16x32_bf16 v[132:135], v[80:83], v[96:99], v[132:135]
  ds_read_b64_tr_b16 v[88:89], v31 offset:8192
  v_mfma_f32_16x16x32_bf16 v[140:143], v[80:83], v[100:103], v[140:143]
  ds_read_b64_tr_b16 v[90:91], v31 offset:8704
  v_mfma_f32_16x16x32_bf16 v[148:151], v[80:83], v[104:107], v[148:151]
  v_mfma_f32_16x16x32_bf16 v[156:159], v[80:83], v[108:111], v[156:159]
  ds_read_b128 v[120:123], v26 offset:0
  s_waitcnt lgkmcnt(4)
  v_mfma_f32_16x16x32_bf16 v[188:191], v[84:87], v[108:111], v[188:191]
  ds_read_b64_tr_b16 v[92:93], v14 offset:8192
  v_mfma_f32_16x16x32_bf16 v[180:183], v[84:87], v[104:107], v[180:183]
  ds_read_b64_tr_b16 v[94:95], v14 offset:8704
  v_mfma_f32_16x16x32_bf16 v[172:175], v[84:87], v[100:103], v[172:175]
  v_mfma_f32_16x16x32_bf16 v[164:167], v[84:87], v[96:99], v[164:167]
  ds_read_b128 v[124:127], v26 offset:2048
  s_waitcnt lgkmcnt(4)
  v_mfma_f32_16x16x32_bf16 v[196:199], v[88:91], v[96:99], v[196:199]
  ds_read_b64_tr_b16 v[80:81], v27 offset:4096
  v_mfma_f32_16x16x32_bf16 v[204:207], v[88:91], v[100:103], v[204:207]
  ds_read_b64_tr_b16 v[82:83], v27 offset:4608
  v_mfma_f32_16x16x32_bf16 v[212:215], v[88:91], v[104:107], v[212:215]
  v_mfma_f32_16x16x32_bf16 v[220:223], v[88:91], v[108:111], v[220:223]
  s_waitcnt lgkmcnt(3)
  v_mfma_f32_16x16x32_bf16 v[252:255], v[92:95], v[108:111], v[252:255]
  ds_read_b64_tr_b16 v[84:85], v28 offset:4096
  v_mfma_f32_16x16x32_bf16 v[244:247], v[92:95], v[104:107], v[244:247]
  ds_read_b64_tr_b16 v[86:87], v28 offset:4608
  v_mfma_f32_16x16x32_bf16 v[236:239], v[92:95], v[100:103], v[236:239]
  v_mfma_f32_16x16x32_bf16 v[228:231], v[92:95], v[96:99], v[228:231]
  s_waitcnt lgkmcnt(2)
  v_mfma_f32_16x16x32_bf16 v[32:35], v[80:83], v[112:115], v[32:35]
  ds_read_b64_tr_b16 v[88:89], v29 offset:4096
  v_mfma_f32_16x16x32_bf16 v[36:39], v[80:83], v[116:119], v[36:39]
  ds_read_b64_tr_b16 v[90:91], v29 offset:4608
  v_mfma_f32_16x16x32_bf16 v[40:43], v[80:83], v[120:123], v[40:43]
  v_mfma_f32_16x16x32_bf16 v[44:47], v[80:83], v[124:127], v[44:47]
  s_waitcnt lgkmcnt(2)
  v_mfma_f32_16x16x32_bf16 v[60:63], v[84:87], v[124:127], v[60:63]
  ds_read_b64_tr_b16 v[92:93], v30 offset:4096
  v_mfma_f32_16x16x32_bf16 v[56:59], v[84:87], v[120:123], v[56:59]
  ds_read_b64_tr_b16 v[94:95], v30 offset:4608
  v_mfma_f32_16x16x32_bf16 v[52:55], v[84:87], v[116:119], v[52:55]
  v_mfma_f32_16x16x32_bf16 v[48:51], v[84:87], v[112:115], v[48:51]
  s_waitcnt lgkmcnt(2)
  v_mfma_f32_16x16x32_bf16 v[64:67], v[88:91], v[112:115], v[64:67]
  ds_read_b64_tr_b16 v[80:81], v31 offset:4096
  v_mfma_f32_16x16x32_bf16 v[68:71], v[88:91], v[116:119], v[68:71]
  ds_read_b64_tr_b16 v[82:83], v31 offset:4608
  v_mfma_f32_16x16x32_bf16 v[72:75], v[88:91], v[120:123], v[72:75]
  v_mfma_f32_16x16x32_bf16 v[76:79], v[88:91], v[124:127], v[76:79]
  s_waitcnt lgkmcnt(2)
  v_mfma_f32_16x16x32_bf16 v[152:155], v[92:95], v[124:127], v[152:155]
  ds_read_b64_tr_b16 v[84:85], v14 offset:4096
  buffer_store_dwordx4 v[224:227], v16, s[12:15], s70 offen offset:0 sc1
  v_mfma_f32_16x16x32_bf16 v[144:147], v[92:95], v[120:123], v[144:147]
  ds_read_b64_tr_b16 v[86:87], v14 offset:4608
  buffer_load_dword v13, v5, s[20:23], s77 offen
  s_add_u32 s77, s77, s78
  v_mfma_f32_16x16x32_bf16 v[136:139], v[92:95], v[116:119], v[136:139]
  v_mfma_f32_16x16x32_bf16 v[128:131], v[92:95], v[112:115], v[128:131]
  s_waitcnt lgkmcnt(2)
  v_mfma_f32_16x16x32_bf16 v[132:135], v[80:83], v[112:115], v[132:135]
  ds_read_b64_tr_b16 v[88:89], v31 offset:12288
  v_mfma_f32_16x16x32_bf16 v[140:143], v[80:83], v[116:119], v[140:143]
  ds_read_b64_tr_b16 v[90:91], v31 offset:12800
  v_mfma_f32_16x16x32_bf16 v[148:151], v[80:83], v[120:123], v[148:151]
  s_getpc_b64 s[34:35]
F_PC5:
  s_sub_u32 s34, s34, F_PC5-gated_mix__compressed_kv_cla__geglu_ffn__prompt_kernel
  s_subb_u32 s35, s35, 0
  s_lshl_b32 s33, s30, 9
  s_add_u32 s33, s33, F_X1A-gated_mix__compressed_kv_cla__geglu_ffn__prompt_kernel
  v_bfe_u32 v1, v16, 4, 2
  v_lshlrev_b32 v1, 7, v1
  v_add_u32 v1, s33, v1
  v_min_u32 v1, F_END-gated_mix__compressed_kv_cla__geglu_ffn__prompt_kernel, v1
  global_load_dword v13, v1, s[34:35]
  s_getpc_b64 s[34:35]
F_PC6:
  s_sub_u32 s34, s34, F_PC6-gated_mix__compressed_kv_cla__geglu_ffn__prompt_kernel
  s_subb_u32 s35, s35, 0
  s_lshl_b32 s33, s30, 9
  s_add_u32 s33, s33, F_X1B-gated_mix__compressed_kv_cla__geglu_ffn__prompt_kernel
  v_bfe_u32 v1, v16, 4, 2
  v_lshlrev_b32 v1, 7, v1
  v_add_u32 v1, s33, v1
  v_min_u32 v1, F_END-gated_mix__compressed_kv_cla__geglu_ffn__prompt_kernel, v1
  global_load_dword v13, v1, s[34:35]
  v_mfma_f32_16x16x32_bf16 v[156:159], v[80:83], v[124:127], v[156:159]
  s_waitcnt lgkmcnt(2)
  v_mfma_f32_16x16x32_bf16 v[188:191], v[84:87], v[124:127], v[188:191]
  ds_read_b64_tr_b16 v[92:93], v14 offset:12288
  buffer_store_dwordx4 v[232:235], v16, s[12:15], s70 offen offset:1024 sc1
  s_add_u32 s70, s70, 8192
  v_mfma_f32_16x16x32_bf16 v[180:183], v[84:87], v[120:123], v[180:183]
  ds_read_b64_tr_b16 v[94:95], v14 offset:12800
  v_mfma_f32_16x16x32_bf16 v[172:175], v[84:87], v[116:119], v[172:175]
  v_mfma_f32_16x16x32_bf16 v[164:167], v[84:87], v[112:115], v[164:167]
  s_waitcnt lgkmcnt(0)
  s_barrier
  v_mfma_f32_16x16x32_bf16 v[196:199], v[88:91], v[112:115], v[196:199]
  ds_read_b64_tr_b16 v[80:81], v27 offset:32768
  ds_read_b64_tr_b16 v[82:83], v27 offset:33280
  v_mfma_f32_16x16x32_bf16 v[204:207], v[88:91], v[116:119], v[204:207]
  ds_read_b128 v[96:99], v23 offset:32768
  ds_read_b128 v[100:103], v23 offset:34816
  v_mfma_f32_16x16x32_bf16 v[212:215], v[88:91], v[120:123], v[212:215]
  ds_read_b128 v[104:107], v25 offset:32768
  ds_read_b128 v[108:111], v25 offset:34816
  v_mfma_f32_16x16x32_bf16 v[220:223], v[88:91], v[124:127], v[220:223]
  ds_read_b64_tr_b16 v[84:85], v28 offset:32768
  ds_read_b64_tr_b16 v[86:87], v28 offset:33280
  v_mfma_f32_16x16x32_bf16 v[252:255], v[92:95], v[124:127], v[252:255]
  v_mfma_f32_16x16x32_bf16 v[244:247], v[92:95], v[120:123], v[244:247]
  v_mfma_f32_16x16x32_bf16 v[236:239], v[92:95], v[116:119], v[236:239]
  v_mfma_f32_16x16x32_bf16 v[228:231], v[92:95], v[112:115], v[228:231]
  s_waitcnt lgkmcnt(5)
  v_mfma_f32_16x16x32_bf16 v[32:35], v[80:83], v[96:99], v[32:35]
  ds_read_b64_tr_b16 v[88:89], v29 offset:32768
  s_waitcnt lgkmcnt(5)
  v_mfma_f32_16x16x32_bf16 v[36:39], v[80:83], v[100:103], v[36:39]
  ds_read_b64_tr_b16 v[90:91], v29 offset:33280
  s_waitcnt lgkmcnt(5)
  v_mfma_f32_16x16x32_bf16 v[40:43], v[80:83], v[104:107], v[40:43]
  s_waitcnt lgkmcnt(4)
  v_mfma_f32_16x16x32_bf16 v[44:47], v[80:83], v[108:111], v[44:47]
  s_waitcnt lgkmcnt(2)
  v_mfma_f32_16x16x32_bf16 v[60:63], v[84:87], v[108:111], v[60:63]
  ds_read_b64_tr_b16 v[92:93], v30 offset:32768
  v_mfma_f32_16x16x32_bf16 v[56:59], v[84:87], v[104:107], v[56:59]
  ds_read_b64_tr_b16 v[94:95], v30 offset:33280
  v_mfma_f32_16x16x32_bf16 v[52:55], v[84:87], v[100:103], v[52:55]
  v_mfma_f32_16x16x32_bf16 v[48:51], v[84:87], v[96:99], v[48:51]
  s_waitcnt lgkmcnt(2)
  v_mfma_f32_16x16x32_bf16 v[64:67], v[88:91], v[96:99], v[64:67]
  ds_read_b64_tr_b16 v[80:81], v31 offset:32768
  v_mfma_f32_16x16x32_bf16 v[68:71], v[88:91], v[100:103], v[68:71]
  ds_read_b64_tr_b16 v[82:83], v31 offset:33280
  v_mfma_f32_16x16x32_bf16 v[72:75], v[88:91], v[104:107], v[72:75]
  v_mfma_f32_16x16x32_bf16 v[76:79], v[88:91], v[108:111], v[76:79]
  ds_read_b128 v[112:115], v24 offset:32768
  s_waitcnt lgkmcnt(3)
  v_mfma_f32_16x16x32_bf16 v[152:155], v[92:95], v[108:111], v[152:155]
  ds_read_b64_tr_b16 v[84:85], v14 offset:32768
  v_mfma_f32_16x16x32_bf16 v[144:147], v[92:95], v[104:107], v[144:147]
  ds_read_b64_tr_b16 v[86:87], v14 offset:33280
  v_mfma_f32_16x16x32_bf16 v[136:139], v[92:95], v[100:103], v[136:139]
  v_mfma_f32_16x16x32_bf16 v[128:131], v[92:95], v[96:99], v[128:131]
  ds_read_b128 v[116:119], v24 offset:34816
  s_waitcnt lgkmcnt(4)
  v_mfma_f32_16x16x32_bf16 v[132:135], v[80:83], v[96:99], v[132:135]
  ds_read_b64_tr_b16 v[88:89], v31 offset:40960
  v_mfma_f32_16x16x32_bf16 v[140:143], v[80:83], v[100:103], v[140:143]
  ds_read_b64_tr_b16 v[90:91], v31 offset:41472
  v_mfma_f32_16x16x32_bf16 v[148:151], v[80:83], v[104:107], v[148:151]
  v_mfma_f32_16x16x32_bf16 v[156:159], v[80:83], v[108:111], v[156:159]
  ds_read_b128 v[120:123], v26 offset:32768
  s_waitcnt lgkmcnt(4)
  v_mfma_f32_16x16x32_bf16 v[188:191], v[84:87], v[108:111], v[188:191]
  ds_read_b64_tr_b16 v[92:93], v14 offset:40960
  v_mfma_f32_16x16x32_bf16 v[180:183], v[84:87], v[104:107], v[180:183]
  ds_read_b64_tr_b16 v[94:95], v14 offset:41472
  v_mfma_f32_16x16x32_bf16 v[172:175], v[84:87], v[100:103], v[172:175]
  v_mfma_f32_16x16x32_bf16 v[164:167], v[84:87], v[96:99], v[164:167]
  ds_read_b128 v[124:127], v26 offset:34816
  s_waitcnt lgkmcnt(4)
  v_mfma_f32_16x16x32_bf16 v[196:199], v[88:91], v[96:99], v[196:199]
  ds_read_b64_tr_b16 v[80:81], v27 offset:36864
  v_mfma_f32_16x16x32_bf16 v[204:207], v[88:91], v[100:103], v[204:207]
  ds_read_b64_tr_b16 v[82:83], v27 offset:37376
  v_mfma_f32_16x16x32_bf16 v[212:215], v[88:91], v[104:107], v[212:215]
  v_mfma_f32_16x16x32_bf16 v[220:223], v[88:91], v[108:111], v[220:223]
  s_waitcnt lgkmcnt(3)
  v_mfma_f32_16x16x32_bf16 v[252:255], v[92:95], v[108:111], v[252:255]
  ds_read_b64_tr_b16 v[84:85], v28 offset:36864
  v_mfma_f32_16x16x32_bf16 v[244:247], v[92:95], v[104:107], v[244:247]
  ds_read_b64_tr_b16 v[86:87], v28 offset:37376
  v_mfma_f32_16x16x32_bf16 v[236:239], v[92:95], v[100:103], v[236:239]
  v_mfma_f32_16x16x32_bf16 v[228:231], v[92:95], v[96:99], v[228:231]
  s_waitcnt lgkmcnt(2)
  v_mfma_f32_16x16x32_bf16 v[32:35], v[80:83], v[112:115], v[32:35]
  ds_read_b64_tr_b16 v[88:89], v29 offset:36864
  v_mfma_f32_16x16x32_bf16 v[36:39], v[80:83], v[116:119], v[36:39]
  ds_read_b64_tr_b16 v[90:91], v29 offset:37376
  v_mfma_f32_16x16x32_bf16 v[40:43], v[80:83], v[120:123], v[40:43]
  v_mfma_f32_16x16x32_bf16 v[44:47], v[80:83], v[124:127], v[44:47]
  s_waitcnt lgkmcnt(2)
  v_mfma_f32_16x16x32_bf16 v[60:63], v[84:87], v[124:127], v[60:63]
  ds_read_b64_tr_b16 v[92:93], v30 offset:36864
  v_mfma_f32_16x16x32_bf16 v[56:59], v[84:87], v[120:123], v[56:59]
  ds_read_b64_tr_b16 v[94:95], v30 offset:37376
  v_mfma_f32_16x16x32_bf16 v[52:55], v[84:87], v[116:119], v[52:55]
  v_mfma_f32_16x16x32_bf16 v[48:51], v[84:87], v[112:115], v[48:51]
  s_waitcnt lgkmcnt(2)
  v_mfma_f32_16x16x32_bf16 v[64:67], v[88:91], v[112:115], v[64:67]
  ds_read_b64_tr_b16 v[80:81], v31 offset:36864
  v_mfma_f32_16x16x32_bf16 v[68:71], v[88:91], v[116:119], v[68:71]
  ds_read_b64_tr_b16 v[82:83], v31 offset:37376
  v_mfma_f32_16x16x32_bf16 v[72:75], v[88:91], v[120:123], v[72:75]
  v_mfma_f32_16x16x32_bf16 v[76:79], v[88:91], v[124:127], v[76:79]
  s_waitcnt lgkmcnt(2)
  v_mfma_f32_16x16x32_bf16 v[152:155], v[92:95], v[124:127], v[152:155]
  ds_read_b64_tr_b16 v[84:85], v14 offset:36864
  buffer_store_dwordx4 v[240:243], v16, s[12:15], s71 offen offset:0 sc1
  v_mfma_f32_16x16x32_bf16 v[144:147], v[92:95], v[120:123], v[144:147]
  ds_read_b64_tr_b16 v[86:87], v14 offset:37376
  buffer_load_dword v13, v4, s[16:19], s76 offen offset:1024
  v_mfma_f32_16x16x32_bf16 v[136:139], v[92:95], v[116:119], v[136:139]
  v_mfma_f32_16x16x32_bf16 v[128:131], v[92:95], v[112:115], v[128:131]
  s_waitcnt lgkmcnt(2)
  v_mfma_f32_16x16x32_bf16 v[132:135], v[80:83], v[112:115], v[132:135]
  ds_read_b64_tr_b16 v[88:89], v31 offset:45056
  v_mfma_f32_16x16x32_bf16 v[140:143], v[80:83], v[116:119], v[140:143]
  ds_read_b64_tr_b16 v[90:91], v31 offset:45568
  v_mfma_f32_16x16x32_bf16 v[148:151], v[80:83], v[120:123], v[148:151]
  v_mfma_f32_16x16x32_bf16 v[156:159], v[80:83], v[124:127], v[156:159]
  s_waitcnt lgkmcnt(2)
  v_mfma_f32_16x16x32_bf16 v[188:191], v[84:87], v[124:127], v[188:191]
  ds_read_b64_tr_b16 v[92:93], v14 offset:45056
  buffer_store_dwordx4 v[248:251], v16, s[12:15], s71 offen offset:1024 sc1
  s_add_u32 s71, s71, 8192
  v_mfma_f32_16x16x32_bf16 v[180:183], v[84:87], v[120:123], v[180:183]
  ds_read_b64_tr_b16 v[94:95], v14 offset:45568
  v_mfma_f32_16x16x32_bf16 v[172:175], v[84:87], v[116:119], v[172:175]
  v_mfma_f32_16x16x32_bf16 v[164:167], v[84:87], v[112:115], v[164:167]
  s_waitcnt lgkmcnt(0)
  s_barrier
  v_mfma_f32_16x16x32_bf16 v[196:199], v[88:91], v[112:115], v[196:199]
  ds_read_b64_tr_b16 v[80:81], v27 offset:0
  ds_read_b64_tr_b16 v[82:83], v27 offset:512
  v_mfma_f32_16x16x32_bf16 v[204:207], v[88:91], v[116:119], v[204:207]
  ds_read_b128 v[96:99], v23 offset:0
  ds_read_b128 v[100:103], v23 offset:2048
  v_mfma_f32_16x16x32_bf16 v[212:215], v[88:91], v[120:123], v[212:215]
  ds_read_b128 v[104:107], v25 offset:0
  ds_read_b128 v[108:111], v25 offset:2048
  v_mfma_f32_16x16x32_bf16 v[220:223], v[88:91], v[124:127], v[220:223]
  ds_read_b64_tr_b16 v[84:85], v28 offset:0
  ds_read_b64_tr_b16 v[86:87], v28 offset:512
  v_mfma_f32_16x16x32_bf16 v[252:255], v[92:95], v[124:127], v[252:255]
  v_lshrrev_b32 v6, 4, v16
  s_lshl_b32 s33, s31, 7
  s_add_u32 s33, s33, 2048
  s_lshl_b32 s34, s96, 7
  s_sub_u32 s35, s33, s34
  v_mov_b32 v7, s34
  v_mad_u32_u24 v7, v6, s35, v7
  s_lshr_b32 s34, s80, 1
  s_lshl_b32 s34, s34, 7
  s_sub_u32 s35, s33, s34
  v_mov_b32 v8, s34
  v_mad_u32_u24 v8, v6, s35, v8
  s_mov_b32 s75, 87048192
  buffer_load_dword v11, off, s[24:27], 0 sc1
  v_lshl_add_u32 v9, v6, 4, 16
  v_mov_b32 v10, 1
  v_lshlrev_b32 v12, 3, v16
  s_lshl_b32 s74, s80, 19
  s_lshl_b32 s33, s31, 13
  s_add_u32 s74, s74, s33
  s_and_b32 s33, s28, 1
  s_lshl_b32 s33, s33, 16
  s_add_u32 s74, s74, s33
  s_and_b32 s33, s28, 2
  s_lshl_b32 s33, s33, 23
  s_add_u32 s74, s74, s33
  v_mfma_f32_16x16x32_bf16 v[244:247], v[92:95], v[120:123], v[244:247]
  v_mfma_f32_16x16x32_bf16 v[236:239], v[92:95], v[116:119], v[236:239]
  v_mfma_f32_16x16x32_bf16 v[228:231], v[92:95], v[112:115], v[228:231]
  s_waitcnt lgkmcnt(5)
  v_mfma_f32_16x16x32_bf16 v[32:35], v[80:83], v[96:99], v[32:35]
  ds_read_b64_tr_b16 v[88:89], v29 offset:0
  s_waitcnt lgkmcnt(5)
  v_mfma_f32_16x16x32_bf16 v[36:39], v[80:83], v[100:103], v[36:39]
  ds_read_b64_tr_b16 v[90:91], v29 offset:512
  s_waitcnt lgkmcnt(5)
  v_mfma_f32_16x16x32_bf16 v[40:43], v[80:83], v[104:107], v[40:43]
  s_waitcnt lgkmcnt(4)
  v_mfma_f32_16x16x32_bf16 v[44:47], v[80:83], v[108:111], v[44:47]
  s_waitcnt lgkmcnt(2)
  v_mfma_f32_16x16x32_bf16 v[60:63], v[84:87], v[108:111], v[60:63]
  ds_read_b64_tr_b16 v[92:93], v30 offset:0
  v_mfma_f32_16x16x32_bf16 v[56:59], v[84:87], v[104:107], v[56:59]
  ds_read_b64_tr_b16 v[94:95], v30 offset:512
  v_mfma_f32_16x16x32_bf16 v[52:55], v[84:87], v[100:103], v[52:55]
  v_mfma_f32_16x16x32_bf16 v[48:51], v[84:87], v[96:99], v[48:51]
  s_waitcnt lgkmcnt(2)
  v_mfma_f32_16x16x32_bf16 v[64:67], v[88:91], v[96:99], v[64:67]
  ds_read_b64_tr_b16 v[80:81], v31 offset:0
  v_mfma_f32_16x16x32_bf16 v[68:71], v[88:91], v[100:103], v[68:71]
  ds_read_b64_tr_b16 v[82:83], v31 offset:512
  v_mfma_f32_16x16x32_bf16 v[72:75], v[88:91], v[104:107], v[72:75]
  v_mfma_f32_16x16x32_bf16 v[76:79], v[88:91], v[108:111], v[76:79]
  ds_read_b128 v[112:115], v24 offset:0
  s_waitcnt lgkmcnt(3)
  v_mfma_f32_16x16x32_bf16 v[152:155], v[92:95], v[108:111], v[152:155]
  ds_read_b64_tr_b16 v[84:85], v14 offset:0
  v_mfma_f32_16x16x32_bf16 v[144:147], v[92:95], v[104:107], v[144:147]
  ds_read_b64_tr_b16 v[86:87], v14 offset:512
  v_mfma_f32_16x16x32_bf16 v[136:139], v[92:95], v[100:103], v[136:139]
  v_mfma_f32_16x16x32_bf16 v[128:131], v[92:95], v[96:99], v[128:131]
  ds_read_b128 v[116:119], v24 offset:2048
  s_waitcnt lgkmcnt(4)
  v_mfma_f32_16x16x32_bf16 v[132:135], v[80:83], v[96:99], v[132:135]
  ds_read_b64_tr_b16 v[88:89], v31 offset:8192
  v_mfma_f32_16x16x32_bf16 v[140:143], v[80:83], v[100:103], v[140:143]
  ds_read_b64_tr_b16 v[90:91], v31 offset:8704
  v_mfma_f32_16x16x32_bf16 v[148:151], v[80:83], v[104:107], v[148:151]
  v_mfma_f32_16x16x32_bf16 v[156:159], v[80:83], v[108:111], v[156:159]
  ds_read_b128 v[120:123], v26 offset:0
  s_waitcnt lgkmcnt(4)
  v_mfma_f32_16x16x32_bf16 v[188:191], v[84:87], v[108:111], v[188:191]
  ds_read_b64_tr_b16 v[92:93], v14 offset:8192
  v_mfma_f32_16x16x32_bf16 v[180:183], v[84:87], v[104:107], v[180:183]
  ds_read_b64_tr_b16 v[94:95], v14 offset:8704
  v_mfma_f32_16x16x32_bf16 v[172:175], v[84:87], v[100:103], v[172:175]
  v_mfma_f32_16x16x32_bf16 v[164:167], v[84:87], v[96:99], v[164:167]
  ds_read_b128 v[124:127], v26 offset:2048
  s_waitcnt lgkmcnt(4)
  v_mfma_f32_16x16x32_bf16 v[196:199], v[88:91], v[96:99], v[196:199]
  ds_read_b64_tr_b16 v[80:81], v27 offset:4096
  v_mfma_f32_16x16x32_bf16 v[204:207], v[88:91], v[100:103], v[204:207]
  ds_read_b64_tr_b16 v[82:83], v27 offset:4608
  v_mfma_f32_16x16x32_bf16 v[212:215], v[88:91], v[104:107], v[212:215]
  v_mfma_f32_16x16x32_bf16 v[220:223], v[88:91], v[108:111], v[220:223]
  s_waitcnt lgkmcnt(3)
  v_mfma_f32_16x16x32_bf16 v[252:255], v[92:95], v[108:111], v[252:255]
  ds_read_b64_tr_b16 v[84:85], v28 offset:4096
  v_mfma_f32_16x16x32_bf16 v[244:247], v[92:95], v[104:107], v[244:247]
  ds_read_b64_tr_b16 v[86:87], v28 offset:4608
  v_mfma_f32_16x16x32_bf16 v[236:239], v[92:95], v[100:103], v[236:239]
  v_mfma_f32_16x16x32_bf16 v[228:231], v[92:95], v[96:99], v[228:231]
  s_waitcnt lgkmcnt(2)
  v_mfma_f32_16x16x32_bf16 v[32:35], v[80:83], v[112:115], v[32:35]
  ds_read_b64_tr_b16 v[88:89], v29 offset:4096
  v_mfma_f32_16x16x32_bf16 v[36:39], v[80:83], v[116:119], v[36:39]
  ds_read_b64_tr_b16 v[90:91], v29 offset:4608
  v_mfma_f32_16x16x32_bf16 v[40:43], v[80:83], v[120:123], v[40:43]
  v_mfma_f32_16x16x32_bf16 v[44:47], v[80:83], v[124:127], v[44:47]
  s_waitcnt lgkmcnt(2)
  v_mfma_f32_16x16x32_bf16 v[60:63], v[84:87], v[124:127], v[60:63]
  ds_read_b64_tr_b16 v[92:93], v30 offset:4096
  v_mfma_f32_16x16x32_bf16 v[56:59], v[84:87], v[120:123], v[56:59]
  ds_read_b64_tr_b16 v[94:95], v30 offset:4608
  v_mfma_f32_16x16x32_bf16 v[52:55], v[84:87], v[116:119], v[52:55]
  v_mfma_f32_16x16x32_bf16 v[48:51], v[84:87], v[112:115], v[48:51]
  s_waitcnt lgkmcnt(2)
  v_mfma_f32_16x16x32_bf16 v[64:67], v[88:91], v[112:115], v[64:67]
  ds_read_b64_tr_b16 v[80:81], v31 offset:4096
  v_mfma_f32_16x16x32_bf16 v[68:71], v[88:91], v[116:119], v[68:71]
  ds_read_b64_tr_b16 v[82:83], v31 offset:4608
  v_mfma_f32_16x16x32_bf16 v[72:75], v[88:91], v[120:123], v[72:75]
  v_mfma_f32_16x16x32_bf16 v[76:79], v[88:91], v[124:127], v[76:79]
  s_waitcnt lgkmcnt(2)
  v_mfma_f32_16x16x32_bf16 v[152:155], v[92:95], v[124:127], v[152:155]
  ds_read_b64_tr_b16 v[84:85], v14 offset:4096
  v_mfma_f32_16x16x32_bf16 v[144:147], v[92:95], v[120:123], v[144:147]
  ds_read_b64_tr_b16 v[86:87], v14 offset:4608
  v_mfma_f32_16x16x32_bf16 v[136:139], v[92:95], v[116:119], v[136:139]
  v_mfma_f32_16x16x32_bf16 v[128:131], v[92:95], v[112:115], v[128:131]
  s_waitcnt lgkmcnt(2)
  v_mfma_f32_16x16x32_bf16 v[132:135], v[80:83], v[112:115], v[132:135]
  ds_read_b64_tr_b16 v[88:89], v31 offset:12288
  v_mfma_f32_16x16x32_bf16 v[140:143], v[80:83], v[116:119], v[140:143]
  ds_read_b64_tr_b16 v[90:91], v31 offset:12800
  v_mfma_f32_16x16x32_bf16 v[148:151], v[80:83], v[120:123], v[148:151]
  v_mfma_f32_16x16x32_bf16 v[156:159], v[80:83], v[124:127], v[156:159]
  s_waitcnt lgkmcnt(2)
  v_mfma_f32_16x16x32_bf16 v[188:191], v[84:87], v[124:127], v[188:191]
  ds_read_b64_tr_b16 v[92:93], v14 offset:12288
  v_mfma_f32_16x16x32_bf16 v[180:183], v[84:87], v[120:123], v[180:183]
  ds_read_b64_tr_b16 v[94:95], v14 offset:12800
  v_mfma_f32_16x16x32_bf16 v[172:175], v[84:87], v[116:119], v[172:175]
  v_mfma_f32_16x16x32_bf16 v[164:167], v[84:87], v[112:115], v[164:167]
  s_waitcnt vmcnt(1) lgkmcnt(0)
  s_barrier
  v_mfma_f32_16x16x32_bf16 v[196:199], v[88:91], v[112:115], v[196:199]
  ds_read_b64_tr_b16 v[80:81], v27 offset:32768
  ds_read_b64_tr_b16 v[82:83], v27 offset:33280
  v_mfma_f32_16x16x32_bf16 v[204:207], v[88:91], v[116:119], v[204:207]
  ds_read_b128 v[96:99], v23 offset:32768
  ds_read_b128 v[100:103], v23 offset:34816
  v_mfma_f32_16x16x32_bf16 v[212:215], v[88:91], v[120:123], v[212:215]
  ds_read_b128 v[104:107], v25 offset:32768
  ds_read_b128 v[108:111], v25 offset:34816
  v_mfma_f32_16x16x32_bf16 v[220:223], v[88:91], v[124:127], v[220:223]
  ds_read_b64_tr_b16 v[84:85], v28 offset:32768
  ds_read_b64_tr_b16 v[86:87], v28 offset:33280
  v_mfma_f32_16x16x32_bf16 v[252:255], v[92:95], v[124:127], v[252:255]
  v_mfma_f32_16x16x32_bf16 v[244:247], v[92:95], v[120:123], v[244:247]
  v_mfma_f32_16x16x32_bf16 v[236:239], v[92:95], v[116:119], v[236:239]
  v_mfma_f32_16x16x32_bf16 v[228:231], v[92:95], v[112:115], v[228:231]
  s_waitcnt lgkmcnt(5)
  v_mfma_f32_16x16x32_bf16 v[32:35], v[80:83], v[96:99], v[32:35]
  ds_read_b64_tr_b16 v[88:89], v29 offset:32768
  s_waitcnt lgkmcnt(5)
  v_mfma_f32_16x16x32_bf16 v[36:39], v[80:83], v[100:103], v[36:39]
  ds_read_b64_tr_b16 v[90:91], v29 offset:33280
  s_waitcnt vmcnt(0)
  v_readfirstlane_b32 s33, v11
  s_nop 0
  s_cmp_ge_u32 s33, 7
  s_cbranch_scc1 F_ZOK
F_ZP:
  buffer_load_dword v11, off, s[24:27], 0 sc1
  s_waitcnt vmcnt(0)
  v_readfirstlane_b32 s33, v11
  s_nop 0
  s_cmp_lt_u32 s33, 7
  s_cbranch_scc1 F_ZP
F_ZOK:
  s_cmp_eq_u32 s28, 4
  s_cbranch_scc0 F_NA
  s_mov_b64 exec, 3
  buffer_atomic_add v10, v7, s[12:15], s75 offen sc1
  s_mov_b64 exec, -1
F_NA:
  s_waitcnt lgkmcnt(5)
  v_mfma_f32_16x16x32_bf16 v[40:43], v[80:83], v[104:107], v[40:43]
  s_waitcnt lgkmcnt(4)
  v_mfma_f32_16x16x32_bf16 v[44:47], v[80:83], v[108:111], v[44:47]
  s_waitcnt lgkmcnt(2)
  v_mfma_f32_16x16x32_bf16 v[60:63], v[84:87], v[108:111], v[60:63]
  ds_read_b64_tr_b16 v[92:93], v30 offset:32768
  v_mfma_f32_16x16x32_bf16 v[56:59], v[84:87], v[104:107], v[56:59]
  ds_read_b64_tr_b16 v[94:95], v30 offset:33280
  v_mfma_f32_16x16x32_bf16 v[52:55], v[84:87], v[100:103], v[52:55]
  v_mfma_f32_16x16x32_bf16 v[48:51], v[84:87], v[96:99], v[48:51]
  s_waitcnt lgkmcnt(2)
  v_mfma_f32_16x16x32_bf16 v[64:67], v[88:91], v[96:99], v[64:67]
  ds_read_b64_tr_b16 v[80:81], v31 offset:32768
  v_mfma_f32_16x16x32_bf16 v[68:71], v[88:91], v[100:103], v[68:71]
  ds_read_b64_tr_b16 v[82:83], v31 offset:33280
  v_mfma_f32_16x16x32_bf16 v[72:75], v[88:91], v[104:107], v[72:75]
  v_mfma_f32_16x16x32_bf16 v[76:79], v[88:91], v[108:111], v[76:79]
  ds_read_b128 v[112:115], v24 offset:32768
  s_waitcnt lgkmcnt(3)
  v_mfma_f32_16x16x32_bf16 v[152:155], v[92:95], v[108:111], v[152:155]
  ds_read_b64_tr_b16 v[84:85], v14 offset:32768
  v_mfma_f32_16x16x32_bf16 v[144:147], v[92:95], v[104:107], v[144:147]
  ds_read_b64_tr_b16 v[86:87], v14 offset:33280
  v_mfma_f32_16x16x32_bf16 v[136:139], v[92:95], v[100:103], v[136:139]
  v_mfma_f32_16x16x32_bf16 v[128:131], v[92:95], v[96:99], v[128:131]
  ds_read_b128 v[116:119], v24 offset:34816
  s_waitcnt lgkmcnt(4)
  v_mfma_f32_16x16x32_bf16 v[132:135], v[80:83], v[96:99], v[132:135]
  ds_read_b64_tr_b16 v[88:89], v31 offset:40960
  v_mfma_f32_16x16x32_bf16 v[140:143], v[80:83], v[100:103], v[140:143]
  ds_read_b64_tr_b16 v[90:91], v31 offset:41472
  v_mfma_f32_16x16x32_bf16 v[148:151], v[80:83], v[104:107], v[148:151]
  v_mfma_f32_16x16x32_bf16 v[156:159], v[80:83], v[108:111], v[156:159]
  ds_read_b128 v[120:123], v26 offset:32768
  s_waitcnt lgkmcnt(4)
  v_mfma_f32_16x16x32_bf16 v[188:191], v[84:87], v[108:111], v[188:191]
  ds_read_b64_tr_b16 v[92:93], v14 offset:40960
  v_mfma_f32_16x16x32_bf16 v[180:183], v[84:87], v[104:107], v[180:183]
  ds_read_b64_tr_b16 v[94:95], v14 offset:41472
  v_mfma_f32_16x16x32_bf16 v[172:175], v[84:87], v[100:103], v[172:175]
  v_mfma_f32_16x16x32_bf16 v[164:167], v[84:87], v[96:99], v[164:167]
  ds_read_b128 v[124:127], v26 offset:34816
  s_waitcnt lgkmcnt(4)
  v_mfma_f32_16x16x32_bf16 v[196:199], v[88:91], v[96:99], v[196:199]
  ds_read_b64_tr_b16 v[80:81], v27 offset:36864
  v_mfma_f32_16x16x32_bf16 v[204:207], v[88:91], v[100:103], v[204:207]
  ds_read_b64_tr_b16 v[82:83], v27 offset:37376
  v_mfma_f32_16x16x32_bf16 v[212:215], v[88:91], v[104:107], v[212:215]
  v_mfma_f32_16x16x32_bf16 v[220:223], v[88:91], v[108:111], v[220:223]
  s_waitcnt lgkmcnt(3)
  v_mfma_f32_16x16x32_bf16 v[252:255], v[92:95], v[108:111], v[252:255]
  ds_read_b64_tr_b16 v[84:85], v28 offset:36864
  v_mfma_f32_16x16x32_bf16 v[244:247], v[92:95], v[104:107], v[244:247]
  ds_read_b64_tr_b16 v[86:87], v28 offset:37376
  v_mfma_f32_16x16x32_bf16 v[236:239], v[92:95], v[100:103], v[236:239]
  v_mfma_f32_16x16x32_bf16 v[228:231], v[92:95], v[96:99], v[228:231]
  s_waitcnt lgkmcnt(2)
  v_mfma_f32_16x16x32_bf16 v[32:35], v[80:83], v[112:115], v[32:35]
  ds_read_b64_tr_b16 v[88:89], v29 offset:36864
  v_mfma_f32_16x16x32_bf16 v[36:39], v[80:83], v[116:119], v[36:39]
  ds_read_b64_tr_b16 v[90:91], v29 offset:37376
  v_mfma_f32_16x16x32_bf16 v[40:43], v[80:83], v[120:123], v[40:43]
  v_mfma_f32_16x16x32_bf16 v[44:47], v[80:83], v[124:127], v[44:47]
  s_waitcnt lgkmcnt(2)
  v_mfma_f32_16x16x32_bf16 v[60:63], v[84:87], v[124:127], v[60:63]
  ds_read_b64_tr_b16 v[92:93], v30 offset:36864
  v_mfma_f32_16x16x32_bf16 v[56:59], v[84:87], v[120:123], v[56:59]
  ds_read_b64_tr_b16 v[94:95], v30 offset:37376
  v_mfma_f32_16x16x32_bf16 v[52:55], v[84:87], v[116:119], v[52:55]
  v_mfma_f32_16x16x32_bf16 v[48:51], v[84:87], v[112:115], v[48:51]
  s_waitcnt lgkmcnt(2)
  v_mfma_f32_16x16x32_bf16 v[64:67], v[88:91], v[112:115], v[64:67]
  ds_read_b64_tr_b16 v[80:81], v31 offset:36864
  v_mfma_f32_16x16x32_bf16 v[68:71], v[88:91], v[116:119], v[68:71]
  ds_read_b64_tr_b16 v[82:83], v31 offset:37376
  v_mfma_f32_16x16x32_bf16 v[72:75], v[88:91], v[120:123], v[72:75]
  v_mfma_f32_16x16x32_bf16 v[76:79], v[88:91], v[124:127], v[76:79]
  s_waitcnt lgkmcnt(2)
  v_mfma_f32_16x16x32_bf16 v[152:155], v[92:95], v[124:127], v[152:155]
  ds_read_b64_tr_b16 v[84:85], v14 offset:36864
  v_mfma_f32_16x16x32_bf16 v[144:147], v[92:95], v[120:123], v[144:147]
  ds_read_b64_tr_b16 v[86:87], v14 offset:37376
  v_mfma_f32_16x16x32_bf16 v[136:139], v[92:95], v[116:119], v[136:139]
  v_mfma_f32_16x16x32_bf16 v[128:131], v[92:95], v[112:115], v[128:131]
  s_waitcnt lgkmcnt(2)
  v_mfma_f32_16x16x32_bf16 v[132:135], v[80:83], v[112:115], v[132:135]
  ds_read_b64_tr_b16 v[88:89], v31 offset:45056
  v_mfma_f32_16x16x32_bf16 v[140:143], v[80:83], v[116:119], v[140:143]
  ds_read_b64_tr_b16 v[90:91], v31 offset:45568
  v_mfma_f32_16x16x32_bf16 v[148:151], v[80:83], v[120:123], v[148:151]
  v_mfma_f32_16x16x32_bf16 v[156:159], v[80:83], v[124:127], v[156:159]
  s_waitcnt lgkmcnt(2)
  v_mfma_f32_16x16x32_bf16 v[188:191], v[84:87], v[124:127], v[188:191]
  ds_read_b64_tr_b16 v[92:93], v14 offset:45056
  v_mfma_f32_16x16x32_bf16 v[180:183], v[84:87], v[120:123], v[180:183]
  ds_read_b64_tr_b16 v[94:95], v14 offset:45568
  v_mfma_f32_16x16x32_bf16 v[172:175], v[84:87], v[116:119], v[172:175]
  v_mfma_f32_16x16x32_bf16 v[164:167], v[84:87], v[112:115], v[164:167]
  s_waitcnt lgkmcnt(0)
  s_barrier
  v_mfma_f32_16x16x32_bf16 v[196:199], v[88:91], v[112:115], v[196:199]
  ds_read_b64_tr_b16 v[80:81], v27 offset:0
  ds_read_b64_tr_b16 v[82:83], v27 offset:512
  v_mfma_f32_16x16x32_bf16 v[204:207], v[88:91], v[116:119], v[204:207]
  ds_read_b128 v[96:99], v23 offset:0
  ds_read_b128 v[100:103], v23 offset:2048
  v_mfma_f32_16x16x32_bf16 v[212:215], v[88:91], v[120:123], v[212:215]
  ds_read_b128 v[104:107], v25 offset:0
  ds_read_b128 v[108:111], v25 offset:2048
  v_mfma_f32_16x16x32_bf16 v[220:223], v[88:91], v[124:127], v[220:223]
  ds_read_b64_tr_b16 v[84:85], v28 offset:0
  ds_read_b64_tr_b16 v[86:87], v28 offset:512
  v_mfma_f32_16x16x32_bf16 v[252:255], v[92:95], v[124:127], v[252:255]
  v_mfma_f32_16x16x32_bf16 v[244:247], v[92:95], v[120:123], v[244:247]
  v_mfma_f32_16x16x32_bf16 v[236:239], v[92:95], v[116:119], v[236:239]
  v_mfma_f32_16x16x32_bf16 v[228:231], v[92:95], v[112:115], v[228:231]
  s_waitcnt lgkmcnt(5)
  v_mfma_f32_16x16x32_bf16 v[32:35], v[80:83], v[96:99], v[32:35]
  ds_read_b64_tr_b16 v[88:89], v29 offset:0
  s_waitcnt lgkmcnt(5)
  v_mfma_f32_16x16x32_bf16 v[36:39], v[80:83], v[100:103], v[36:39]
  ds_read_b64_tr_b16 v[90:91], v29 offset:512
  s_waitcnt lgkmcnt(5)
  v_mfma_f32_16x16x32_bf16 v[40:43], v[80:83], v[104:107], v[40:43]
  s_waitcnt lgkmcnt(4)
  v_mfma_f32_16x16x32_bf16 v[44:47], v[80:83], v[108:111], v[44:47]
  s_waitcnt lgkmcnt(2)
  v_mfma_f32_16x16x32_bf16 v[60:63], v[84:87], v[108:111], v[60:63]
  ds_read_b64_tr_b16 v[92:93], v30 offset:0
  v_mfma_f32_16x16x32_bf16 v[56:59], v[84:87], v[104:107], v[56:59]
  ds_read_b64_tr_b16 v[94:95], v30 offset:512
  v_mfma_f32_16x16x32_bf16 v[52:55], v[84:87], v[100:103], v[52:55]
  v_mfma_f32_16x16x32_bf16 v[48:51], v[84:87], v[96:99], v[48:51]
  s_waitcnt lgkmcnt(2)
  v_mfma_f32_16x16x32_bf16 v[64:67], v[88:91], v[96:99], v[64:67]
  ds_read_b64_tr_b16 v[80:81], v31 offset:0
  v_mfma_f32_16x16x32_bf16 v[68:71], v[88:91], v[100:103], v[68:71]
  ds_read_b64_tr_b16 v[82:83], v31 offset:512
  v_mfma_f32_16x16x32_bf16 v[72:75], v[88:91], v[104:107], v[72:75]
  v_mfma_f32_16x16x32_bf16 v[76:79], v[88:91], v[108:111], v[76:79]
  ds_read_b128 v[112:115], v24 offset:0
  s_waitcnt lgkmcnt(3)
  v_mfma_f32_16x16x32_bf16 v[152:155], v[92:95], v[108:111], v[152:155]
  ds_read_b64_tr_b16 v[84:85], v14 offset:0
  v_mfma_f32_16x16x32_bf16 v[144:147], v[92:95], v[104:107], v[144:147]
  ds_read_b64_tr_b16 v[86:87], v14 offset:512
  v_mfma_f32_16x16x32_bf16 v[136:139], v[92:95], v[100:103], v[136:139]
  v_mfma_f32_16x16x32_bf16 v[128:131], v[92:95], v[96:99], v[128:131]
  ds_read_b128 v[116:119], v24 offset:2048
  s_waitcnt lgkmcnt(4)
  v_mfma_f32_16x16x32_bf16 v[132:135], v[80:83], v[96:99], v[132:135]
  ds_read_b64_tr_b16 v[88:89], v31 offset:8192
  v_mfma_f32_16x16x32_bf16 v[140:143], v[80:83], v[100:103], v[140:143]
  ds_read_b64_tr_b16 v[90:91], v31 offset:8704
  v_mfma_f32_16x16x32_bf16 v[148:151], v[80:83], v[104:107], v[148:151]
  v_mfma_f32_16x16x32_bf16 v[156:159], v[80:83], v[108:111], v[156:159]
  ds_read_b128 v[120:123], v26 offset:0
  s_waitcnt lgkmcnt(4)
  v_mfma_f32_16x16x32_bf16 v[188:191], v[84:87], v[108:111], v[188:191]
  ds_read_b64_tr_b16 v[92:93], v14 offset:8192
  v_mfma_f32_16x16x32_bf16 v[180:183], v[84:87], v[104:107], v[180:183]
  ds_read_b64_tr_b16 v[94:95], v14 offset:8704
  v_mfma_f32_16x16x32_bf16 v[172:175], v[84:87], v[100:103], v[172:175]
  v_mfma_f32_16x16x32_bf16 v[164:167], v[84:87], v[96:99], v[164:167]
  ds_read_b128 v[124:127], v26 offset:2048
  s_waitcnt lgkmcnt(4)
  v_mfma_f32_16x16x32_bf16 v[196:199], v[88:91], v[96:99], v[196:199]
  ds_read_b64_tr_b16 v[80:81], v27 offset:4096
  v_mfma_f32_16x16x32_bf16 v[204:207], v[88:91], v[100:103], v[204:207]
  ds_read_b64_tr_b16 v[82:83], v27 offset:4608
  v_mfma_f32_16x16x32_bf16 v[212:215], v[88:91], v[104:107], v[212:215]
  v_mfma_f32_16x16x32_bf16 v[220:223], v[88:91], v[108:111], v[220:223]
  s_waitcnt lgkmcnt(3)
  v_mfma_f32_16x16x32_bf16 v[252:255], v[92:95], v[108:111], v[252:255]
  ds_read_b64_tr_b16 v[84:85], v28 offset:4096
  v_mfma_f32_16x16x32_bf16 v[244:247], v[92:95], v[104:107], v[244:247]
  ds_read_b64_tr_b16 v[86:87], v28 offset:4608
  v_mfma_f32_16x16x32_bf16 v[236:239], v[92:95], v[100:103], v[236:239]
  v_mfma_f32_16x16x32_bf16 v[228:231], v[92:95], v[96:99], v[228:231]
  s_waitcnt lgkmcnt(2)
  v_mfma_f32_16x16x32_bf16 v[32:35], v[80:83], v[112:115], v[32:35]
  ds_read_b64_tr_b16 v[88:89], v29 offset:4096
  v_mfma_f32_16x16x32_bf16 v[36:39], v[80:83], v[116:119], v[36:39]
  ds_read_b64_tr_b16 v[90:91], v29 offset:4608
  v_mfma_f32_16x16x32_bf16 v[40:43], v[80:83], v[120:123], v[40:43]
  v_mfma_f32_16x16x32_bf16 v[44:47], v[80:83], v[124:127], v[44:47]
  s_waitcnt lgkmcnt(2)
  v_mfma_f32_16x16x32_bf16 v[60:63], v[84:87], v[124:127], v[60:63]
  ds_read_b64_tr_b16 v[92:93], v30 offset:4096
  v_mfma_f32_16x16x32_bf16 v[56:59], v[84:87], v[120:123], v[56:59]
  ds_read_b64_tr_b16 v[94:95], v30 offset:4608
  v_mfma_f32_16x16x32_bf16 v[52:55], v[84:87], v[116:119], v[52:55]
  v_mfma_f32_16x16x32_bf16 v[48:51], v[84:87], v[112:115], v[48:51]
  s_waitcnt lgkmcnt(2)
  v_mfma_f32_16x16x32_bf16 v[64:67], v[88:91], v[112:115], v[64:67]
  ds_read_b64_tr_b16 v[80:81], v31 offset:4096
  v_mfma_f32_16x16x32_bf16 v[68:71], v[88:91], v[116:119], v[68:71]
  ds_read_b64_tr_b16 v[82:83], v31 offset:4608
  v_mfma_f32_16x16x32_bf16 v[72:75], v[88:91], v[120:123], v[72:75]
  v_mfma_f32_16x16x32_bf16 v[76:79], v[88:91], v[124:127], v[76:79]
  s_waitcnt lgkmcnt(2)
  v_mfma_f32_16x16x32_bf16 v[152:155], v[92:95], v[124:127], v[152:155]
  ds_read_b64_tr_b16 v[84:85], v14 offset:4096
  v_mfma_f32_16x16x32_bf16 v[144:147], v[92:95], v[120:123], v[144:147]
  ds_read_b64_tr_b16 v[86:87], v14 offset:4608
  v_mfma_f32_16x16x32_bf16 v[136:139], v[92:95], v[116:119], v[136:139]
  v_mfma_f32_16x16x32_bf16 v[128:131], v[92:95], v[112:115], v[128:131]
  s_waitcnt lgkmcnt(2)
  v_mfma_f32_16x16x32_bf16 v[132:135], v[80:83], v[112:115], v[132:135]
  ds_read_b64_tr_b16 v[88:89], v31 offset:12288
  s_mov_b64 exec, 3
  buffer_load_dword v11, v8, s[12:15], s75 offen sc1
  s_mov_b64 exec, -1
  v_mfma_f32_16x16x32_bf16 v[140:143], v[80:83], v[116:119], v[140:143]
  ds_read_b64_tr_b16 v[90:91], v31 offset:12800
  v_mfma_f32_16x16x32_bf16 v[148:151], v[80:83], v[120:123], v[148:151]
  v_mfma_f32_16x16x32_bf16 v[156:159], v[80:83], v[124:127], v[156:159]
  s_waitcnt lgkmcnt(2)
  v_mfma_f32_16x16x32_bf16 v[188:191], v[84:87], v[124:127], v[188:191]
  ds_read_b64_tr_b16 v[92:93], v14 offset:12288
  v_mfma_f32_16x16x32_bf16 v[180:183], v[84:87], v[120:123], v[180:183]
  ds_read_b64_tr_b16 v[94:95], v14 offset:12800
  v_mfma_f32_16x16x32_bf16 v[172:175], v[84:87], v[116:119], v[172:175]
  v_mfma_f32_16x16x32_bf16 v[164:167], v[84:87], v[112:115], v[164:167]
  s_waitcnt lgkmcnt(0)
  s_barrier
  v_mfma_f32_16x16x32_bf16 v[196:199], v[88:91], v[112:115], v[196:199]
  ds_read_b64_tr_b16 v[80:81], v31 offset:32768
  ds_read_b64_tr_b16 v[82:83], v31 offset:33280
  v_mfma_f32_16x16x32_bf16 v[204:207], v[88:91], v[116:119], v[204:207]
  ds_read_b128 v[96:99], v23 offset:32768
  ds_read_b128 v[100:103], v23 offset:34816
  v_mfma_f32_16x16x32_bf16 v[212:215], v[88:91], v[120:123], v[212:215]
  ds_read_b128 v[104:107], v25 offset:32768
  ds_read_b128 v[108:111], v25 offset:34816
  v_mfma_f32_16x16x32_bf16 v[220:223], v[88:91], v[124:127], v[220:223]
  ds_read_b64_tr_b16 v[84:85], v14 offset:32768
  ds_read_b64_tr_b16 v[86:87], v14 offset:33280
  v_mfma_f32_16x16x32_bf16 v[252:255], v[92:95], v[124:127], v[252:255]
  v_mfma_f32_16x16x32_bf16 v[244:247], v[92:95], v[120:123], v[244:247]
  v_mfma_f32_16x16x32_bf16 v[236:239], v[92:95], v[116:119], v[236:239]
  v_mfma_f32_16x16x32_bf16 v[228:231], v[92:95], v[112:115], v[228:231]
  s_waitcnt lgkmcnt(5)
  v_mfma_f32_16x16x32_bf16 v[132:135], v[80:83], v[96:99], v[132:135]
  ds_read_b64_tr_b16 v[88:89], v31 offset:40960
  s_waitcnt lgkmcnt(5)
  v_mfma_f32_16x16x32_bf16 v[140:143], v[80:83], v[100:103], v[140:143]
  ds_read_b64_tr_b16 v[90:91], v31 offset:41472
  s_waitcnt lgkmcnt(5)
  v_mfma_f32_16x16x32_bf16 v[148:151], v[80:83], v[104:107], v[148:151]
  ds_read_b128 v[112:115], v24 offset:32768
  s_waitcnt lgkmcnt(5)
  v_mfma_f32_16x16x32_bf16 v[156:159], v[80:83], v[108:111], v[156:159]
  ds_read_b128 v[116:119], v24 offset:34816
  s_waitcnt lgkmcnt(4)
  v_mfma_f32_16x16x32_bf16 v[188:191], v[84:87], v[108:111], v[188:191]
  ds_read_b64_tr_b16 v[92:93], v14 offset:40960
  v_mfma_f32_16x16x32_bf16 v[180:183], v[84:87], v[104:107], v[180:183]
  ds_read_b64_tr_b16 v[94:95], v14 offset:41472
  v_mfma_f32_16x16x32_bf16 v[172:175], v[84:87], v[100:103], v[172:175]
  ds_read_b128 v[120:123], v26 offset:32768
  v_mfma_f32_16x16x32_bf16 v[164:167], v[84:87], v[96:99], v[164:167]
  ds_read_b128 v[124:127], v26 offset:34816
  s_waitcnt lgkmcnt(6)
  v_mfma_f32_16x16x32_bf16 v[196:199], v[88:91], v[96:99], v[196:199]
  ds_read_b64_tr_b16 v[80:81], v31 offset:36864
  v_mfma_f32_16x16x32_bf16 v[204:207], v[88:91], v[100:103], v[204:207]
  ds_read_b64_tr_b16 v[82:83], v31 offset:37376
  v_mfma_f32_16x16x32_bf16 v[212:215], v[88:91], v[104:107], v[212:215]
  v_mfma_f32_16x16x32_bf16 v[220:223], v[88:91], v[108:111], v[220:223]
  s_waitcnt lgkmcnt(4)
  v_mfma_f32_16x16x32_bf16 v[252:255], v[92:95], v[108:111], v[252:255]
  ds_read_b64_tr_b16 v[84:85], v14 offset:36864
  v_mfma_f32_16x16x32_bf16 v[244:247], v[92:95], v[104:107], v[244:247]
  ds_read_b64_tr_b16 v[86:87], v14 offset:37376
  v_mfma_f32_16x16x32_bf16 v[236:239], v[92:95], v[100:103], v[236:239]
  s_mov_b64 exec, 3
  s_waitcnt vmcnt(0)
  v_cmp_ge_u32 vcc, v11, v9
  s_mov_b64 exec, -1
  s_mov_b32 s93, vcc_lo
  s_bitcmp1_b32 s93, 0
  s_cbranch_scc0 F_NP
  buffer_load_dword v13, v12, s[12:15], s74 offen sc1
F_NP:
  v_mfma_f32_16x16x32_bf16 v[228:231], v[92:95], v[96:99], v[228:231]
  s_waitcnt lgkmcnt(2)
  v_mfma_f32_16x16x32_bf16 v[132:135], v[80:83], v[112:115], v[132:135]
  ds_read_b64_tr_b16 v[88:89], v31 offset:45056
  v_mfma_f32_16x16x32_bf16 v[140:143], v[80:83], v[116:119], v[140:143]
  ds_read_b64_tr_b16 v[90:91], v31 offset:45568
  v_mfma_f32_16x16x32_bf16 v[148:151], v[80:83], v[120:123], v[148:151]
  ds_read_b128 v[96:99], v23 offset:32768
  v_mfma_f32_16x16x32_bf16 v[156:159], v[80:83], v[124:127], v[156:159]
  ds_read_b128 v[100:103], v23 offset:34816
  s_waitcnt lgkmcnt(4)
  v_mfma_f32_16x16x32_bf16 v[188:191], v[84:87], v[124:127], v[188:191]
  ds_read_b64_tr_b16 v[92:93], v14 offset:45056
  s_mov_b32 s94, 0xbdd2d3e8
  v_mov_b32 v1, 0xc0135761
  v_mfma_f32_16x16x32_bf16 v[180:183], v[84:87], v[120:123], v[180:183]
  ds_read_b64_tr_b16 v[94:95], v14 offset:45568
  v_mfma_f32_16x16x32_bf16 v[172:175], v[84:87], v[116:119], v[172:175]
  ds_read_b128 v[104:107], v25 offset:32768
  v_mfma_f32_16x16x32_bf16 v[164:167], v[84:87], v[112:115], v[164:167]
  ds_read_b128 v[108:111], v25 offset:34816
  s_waitcnt lgkmcnt(6)
  v_mfma_f32_16x16x32_bf16 v[196:199], v[88:91], v[112:115], v[196:199]
  ds_read_b64_tr_b16 v[80:81], v27 offset:32768
  v_mfma_f32_16x16x32_bf16 v[204:207], v[88:91], v[116:119], v[204:207]
  ds_read_b64_tr_b16 v[82:83], v27 offset:33280
  v_mfma_f32_16x16x32_bf16 v[212:215], v[88:91], v[120:123], v[212:215]
  v_mfma_f32_16x16x32_bf16 v[220:223], v[88:91], v[124:127], v[220:223]
  s_waitcnt lgkmcnt(4)
  v_mfma_f32_16x16x32_bf16 v[252:255], v[92:95], v[124:127], v[252:255]
  ds_read_b64_tr_b16 v[84:85], v28 offset:32768
  v_mfma_f32_16x16x32_bf16 v[244:247], v[92:95], v[120:123], v[244:247]
  ds_read_b64_tr_b16 v[86:87], v28 offset:33280
  v_mfma_f32_16x16x32_bf16 v[236:239], v[92:95], v[116:119], v[236:239]
  v_mfma_f32_16x16x32_bf16 v[228:231], v[92:95], v[112:115], v[228:231]
  s_waitcnt lgkmcnt(2)
  v_mfma_f32_16x16x32_bf16 v[32:35], v[80:83], v[96:99], v[32:35]
  ds_read_b64_tr_b16 v[88:89], v29 offset:32768
  v_mfma_f32_16x16x32_bf16 v[36:39], v[80:83], v[100:103], v[36:39]
  ds_read_b64_tr_b16 v[90:91], v29 offset:33280
  v_mfma_f32_16x16x32_bf16 v[40:43], v[80:83], v[104:107], v[40:43]
  ds_read_b128 v[112:115], v24 offset:32768
  v_mul_f32 v160, v132, v132
  v_mfma_f32_16x16x32_bf16 v[44:47], v[80:83], v[108:111], v[44:47]
  ds_read_b128 v[116:119], v24 offset:34816
  v_mul_f32 v161, v133, v133
  s_waitcnt lgkmcnt(4)
  v_mfma_f32_16x16x32_bf16 v[60:63], v[84:87], v[108:111], v[60:63]
  ds_read_b64_tr_b16 v[92:93], v30 offset:32768
  v_mul_f32 v162, v134, v134
  v_mfma_f32_16x16x32_bf16 v[56:59], v[84:87], v[104:107], v[56:59]
  ds_read_b64_tr_b16 v[94:95], v30 offset:33280
  v_mul_f32 v163, v135, v135
  v_mfma_f32_16x16x32_bf16 v[52:55], v[84:87], v[100:103], v[52:55]
  ds_read_b128 v[120:123], v26 offset:32768
  v_fma_f32 v160, v160, s94, v1
  v_mfma_f32_16x16x32_bf16 v[48:51], v[84:87], v[96:99], v[48:51]
  ds_read_b128 v[124:127], v26 offset:34816
  v_fma_f32 v161, v161, s94, v1
  s_waitcnt lgkmcnt(6)
  v_mfma_f32_16x16x32_bf16 v[64:67], v[88:91], v[96:99], v[64:67]
  ds_read_b64_tr_b16 v[80:81], v27 offset:36864
  v_fma_f32 v162, v162, s94, v1
  v_mfma_f32_16x16x32_bf16 v[68:71], v[88:91], v[100:103], v[68:71]
  ds_read_b64_tr_b16 v[82:83], v27 offset:37376
  v_fma_f32 v163, v163, s94, v1
  v_mfma_f32_16x16x32_bf16 v[72:75], v[88:91], v[104:107], v[72:75]
  v_mul_f32 v160, v160, v132
  v_mul_f32 v161, v161, v133
  v_mfma_f32_16x16x32_bf16 v[76:79], v[88:91], v[108:111], v[76:79]
  v_mul_f32 v162, v162, v134
  v_mul_f32 v163, v163, v135
  s_waitcnt lgkmcnt(4)
  v_mfma_f32_16x16x32_bf16 v[152:155], v[92:95], v[108:111], v[152:155]
  ds_read_b64_tr_b16 v[84:85], v28 offset:36864
  v_exp_f32 v160, v160
  v_mfma_f32_16x16x32_bf16 v[144:147], v[92:95], v[104:107], v[144:147]
  ds_read_b64_tr_b16 v[86:87], v28 offset:37376
  v_mul_f32 v132, v132, v196
  v_mfma_f32_16x16x32_bf16 v[136:139], v[92:95], v[100:103], v[136:139]
  v_exp_f32 v161, v161
  v_mul_f32 v133, v133, v197
  v_mfma_f32_16x16x32_bf16 v[128:131], v[92:95], v[96:99], v[128:131]
  v_exp_f32 v162, v162
  v_mul_f32 v134, v134, v198
  s_waitcnt lgkmcnt(2)
  v_mfma_f32_16x16x32_bf16 v[32:35], v[80:83], v[112:115], v[32:35]
  ds_read_b64_tr_b16 v[88:89], v29 offset:36864
  v_exp_f32 v163, v163
  v_mfma_f32_16x16x32_bf16 v[36:39], v[80:83], v[116:119], v[36:39]
  ds_read_b64_tr_b16 v[90:91], v29 offset:37376
  v_mul_f32 v135, v135, v199
  v_mfma_f32_16x16x32_bf16 v[40:43], v[80:83], v[120:123], v[40:43]
  v_add_f32 v160, 1.0, v160
  v_add_f32 v161, 1.0, v161
  v_mfma_f32_16x16x32_bf16 v[44:47], v[80:83], v[124:127], v[44:47]
  v_add_f32 v162, 1.0, v162
  v_add_f32 v163, 1.0, v163
  s_waitcnt lgkmcnt(2)
  v_mfma_f32_16x16x32_bf16 v[60:63], v[84:87], v[124:127], v[60:63]
  ds_read_b64_tr_b16 v[92:93], v30 offset:36864
  v_rcp_f32 v160, v160
  v_mfma_f32_16x16x32_bf16 v[56:59], v[84:87], v[120:123], v[56:59]
  ds_read_b64_tr_b16 v[94:95], v30 offset:37376
  v_rcp_f32 v161, v161
  v_mfma_f32_16x16x32_bf16 v[52:55], v[84:87], v[116:119], v[52:55]
  v_rcp_f32 v162, v162
  v_rcp_f32 v163, v163
  v_mfma_f32_16x16x32_bf16 v[48:51], v[84:87], v[112:115], v[48:51]
  v_mul_f32 v160, v160, v132
  v_mul_f32 v161, v161, v133
  s_cmp_eq_u32 s28, 4
  s_cbranch_scc0 F_RDY
  s_waitcnt vmcnt(0)
  s_cmp_eq_u32 s93, 3
  s_cbranch_scc1 F_RDY
  s_mov_b64 exec, 3
F_SPIN:
  buffer_load_dword v11, v8, s[12:15], s75 offen sc1
  s_waitcnt vmcnt(0)
  v_cmp_ge_u32 vcc, v11, v9
  s_nop 0
  s_mov_b32 s93, vcc_lo
  s_cmp_eq_u32 s93, 3
  s_cbranch_scc0 F_SPIN
  s_mov_b64 exec, -1
F_RDY:
  s_waitcnt lgkmcnt(0)
  s_barrier
  v_mfma_f32_16x16x32_bf16 v[64:67], v[88:91], v[112:115], v[64:67]
  v_mul_f32 v162, v162, v134
  v_mul_f32 v163, v163, v135
  v_mfma_f32_16x16x32_bf16 v[68:71], v[88:91], v[116:119], v[68:71]
  v_cvt_pk_bf16_f32 v224, v160, v161
  v_cvt_pk_bf16_f32 v225, v162, v163
  v_mfma_f32_16x16x32_bf16 v[72:75], v[88:91], v[120:123], v[72:75]
  v_mul_f32 v168, v164, v164
  v_mul_f32 v169, v165, v165
  v_mfma_f32_16x16x32_bf16 v[76:79], v[88:91], v[124:127], v[76:79]
  v_mul_f32 v170, v166, v166
  v_mul_f32 v171, v167, v167
  v_mfma_f32_16x16x32_bf16 v[152:155], v[92:95], v[124:127], v[152:155]
  v_fma_f32 v168, v168, s94, v1
  v_fma_f32 v169, v169, s94, v1
  v_mfma_f32_16x16x32_bf16 v[144:147], v[92:95], v[120:123], v[144:147]
  v_fma_f32 v170, v170, s94, v1
  v_fma_f32 v171, v171, s94, v1
  v_mfma_f32_16x16x32_bf16 v[136:139], v[92:95], v[116:119], v[136:139]
  v_mul_f32 v168, v168, v164
  v_mul_f32 v169, v169, v165
  v_mfma_f32_16x16x32_bf16 v[128:131], v[92:95], v[112:115], v[128:131]
  v_mul_f32 v170, v170, v166
  v_mul_f32 v171, v171, v167
  s_mov_b32 s93, s72
  s_lshl_b32 s85, s31, 1
  s_add_u32 s85, s85, 3
  s_mul_i32 s84, s85, 52
  s_lshr_b32 s84, s84, 8
  s_mul_i32 s84, s84, 5
  s_sub_u32 s85, s85, s84
  s_lshl_b32 s85, s85, 15
  s_lshl_b32 s86, s80, 19
  s_lshl_b32 s88, s81, 12
  s_add_u32 s86, s86, s88
  s_add_u32 s87, s86, 16777216
  s_add_u32 s88, s88, s85
  s_mov_b32 m0, s88
  s_nop 0
  buffer_load_dwordx4 v16, s[12:15], s86 offen offset:0 sc1 lds
  buffer_load_dwordx4 v16, s[12:15], s86 offen offset:1024 sc1 lds
  buffer_load_dwordx4 v16, s[12:15], s86 offen offset:2048 sc1 lds
  buffer_load_dwordx4 v16, s[12:15], s86 offen offset:3072 sc1 lds
  s_add_u32 m0, s88, 16384
  s_add_u32 s86, s86, 16384
  buffer_load_dwordx4 v16, s[12:15], s87 offen offset:0 sc1 lds
  buffer_load_dwordx4 v16, s[12:15], s87 offen offset:1024 sc1 lds
  buffer_load_dwordx4 v16, s[12:15], s87 offen offset:2048 sc1 lds
  buffer_load_dwordx4 v16, s[12:15], s87 offen offset:3072 sc1 lds
  s_add_u32 s87, s87, 16384
  s_add_u32 s88, s88, 32768
  s_sub_u32 s96, s88, 163840
  s_cselect_b32 s88, s88, s96
  v_exp_f32 v168, v168
  v_mul_f32 v164, v164, v228
  v_exp_f32 v169, v169
  v_mul_f32 v165, v165, v229
  v_exp_f32 v170, v170
  v_mul_f32 v166, v166, v230
  v_exp_f32 v171, v171
  v_mul_f32 v167, v167, v231
  v_add_f32 v168, 1.0, v168
  v_add_f32 v169, 1.0, v169
  v_add_f32 v170, 1.0, v170
  v_add_f32 v171, 1.0, v171
  v_rcp_f32 v168, v168
  v_rcp_f32 v169, v169
  v_rcp_f32 v170, v170
  v_rcp_f32 v171, v171
  v_mul_f32 v168, v168, v164
  v_mul_f32 v169, v169, v165
  v_mul_f32 v170, v170, v166
  v_mul_f32 v171, v171, v167
  v_cvt_pk_bf16_f32 v226, v168, v169
  v_cvt_pk_bf16_f32 v227, v170, v171
  v_pk_mul_f32 v[176:177], v[140:141], v[140:141]
  v_pk_mul_f32 v[178:179], v[142:143], v[142:143]
  v_pk_mul_f32 v[184:185], v[172:173], v[172:173]
  v_pk_mul_f32 v[186:187], v[174:175], v[174:175]
  v_pk_fma_f32 v[176:177], v[176:177], s[94:95], v[0:1] op_sel:[0,0,1] op_sel_hi:[1,0,1]
  v_pk_fma_f32 v[178:179], v[178:179], s[94:95], v[0:1] op_sel:[0,0,1] op_sel_hi:[1,0,1]
  v_pk_fma_f32 v[184:185], v[184:185], s[94:95], v[0:1] op_sel:[0,0,1] op_sel_hi:[1,0,1]
  v_pk_fma_f32 v[186:187], v[186:187], s[94:95], v[0:1] op_sel:[0,0,1] op_sel_hi:[1,0,1]
  v_pk_mul_f32 v[176:177], v[176:177], v[140:141]
  v_pk_mul_f32 v[178:179], v[178:179], v[142:143]
  v_pk_mul_f32 v[184:185], v[184:185], v[172:173]
  v_pk_mul_f32 v[186:187], v[186:187], v[174:175]
  v_exp_f32 v176, v176
  v_exp_f32 v177, v177
  v_exp_f32 v178, v178
  v_exp_f32 v179, v179
  v_pk_mul_f32 v[140:141], v[140:141], v[204:205]
  v_pk_mul_f32 v[142:143], v[142:143], v[206:207]
  v_exp_f32 v184, v184
  v_exp_f32 v185, v185
  v_exp_f32 v186, v186
  v_exp_f32 v187, v187
  v_pk_mul_f32 v[172:173], v[172:173], v[236:237]
  v_pk_mul_f32 v[174:175], v[174:175], v[238:239]
  v_pk_add_f32 v[176:177], v[176:177], 1.0 op_sel_hi:[1,0]
  v_pk_add_f32 v[178:179], v[178:179], 1.0 op_sel_hi:[1,0]
  v_pk_add_f32 v[184:185], v[184:185], 1.0 op_sel_hi:[1,0]
  v_pk_add_f32 v[186:187], v[186:187], 1.0 op_sel_hi:[1,0]
  v_rcp_f32 v176, v176
  v_rcp_f32 v177, v177
  v_rcp_f32 v178, v178
  v_rcp_f32 v179, v179
  v_rcp_f32 v184, v184
  v_rcp_f32 v185, v185
  v_rcp_f32 v186, v186
  v_rcp_f32 v187, v187
  v_pk_mul_f32 v[176:177], v[176:177], v[140:141]
  v_pk_mul_f32 v[178:179], v[178:179], v[142:143]
  v_pk_mul_f32 v[184:185], v[184:185], v[172:173]
  v_pk_mul_f32 v[186:187], v[186:187], v[174:175]
  v_cvt_pk_bf16_f32 v232, v176, v177
  v_cvt_pk_bf16_f32 v233, v178, v179
  v_cvt_pk_bf16_f32 v234, v184, v185
  v_cvt_pk_bf16_f32 v235, v186, v187
  v_pk_mul_f32 v[160:161], v[148:149], v[148:149]
  v_pk_mul_f32 v[162:163], v[150:151], v[150:151]
  v_pk_mul_f32 v[168:169], v[180:181], v[180:181]
  v_pk_mul_f32 v[170:171], v[182:183], v[182:183]
  v_pk_fma_f32 v[160:161], v[160:161], s[94:95], v[0:1] op_sel:[0,0,1] op_sel_hi:[1,0,1]
  v_pk_fma_f32 v[162:163], v[162:163], s[94:95], v[0:1] op_sel:[0,0,1] op_sel_hi:[1,0,1]
  v_pk_fma_f32 v[168:169], v[168:169], s[94:95], v[0:1] op_sel:[0,0,1] op_sel_hi:[1,0,1]
  v_pk_fma_f32 v[170:171], v[170:171], s[94:95], v[0:1] op_sel:[0,0,1] op_sel_hi:[1,0,1]
  v_pk_mul_f32 v[160:161], v[160:161], v[148:149]
  v_pk_mul_f32 v[162:163], v[162:163], v[150:151]
  v_pk_mul_f32 v[168:169], v[168:169], v[180:181]
  v_pk_mul_f32 v[170:171], v[170:171], v[182:183]
  v_exp_f32 v160, v160
  v_exp_f32 v161, v161
  v_exp_f32 v162, v162
  v_exp_f32 v163, v163
  v_pk_mul_f32 v[148:149], v[148:149], v[212:213]
  v_pk_mul_f32 v[150:151], v[150:151], v[214:215]
  v_exp_f32 v168, v168
  v_exp_f32 v169, v169
  v_exp_f32 v170, v170
  v_exp_f32 v171, v171
  v_pk_mul_f32 v[180:181], v[180:181], v[244:245]
  v_pk_mul_f32 v[182:183], v[182:183], v[246:247]
  v_pk_add_f32 v[160:161], v[160:161], 1.0 op_sel_hi:[1,0]
  v_pk_add_f32 v[162:163], v[162:163], 1.0 op_sel_hi:[1,0]
  v_pk_add_f32 v[168:169], v[168:169], 1.0 op_sel_hi:[1,0]
  v_pk_add_f32 v[170:171], v[170:171], 1.0 op_sel_hi:[1,0]
  v_rcp_f32 v160, v160
  v_rcp_f32 v161, v161
  v_rcp_f32 v162, v162
  v_rcp_f32 v163, v163
  v_rcp_f32 v168, v168
  v_rcp_f32 v169, v169
  v_rcp_f32 v170, v170
  v_rcp_f32 v171, v171
  v_pk_mul_f32 v[160:161], v[160:161], v[148:149]
  v_pk_mul_f32 v[162:163], v[162:163], v[150:151]
  v_pk_mul_f32 v[168:169], v[168:169], v[180:181]
  v_pk_mul_f32 v[170:171], v[170:171], v[182:183]
  v_cvt_pk_bf16_f32 v240, v160, v161
  v_cvt_pk_bf16_f32 v241, v162, v163
  v_cvt_pk_bf16_f32 v242, v168, v169
  v_cvt_pk_bf16_f32 v243, v170, v171
  v_pk_mul_f32 v[176:177], v[156:157], v[156:157]
  v_pk_mul_f32 v[178:179], v[158:159], v[158:159]
  v_pk_mul_f32 v[184:185], v[188:189], v[188:189]
  v_pk_mul_f32 v[186:187], v[190:191], v[190:191]
  v_pk_fma_f32 v[176:177], v[176:177], s[94:95], v[0:1] op_sel:[0,0,1] op_sel_hi:[1,0,1]
  v_pk_fma_f32 v[178:179], v[178:179], s[94:95], v[0:1] op_sel:[0,0,1] op_sel_hi:[1,0,1]
  v_pk_fma_f32 v[184:185], v[184:185], s[94:95], v[0:1] op_sel:[0,0,1] op_sel_hi:[1,0,1]
  v_pk_fma_f32 v[186:187], v[186:187], s[94:95], v[0:1] op_sel:[0,0,1] op_sel_hi:[1,0,1]
  v_pk_mul_f32 v[176:177], v[176:177], v[156:157]
  v_pk_mul_f32 v[178:179], v[178:179], v[158:159]
  v_pk_mul_f32 v[184:185], v[184:185], v[188:189]
  v_pk_mul_f32 v[186:187], v[186:187], v[190:191]
  v_exp_f32 v176, v176
  v_exp_f32 v177, v177
  v_exp_f32 v178, v178
  v_exp_f32 v179, v179
  v_pk_mul_f32 v[156:157], v[156:157], v[220:221]
  v_pk_mul_f32 v[158:159], v[158:159], v[222:223]
  v_exp_f32 v184, v184
  v_exp_f32 v185, v185
  v_exp_f32 v186, v186
  v_exp_f32 v187, v187
  v_pk_mul_f32 v[188:189], v[188:189], v[252:253]
  v_pk_mul_f32 v[190:191], v[190:191], v[254:255]
  v_pk_add_f32 v[176:177], v[176:177], 1.0 op_sel_hi:[1,0]
  v_pk_add_f32 v[178:179], v[178:179], 1.0 op_sel_hi:[1,0]
  v_pk_add_f32 v[184:185], v[184:185], 1.0 op_sel_hi:[1,0]
  v_pk_add_f32 v[186:187], v[186:187], 1.0 op_sel_hi:[1,0]
  v_rcp_f32 v176, v176
  v_rcp_f32 v177, v177
  v_rcp_f32 v178, v178
  v_rcp_f32 v179, v179
  v_rcp_f32 v184, v184
  v_rcp_f32 v185, v185
  v_rcp_f32 v186, v186
  v_rcp_f32 v187, v187
  v_pk_mul_f32 v[176:177], v[176:177], v[156:157]
  v_pk_mul_f32 v[178:179], v[178:179], v[158:159]
  v_pk_mul_f32 v[184:185], v[184:185], v[188:189]
  v_pk_mul_f32 v[186:187], v[186:187], v[190:191]
  v_cvt_pk_bf16_f32 v248, v176, v177
  v_cvt_pk_bf16_f32 v249, v178, v179
  v_cvt_pk_bf16_f32 v250, v184, v185
  v_cvt_pk_bf16_f32 v251, v186, v187
  s_add_u32 s33, s85, 131072
  s_sub_u32 s34, s33, 163840
  s_cselect_b32 s33, s33, s34
  s_lshl_b32 s34, s28, 12
  s_add_u32 s33, s33, s34
  v_add_u32 v24, s33, v16
  v_xor_b32 v25, 4096, v24
  s_mov_b32 s34, 0x3e0293ee
  s_bitcmp1_b32 s28, 0
  s_cbranch_scc1 F_X1B
  v_pk_mul_f32 v[36:37], v[36:37], s[34:35] op_sel_hi:[1,0]
  v_pk_mul_f32 v[38:39], v[38:39], s[34:35] op_sel_hi:[1,0]
  v_pk_mul_f32 v[52:53], v[52:53], s[34:35] op_sel_hi:[1,0]
  v_pk_mul_f32 v[54:55], v[54:55], s[34:35] op_sel_hi:[1,0]
  v_cvt_pk_bf16_f32 v96, v36, v37
  v_cvt_pk_bf16_f32 v97, v38, v39
  v_cvt_pk_bf16_f32 v98, v52, v53
  v_cvt_pk_bf16_f32 v99, v54, v55
  ds_write_b128 v24, v[96:99] offset:0
  v_pk_mul_f32 v[68:69], v[68:69], s[34:35] op_sel_hi:[1,0]
  v_pk_mul_f32 v[70:71], v[70:71], s[34:35] op_sel_hi:[1,0]
  v_pk_mul_f32 v[136:137], v[136:137], s[34:35] op_sel_hi:[1,0]
  v_pk_mul_f32 v[138:139], v[138:139], s[34:35] op_sel_hi:[1,0]
  v_cvt_pk_bf16_f32 v100, v68, v69
  v_cvt_pk_bf16_f32 v101, v70, v71
  v_cvt_pk_bf16_f32 v102, v136, v137
  v_cvt_pk_bf16_f32 v103, v138, v139
  ds_write_b128 v24, v[100:103] offset:1024
  v_pk_mul_f32 v[40:41], v[40:41], s[34:35] op_sel_hi:[1,0]
  v_pk_mul_f32 v[42:43], v[42:43], s[34:35] op_sel_hi:[1,0]
  v_pk_mul_f32 v[56:57], v[56:57], s[34:35] op_sel_hi:[1,0]
  v_pk_mul_f32 v[58:59], v[58:59], s[34:35] op_sel_hi:[1,0]
  v_cvt_pk_bf16_f32 v104, v40, v41
  v_cvt_pk_bf16_f32 v105, v42, v43
  v_cvt_pk_bf16_f32 v106, v56, v57
  v_cvt_pk_bf16_f32 v107, v58, v59
  ds_write_b128 v24, v[104:107] offset:2048
  v_pk_mul_f32 v[72:73], v[72:73], s[34:35] op_sel_hi:[1,0]
  v_pk_mul_f32 v[74:75], v[74:75], s[34:35] op_sel_hi:[1,0]
  v_pk_mul_f32 v[144:145], v[144:145], s[34:35] op_sel_hi:[1,0]
  v_pk_mul_f32 v[146:147], v[146:147], s[34:35] op_sel_hi:[1,0]
  v_cvt_pk_bf16_f32 v108, v72, v73
  v_cvt_pk_bf16_f32 v109, v74, v75
  v_cvt_pk_bf16_f32 v110, v144, v145
  v_cvt_pk_bf16_f32 v111, v146, v147
  ds_write_b128 v24, v[108:111] offset:3072
  v_pk_mul_f32 v[32:33], v[32:33], s[34:35] op_sel_hi:[1,0]
  v_pk_mul_f32 v[34:35], v[34:35], s[34:35] op_sel_hi:[1,0]
  v_pk_mul_f32 v[48:49], v[48:49], s[34:35] op_sel_hi:[1,0]
  v_pk_mul_f32 v[50:51], v[50:51], s[34:35] op_sel_hi:[1,0]
  v_cvt_pk_bf16_f32 v192, v32, v33
  v_cvt_pk_bf16_f32 v193, v34, v35
  v_cvt_pk_bf16_f32 v194, v48, v49
  v_cvt_pk_bf16_f32 v195, v50, v51
  v_pk_mul_f32 v[64:65], v[64:65], s[34:35] op_sel_hi:[1,0]
  v_pk_mul_f32 v[66:67], v[66:67], s[34:35] op_sel_hi:[1,0]
  v_pk_mul_f32 v[128:129], v[128:129], s[34:35] op_sel_hi:[1,0]
  v_pk_mul_f32 v[130:131], v[130:131], s[34:35] op_sel_hi:[1,0]
  v_cvt_pk_bf16_f32 v196, v64, v65
  v_cvt_pk_bf16_f32 v197, v66, v67
  v_cvt_pk_bf16_f32 v198, v128, v129
  v_cvt_pk_bf16_f32 v199, v130, v131
  v_pk_mul_f32 v[44:45], v[44:45], s[34:35] op_sel_hi:[1,0]
  v_pk_mul_f32 v[46:47], v[46:47], s[34:35] op_sel_hi:[1,0]
  v_pk_mul_f32 v[60:61], v[60:61], s[34:35] op_sel_hi:[1,0]
  v_pk_mul_f32 v[62:63], v[62:63], s[34:35] op_sel_hi:[1,0]
  v_cvt_pk_bf16_f32 v208, v44, v45
  v_cvt_pk_bf16_f32 v209, v46, v47
  v_cvt_pk_bf16_f32 v210, v60, v61
  v_cvt_pk_bf16_f32 v211, v62, v63
  v_pk_mul_f32 v[76:77], v[76:77], s[34:35] op_sel_hi:[1,0]
  v_pk_mul_f32 v[78:79], v[78:79], s[34:35] op_sel_hi:[1,0]
  v_pk_mul_f32 v[152:153], v[152:153], s[34:35] op_sel_hi:[1,0]
  v_pk_mul_f32 v[154:155], v[154:155], s[34:35] op_sel_hi:[1,0]
  v_cvt_pk_bf16_f32 v212, v76, v77
  v_cvt_pk_bf16_f32 v213, v78, v79
  v_cvt_pk_bf16_f32 v214, v152, v153
  v_cvt_pk_bf16_f32 v215, v154, v155
  s_branch F_X2B
F_X1B:
  v_pk_mul_f32 v[32:33], v[32:33], s[34:35] op_sel_hi:[1,0]
  v_pk_mul_f32 v[34:35], v[34:35], s[34:35] op_sel_hi:[1,0]
  v_pk_mul_f32 v[48:49], v[48:49], s[34:35] op_sel_hi:[1,0]
  v_pk_mul_f32 v[50:51], v[50:51], s[34:35] op_sel_hi:[1,0]
  v_cvt_pk_bf16_f32 v96, v32, v33
  v_cvt_pk_bf16_f32 v97, v34, v35
  v_cvt_pk_bf16_f32 v98, v48, v49
  v_cvt_pk_bf16_f32 v99, v50, v51
  ds_write_b128 v24, v[96:99] offset:0
  v_pk_mul_f32 v[64:65], v[64:65], s[34:35] op_sel_hi:[1,0]
  v_pk_mul_f32 v[66:67], v[66:67], s[34:35] op_sel_hi:[1,0]
  v_pk_mul_f32 v[128:129], v[128:129], s[34:35] op_sel_hi:[1,0]
  v_pk_mul_f32 v[130:131], v[130:131], s[34:35] op_sel_hi:[1,0]
  v_cvt_pk_bf16_f32 v100, v64, v65
  v_cvt_pk_bf16_f32 v101, v66, v67
  v_cvt_pk_bf16_f32 v102, v128, v129
  v_cvt_pk_bf16_f32 v103, v130, v131
  ds_write_b128 v24, v[100:103] offset:1024
  v_pk_mul_f32 v[44:45], v[44:45], s[34:35] op_sel_hi:[1,0]
  v_pk_mul_f32 v[46:47], v[46:47], s[34:35] op_sel_hi:[1,0]
  v_pk_mul_f32 v[60:61], v[60:61], s[34:35] op_sel_hi:[1,0]
  v_pk_mul_f32 v[62:63], v[62:63], s[34:35] op_sel_hi:[1,0]
  v_cvt_pk_bf16_f32 v104, v44, v45
  v_cvt_pk_bf16_f32 v105, v46, v47
  v_cvt_pk_bf16_f32 v106, v60, v61
  v_cvt_pk_bf16_f32 v107, v62, v63
  ds_write_b128 v24, v[104:107] offset:2048
  v_pk_mul_f32 v[76:77], v[76:77], s[34:35] op_sel_hi:[1,0]
  v_pk_mul_f32 v[78:79], v[78:79], s[34:35] op_sel_hi:[1,0]
  v_pk_mul_f32 v[152:153], v[152:153], s[34:35] op_sel_hi:[1,0]
  v_pk_mul_f32 v[154:155], v[154:155], s[34:35] op_sel_hi:[1,0]
  v_cvt_pk_bf16_f32 v108, v76, v77
  v_cvt_pk_bf16_f32 v109, v78, v79
  v_cvt_pk_bf16_f32 v110, v152, v153
  v_cvt_pk_bf16_f32 v111, v154, v155
  ds_write_b128 v24, v[108:111] offset:3072
  v_pk_mul_f32 v[36:37], v[36:37], s[34:35] op_sel_hi:[1,0]
  v_pk_mul_f32 v[38:39], v[38:39], s[34:35] op_sel_hi:[1,0]
  v_pk_mul_f32 v[52:53], v[52:53], s[34:35] op_sel_hi:[1,0]
  v_pk_mul_f32 v[54:55], v[54:55], s[34:35] op_sel_hi:[1,0]
  v_cvt_pk_bf16_f32 v200, v36, v37
  v_cvt_pk_bf16_f32 v201, v38, v39
  v_cvt_pk_bf16_f32 v202, v52, v53
  v_cvt_pk_bf16_f32 v203, v54, v55
  v_pk_mul_f32 v[68:69], v[68:69], s[34:35] op_sel_hi:[1,0]
  v_pk_mul_f32 v[70:71], v[70:71], s[34:35] op_sel_hi:[1,0]
  v_pk_mul_f32 v[136:137], v[136:137], s[34:35] op_sel_hi:[1,0]
  v_pk_mul_f32 v[138:139], v[138:139], s[34:35] op_sel_hi:[1,0]
  v_cvt_pk_bf16_f32 v204, v68, v69
  v_cvt_pk_bf16_f32 v205, v70, v71
  v_cvt_pk_bf16_f32 v206, v136, v137
  v_cvt_pk_bf16_f32 v207, v138, v139
  v_pk_mul_f32 v[40:41], v[40:41], s[34:35] op_sel_hi:[1,0]
  v_pk_mul_f32 v[42:43], v[42:43], s[34:35] op_sel_hi:[1,0]
  v_pk_mul_f32 v[56:57], v[56:57], s[34:35] op_sel_hi:[1,0]
  v_pk_mul_f32 v[58:59], v[58:59], s[34:35] op_sel_hi:[1,0]
  v_cvt_pk_bf16_f32 v216, v40, v41
  v_cvt_pk_bf16_f32 v217, v42, v43
  v_cvt_pk_bf16_f32 v218, v56, v57
  v_cvt_pk_bf16_f32 v219, v58, v59
  v_pk_mul_f32 v[72:73], v[72:73], s[34:35] op_sel_hi:[1,0]
  v_pk_mul_f32 v[74:75], v[74:75], s[34:35] op_sel_hi:[1,0]
  v_pk_mul_f32 v[144:145], v[144:145], s[34:35] op_sel_hi:[1,0]
  v_pk_mul_f32 v[146:147], v[146:147], s[34:35] op_sel_hi:[1,0]
  v_cvt_pk_bf16_f32 v220, v72, v73
  v_cvt_pk_bf16_f32 v221, v74, v75
  v_cvt_pk_bf16_f32 v222, v144, v145
  v_cvt_pk_bf16_f32 v223, v146, v147
F_X2B:
  s_lshr_b32 s64, s29, 1
  s_sub_u32 s65, 15, s31
  s_bitcmp1_b32 s29, 0
  s_cselect_b32 s65, s65, s31
  s_mov_b32 s66, s32
  s_mov_b32 s67, s95
  s_mov_b32 s68, s81
  v_lshrrev_b32 v112, 4, v16
  s_mul_i32 s69, s28, 5120
  s_mul_i32 s34, s66, 320
  s_mul_i32 s33, s28, 20480
  s_add_u32 s34, s34, s33
  s_mul_i32 s70, s64, 573440
  s_add_u32 s70, s70, s34
  s_mul_i32 s71, s64, 1310720
  s_add_u32 s71, s71, s34
  s_lshl_b32 s74, s65, 3
  s_lshl_b32 s33, s68, 1
  s_add_u32 s74, s74, s33
  s_mul_i32 s72, s74, 182
  s_mul_i32 s33, s64, 14
  s_add_u32 s72, s72, s33
  s_add_u32 s72, s72, s67
  s_add_u32 s72, s72, 32896
  s_lshl_b32 s72, s72, 10
  s_mul_i32 s33, s67, 186368
  s_add_u32 s72, s72, s33
  s_lshl_b32 s33, s33, 1
  s_sub_u32 s77, 186368, s33
  s_add_u32 s73, s72, s77
  v_and_b32 v113, 15, v112
  v_lshlrev_b32 v11, 3, v113
  s_add_u32 s76, s74, s67
  s_lshl_b32 s76, s76, 7
  s_add_u32 s76, s76, 58720256
  v_lshrrev_b32 v115, 4, v112
  v_xor_b32 v23, 32, v22
  v_mul_u32_u24 v113, 1280, v113
  v_lshl_add_u32 v10, v115, 3, v113
  s_lshl_b32 s75, s65, 2
  s_add_u32 s75, s75, s66
  s_mov_b32 s4, s54
  s_mov_b32 s5, s55
  s_mov_b32 s6, 2211840
  s_mov_b32 s7, 0x20000
  s_mov_b32 s8, s46
  s_mov_b32 s9, s47
  s_mov_b32 s10, 5242880
  s_mov_b32 s11, 0x20000
  s_mov_b32 s16, s54
  s_mov_b32 s17, s55
  s_mov_b32 s18, 2211840
  s_mov_b32 s19, 0x20000
  s_cmp_lt_u32 s28, 4
  s_cselect_b32 s18, 2211840, 0
  s_mov_b32 s20, s62
  s_mov_b32 s21, s63
  s_mov_b32 s22, 100663296
  s_mov_b32 s23, 0x20000
  s_cmp_lt_u32 s64, 3
  s_cselect_b32 s22, 100663296, 0
  v_and_b32 v113, 15, v112
  v_lshlrev_b32 v114, 2, v115
  v_sub_u32 v113, v113, v114
  v_mov_b32 v114, 0xf149f2ca
  v_cmp_le_i32 vcc, 0, v113
  s_nop 1
  v_cndmask_b32 v28, v114, 0, vcc
  v_cmp_le_i32 vcc, 1, v113
  s_nop 1
  v_cndmask_b32 v29, v114, 0, vcc
  v_cmp_le_i32 vcc, 2, v113
  s_nop 1
  v_cndmask_b32 v30, v114, 0, vcc
  v_cmp_le_i32 vcc, 3, v113
  s_nop 1
  v_cndmask_b32 v31, v114, 0, vcc
  s_waitcnt vmcnt(0) lgkmcnt(0)
  s_barrier
  s_bitcmp1_b32 s28, 0
  s_cbranch_scc1 F_X3B
  ds_read_b128 v[200:203], v25 offset:0
  ds_read_b128 v[204:207], v25 offset:1024
  ds_read_b128 v[216:219], v25 offset:2048
  ds_read_b128 v[220:223], v25 offset:3072
  s_branch F_X4B
F_X3B:
  ds_read_b128 v[192:195], v25 offset:0
  ds_read_b128 v[196:199], v25 offset:1024
  ds_read_b128 v[208:211], v25 offset:2048
  ds_read_b128 v[212:215], v25 offset:3072
F_X4B:
  v_add_u32 v24, s85, v16
  ds_read_b128 v[32:35], v24 offset:0
  ds_read_b128 v[36:39], v24 offset:1024
  ds_read_b128 v[40:43], v24 offset:2048
  ds_read_b128 v[44:47], v24 offset:3072
  s_lshl_b32 s33, s89, 7
  s_add_u32 s33, s33, 58720256
  s_lshl_b32 s34, s90, 7
  s_add_u32 s34, s34, 58720256
  buffer_load_dword v26, v11, s[12:15], s33 offen sc1
  buffer_load_dword v27, v11, s[12:15], s34 offen sc1
  v_mov_b32 v25, v24
  s_add_u32 s85, s85, 32768
  s_sub_u32 s33, s85, 163840
  s_cselect_b32 s85, s85, s33
  s_setprio 1
  s_mov_b32 m0, s88
  s_nop 0
  buffer_load_dwordx4 v16, s[12:15], s86 offen offset:0 sc1 lds
  buffer_load_dwordx4 v16, s[12:15], s86 offen offset:1024 sc1 lds
  buffer_load_dwordx4 v16, s[12:15], s86 offen offset:2048 sc1 lds
  s_cmp_eq_u32 s89, 0
  s_cselect_b32 s33, 1.0, 0
  v_mul_f32 v112, s33, v28
  v_mul_f32 v113, s33, v29
  v_mul_f32 v114, s33, v30
  v_mul_f32 v115, s33, v31
  s_waitcnt lgkmcnt(3)
  s_nop 0
  v_mfma_f32_16x16x32_bf16 v[64:67], v[32:35], v[192:195], v[112:115]
  v_mfma_f32_16x16x32_bf16 v[68:71], v[32:35], v[208:211], 0
  s_waitcnt lgkmcnt(2)
  v_mfma_f32_16x16x32_bf16 v[64:67], v[36:39], v[196:199], v[64:67]
  v_mfma_f32_16x16x32_bf16 v[68:71], v[36:39], v[212:215], v[68:71]
  s_waitcnt lgkmcnt(1)
  v_mfma_f32_16x16x32_bf16 v[64:67], v[40:43], v[200:203], v[64:67]
  v_mfma_f32_16x16x32_bf16 v[68:71], v[40:43], v[216:219], v[68:71]
  s_waitcnt lgkmcnt(0)
  v_mfma_f32_16x16x32_bf16 v[64:67], v[44:47], v[204:207], v[64:67]
  v_mfma_f32_16x16x32_bf16 v[68:71], v[44:47], v[220:223], v[68:71]
  ds_read_b128 v[32:35], v24 offset:0
  ds_read_b128 v[36:39], v24 offset:1024
  ds_read_b128 v[40:43], v24 offset:2048
  ds_read_b128 v[44:47], v24 offset:3072
  ds_read_b128 v[48:51], v24 offset:4096
  ds_read_b128 v[52:55], v24 offset:5120
  buffer_load_dwordx4 v16, s[12:15], s86 offen offset:3072 sc1 lds
  s_add_u32 m0, s88, 16384
  s_add_u32 s86, s86, 16384
  buffer_load_dwordx4 v16, s[12:15], s87 offen offset:0 sc1 lds
  buffer_load_dwordx4 v16, s[12:15], s87 offen offset:1024 sc1 lds
  buffer_load_dwordx4 v16, s[12:15], s87 offen offset:2048 sc1 lds
  v_mov_b32 v228, 0
  v_mov_b32 v229, 0
  v_max3_f32 v64, v64, v65, v66
  v_max_f32 v64, v64, v67
  v_max3_f32 v68, v68, v69, v70
  v_max_f32 v68, v68, v71
  v_mov_b32 v65, v64
  v_mov_b32 v69, v68
  s_nop 0
  v_permlane32_swap_b32 v64, v65
  v_permlane32_swap_b32 v68, v69
  v_max_f32 v64, v64, v65
  v_max_f32 v68, v68, v69
  buffer_load_dwordx4 v16, s[12:15], s87 offen offset:3072 sc1 lds
  s_add_u32 s87, s87, 16384
  s_add_u32 s88, s88, 32768
  s_sub_u32 s96, s88, 163840
  s_cselect_b32 s88, s88, s96
  s_mov_b32 m0, s88
  v_mov_b32 v65, v64
  v_mov_b32 v69, v68
  s_nop 0
  v_permlane16_swap_b32 v64, v65
  v_permlane16_swap_b32 v68, v69
  v_max_f32 v64, v64, v65
  v_max_f32 v68, v68, v69
  buffer_load_dwordx4 v16, s[12:15], s86 offen offset:0 sc1 lds
  buffer_load_dwordx4 v16, s[12:15], s86 offen offset:1024 sc1 lds
  v_sub_f32 v112, 0, v64
  v_sub_f32 v120, v28, v64
  buffer_load_dwordx4 v16, s[12:15], s86 offen offset:2048 sc1 lds
  v_sub_f32 v113, 0, v64
  v_sub_f32 v121, v29, v64
  buffer_load_dwordx4 v16, s[12:15], s86 offen offset:3072 sc1 lds
  s_add_u32 m0, s88, 16384
  s_add_u32 s86, s86, 16384
  v_sub_f32 v114, 0, v64
  v_sub_f32 v122, v30, v64
  buffer_load_dwordx4 v16, s[12:15], s87 offen offset:0 sc1 lds
  v_sub_f32 v115, 0, v64
  v_sub_f32 v123, v31, v64
  buffer_load_dwordx4 v16, s[12:15], s87 offen offset:1024 sc1 lds
  v_sub_f32 v116, 0, v68
  v_sub_f32 v124, v28, v68
  buffer_load_dwordx4 v16, s[12:15], s87 offen offset:2048 sc1 lds
  v_sub_f32 v117, 0, v68
  v_sub_f32 v125, v29, v68
  buffer_load_dwordx4 v16, s[12:15], s87 offen offset:3072 sc1 lds
  s_add_u32 s87, s87, 16384
  s_add_u32 s88, s88, 32768
  s_sub_u32 s96, s88, 163840
  s_cselect_b32 s88, s88, s96
  v_sub_f32 v118, 0, v68
  v_sub_f32 v126, v30, v68
  s_mov_b32 m0, s88
  v_sub_f32 v119, 0, v68
  v_sub_f32 v127, v31, v68
  buffer_load_dwordx4 v16, s[12:15], s86 offen offset:0 sc1 lds
  buffer_load_dwordx4 v16, s[12:15], s86 offen offset:1024 sc1 lds
  buffer_load_dwordx4 v16, s[12:15], s86 offen offset:2048 sc1 lds
  buffer_load_dwordx4 v16, s[12:15], s86 offen offset:3072 sc1 lds
  s_add_u32 m0, s88, 16384
  s_add_u32 s86, s86, 16384
  buffer_load_dwordx4 v16, s[12:15], s87 offen offset:0 sc1 lds
  buffer_load_dwordx4 v16, s[12:15], s87 offen offset:1024 sc1 lds
  buffer_load_dwordx4 v16, s[12:15], s87 offen offset:2048 sc1 lds
  buffer_load_dwordx4 v16, s[12:15], s87 offen offset:3072 sc1 lds
  s_add_u32 s87, s87, 16384
  s_add_u32 s88, s88, 32768
  s_sub_u32 s96, s88, 163840
  s_cselect_b32 s88, s88, s96
  buffer_store_dwordx4 v[224:227], v16, s[12:15], s93 offen sc1
  s_sub_u32 s84, s82, 2
  s_mov_b32 s92, 1
  s_cmp_lg_u32 s84, 0
  s_cbranch_scc1 F_FIRSTB
  v_mov_b32 v80, 0x0
  v_mov_b32 v81, 0x0
  v_mov_b32 v82, 0x0
  v_mov_b32 v83, 0x0
  v_mov_b32 v84, 0x0
  v_mov_b32 v85, 0x0
  v_mov_b32 v86, 0x0
  v_mov_b32 v87, 0x0
  v_mov_b32 v88, 0x0
  v_mov_b32 v89, 0x0
  v_mov_b32 v90, 0x0
  v_mov_b32 v91, 0xf149f2ca
  v_mov_b32 v92, 0xf149f2ca
  v_mov_b32 v93, 0xf149f2ca
  v_mov_b32 v94, 0xf149f2ca
  v_mov_b32 v95, 0xf149f2ca
  v_mov_b32 v104, 0
  v_mov_b32 v105, 0
  v_mov_b32 v106, 0
  v_mov_b32 v107, 0
  v_mov_b32 v108, 0
  v_mov_b32 v109, 0
  v_mov_b32 v110, 0
  v_mov_b32 v111, 0
  v_mov_b32 v128, 0
  v_mov_b32 v129, 0
  v_mov_b32 v130, 0
  v_mov_b32 v131, 0
  v_mov_b32 v132, 0
  v_mov_b32 v133, 0
  v_mov_b32 v134, 0
  v_mov_b32 v135, 0
  v_mov_b32 v136, 0
  v_mov_b32 v137, 0
  v_mov_b32 v138, 0
  v_mov_b32 v139, 0
  v_mov_b32 v140, 0
  v_mov_b32 v141, 0
  v_mov_b32 v142, 0
  v_mov_b32 v143, 0
  v_mov_b32 v144, 0
  v_mov_b32 v145, 0
  v_mov_b32 v146, 0
  v_mov_b32 v147, 0
  v_mov_b32 v148, 0
  v_mov_b32 v149, 0
  v_mov_b32 v150, 0
  v_mov_b32 v151, 0
  v_mov_b32 v152, 0
  v_mov_b32 v153, 0
  v_mov_b32 v154, 0
  v_mov_b32 v155, 0
  v_mov_b32 v156, 0
  v_mov_b32 v157, 0
  v_mov_b32 v158, 0
  v_mov_b32 v159, 0
  v_mov_b32 v160, 0
  v_mov_b32 v161, 0
  v_mov_b32 v162, 0
  v_mov_b32 v163, 0
  v_mov_b32 v164, 0
  v_mov_b32 v165, 0
  v_mov_b32 v166, 0
  v_mov_b32 v167, 0
  v_mov_b32 v168, 0
  v_mov_b32 v169, 0
  v_mov_b32 v170, 0
  v_mov_b32 v171, 0
  v_mov_b32 v172, 0
  v_mov_b32 v173, 0
  v_mov_b32 v174, 0
  v_mov_b32 v175, 0
  v_mov_b32 v176, 0
  v_mov_b32 v177, 0
  v_mov_b32 v178, 0
  v_mov_b32 v179, 0
  v_mov_b32 v180, 0
  v_mov_b32 v181, 0
  v_mov_b32 v182, 0
  v_mov_b32 v183, 0
  v_mov_b32 v184, 0
  v_mov_b32 v185, 0
  v_mov_b32 v186, 0
  v_mov_b32 v187, 0
  v_mov_b32 v188, 0
  v_mov_b32 v189, 0
  v_mov_b32 v190, 0
  v_mov_b32 v191, 0
  s_branch F_DIAGB
F_FIRSTB:
  s_waitcnt lgkmcnt(4)
  v_mfma_f32_16x16x32_bf16 v[64:67], v[32:35], v[192:195], v[112:115]
  ds_read_b128 v[56:59], v24 offset:6144
  v_mov_b32 v25, v24
  v_mfma_f32_16x16x32_bf16 v[68:71], v[32:35], v[208:211], v[116:119]
  v_mfma_f32_16x16x32_bf16 v[64:67], v[36:39], v[196:199], v[64:67]
  ds_read_b128 v[60:63], v24 offset:7168
  v_mfma_f32_16x16x32_bf16 v[68:71], v[36:39], v[212:215], v[68:71]
  s_waitcnt lgkmcnt(4)
  v_mfma_f32_16x16x32_bf16 v[64:67], v[40:43], v[200:203], v[64:67]
  ds_read_b128 v[32:35], v24 offset:8192
  v_mfma_f32_16x16x32_bf16 v[68:71], v[40:43], v[216:219], v[68:71]
  v_mfma_f32_16x16x32_bf16 v[64:67], v[44:47], v[204:207], v[64:67]
  ds_read_b128 v[36:39], v24 offset:9216
  v_mfma_f32_16x16x32_bf16 v[68:71], v[44:47], v[220:223], v[68:71]
  s_waitcnt lgkmcnt(4)
  v_mfma_f32_16x16x32_bf16 v[72:75], v[48:51], v[192:195], v[112:115]
  ds_read_b128 v[40:43], v24 offset:10240
  v_mfma_f32_16x16x32_bf16 v[76:79], v[48:51], v[208:211], v[116:119]
  v_mfma_f32_16x16x32_bf16 v[72:75], v[52:55], v[196:199], v[72:75]
  ds_read_b128 v[44:47], v24 offset:11264
  v_mfma_f32_16x16x32_bf16 v[76:79], v[52:55], v[212:215], v[76:79]
  v_exp_f32 v64, v64
  s_waitcnt lgkmcnt(4)
  v_mfma_f32_16x16x32_bf16 v[72:75], v[56:59], v[200:203], v[72:75]
  ds_read_b128 v[48:51], v24 offset:12288
  v_add_f32 v228, v228, v64
  v_mfma_f32_16x16x32_bf16 v[76:79], v[56:59], v[216:219], v[76:79]
  v_exp_f32 v65, v65
  v_mfma_f32_16x16x32_bf16 v[72:75], v[60:63], v[204:207], v[72:75]
  ds_read_b128 v[52:55], v24 offset:13312
  v_add_f32 v228, v228, v65
  v_cvt_pk_bf16_f32 v96, v64, v65
  v_mfma_f32_16x16x32_bf16 v[76:79], v[60:63], v[220:223], v[76:79]
  v_exp_f32 v66, v66
  s_waitcnt lgkmcnt(4)
  v_mfma_f32_16x16x32_bf16 v[80:83], v[32:35], v[192:195], v[112:115]
  ds_read_b128 v[56:59], v24 offset:14336
  v_add_f32 v228, v228, v66
  v_mfma_f32_16x16x32_bf16 v[84:87], v[32:35], v[208:211], v[116:119]
  v_exp_f32 v67, v67
  v_mfma_f32_16x16x32_bf16 v[80:83], v[36:39], v[196:199], v[80:83]
  ds_read_b128 v[60:63], v24 offset:15360
  v_add_u32 v24, s85, v16
  v_add_f32 v228, v228, v67
  v_cvt_pk_bf16_f32 v97, v66, v67
  v_mfma_f32_16x16x32_bf16 v[84:87], v[36:39], v[212:215], v[84:87]
  v_exp_f32 v68, v68
  s_waitcnt lgkmcnt(4)
  v_mfma_f32_16x16x32_bf16 v[80:83], v[40:43], v[200:203], v[80:83]
  ds_read_b128 v[32:35], v25 offset:16384
  s_add_u32 s85, s85, 32768
  s_sub_u32 s33, s85, 163840
  s_cselect_b32 s85, s85, s33
  v_add_f32 v229, v229, v68
  v_mfma_f32_16x16x32_bf16 v[84:87], v[40:43], v[216:219], v[84:87]
  v_exp_f32 v69, v69
  v_mfma_f32_16x16x32_bf16 v[80:83], v[44:47], v[204:207], v[80:83]
  ds_read_b128 v[36:39], v25 offset:17408
  v_add_f32 v229, v229, v69
  v_cvt_pk_bf16_f32 v100, v68, v69
  v_mfma_f32_16x16x32_bf16 v[84:87], v[44:47], v[220:223], v[84:87]
  v_exp_f32 v70, v70
  s_waitcnt lgkmcnt(4)
  v_mfma_f32_16x16x32_bf16 v[88:91], v[48:51], v[192:195], v[112:115]
  ds_read_b128 v[40:43], v25 offset:18432
  v_add_f32 v229, v229, v70
  v_mfma_f32_16x16x32_bf16 v[92:95], v[48:51], v[208:211], v[116:119]
  v_exp_f32 v71, v71
  v_mfma_f32_16x16x32_bf16 v[88:91], v[52:55], v[196:199], v[88:91]
  ds_read_b128 v[44:47], v25 offset:19456
  v_add_f32 v229, v229, v71
  v_cvt_pk_bf16_f32 v101, v70, v71
  v_mfma_f32_16x16x32_bf16 v[92:95], v[52:55], v[212:215], v[92:95]
  v_exp_f32 v72, v72
  s_waitcnt lgkmcnt(4)
  v_mfma_f32_16x16x32_bf16 v[88:91], v[56:59], v[200:203], v[88:91]
  ds_read_b128 v[48:51], v25 offset:20480
  v_add_f32 v228, v228, v72
  v_mfma_f32_16x16x32_bf16 v[92:95], v[56:59], v[216:219], v[92:95]
  v_exp_f32 v73, v73
  v_mfma_f32_16x16x32_bf16 v[88:91], v[60:63], v[204:207], v[88:91]
  ds_read_b128 v[52:55], v25 offset:21504
  v_add_f32 v228, v228, v73
  v_cvt_pk_bf16_f32 v98, v72, v73
  v_mfma_f32_16x16x32_bf16 v[92:95], v[60:63], v[220:223], v[92:95]
  s_waitcnt vmcnt(17)
  s_barrier
  v_exp_f32 v74, v74
  s_waitcnt lgkmcnt(4)
  v_exp_f32 v75, v75
  v_add_f32 v228, v228, v74
  v_add_f32 v228, v228, v75
  v_cvt_pk_bf16_f32 v99, v74, v75
  s_nop 1
  v_mfma_f32_16x16x32_bf16 v[128:131], v[32:35], v[96:99], 0
  ds_read_b128 v[56:59], v25 offset:22528
  s_mov_b32 m0, s88
  s_nop 0
  buffer_load_dwordx4 v16, s[12:15], s86 offen offset:0 sc1 lds
  v_exp_f32 v76, v76
  v_exp_f32 v77, v77
  v_add_f32 v229, v229, v76
  v_add_f32 v229, v229, v77
  v_cvt_pk_bf16_f32 v102, v76, v77
  v_exp_f32 v78, v78
  v_exp_f32 v79, v79
  v_add_f32 v229, v229, v78
  v_add_f32 v229, v229, v79
  v_cvt_pk_bf16_f32 v103, v78, v79
  s_nop 1
  v_mfma_f32_16x16x32_bf16 v[160:163], v[32:35], v[100:103], 0
  buffer_load_dwordx4 v16, s[12:15], s86 offen offset:1024 sc1 lds
  v_exp_f32 v80, v80
  v_mfma_f32_16x16x32_bf16 v[164:167], v[36:39], v[100:103], 0
  ds_read_b128 v[60:63], v25 offset:23552
  buffer_load_dwordx4 v16, s[12:15], s86 offen offset:2048 sc1 lds
  v_add_f32 v228, v228, v80
  v_mfma_f32_16x16x32_bf16 v[132:135], v[36:39], v[96:99], 0
  buffer_load_dwordx4 v16, s[12:15], s86 offen offset:3072 sc1 lds
  v_exp_f32 v81, v81
  s_waitcnt lgkmcnt(4)
  v_mfma_f32_16x16x32_bf16 v[136:139], v[40:43], v[96:99], 0
  ds_read_b128 v[32:35], v24 offset:0
  s_add_u32 m0, s88, 16384
  v_add_f32 v228, v228, v81
  v_cvt_pk_bf16_f32 v104, v80, v81
  v_mfma_f32_16x16x32_bf16 v[168:171], v[40:43], v[100:103], 0
  s_add_u32 s86, s86, 16384
  buffer_load_dwordx4 v16, s[12:15], s87 offen offset:0 sc1 lds
  v_exp_f32 v82, v82
  v_mfma_f32_16x16x32_bf16 v[172:175], v[44:47], v[100:103], 0
  ds_read_b128 v[36:39], v24 offset:1024
  buffer_load_dwordx4 v16, s[12:15], s87 offen offset:1024 sc1 lds
  v_add_f32 v228, v228, v82
  v_mfma_f32_16x16x32_bf16 v[140:143], v[44:47], v[96:99], 0
  buffer_load_dwordx4 v16, s[12:15], s87 offen offset:2048 sc1 lds
  v_exp_f32 v83, v83
  s_waitcnt lgkmcnt(4)
  v_mfma_f32_16x16x32_bf16 v[144:147], v[48:51], v[96:99], 0
  ds_read_b128 v[40:43], v24 offset:2048
  buffer_load_dwordx4 v16, s[12:15], s87 offen offset:3072 sc1 lds
  v_add_f32 v228, v228, v83
  v_cvt_pk_bf16_f32 v105, v82, v83
  v_mfma_f32_16x16x32_bf16 v[176:179], v[48:51], v[100:103], 0
  s_add_u32 s87, s87, 16384
  s_add_u32 s88, s88, 32768
  s_sub_u32 s96, s88, 163840
  s_cselect_b32 s88, s88, s96
  v_exp_f32 v84, v84
  v_mfma_f32_16x16x32_bf16 v[180:183], v[52:55], v[100:103], 0
  ds_read_b128 v[44:47], v24 offset:3072
  v_add_f32 v229, v229, v84
  v_mfma_f32_16x16x32_bf16 v[148:151], v[52:55], v[96:99], 0
  v_exp_f32 v85, v85
  s_waitcnt lgkmcnt(4)
  v_mfma_f32_16x16x32_bf16 v[152:155], v[56:59], v[96:99], 0
  ds_read_b128 v[48:51], v24 offset:4096
  v_add_f32 v229, v229, v85
  v_cvt_pk_bf16_f32 v108, v84, v85
  v_mfma_f32_16x16x32_bf16 v[184:187], v[56:59], v[100:103], 0
  v_exp_f32 v86, v86
  v_mfma_f32_16x16x32_bf16 v[188:191], v[60:63], v[100:103], 0
  ds_read_b128 v[52:55], v24 offset:5120
  v_add_f32 v229, v229, v86
  v_mfma_f32_16x16x32_bf16 v[156:159], v[60:63], v[96:99], 0
  v_exp_f32 v87, v87
  v_exp_f32 v88, v88
  v_exp_f32 v89, v89
  v_exp_f32 v90, v90
  v_add_f32 v229, v229, v87
  v_cvt_pk_bf16_f32 v109, v86, v87
  v_add_f32 v228, v228, v88
  v_add_f32 v228, v228, v89
  v_cvt_pk_bf16_f32 v106, v88, v89
  s_sub_u32 s84, s84, 1
  s_add_u32 s34, s93, 186368
  buffer_store_dwordx4 v[232:235], v16, s[12:15], s34 offen sc1
  s_mov_b32 s92, 2
  .p2align 6
F_LOOPB:
  s_waitcnt lgkmcnt(4)
  v_mfma_f32_16x16x32_bf16 v[64:67], v[32:35], v[192:195], v[112:115]
  ds_read_b128 v[56:59], v24 offset:6144
  v_add_f32 v228, v228, v90
  v_mfma_f32_16x16x32_bf16 v[68:71], v[32:35], v[208:211], v[116:119]
  v_exp_f32 v91, v91
  v_mfma_f32_16x16x32_bf16 v[64:67], v[36:39], v[196:199], v[64:67]
  ds_read_b128 v[60:63], v24 offset:7168
  v_add_f32 v228, v228, v91
  v_cvt_pk_bf16_f32 v107, v90, v91
  v_mfma_f32_16x16x32_bf16 v[68:71], v[36:39], v[212:215], v[68:71]
  v_exp_f32 v92, v92
  s_waitcnt lgkmcnt(4)
  v_mfma_f32_16x16x32_bf16 v[64:67], v[40:43], v[200:203], v[64:67]
  ds_read_b128 v[32:35], v25 offset:24576
  v_add_f32 v229, v229, v92
  v_mfma_f32_16x16x32_bf16 v[68:71], v[40:43], v[216:219], v[68:71]
  v_exp_f32 v93, v93
  v_mfma_f32_16x16x32_bf16 v[64:67], v[44:47], v[204:207], v[64:67]
  ds_read_b128 v[36:39], v25 offset:25600
  v_add_f32 v229, v229, v93
  v_cvt_pk_bf16_f32 v110, v92, v93
  v_mfma_f32_16x16x32_bf16 v[68:71], v[44:47], v[220:223], v[68:71]
  v_exp_f32 v94, v94
  s_waitcnt lgkmcnt(4)
  v_mfma_f32_16x16x32_bf16 v[72:75], v[48:51], v[192:195], v[112:115]
  ds_read_b128 v[40:43], v25 offset:26624
  v_add_f32 v229, v229, v94
  v_mfma_f32_16x16x32_bf16 v[76:79], v[48:51], v[208:211], v[116:119]
  v_exp_f32 v95, v95
  v_mfma_f32_16x16x32_bf16 v[72:75], v[52:55], v[196:199], v[72:75]
  ds_read_b128 v[44:47], v25 offset:27648
  v_add_f32 v229, v229, v95
  v_cvt_pk_bf16_f32 v111, v94, v95
  v_mfma_f32_16x16x32_bf16 v[76:79], v[52:55], v[212:215], v[76:79]
  v_exp_f32 v64, v64
  s_waitcnt lgkmcnt(4)
  v_mfma_f32_16x16x32_bf16 v[72:75], v[56:59], v[200:203], v[72:75]
  ds_read_b128 v[48:51], v25 offset:28672
  v_add_f32 v228, v228, v64
  v_mfma_f32_16x16x32_bf16 v[76:79], v[56:59], v[216:219], v[76:79]
  v_exp_f32 v65, v65
  v_mfma_f32_16x16x32_bf16 v[72:75], v[60:63], v[204:207], v[72:75]
  ds_read_b128 v[52:55], v25 offset:29696
  v_add_f32 v228, v228, v65
  v_cvt_pk_bf16_f32 v96, v64, v65
  v_mfma_f32_16x16x32_bf16 v[76:79], v[60:63], v[220:223], v[76:79]
  v_exp_f32 v66, v66
  s_waitcnt lgkmcnt(4)
  v_mfma_f32_16x16x32_bf16 v[128:131], v[32:35], v[104:107], v[128:131]
  ds_read_b128 v[56:59], v25 offset:30720
  v_add_f32 v228, v228, v66
  v_mfma_f32_16x16x32_bf16 v[160:163], v[32:35], v[108:111], v[160:163]
  v_exp_f32 v67, v67
  v_mfma_f32_16x16x32_bf16 v[164:167], v[36:39], v[108:111], v[164:167]
  ds_read_b128 v[60:63], v25 offset:31744
  v_mov_b32 v25, v24
  v_add_f32 v228, v228, v67
  v_cvt_pk_bf16_f32 v97, v66, v67
  v_mfma_f32_16x16x32_bf16 v[132:135], v[36:39], v[104:107], v[132:135]
  v_exp_f32 v68, v68
  s_waitcnt lgkmcnt(4)
  v_mfma_f32_16x16x32_bf16 v[136:139], v[40:43], v[104:107], v[136:139]
  ds_read_b128 v[32:35], v24 offset:8192
  v_add_f32 v229, v229, v68
  v_mfma_f32_16x16x32_bf16 v[168:171], v[40:43], v[108:111], v[168:171]
  v_exp_f32 v69, v69
  v_mfma_f32_16x16x32_bf16 v[172:175], v[44:47], v[108:111], v[172:175]
  ds_read_b128 v[36:39], v24 offset:9216
  v_add_f32 v229, v229, v69
  v_cvt_pk_bf16_f32 v100, v68, v69
  v_mfma_f32_16x16x32_bf16 v[140:143], v[44:47], v[104:107], v[140:143]
  v_exp_f32 v70, v70
  s_waitcnt lgkmcnt(4)
  v_mfma_f32_16x16x32_bf16 v[144:147], v[48:51], v[104:107], v[144:147]
  ds_read_b128 v[40:43], v24 offset:10240
  v_add_f32 v229, v229, v70
  v_mfma_f32_16x16x32_bf16 v[176:179], v[48:51], v[108:111], v[176:179]
  v_exp_f32 v71, v71
  v_mfma_f32_16x16x32_bf16 v[180:183], v[52:55], v[108:111], v[180:183]
  ds_read_b128 v[44:47], v24 offset:11264
  v_add_f32 v229, v229, v71
  v_cvt_pk_bf16_f32 v101, v70, v71
  v_mfma_f32_16x16x32_bf16 v[148:151], v[52:55], v[104:107], v[148:151]
  v_exp_f32 v72, v72
  s_waitcnt lgkmcnt(4)
  v_mfma_f32_16x16x32_bf16 v[152:155], v[56:59], v[104:107], v[152:155]
  ds_read_b128 v[48:51], v24 offset:12288
  v_add_f32 v228, v228, v72
  v_mfma_f32_16x16x32_bf16 v[184:187], v[56:59], v[108:111], v[184:187]
  v_exp_f32 v73, v73
  v_mfma_f32_16x16x32_bf16 v[188:191], v[60:63], v[108:111], v[188:191]
  ds_read_b128 v[52:55], v24 offset:13312
  v_add_f32 v228, v228, v73
  v_cvt_pk_bf16_f32 v98, v72, v73
  v_mfma_f32_16x16x32_bf16 v[156:159], v[60:63], v[104:107], v[156:159]
  s_waitcnt vmcnt(16)
  s_barrier
  v_exp_f32 v74, v74
  s_waitcnt lgkmcnt(4)
  v_mfma_f32_16x16x32_bf16 v[80:83], v[32:35], v[192:195], v[112:115]
  ds_read_b128 v[56:59], v24 offset:14336
  s_mov_b32 m0, s88
  s_nop 0
  buffer_load_dwordx4 v16, s[12:15], s86 offen offset:0 sc1 lds
  v_add_f32 v228, v228, v74
  v_mfma_f32_16x16x32_bf16 v[84:87], v[32:35], v[208:211], v[116:119]
  v_exp_f32 v75, v75
  v_mfma_f32_16x16x32_bf16 v[80:83], v[36:39], v[196:199], v[80:83]
  ds_read_b128 v[60:63], v24 offset:15360
  v_add_u32 v24, s85, v16
  v_add_f32 v228, v228, v75
  v_cvt_pk_bf16_f32 v99, v74, v75
  v_mfma_f32_16x16x32_bf16 v[84:87], v[36:39], v[212:215], v[84:87]
  buffer_load_dwordx4 v16, s[12:15], s86 offen offset:1024 sc1 lds
  v_exp_f32 v76, v76
  s_waitcnt lgkmcnt(4)
  v_mfma_f32_16x16x32_bf16 v[80:83], v[40:43], v[200:203], v[80:83]
  ds_read_b128 v[32:35], v25 offset:16384
  s_add_u32 s85, s85, 32768
  s_sub_u32 s33, s85, 163840
  s_cselect_b32 s85, s85, s33
  v_add_f32 v229, v229, v76
  v_mfma_f32_16x16x32_bf16 v[84:87], v[40:43], v[216:219], v[84:87]
  v_exp_f32 v77, v77
  v_mfma_f32_16x16x32_bf16 v[80:83], v[44:47], v[204:207], v[80:83]
  ds_read_b128 v[36:39], v25 offset:17408
  buffer_load_dwordx4 v16, s[12:15], s86 offen offset:2048 sc1 lds
  v_add_f32 v229, v229, v77
  v_cvt_pk_bf16_f32 v102, v76, v77
  v_mfma_f32_16x16x32_bf16 v[84:87], v[44:47], v[220:223], v[84:87]
  v_exp_f32 v78, v78
  s_waitcnt lgkmcnt(4)
  v_mfma_f32_16x16x32_bf16 v[88:91], v[48:51], v[192:195], v[112:115]
  ds_read_b128 v[40:43], v25 offset:18432
  v_add_f32 v229, v229, v78
  v_mfma_f32_16x16x32_bf16 v[92:95], v[48:51], v[208:211], v[116:119]
  buffer_load_dwordx4 v16, s[12:15], s86 offen offset:3072 sc1 lds
  v_exp_f32 v79, v79
  v_mfma_f32_16x16x32_bf16 v[88:91], v[52:55], v[196:199], v[88:91]
  ds_read_b128 v[44:47], v25 offset:19456
  v_add_f32 v229, v229, v79
  v_cvt_pk_bf16_f32 v103, v78, v79
  v_mfma_f32_16x16x32_bf16 v[92:95], v[52:55], v[212:215], v[92:95]
  v_exp_f32 v80, v80
  s_waitcnt lgkmcnt(4)
  v_mfma_f32_16x16x32_bf16 v[88:91], v[56:59], v[200:203], v[88:91]
  ds_read_b128 v[48:51], v25 offset:20480
  s_add_u32 m0, s88, 16384
  v_add_f32 v228, v228, v80
  v_mfma_f32_16x16x32_bf16 v[92:95], v[56:59], v[216:219], v[92:95]
  v_exp_f32 v81, v81
  v_mfma_f32_16x16x32_bf16 v[88:91], v[60:63], v[204:207], v[88:91]
  ds_read_b128 v[52:55], v25 offset:21504
  v_add_f32 v228, v228, v81
  v_cvt_pk_bf16_f32 v104, v80, v81
  v_mfma_f32_16x16x32_bf16 v[92:95], v[60:63], v[220:223], v[92:95]
  s_add_u32 s86, s86, 16384
  buffer_load_dwordx4 v16, s[12:15], s87 offen offset:0 sc1 lds
  v_exp_f32 v82, v82
  s_waitcnt lgkmcnt(4)
  v_mfma_f32_16x16x32_bf16 v[128:131], v[32:35], v[96:99], v[128:131]
  ds_read_b128 v[56:59], v25 offset:22528
  v_add_f32 v228, v228, v82
  v_mfma_f32_16x16x32_bf16 v[160:163], v[32:35], v[100:103], v[160:163]
  v_exp_f32 v83, v83
  v_mfma_f32_16x16x32_bf16 v[164:167], v[36:39], v[100:103], v[164:167]
  ds_read_b128 v[60:63], v25 offset:23552
  buffer_load_dwordx4 v16, s[12:15], s87 offen offset:1024 sc1 lds
  v_add_f32 v228, v228, v83
  v_cvt_pk_bf16_f32 v105, v82, v83
  v_mfma_f32_16x16x32_bf16 v[132:135], v[36:39], v[96:99], v[132:135]
  v_exp_f32 v84, v84
  s_waitcnt lgkmcnt(4)
  v_mfma_f32_16x16x32_bf16 v[136:139], v[40:43], v[96:99], v[136:139]
  ds_read_b128 v[32:35], v24 offset:0
  v_add_f32 v229, v229, v84
  v_mfma_f32_16x16x32_bf16 v[168:171], v[40:43], v[100:103], v[168:171]
  buffer_load_dwordx4 v16, s[12:15], s87 offen offset:2048 sc1 lds
  v_exp_f32 v85, v85
  v_mfma_f32_16x16x32_bf16 v[172:175], v[44:47], v[100:103], v[172:175]
  ds_read_b128 v[36:39], v24 offset:1024
  v_add_f32 v229, v229, v85
  v_cvt_pk_bf16_f32 v108, v84, v85
  v_mfma_f32_16x16x32_bf16 v[140:143], v[44:47], v[96:99], v[140:143]
  s_sub_u32 s84, s84, 1
  v_exp_f32 v86, v86
  s_waitcnt lgkmcnt(4)
  v_mfma_f32_16x16x32_bf16 v[144:147], v[48:51], v[96:99], v[144:147]
  ds_read_b128 v[40:43], v24 offset:2048
  buffer_load_dwordx4 v16, s[12:15], s87 offen offset:3072 sc1 lds
  v_add_f32 v229, v229, v86
  v_mfma_f32_16x16x32_bf16 v[176:179], v[48:51], v[100:103], v[176:179]
  v_exp_f32 v87, v87
  v_mfma_f32_16x16x32_bf16 v[180:183], v[52:55], v[100:103], v[180:183]
  ds_read_b128 v[44:47], v24 offset:3072
  v_add_f32 v229, v229, v87
  v_cvt_pk_bf16_f32 v109, v86, v87
  v_mfma_f32_16x16x32_bf16 v[148:151], v[52:55], v[96:99], v[148:151]
  s_add_u32 s87, s87, 16384
  s_add_u32 s88, s88, 32768
  s_sub_u32 s96, s88, 163840
  s_cselect_b32 s88, s88, s96
  v_exp_f32 v88, v88
  s_waitcnt lgkmcnt(4)
  v_mfma_f32_16x16x32_bf16 v[152:155], v[56:59], v[96:99], v[152:155]
  ds_read_b128 v[48:51], v24 offset:4096
  v_add_f32 v228, v228, v88
  v_mfma_f32_16x16x32_bf16 v[184:187], v[56:59], v[100:103], v[184:187]
  v_exp_f32 v89, v89
  v_mfma_f32_16x16x32_bf16 v[188:191], v[60:63], v[100:103], v[188:191]
  ds_read_b128 v[52:55], v24 offset:5120
  v_add_f32 v228, v228, v89
  v_cvt_pk_bf16_f32 v106, v88, v89
  v_mfma_f32_16x16x32_bf16 v[156:159], v[60:63], v[96:99], v[156:159]
  v_exp_f32 v90, v90
  s_cmp_lt_u32 s92, 4
  s_cbranch_scc1 F_HOOKB
F_BACKB:
  s_cmp_lg_u32 s84, 0
  s_cbranch_scc1 F_LOOPB
F_DIAGB:
  s_cmp_eq_u32 s81, 0
  s_cbranch_scc1 F_DB0
  s_cmp_eq_u32 s81, 1
  s_cbranch_scc1 F_DB1
  s_cmp_eq_u32 s81, 2
  s_cbranch_scc1 F_DB2
F_DB3:
  s_waitcnt lgkmcnt(4)
  v_mfma_f32_16x16x32_bf16 v[64:67], v[32:35], v[192:195], v[112:115]
  ds_read_b128 v[56:59], v24 offset:6144
  v_add_f32 v228, v228, v90
  v_mfma_f32_16x16x32_bf16 v[68:71], v[32:35], v[208:211], v[116:119]
  v_exp_f32 v91, v91
  v_mfma_f32_16x16x32_bf16 v[64:67], v[36:39], v[196:199], v[64:67]
  ds_read_b128 v[60:63], v24 offset:7168
  v_add_f32 v228, v228, v91
  v_cvt_pk_bf16_f32 v107, v90, v91
  v_mfma_f32_16x16x32_bf16 v[68:71], v[36:39], v[212:215], v[68:71]
  v_exp_f32 v92, v92
  s_waitcnt lgkmcnt(4)
  v_mfma_f32_16x16x32_bf16 v[64:67], v[40:43], v[200:203], v[64:67]
  ds_read_b128 v[32:35], v25 offset:24576
  v_add_f32 v229, v229, v92
  v_mfma_f32_16x16x32_bf16 v[68:71], v[40:43], v[216:219], v[68:71]
  v_exp_f32 v93, v93
  v_mfma_f32_16x16x32_bf16 v[64:67], v[44:47], v[204:207], v[64:67]
  ds_read_b128 v[36:39], v25 offset:25600
  v_add_f32 v229, v229, v93
  v_cvt_pk_bf16_f32 v110, v92, v93
  v_mfma_f32_16x16x32_bf16 v[68:71], v[44:47], v[220:223], v[68:71]
  v_exp_f32 v94, v94
  s_waitcnt lgkmcnt(4)
  v_mfma_f32_16x16x32_bf16 v[72:75], v[48:51], v[192:195], v[112:115]
  ds_read_b128 v[40:43], v25 offset:26624
  v_add_f32 v229, v229, v94
  v_mfma_f32_16x16x32_bf16 v[76:79], v[48:51], v[208:211], v[116:119]
  v_exp_f32 v95, v95
  v_mfma_f32_16x16x32_bf16 v[72:75], v[52:55], v[196:199], v[72:75]
  ds_read_b128 v[44:47], v25 offset:27648
  v_add_f32 v229, v229, v95
  v_cvt_pk_bf16_f32 v111, v94, v95
  v_mfma_f32_16x16x32_bf16 v[76:79], v[52:55], v[212:215], v[76:79]
  v_exp_f32 v64, v64
  s_waitcnt lgkmcnt(4)
  v_mfma_f32_16x16x32_bf16 v[72:75], v[56:59], v[200:203], v[72:75]
  ds_read_b128 v[48:51], v25 offset:28672
  v_add_f32 v228, v228, v64
  v_mfma_f32_16x16x32_bf16 v[76:79], v[56:59], v[216:219], v[76:79]
  v_exp_f32 v65, v65
  v_mfma_f32_16x16x32_bf16 v[72:75], v[60:63], v[204:207], v[72:75]
  ds_read_b128 v[52:55], v25 offset:29696
  v_add_f32 v228, v228, v65
  v_cvt_pk_bf16_f32 v96, v64, v65
  v_mfma_f32_16x16x32_bf16 v[76:79], v[60:63], v[220:223], v[76:79]
  v_exp_f32 v66, v66
  s_waitcnt lgkmcnt(4)
  v_mfma_f32_16x16x32_bf16 v[128:131], v[32:35], v[104:107], v[128:131]
  ds_read_b128 v[56:59], v25 offset:30720
  v_add_f32 v228, v228, v66
  v_mfma_f32_16x16x32_bf16 v[160:163], v[32:35], v[108:111], v[160:163]
  v_exp_f32 v67, v67
  v_mfma_f32_16x16x32_bf16 v[164:167], v[36:39], v[108:111], v[164:167]
  ds_read_b128 v[60:63], v25 offset:31744
  v_mov_b32 v25, v24
  v_add_f32 v228, v228, v67
  v_cvt_pk_bf16_f32 v97, v66, v67
  v_mfma_f32_16x16x32_bf16 v[132:135], v[36:39], v[104:107], v[132:135]
  v_exp_f32 v68, v68
  s_waitcnt lgkmcnt(4)
  v_mfma_f32_16x16x32_bf16 v[136:139], v[40:43], v[104:107], v[136:139]
  ds_read_b128 v[32:35], v24 offset:8192
  v_add_f32 v229, v229, v68
  v_mfma_f32_16x16x32_bf16 v[168:171], v[40:43], v[108:111], v[168:171]
  v_exp_f32 v69, v69
  v_mfma_f32_16x16x32_bf16 v[172:175], v[44:47], v[108:111], v[172:175]
  ds_read_b128 v[36:39], v24 offset:9216
  v_add_f32 v229, v229, v69
  v_cvt_pk_bf16_f32 v100, v68, v69
  v_mfma_f32_16x16x32_bf16 v[140:143], v[44:47], v[104:107], v[140:143]
  v_exp_f32 v70, v70
  s_waitcnt lgkmcnt(4)
  v_mfma_f32_16x16x32_bf16 v[144:147], v[48:51], v[104:107], v[144:147]
  ds_read_b128 v[40:43], v24 offset:10240
  v_add_f32 v229, v229, v70
  v_mfma_f32_16x16x32_bf16 v[176:179], v[48:51], v[108:111], v[176:179]
  v_exp_f32 v71, v71
  v_mfma_f32_16x16x32_bf16 v[180:183], v[52:55], v[108:111], v[180:183]
  ds_read_b128 v[44:47], v24 offset:11264
  v_add_f32 v229, v229, v71
  v_cvt_pk_bf16_f32 v101, v70, v71
  v_mfma_f32_16x16x32_bf16 v[148:151], v[52:55], v[104:107], v[148:151]
  v_exp_f32 v72, v72
  s_waitcnt lgkmcnt(4)
  v_mfma_f32_16x16x32_bf16 v[152:155], v[56:59], v[104:107], v[152:155]
  ds_read_b128 v[48:51], v24 offset:12288
  v_add_f32 v228, v228, v72
  v_mfma_f32_16x16x32_bf16 v[184:187], v[56:59], v[108:111], v[184:187]
  v_exp_f32 v73, v73
  v_mfma_f32_16x16x32_bf16 v[188:191], v[60:63], v[108:111], v[188:191]
  ds_read_b128 v[52:55], v24 offset:13312
  v_add_f32 v228, v228, v73
  v_cvt_pk_bf16_f32 v98, v72, v73
  v_mfma_f32_16x16x32_bf16 v[156:159], v[60:63], v[104:107], v[156:159]
  s_waitcnt vmcnt(16)
  s_barrier
  v_exp_f32 v74, v74
  s_waitcnt lgkmcnt(4)
  v_mfma_f32_16x16x32_bf16 v[80:83], v[32:35], v[192:195], v[112:115]
  ds_read_b128 v[56:59], v24 offset:14336
  s_mov_b32 m0, s88
  s_nop 0
  buffer_load_dwordx4 v16, s[12:15], s86 offen offset:0 sc1 lds
  v_add_f32 v228, v228, v74
  v_mfma_f32_16x16x32_bf16 v[84:87], v[32:35], v[208:211], v[116:119]
  v_exp_f32 v75, v75
  v_mfma_f32_16x16x32_bf16 v[80:83], v[36:39], v[196:199], v[80:83]
  ds_read_b128 v[60:63], v24 offset:15360
  v_add_u32 v24, s85, v16
  v_add_f32 v228, v228, v75
  v_cvt_pk_bf16_f32 v99, v74, v75
  v_mfma_f32_16x16x32_bf16 v[84:87], v[36:39], v[212:215], v[84:87]
  buffer_load_dwordx4 v16, s[12:15], s86 offen offset:1024 sc1 lds
  v_exp_f32 v76, v76
  s_waitcnt lgkmcnt(4)
  v_mfma_f32_16x16x32_bf16 v[80:83], v[40:43], v[200:203], v[80:83]
  ds_read_b128 v[32:35], v25 offset:16384
  s_add_u32 s85, s85, 32768
  s_sub_u32 s33, s85, 163840
  s_cselect_b32 s85, s85, s33
  v_add_f32 v229, v229, v76
  v_mfma_f32_16x16x32_bf16 v[84:87], v[40:43], v[216:219], v[84:87]
  v_exp_f32 v77, v77
  v_mfma_f32_16x16x32_bf16 v[80:83], v[44:47], v[204:207], v[80:83]
  ds_read_b128 v[36:39], v25 offset:17408
  buffer_load_dwordx4 v16, s[12:15], s86 offen offset:2048 sc1 lds
  v_add_f32 v229, v229, v77
  v_cvt_pk_bf16_f32 v102, v76, v77
  v_mfma_f32_16x16x32_bf16 v[84:87], v[44:47], v[220:223], v[84:87]
  v_exp_f32 v78, v78
  s_waitcnt lgkmcnt(4)
  v_mfma_f32_16x16x32_bf16 v[88:91], v[48:51], v[192:195], v[120:123]
  ds_read_b128 v[40:43], v25 offset:18432
  v_add_f32 v229, v229, v78
  v_mfma_f32_16x16x32_bf16 v[92:95], v[48:51], v[208:211], v[116:119]
  buffer_load_dwordx4 v16, s[12:15], s86 offen offset:3072 sc1 lds
  v_exp_f32 v79, v79
  v_mfma_f32_16x16x32_bf16 v[88:91], v[52:55], v[196:199], v[88:91]
  ds_read_b128 v[44:47], v25 offset:19456
  v_add_f32 v229, v229, v79
  v_cvt_pk_bf16_f32 v103, v78, v79
  v_mfma_f32_16x16x32_bf16 v[92:95], v[52:55], v[212:215], v[92:95]
  v_exp_f32 v80, v80
  s_waitcnt lgkmcnt(4)
  v_mfma_f32_16x16x32_bf16 v[88:91], v[56:59], v[200:203], v[88:91]
  ds_read_b128 v[48:51], v25 offset:20480
  s_add_u32 m0, s88, 16384
  v_add_f32 v228, v228, v80
  v_mfma_f32_16x16x32_bf16 v[92:95], v[56:59], v[216:219], v[92:95]
  v_exp_f32 v81, v81
  v_mfma_f32_16x16x32_bf16 v[88:91], v[60:63], v[204:207], v[88:91]
  ds_read_b128 v[52:55], v25 offset:21504
  v_add_f32 v228, v228, v81
  v_cvt_pk_bf16_f32 v104, v80, v81
  v_mfma_f32_16x16x32_bf16 v[92:95], v[60:63], v[220:223], v[92:95]
  s_add_u32 s86, s86, 16384
  buffer_load_dwordx4 v16, s[12:15], s87 offen offset:0 sc1 lds
  v_exp_f32 v82, v82
  s_waitcnt lgkmcnt(4)
  v_mfma_f32_16x16x32_bf16 v[128:131], v[32:35], v[96:99], v[128:131]
  ds_read_b128 v[56:59], v25 offset:22528
  v_add_f32 v228, v228, v82
  v_mfma_f32_16x16x32_bf16 v[160:163], v[32:35], v[100:103], v[160:163]
  v_exp_f32 v83, v83
  v_mfma_f32_16x16x32_bf16 v[164:167], v[36:39], v[100:103], v[164:167]
  ds_read_b128 v[60:63], v25 offset:23552
  buffer_load_dwordx4 v16, s[12:15], s87 offen offset:1024 sc1 lds
  v_add_f32 v228, v228, v83
  v_cvt_pk_bf16_f32 v105, v82, v83
  v_mfma_f32_16x16x32_bf16 v[132:135], v[36:39], v[96:99], v[132:135]
  v_exp_f32 v84, v84
  s_waitcnt lgkmcnt(4)
  v_mfma_f32_16x16x32_bf16 v[136:139], v[40:43], v[96:99], v[136:139]
  ds_read_b128 v[32:35], v24 offset:0
  v_add_f32 v229, v229, v84
  v_mfma_f32_16x16x32_bf16 v[168:171], v[40:43], v[100:103], v[168:171]
  buffer_load_dwordx4 v16, s[12:15], s87 offen offset:2048 sc1 lds
  v_exp_f32 v85, v85
  v_mfma_f32_16x16x32_bf16 v[172:175], v[44:47], v[100:103], v[172:175]
  ds_read_b128 v[36:39], v24 offset:1024
  v_add_f32 v229, v229, v85
  v_cvt_pk_bf16_f32 v108, v84, v85
  v_mfma_f32_16x16x32_bf16 v[140:143], v[44:47], v[96:99], v[140:143]
  v_exp_f32 v86, v86
  s_waitcnt lgkmcnt(4)
  v_mfma_f32_16x16x32_bf16 v[144:147], v[48:51], v[96:99], v[144:147]
  ds_read_b128 v[40:43], v24 offset:2048
  buffer_load_dwordx4 v16, s[12:15], s87 offen offset:3072 sc1 lds
  v_add_f32 v229, v229, v86
  v_mfma_f32_16x16x32_bf16 v[176:179], v[48:51], v[100:103], v[176:179]
  v_exp_f32 v87, v87
  v_mfma_f32_16x16x32_bf16 v[180:183], v[52:55], v[100:103], v[180:183]
  ds_read_b128 v[44:47], v24 offset:3072
  v_add_f32 v229, v229, v87
  v_cvt_pk_bf16_f32 v109, v86, v87
  v_mfma_f32_16x16x32_bf16 v[148:151], v[52:55], v[96:99], v[148:151]
  s_add_u32 s87, s87, 16384
  s_add_u32 s88, s88, 32768
  s_sub_u32 s96, s88, 163840
  s_cselect_b32 s88, s88, s96
  v_exp_f32 v88, v88
  s_waitcnt lgkmcnt(4)
  v_mfma_f32_16x16x32_bf16 v[152:155], v[56:59], v[96:99], v[152:155]
  ds_read_b128 v[48:51], v25 offset:24576
  v_add_f32 v228, v228, v88
  v_mfma_f32_16x16x32_bf16 v[184:187], v[56:59], v[100:103], v[184:187]
  v_exp_f32 v89, v89
  v_mfma_f32_16x16x32_bf16 v[188:191], v[60:63], v[100:103], v[188:191]
  ds_read_b128 v[52:55], v25 offset:25600
  v_add_f32 v228, v228, v89
  v_cvt_pk_bf16_f32 v106, v88, v89
  v_mfma_f32_16x16x32_bf16 v[156:159], v[60:63], v[96:99], v[156:159]
  v_exp_f32 v90, v90
  s_waitcnt lgkmcnt(4)
  v_mfma_f32_16x16x32_bf16 v[68:71], v[32:35], v[208:211], v[124:127]
  ds_read_b128 v[56:59], v25 offset:26624
  v_exp_f32 v91, v91
  v_mfma_f32_16x16x32_bf16 v[68:71], v[36:39], v[212:215], v[68:71]
  ds_read_b128 v[60:63], v25 offset:27648
  v_exp_f32 v92, v92
  s_waitcnt lgkmcnt(4)
  v_mfma_f32_16x16x32_bf16 v[68:71], v[40:43], v[216:219], v[68:71]
  ds_read_b128 v[32:35], v25 offset:28672
  v_exp_f32 v93, v93
  v_mfma_f32_16x16x32_bf16 v[68:71], v[44:47], v[220:223], v[68:71]
  ds_read_b128 v[36:39], v25 offset:29696
  v_exp_f32 v94, v94
  s_waitcnt lgkmcnt(4)
  v_add_f32 v228, v228, v90
  v_add_f32 v228, v228, v91
  v_cvt_pk_bf16_f32 v107, v90, v91
  s_nop 1
  v_mfma_f32_16x16x32_bf16 v[128:131], v[48:51], v[104:107], v[128:131]
  ds_read_b128 v[40:43], v25 offset:30720
  v_add_f32 v229, v229, v92
  v_add_f32 v229, v229, v93
  v_cvt_pk_bf16_f32 v110, v92, v93
  v_exp_f32 v95, v95
  v_add_f32 v229, v229, v94
  v_add_f32 v229, v229, v95
  v_cvt_pk_bf16_f32 v111, v94, v95
  s_nop 1
  v_mfma_f32_16x16x32_bf16 v[160:163], v[48:51], v[108:111], v[160:163]
  v_mov_b32 v102, 0
  v_mov_b32 v103, 0
  v_mfma_f32_16x16x32_bf16 v[164:167], v[52:55], v[108:111], v[164:167]
  ds_read_b128 v[44:47], v25 offset:31744
  v_mov_b32 v25, v24
  v_mfma_f32_16x16x32_bf16 v[132:135], v[52:55], v[104:107], v[132:135]
  v_exp_f32 v68, v68
  s_waitcnt lgkmcnt(4)
  v_mfma_f32_16x16x32_bf16 v[136:139], v[56:59], v[104:107], v[136:139]
  ds_read_b128 v[48:51], v25 offset:16384
  v_add_f32 v229, v229, v68
  v_mfma_f32_16x16x32_bf16 v[168:171], v[56:59], v[108:111], v[168:171]
  v_exp_f32 v69, v69
  v_mfma_f32_16x16x32_bf16 v[172:175], v[60:63], v[108:111], v[172:175]
  ds_read_b128 v[52:55], v25 offset:17408
  v_add_f32 v229, v229, v69
  v_cvt_pk_bf16_f32 v100, v68, v69
  v_mfma_f32_16x16x32_bf16 v[140:143], v[60:63], v[104:107], v[140:143]
  v_exp_f32 v70, v70
  s_waitcnt lgkmcnt(4)
  v_mfma_f32_16x16x32_bf16 v[144:147], v[32:35], v[104:107], v[144:147]
  ds_read_b128 v[56:59], v25 offset:18432
  v_add_f32 v229, v229, v70
  v_mfma_f32_16x16x32_bf16 v[176:179], v[32:35], v[108:111], v[176:179]
  v_exp_f32 v71, v71
  v_mfma_f32_16x16x32_bf16 v[180:183], v[36:39], v[108:111], v[180:183]
  ds_read_b128 v[60:63], v25 offset:19456
  v_add_f32 v229, v229, v71
  v_cvt_pk_bf16_f32 v101, v70, v71
  v_mfma_f32_16x16x32_bf16 v[148:151], v[36:39], v[104:107], v[148:151]
  s_waitcnt lgkmcnt(4)
  v_mfma_f32_16x16x32_bf16 v[152:155], v[40:43], v[104:107], v[152:155]
  ds_read_b128 v[32:35], v25 offset:20480
  v_mfma_f32_16x16x32_bf16 v[184:187], v[40:43], v[108:111], v[184:187]
  v_mfma_f32_16x16x32_bf16 v[188:191], v[44:47], v[108:111], v[188:191]
  ds_read_b128 v[36:39], v25 offset:21504
  v_mfma_f32_16x16x32_bf16 v[156:159], v[44:47], v[104:107], v[156:159]
  s_waitcnt vmcnt(16)
  s_barrier
  s_waitcnt lgkmcnt(4)
  v_mfma_f32_16x16x32_bf16 v[160:163], v[48:51], v[100:103], v[160:163]
  ds_read_b128 v[40:43], v25 offset:22528
  s_mov_b32 m0, s88
  s_nop 0
  buffer_load_dwordx4 v16, s[12:15], s86 offen offset:0 sc1 lds
  v_mfma_f32_16x16x32_bf16 v[164:167], v[52:55], v[100:103], v[164:167]
  ds_read_b128 v[44:47], v25 offset:23552
  buffer_load_dwordx4 v16, s[12:15], s86 offen offset:1024 sc1 lds
  s_waitcnt lgkmcnt(4)
  v_mfma_f32_16x16x32_bf16 v[168:171], v[56:59], v[100:103], v[168:171]
  buffer_load_dwordx4 v16, s[12:15], s86 offen offset:2048 sc1 lds
  v_mfma_f32_16x16x32_bf16 v[172:175], v[60:63], v[100:103], v[172:175]
  buffer_load_dwordx4 v16, s[12:15], s86 offen offset:3072 sc1 lds
  s_waitcnt lgkmcnt(2)
  v_mfma_f32_16x16x32_bf16 v[176:179], v[32:35], v[100:103], v[176:179]
  s_add_u32 m0, s88, 16384
  v_mfma_f32_16x16x32_bf16 v[180:183], v[36:39], v[100:103], v[180:183]
  s_add_u32 s86, s86, 16384
  buffer_load_dwordx4 v16, s[12:15], s87 offen offset:0 sc1 lds
  s_waitcnt lgkmcnt(0)
  v_mfma_f32_16x16x32_bf16 v[184:187], v[40:43], v[100:103], v[184:187]
  buffer_load_dwordx4 v16, s[12:15], s87 offen offset:1024 sc1 lds
  v_mfma_f32_16x16x32_bf16 v[188:191], v[44:47], v[100:103], v[188:191]
  buffer_load_dwordx4 v16, s[12:15], s87 offen offset:2048 sc1 lds
  buffer_load_dwordx4 v16, s[12:15], s87 offen offset:3072 sc1 lds
  s_add_u32 s87, s87, 16384
  s_add_u32 s88, s88, 32768
  s_sub_u32 s96, s88, 163840
  s_cselect_b32 s88, s88, s96
  s_branch F_CHK
F_DB0:
  s_waitcnt lgkmcnt(4)
  v_mfma_f32_16x16x32_bf16 v[64:67], v[32:35], v[192:195], v[120:123]
  ds_read_b128 v[56:59], v24 offset:6144
  v_add_f32 v228, v228, v90
  v_mov_b32 v98, 0
  v_mfma_f32_16x16x32_bf16 v[68:71], v[32:35], v[208:211], v[116:119]
  v_exp_f32 v91, v91
  v_mfma_f32_16x16x32_bf16 v[64:67], v[36:39], v[196:199], v[64:67]
  ds_read_b128 v[60:63], v24 offset:7168
  v_add_f32 v228, v228, v91
  v_cvt_pk_bf16_f32 v107, v90, v91
  v_mfma_f32_16x16x32_bf16 v[68:71], v[36:39], v[212:215], v[68:71]
  v_exp_f32 v92, v92
  s_waitcnt lgkmcnt(4)
  v_mfma_f32_16x16x32_bf16 v[64:67], v[40:43], v[200:203], v[64:67]
  ds_read_b128 v[32:35], v25 offset:24576
  v_add_f32 v229, v229, v92
  v_mov_b32 v99, 0
  v_mfma_f32_16x16x32_bf16 v[68:71], v[40:43], v[216:219], v[68:71]
  v_exp_f32 v93, v93
  v_mfma_f32_16x16x32_bf16 v[64:67], v[44:47], v[204:207], v[64:67]
  ds_read_b128 v[36:39], v25 offset:25600
  v_add_f32 v229, v229, v93
  v_cvt_pk_bf16_f32 v110, v92, v93
  v_mfma_f32_16x16x32_bf16 v[68:71], v[44:47], v[220:223], v[68:71]
  v_exp_f32 v94, v94
  s_waitcnt lgkmcnt(4)
  v_mfma_f32_16x16x32_bf16 v[76:79], v[48:51], v[208:211], v[116:119]
  ds_read_b128 v[40:43], v25 offset:26624
  v_exp_f32 v95, v95
  v_mfma_f32_16x16x32_bf16 v[76:79], v[52:55], v[212:215], v[76:79]
  ds_read_b128 v[44:47], v25 offset:27648
  v_add_f32 v229, v229, v94
  v_add_f32 v229, v229, v95
  s_waitcnt lgkmcnt(4)
  v_mfma_f32_16x16x32_bf16 v[76:79], v[56:59], v[216:219], v[76:79]
  ds_read_b128 v[48:51], v25 offset:28672
  v_exp_f32 v64, v64
  v_mfma_f32_16x16x32_bf16 v[76:79], v[60:63], v[220:223], v[76:79]
  ds_read_b128 v[52:55], v25 offset:29696
  v_exp_f32 v65, v65
  s_waitcnt lgkmcnt(4)
  v_mfma_f32_16x16x32_bf16 v[128:131], v[32:35], v[104:107], v[128:131]
  ds_read_b128 v[56:59], v25 offset:30720
  v_cvt_pk_bf16_f32 v111, v94, v95
  v_add_f32 v228, v228, v64
  s_nop 0
  v_mfma_f32_16x16x32_bf16 v[160:163], v[32:35], v[108:111], v[160:163]
  v_exp_f32 v66, v66
  v_mfma_f32_16x16x32_bf16 v[164:167], v[36:39], v[108:111], v[164:167]
  ds_read_b128 v[60:63], v25 offset:31744
  v_mov_b32 v25, v24
  v_add_f32 v228, v228, v65
  v_cvt_pk_bf16_f32 v96, v64, v65
  v_mfma_f32_16x16x32_bf16 v[132:135], v[36:39], v[104:107], v[132:135]
  v_exp_f32 v67, v67
  s_waitcnt lgkmcnt(4)
  v_mfma_f32_16x16x32_bf16 v[136:139], v[40:43], v[104:107], v[136:139]
  ds_read_b128 v[32:35], v24 offset:8192
  v_add_f32 v228, v228, v66
  v_add_f32 v228, v228, v67
  v_mfma_f32_16x16x32_bf16 v[168:171], v[40:43], v[108:111], v[168:171]
  v_exp_f32 v68, v68
  v_mfma_f32_16x16x32_bf16 v[172:175], v[44:47], v[108:111], v[172:175]
  ds_read_b128 v[36:39], v24 offset:9216
  v_cvt_pk_bf16_f32 v97, v66, v67
  v_add_f32 v229, v229, v68
  v_mfma_f32_16x16x32_bf16 v[140:143], v[44:47], v[104:107], v[140:143]
  v_exp_f32 v69, v69
  s_waitcnt lgkmcnt(4)
  v_mfma_f32_16x16x32_bf16 v[144:147], v[48:51], v[104:107], v[144:147]
  ds_read_b128 v[40:43], v24 offset:10240
  v_add_f32 v229, v229, v69
  v_cvt_pk_bf16_f32 v100, v68, v69
  v_mfma_f32_16x16x32_bf16 v[176:179], v[48:51], v[108:111], v[176:179]
  v_exp_f32 v70, v70
  v_mfma_f32_16x16x32_bf16 v[180:183], v[52:55], v[108:111], v[180:183]
  ds_read_b128 v[44:47], v24 offset:11264
  v_add_f32 v229, v229, v70
  v_mfma_f32_16x16x32_bf16 v[148:151], v[52:55], v[104:107], v[148:151]
  v_exp_f32 v71, v71
  s_waitcnt lgkmcnt(4)
  v_mfma_f32_16x16x32_bf16 v[152:155], v[56:59], v[104:107], v[152:155]
  ds_read_b128 v[48:51], v24 offset:12288
  v_add_f32 v229, v229, v71
  v_cvt_pk_bf16_f32 v101, v70, v71
  v_mfma_f32_16x16x32_bf16 v[184:187], v[56:59], v[108:111], v[184:187]
  v_exp_f32 v76, v76
  v_mfma_f32_16x16x32_bf16 v[188:191], v[60:63], v[108:111], v[188:191]
  ds_read_b128 v[52:55], v24 offset:13312
  v_add_f32 v229, v229, v76
  v_mfma_f32_16x16x32_bf16 v[156:159], v[60:63], v[104:107], v[156:159]
  s_waitcnt vmcnt(16)
  s_barrier
  v_exp_f32 v77, v77
  s_waitcnt lgkmcnt(4)
  v_mfma_f32_16x16x32_bf16 v[84:87], v[32:35], v[208:211], v[116:119]
  ds_read_b128 v[56:59], v24 offset:14336
  s_mov_b32 m0, s88
  s_nop 0
  buffer_load_dwordx4 v16, s[12:15], s86 offen offset:0 sc1 lds
  v_exp_f32 v78, v78
  v_mfma_f32_16x16x32_bf16 v[84:87], v[36:39], v[212:215], v[84:87]
  ds_read_b128 v[60:63], v24 offset:15360
  v_add_u32 v24, s85, v16
  v_exp_f32 v79, v79
  s_waitcnt lgkmcnt(4)
  v_mfma_f32_16x16x32_bf16 v[84:87], v[40:43], v[216:219], v[84:87]
  ds_read_b128 v[32:35], v25 offset:16384
  buffer_load_dwordx4 v16, s[12:15], s86 offen offset:1024 sc1 lds
  v_add_f32 v229, v229, v77
  v_cvt_pk_bf16_f32 v102, v76, v77
  v_mfma_f32_16x16x32_bf16 v[84:87], v[44:47], v[220:223], v[84:87]
  ds_read_b128 v[36:39], v25 offset:17408
  s_add_u32 s85, s85, 32768
  s_sub_u32 s33, s85, 163840
  s_cselect_b32 s85, s85, s33
  v_add_f32 v229, v229, v78
  v_add_f32 v229, v229, v79
  s_waitcnt lgkmcnt(4)
  v_mfma_f32_16x16x32_bf16 v[92:95], v[48:51], v[208:211], v[116:119]
  ds_read_b128 v[40:43], v25 offset:18432
  buffer_load_dwordx4 v16, s[12:15], s86 offen offset:2048 sc1 lds
  v_cvt_pk_bf16_f32 v103, v78, v79
  v_mfma_f32_16x16x32_bf16 v[92:95], v[52:55], v[212:215], v[92:95]
  ds_read_b128 v[44:47], v25 offset:19456
  s_waitcnt lgkmcnt(4)
  v_mfma_f32_16x16x32_bf16 v[92:95], v[56:59], v[216:219], v[92:95]
  ds_read_b128 v[48:51], v25 offset:20480
  buffer_load_dwordx4 v16, s[12:15], s86 offen offset:3072 sc1 lds
  v_mfma_f32_16x16x32_bf16 v[92:95], v[60:63], v[220:223], v[92:95]
  ds_read_b128 v[52:55], v25 offset:21504
  v_exp_f32 v84, v84
  s_waitcnt lgkmcnt(4)
  v_mfma_f32_16x16x32_bf16 v[128:131], v[32:35], v[96:99], v[128:131]
  ds_read_b128 v[56:59], v25 offset:22528
  s_add_u32 m0, s88, 16384
  v_add_f32 v229, v229, v84
  v_mfma_f32_16x16x32_bf16 v[160:163], v[32:35], v[100:103], v[160:163]
  v_exp_f32 v85, v85
  v_mfma_f32_16x16x32_bf16 v[164:167], v[36:39], v[100:103], v[164:167]
  ds_read_b128 v[60:63], v25 offset:23552
  s_add_u32 s86, s86, 16384
  buffer_load_dwordx4 v16, s[12:15], s87 offen offset:0 sc1 lds
  v_add_f32 v229, v229, v85
  v_cvt_pk_bf16_f32 v108, v84, v85
  v_mfma_f32_16x16x32_bf16 v[132:135], v[36:39], v[96:99], v[132:135]
  v_exp_f32 v86, v86
  s_waitcnt lgkmcnt(4)
  v_mfma_f32_16x16x32_bf16 v[136:139], v[40:43], v[96:99], v[136:139]
  ds_read_b128 v[32:35], v24 offset:0
  buffer_load_dwordx4 v16, s[12:15], s87 offen offset:1024 sc1 lds
  v_add_f32 v229, v229, v86
  v_mfma_f32_16x16x32_bf16 v[168:171], v[40:43], v[100:103], v[168:171]
  v_exp_f32 v87, v87
  v_mfma_f32_16x16x32_bf16 v[172:175], v[44:47], v[100:103], v[172:175]
  ds_read_b128 v[36:39], v24 offset:1024
  buffer_load_dwordx4 v16, s[12:15], s87 offen offset:2048 sc1 lds
  v_add_f32 v229, v229, v87
  v_cvt_pk_bf16_f32 v109, v86, v87
  v_mfma_f32_16x16x32_bf16 v[140:143], v[44:47], v[96:99], v[140:143]
  v_exp_f32 v92, v92
  s_waitcnt lgkmcnt(4)
  v_mfma_f32_16x16x32_bf16 v[144:147], v[48:51], v[96:99], v[144:147]
  ds_read_b128 v[40:43], v24 offset:2048
  buffer_load_dwordx4 v16, s[12:15], s87 offen offset:3072 sc1 lds
  v_add_f32 v229, v229, v92
  v_mfma_f32_16x16x32_bf16 v[176:179], v[48:51], v[100:103], v[176:179]
  v_exp_f32 v93, v93
  v_mfma_f32_16x16x32_bf16 v[180:183], v[52:55], v[100:103], v[180:183]
  ds_read_b128 v[44:47], v24 offset:3072
  s_add_u32 s87, s87, 16384
  s_add_u32 s88, s88, 32768
  s_sub_u32 s96, s88, 163840
  s_cselect_b32 s88, s88, s96
  v_add_f32 v229, v229, v93
  v_cvt_pk_bf16_f32 v110, v92, v93
  v_mfma_f32_16x16x32_bf16 v[148:151], v[52:55], v[96:99], v[148:151]
  v_exp_f32 v94, v94
  s_waitcnt lgkmcnt(4)
  v_mfma_f32_16x16x32_bf16 v[152:155], v[56:59], v[96:99], v[152:155]
  ds_read_b128 v[48:51], v24 offset:4096
  v_add_f32 v229, v229, v94
  v_mfma_f32_16x16x32_bf16 v[184:187], v[56:59], v[100:103], v[184:187]
  v_exp_f32 v95, v95
  v_mfma_f32_16x16x32_bf16 v[188:191], v[60:63], v[100:103], v[188:191]
  ds_read_b128 v[52:55], v24 offset:5120
  v_add_f32 v229, v229, v95
  v_cvt_pk_bf16_f32 v111, v94, v95
  v_mfma_f32_16x16x32_bf16 v[156:159], v[60:63], v[96:99], v[156:159]
  s_waitcnt lgkmcnt(4)
  v_mfma_f32_16x16x32_bf16 v[68:71], v[32:35], v[208:211], v[116:119]
  ds_read_b128 v[56:59], v24 offset:6144
  v_mfma_f32_16x16x32_bf16 v[68:71], v[36:39], v[212:215], v[68:71]
  ds_read_b128 v[60:63], v24 offset:7168
  s_waitcnt lgkmcnt(4)
  v_mfma_f32_16x16x32_bf16 v[68:71], v[40:43], v[216:219], v[68:71]
  ds_read_b128 v[32:35], v25 offset:24576
  v_mfma_f32_16x16x32_bf16 v[68:71], v[44:47], v[220:223], v[68:71]
  ds_read_b128 v[36:39], v25 offset:25600
  s_waitcnt lgkmcnt(4)
  v_mfma_f32_16x16x32_bf16 v[76:79], v[48:51], v[208:211], v[116:119]
  ds_read_b128 v[40:43], v25 offset:26624
  v_mfma_f32_16x16x32_bf16 v[76:79], v[52:55], v[212:215], v[76:79]
  ds_read_b128 v[44:47], v25 offset:27648
  s_waitcnt lgkmcnt(4)
  v_mfma_f32_16x16x32_bf16 v[76:79], v[56:59], v[216:219], v[76:79]
  ds_read_b128 v[48:51], v25 offset:28672
  v_mfma_f32_16x16x32_bf16 v[76:79], v[60:63], v[220:223], v[76:79]
  ds_read_b128 v[52:55], v25 offset:29696
  v_exp_f32 v68, v68
  s_waitcnt lgkmcnt(4)
  v_mfma_f32_16x16x32_bf16 v[160:163], v[32:35], v[108:111], v[160:163]
  ds_read_b128 v[56:59], v25 offset:30720
  v_exp_f32 v69, v69
  v_mfma_f32_16x16x32_bf16 v[164:167], v[36:39], v[108:111], v[164:167]
  ds_read_b128 v[60:63], v25 offset:31744
  v_mov_b32 v25, v24
  v_exp_f32 v70, v70
  s_waitcnt lgkmcnt(4)
  v_mfma_f32_16x16x32_bf16 v[168:171], v[40:43], v[108:111], v[168:171]
  ds_read_b128 v[32:35], v24 offset:8192
  v_exp_f32 v71, v71
  v_mfma_f32_16x16x32_bf16 v[172:175], v[44:47], v[108:111], v[172:175]
  ds_read_b128 v[36:39], v24 offset:9216
  v_exp_f32 v76, v76
  s_waitcnt lgkmcnt(4)
  v_mfma_f32_16x16x32_bf16 v[176:179], v[48:51], v[108:111], v[176:179]
  ds_read_b128 v[40:43], v24 offset:10240
  v_exp_f32 v77, v77
  v_mfma_f32_16x16x32_bf16 v[180:183], v[52:55], v[108:111], v[180:183]
  ds_read_b128 v[44:47], v24 offset:11264
  v_exp_f32 v78, v78
  s_waitcnt lgkmcnt(4)
  v_mfma_f32_16x16x32_bf16 v[184:187], v[56:59], v[108:111], v[184:187]
  ds_read_b128 v[48:51], v24 offset:12288
  v_exp_f32 v79, v79
  v_mfma_f32_16x16x32_bf16 v[188:191], v[60:63], v[108:111], v[188:191]
  ds_read_b128 v[52:55], v24 offset:13312
  v_add_f32 v229, v229, v68
  v_add_f32 v229, v229, v69
  s_waitcnt lgkmcnt(4)
  v_mfma_f32_16x16x32_bf16 v[84:87], v[32:35], v[208:211], v[116:119]
  ds_read_b128 v[56:59], v24 offset:14336
  s_waitcnt vmcnt(16)
  s_barrier
  v_cvt_pk_bf16_f32 v100, v68, v69
  v_add_f32 v229, v229, v70
  v_mfma_f32_16x16x32_bf16 v[84:87], v[36:39], v[212:215], v[84:87]
  ds_read_b128 v[60:63], v24 offset:15360
  s_mov_b32 m0, s88
  s_nop 0
  buffer_load_dwordx4 v16, s[12:15], s86 offen offset:0 sc1 lds
  v_add_f32 v229, v229, v71
  v_cvt_pk_bf16_f32 v101, v70, v71
  s_waitcnt lgkmcnt(4)
  v_mfma_f32_16x16x32_bf16 v[84:87], v[40:43], v[216:219], v[84:87]
  ds_read_b128 v[32:35], v25 offset:16384
  buffer_load_dwordx4 v16, s[12:15], s86 offen offset:1024 sc1 lds
  v_add_f32 v229, v229, v76
  v_add_f32 v229, v229, v77
  v_mfma_f32_16x16x32_bf16 v[84:87], v[44:47], v[220:223], v[84:87]
  ds_read_b128 v[36:39], v25 offset:17408
  buffer_load_dwordx4 v16, s[12:15], s86 offen offset:2048 sc1 lds
  v_cvt_pk_bf16_f32 v102, v76, v77
  v_add_f32 v229, v229, v78
  s_waitcnt lgkmcnt(4)
  v_mfma_f32_16x16x32_bf16 v[92:95], v[48:51], v[208:211], v[124:127]
  ds_read_b128 v[40:43], v25 offset:18432
  buffer_load_dwordx4 v16, s[12:15], s86 offen offset:3072 sc1 lds
  v_add_f32 v229, v229, v79
  v_cvt_pk_bf16_f32 v103, v78, v79
  v_mfma_f32_16x16x32_bf16 v[92:95], v[52:55], v[212:215], v[92:95]
  ds_read_b128 v[44:47], v25 offset:19456
  s_add_u32 m0, s88, 16384
  s_waitcnt lgkmcnt(4)
  v_mfma_f32_16x16x32_bf16 v[92:95], v[56:59], v[216:219], v[92:95]
  ds_read_b128 v[48:51], v25 offset:20480
  s_add_u32 s86, s86, 16384
  buffer_load_dwordx4 v16, s[12:15], s87 offen offset:0 sc1 lds
  v_mfma_f32_16x16x32_bf16 v[92:95], v[60:63], v[220:223], v[92:95]
  ds_read_b128 v[52:55], v25 offset:21504
  buffer_load_dwordx4 v16, s[12:15], s87 offen offset:1024 sc1 lds
  v_exp_f32 v84, v84
  s_waitcnt lgkmcnt(4)
  v_mfma_f32_16x16x32_bf16 v[160:163], v[32:35], v[100:103], v[160:163]
  ds_read_b128 v[56:59], v25 offset:22528
  buffer_load_dwordx4 v16, s[12:15], s87 offen offset:2048 sc1 lds
  v_exp_f32 v85, v85
  v_mfma_f32_16x16x32_bf16 v[164:167], v[36:39], v[100:103], v[164:167]
  ds_read_b128 v[60:63], v25 offset:23552
  buffer_load_dwordx4 v16, s[12:15], s87 offen offset:3072 sc1 lds
  v_exp_f32 v86, v86
  s_waitcnt lgkmcnt(4)
  v_mfma_f32_16x16x32_bf16 v[168:171], v[40:43], v[100:103], v[168:171]
  ds_read_b128 v[32:35], v25 offset:24576
  s_add_u32 s87, s87, 16384
  s_add_u32 s88, s88, 32768
  s_sub_u32 s96, s88, 163840
  s_cselect_b32 s88, s88, s96
  v_exp_f32 v87, v87
  v_mfma_f32_16x16x32_bf16 v[172:175], v[44:47], v[100:103], v[172:175]
  ds_read_b128 v[36:39], v25 offset:25600
  v_exp_f32 v92, v92
  s_waitcnt lgkmcnt(4)
  v_mfma_f32_16x16x32_bf16 v[176:179], v[48:51], v[100:103], v[176:179]
  ds_read_b128 v[40:43], v25 offset:26624
  v_exp_f32 v93, v93
  v_mfma_f32_16x16x32_bf16 v[180:183], v[52:55], v[100:103], v[180:183]
  ds_read_b128 v[44:47], v25 offset:27648
  v_exp_f32 v94, v94
  s_waitcnt lgkmcnt(4)
  v_mfma_f32_16x16x32_bf16 v[184:187], v[56:59], v[100:103], v[184:187]
  ds_read_b128 v[48:51], v25 offset:28672
  v_exp_f32 v95, v95
  v_mfma_f32_16x16x32_bf16 v[188:191], v[60:63], v[100:103], v[188:191]
  ds_read_b128 v[52:55], v25 offset:29696
  v_add_f32 v229, v229, v84
  v_add_f32 v229, v229, v85
  s_waitcnt lgkmcnt(4)
  v_cvt_pk_bf16_f32 v108, v84, v85
  v_add_f32 v229, v229, v86
  v_add_f32 v229, v229, v87
  v_cvt_pk_bf16_f32 v109, v86, v87
  v_add_f32 v229, v229, v92
  v_add_f32 v229, v229, v93
  v_cvt_pk_bf16_f32 v110, v92, v93
  v_add_f32 v229, v229, v94
  v_add_f32 v229, v229, v95
  v_cvt_pk_bf16_f32 v111, v94, v95
  s_nop 1
  v_mfma_f32_16x16x32_bf16 v[160:163], v[32:35], v[108:111], v[160:163]
  ds_read_b128 v[56:59], v25 offset:30720
  v_mfma_f32_16x16x32_bf16 v[164:167], v[36:39], v[108:111], v[164:167]
  ds_read_b128 v[60:63], v25 offset:31744
  s_waitcnt lgkmcnt(4)
  v_mfma_f32_16x16x32_bf16 v[168:171], v[40:43], v[108:111], v[168:171]
  v_mfma_f32_16x16x32_bf16 v[172:175], v[44:47], v[108:111], v[172:175]
  s_waitcnt lgkmcnt(2)
  v_mfma_f32_16x16x32_bf16 v[176:179], v[48:51], v[108:111], v[176:179]
  v_mfma_f32_16x16x32_bf16 v[180:183], v[52:55], v[108:111], v[180:183]
  s_waitcnt lgkmcnt(0)
  v_mfma_f32_16x16x32_bf16 v[184:187], v[56:59], v[108:111], v[184:187]
  v_mfma_f32_16x16x32_bf16 v[188:191], v[60:63], v[108:111], v[188:191]
  s_branch F_CHK
F_DB1:
  s_waitcnt lgkmcnt(4)
  v_mfma_f32_16x16x32_bf16 v[64:67], v[32:35], v[192:195], v[112:115]
  ds_read_b128 v[56:59], v24 offset:6144
  v_add_f32 v228, v228, v90
  v_mfma_f32_16x16x32_bf16 v[68:71], v[32:35], v[208:211], v[116:119]
  v_exp_f32 v91, v91
  v_mfma_f32_16x16x32_bf16 v[64:67], v[36:39], v[196:199], v[64:67]
  ds_read_b128 v[60:63], v24 offset:7168
  v_add_f32 v228, v228, v91
  v_cvt_pk_bf16_f32 v107, v90, v91
  v_mfma_f32_16x16x32_bf16 v[68:71], v[36:39], v[212:215], v[68:71]
  v_exp_f32 v92, v92
  s_waitcnt lgkmcnt(4)
  v_mfma_f32_16x16x32_bf16 v[64:67], v[40:43], v[200:203], v[64:67]
  ds_read_b128 v[32:35], v25 offset:24576
  v_add_f32 v229, v229, v92
  v_mfma_f32_16x16x32_bf16 v[68:71], v[40:43], v[216:219], v[68:71]
  v_exp_f32 v93, v93
  v_mfma_f32_16x16x32_bf16 v[64:67], v[44:47], v[204:207], v[64:67]
  ds_read_b128 v[36:39], v25 offset:25600
  v_add_f32 v229, v229, v93
  v_cvt_pk_bf16_f32 v110, v92, v93
  v_mfma_f32_16x16x32_bf16 v[68:71], v[44:47], v[220:223], v[68:71]
  v_exp_f32 v94, v94
  s_waitcnt lgkmcnt(4)
  v_mfma_f32_16x16x32_bf16 v[72:75], v[48:51], v[192:195], v[120:123]
  ds_read_b128 v[40:43], v25 offset:26624
  v_add_f32 v229, v229, v94
  v_mfma_f32_16x16x32_bf16 v[76:79], v[48:51], v[208:211], v[116:119]
  v_exp_f32 v95, v95
  v_mfma_f32_16x16x32_bf16 v[72:75], v[52:55], v[196:199], v[72:75]
  ds_read_b128 v[44:47], v25 offset:27648
  v_add_f32 v229, v229, v95
  v_cvt_pk_bf16_f32 v111, v94, v95
  v_mfma_f32_16x16x32_bf16 v[76:79], v[52:55], v[212:215], v[76:79]
  v_exp_f32 v64, v64
  s_waitcnt lgkmcnt(4)
  v_mfma_f32_16x16x32_bf16 v[72:75], v[56:59], v[200:203], v[72:75]
  ds_read_b128 v[48:51], v25 offset:28672
  v_add_f32 v228, v228, v64
  v_mfma_f32_16x16x32_bf16 v[76:79], v[56:59], v[216:219], v[76:79]
  v_exp_f32 v65, v65
  v_mfma_f32_16x16x32_bf16 v[72:75], v[60:63], v[204:207], v[72:75]
  ds_read_b128 v[52:55], v25 offset:29696
  v_add_f32 v228, v228, v65
  v_cvt_pk_bf16_f32 v96, v64, v65
  v_mfma_f32_16x16x32_bf16 v[76:79], v[60:63], v[220:223], v[76:79]
  v_exp_f32 v66, v66
  s_waitcnt lgkmcnt(4)
  v_mfma_f32_16x16x32_bf16 v[128:131], v[32:35], v[104:107], v[128:131]
  ds_read_b128 v[56:59], v25 offset:30720
  v_add_f32 v228, v228, v66
  v_mfma_f32_16x16x32_bf16 v[160:163], v[32:35], v[108:111], v[160:163]
  v_exp_f32 v67, v67
  v_mfma_f32_16x16x32_bf16 v[164:167], v[36:39], v[108:111], v[164:167]
  ds_read_b128 v[60:63], v25 offset:31744
  v_mov_b32 v25, v24
  v_add_f32 v228, v228, v67
  v_cvt_pk_bf16_f32 v97, v66, v67
  v_mfma_f32_16x16x32_bf16 v[132:135], v[36:39], v[104:107], v[132:135]
  v_exp_f32 v68, v68
  s_waitcnt lgkmcnt(4)
  v_mfma_f32_16x16x32_bf16 v[136:139], v[40:43], v[104:107], v[136:139]
  ds_read_b128 v[32:35], v24 offset:8192
  v_add_f32 v229, v229, v68
  v_mfma_f32_16x16x32_bf16 v[168:171], v[40:43], v[108:111], v[168:171]
  v_exp_f32 v69, v69
  v_mfma_f32_16x16x32_bf16 v[172:175], v[44:47], v[108:111], v[172:175]
  ds_read_b128 v[36:39], v24 offset:9216
  v_add_f32 v229, v229, v69
  v_cvt_pk_bf16_f32 v100, v68, v69
  v_mfma_f32_16x16x32_bf16 v[140:143], v[44:47], v[104:107], v[140:143]
  v_exp_f32 v70, v70
  s_waitcnt lgkmcnt(4)
  v_mfma_f32_16x16x32_bf16 v[144:147], v[48:51], v[104:107], v[144:147]
  ds_read_b128 v[40:43], v24 offset:10240
  v_add_f32 v229, v229, v70
  v_mfma_f32_16x16x32_bf16 v[176:179], v[48:51], v[108:111], v[176:179]
  v_exp_f32 v71, v71
  v_mfma_f32_16x16x32_bf16 v[180:183], v[52:55], v[108:111], v[180:183]
  ds_read_b128 v[44:47], v24 offset:11264
  v_add_f32 v229, v229, v71
  v_cvt_pk_bf16_f32 v101, v70, v71
  v_mfma_f32_16x16x32_bf16 v[148:151], v[52:55], v[104:107], v[148:151]
  v_exp_f32 v72, v72
  s_waitcnt lgkmcnt(4)
  v_mfma_f32_16x16x32_bf16 v[152:155], v[56:59], v[104:107], v[152:155]
  ds_read_b128 v[48:51], v24 offset:12288
  v_add_f32 v228, v228, v72
  v_mfma_f32_16x16x32_bf16 v[184:187], v[56:59], v[108:111], v[184:187]
  v_exp_f32 v73, v73
  v_mfma_f32_16x16x32_bf16 v[188:191], v[60:63], v[108:111], v[188:191]
  ds_read_b128 v[52:55], v24 offset:13312
  v_add_f32 v228, v228, v73
  v_cvt_pk_bf16_f32 v98, v72, v73
  v_mfma_f32_16x16x32_bf16 v[156:159], v[60:63], v[104:107], v[156:159]
  s_waitcnt vmcnt(16)
  s_barrier
  v_exp_f32 v74, v74
  s_waitcnt lgkmcnt(4)
  v_mfma_f32_16x16x32_bf16 v[84:87], v[32:35], v[208:211], v[116:119]
  ds_read_b128 v[56:59], v24 offset:14336
  s_mov_b32 m0, s88
  s_nop 0
  buffer_load_dwordx4 v16, s[12:15], s86 offen offset:0 sc1 lds
  v_exp_f32 v75, v75
  v_mfma_f32_16x16x32_bf16 v[84:87], v[36:39], v[212:215], v[84:87]
  ds_read_b128 v[60:63], v24 offset:15360
  v_add_u32 v24, s85, v16
  v_exp_f32 v76, v76
  s_waitcnt lgkmcnt(4)
  v_mfma_f32_16x16x32_bf16 v[84:87], v[40:43], v[216:219], v[84:87]
  ds_read_b128 v[32:35], v25 offset:16384
  buffer_load_dwordx4 v16, s[12:15], s86 offen offset:1024 sc1 lds
  v_exp_f32 v77, v77
  v_mfma_f32_16x16x32_bf16 v[84:87], v[44:47], v[220:223], v[84:87]
  ds_read_b128 v[36:39], v25 offset:17408
  s_add_u32 s85, s85, 32768
  s_sub_u32 s33, s85, 163840
  s_cselect_b32 s85, s85, s33
  v_exp_f32 v78, v78
  s_waitcnt lgkmcnt(4)
  v_mfma_f32_16x16x32_bf16 v[92:95], v[48:51], v[208:211], v[116:119]
  ds_read_b128 v[40:43], v25 offset:18432
  buffer_load_dwordx4 v16, s[12:15], s86 offen offset:2048 sc1 lds
  v_exp_f32 v79, v79
  v_mfma_f32_16x16x32_bf16 v[92:95], v[52:55], v[212:215], v[92:95]
  ds_read_b128 v[44:47], v25 offset:19456
  v_add_f32 v228, v228, v74
  v_add_f32 v228, v228, v75
  s_waitcnt lgkmcnt(4)
  v_mfma_f32_16x16x32_bf16 v[92:95], v[56:59], v[216:219], v[92:95]
  ds_read_b128 v[48:51], v25 offset:20480
  buffer_load_dwordx4 v16, s[12:15], s86 offen offset:3072 sc1 lds
  v_cvt_pk_bf16_f32 v99, v74, v75
  v_add_f32 v229, v229, v76
  v_mfma_f32_16x16x32_bf16 v[92:95], v[60:63], v[220:223], v[92:95]
  ds_read_b128 v[52:55], v25 offset:21504
  v_exp_f32 v84, v84
  s_waitcnt lgkmcnt(4)
  v_mfma_f32_16x16x32_bf16 v[128:131], v[32:35], v[96:99], v[128:131]
  ds_read_b128 v[56:59], v25 offset:22528
  s_add_u32 m0, s88, 16384
  v_add_f32 v229, v229, v77
  v_cvt_pk_bf16_f32 v102, v76, v77
  v_add_f32 v229, v229, v78
  v_add_f32 v229, v229, v79
  v_cvt_pk_bf16_f32 v103, v78, v79
  s_nop 1
  v_mfma_f32_16x16x32_bf16 v[160:163], v[32:35], v[100:103], v[160:163]
  v_exp_f32 v85, v85
  v_mfma_f32_16x16x32_bf16 v[164:167], v[36:39], v[100:103], v[164:167]
  ds_read_b128 v[60:63], v25 offset:23552
  s_add_u32 s86, s86, 16384
  buffer_load_dwordx4 v16, s[12:15], s87 offen offset:0 sc1 lds
  v_add_f32 v229, v229, v84
  v_add_f32 v229, v229, v85
  v_mfma_f32_16x16x32_bf16 v[132:135], v[36:39], v[96:99], v[132:135]
  v_exp_f32 v86, v86
  s_waitcnt lgkmcnt(4)
  v_mfma_f32_16x16x32_bf16 v[136:139], v[40:43], v[96:99], v[136:139]
  ds_read_b128 v[32:35], v24 offset:0
  buffer_load_dwordx4 v16, s[12:15], s87 offen offset:1024 sc1 lds
  v_cvt_pk_bf16_f32 v108, v84, v85
  v_add_f32 v229, v229, v86
  v_mfma_f32_16x16x32_bf16 v[168:171], v[40:43], v[100:103], v[168:171]
  v_exp_f32 v87, v87
  v_mfma_f32_16x16x32_bf16 v[172:175], v[44:47], v[100:103], v[172:175]
  ds_read_b128 v[36:39], v24 offset:1024
  buffer_load_dwordx4 v16, s[12:15], s87 offen offset:2048 sc1 lds
  v_add_f32 v229, v229, v87
  v_cvt_pk_bf16_f32 v109, v86, v87
  v_mfma_f32_16x16x32_bf16 v[140:143], v[44:47], v[96:99], v[140:143]
  v_exp_f32 v92, v92
  s_waitcnt lgkmcnt(4)
  v_mfma_f32_16x16x32_bf16 v[144:147], v[48:51], v[96:99], v[144:147]
  ds_read_b128 v[40:43], v24 offset:2048
  buffer_load_dwordx4 v16, s[12:15], s87 offen offset:3072 sc1 lds
  v_add_f32 v229, v229, v92
  v_mfma_f32_16x16x32_bf16 v[176:179], v[48:51], v[100:103], v[176:179]
  v_exp_f32 v93, v93
  v_mfma_f32_16x16x32_bf16 v[180:183], v[52:55], v[100:103], v[180:183]
  ds_read_b128 v[44:47], v24 offset:3072
  s_add_u32 s87, s87, 16384
  s_add_u32 s88, s88, 32768
  s_sub_u32 s96, s88, 163840
  s_cselect_b32 s88, s88, s96
  v_add_f32 v229, v229, v93
  v_cvt_pk_bf16_f32 v110, v92, v93
  v_mfma_f32_16x16x32_bf16 v[148:151], v[52:55], v[96:99], v[148:151]
  v_exp_f32 v94, v94
  s_waitcnt lgkmcnt(4)
  v_mfma_f32_16x16x32_bf16 v[152:155], v[56:59], v[96:99], v[152:155]
  ds_read_b128 v[48:51], v24 offset:4096
  v_add_f32 v229, v229, v94
  v_mfma_f32_16x16x32_bf16 v[184:187], v[56:59], v[100:103], v[184:187]
  v_exp_f32 v95, v95
  v_mfma_f32_16x16x32_bf16 v[188:191], v[60:63], v[100:103], v[188:191]
  ds_read_b128 v[52:55], v24 offset:5120
  v_add_f32 v229, v229, v95
  v_cvt_pk_bf16_f32 v111, v94, v95
  v_mfma_f32_16x16x32_bf16 v[156:159], v[60:63], v[96:99], v[156:159]
  s_waitcnt lgkmcnt(4)
  v_mfma_f32_16x16x32_bf16 v[68:71], v[32:35], v[208:211], v[116:119]
  ds_read_b128 v[56:59], v24 offset:6144
  v_mfma_f32_16x16x32_bf16 v[68:71], v[36:39], v[212:215], v[68:71]
  ds_read_b128 v[60:63], v24 offset:7168
  s_waitcnt lgkmcnt(4)
  v_mfma_f32_16x16x32_bf16 v[68:71], v[40:43], v[216:219], v[68:71]
  ds_read_b128 v[32:35], v25 offset:24576
  v_mfma_f32_16x16x32_bf16 v[68:71], v[44:47], v[220:223], v[68:71]
  ds_read_b128 v[36:39], v25 offset:25600
  s_waitcnt lgkmcnt(4)
  v_mfma_f32_16x16x32_bf16 v[76:79], v[48:51], v[208:211], v[116:119]
  ds_read_b128 v[40:43], v25 offset:26624
  v_mfma_f32_16x16x32_bf16 v[76:79], v[52:55], v[212:215], v[76:79]
  ds_read_b128 v[44:47], v25 offset:27648
  s_waitcnt lgkmcnt(4)
  v_mfma_f32_16x16x32_bf16 v[76:79], v[56:59], v[216:219], v[76:79]
  ds_read_b128 v[48:51], v25 offset:28672
  v_mfma_f32_16x16x32_bf16 v[76:79], v[60:63], v[220:223], v[76:79]
  ds_read_b128 v[52:55], v25 offset:29696
  v_exp_f32 v68, v68
  s_waitcnt lgkmcnt(4)
  v_mfma_f32_16x16x32_bf16 v[160:163], v[32:35], v[108:111], v[160:163]
  ds_read_b128 v[56:59], v25 offset:30720
  v_exp_f32 v69, v69
  v_mfma_f32_16x16x32_bf16 v[164:167], v[36:39], v[108:111], v[164:167]
  ds_read_b128 v[60:63], v25 offset:31744
  v_mov_b32 v25, v24
  v_exp_f32 v70, v70
  s_waitcnt lgkmcnt(4)
  v_mfma_f32_16x16x32_bf16 v[168:171], v[40:43], v[108:111], v[168:171]
  ds_read_b128 v[32:35], v24 offset:8192
  v_exp_f32 v71, v71
  v_mfma_f32_16x16x32_bf16 v[172:175], v[44:47], v[108:111], v[172:175]
  ds_read_b128 v[36:39], v24 offset:9216
  v_exp_f32 v76, v76
  s_waitcnt lgkmcnt(4)
  v_mfma_f32_16x16x32_bf16 v[176:179], v[48:51], v[108:111], v[176:179]
  ds_read_b128 v[40:43], v24 offset:10240
  v_exp_f32 v77, v77
  v_mfma_f32_16x16x32_bf16 v[180:183], v[52:55], v[108:111], v[180:183]
  ds_read_b128 v[44:47], v24 offset:11264
  v_exp_f32 v78, v78
  s_waitcnt lgkmcnt(4)
  v_mfma_f32_16x16x32_bf16 v[184:187], v[56:59], v[108:111], v[184:187]
  ds_read_b128 v[48:51], v25 offset:16384
  v_exp_f32 v79, v79
  v_mfma_f32_16x16x32_bf16 v[188:191], v[60:63], v[108:111], v[188:191]
  ds_read_b128 v[52:55], v25 offset:17408
  v_add_f32 v229, v229, v68
  v_add_f32 v229, v229, v69
  s_waitcnt lgkmcnt(4)
  v_mfma_f32_16x16x32_bf16 v[84:87], v[32:35], v[208:211], v[124:127]
  ds_read_b128 v[56:59], v25 offset:18432
  s_waitcnt vmcnt(16)
  s_barrier
  v_cvt_pk_bf16_f32 v100, v68, v69
  v_add_f32 v229, v229, v70
  v_mfma_f32_16x16x32_bf16 v[84:87], v[36:39], v[212:215], v[84:87]
  ds_read_b128 v[60:63], v25 offset:19456
  s_mov_b32 m0, s88
  s_nop 0
  buffer_load_dwordx4 v16, s[12:15], s86 offen offset:0 sc1 lds
  v_add_f32 v229, v229, v71
  v_cvt_pk_bf16_f32 v101, v70, v71
  s_waitcnt lgkmcnt(4)
  v_mfma_f32_16x16x32_bf16 v[84:87], v[40:43], v[216:219], v[84:87]
  ds_read_b128 v[32:35], v25 offset:20480
  buffer_load_dwordx4 v16, s[12:15], s86 offen offset:1024 sc1 lds
  v_add_f32 v229, v229, v76
  v_add_f32 v229, v229, v77
  v_mfma_f32_16x16x32_bf16 v[84:87], v[44:47], v[220:223], v[84:87]
  ds_read_b128 v[36:39], v25 offset:21504
  buffer_load_dwordx4 v16, s[12:15], s86 offen offset:2048 sc1 lds
  v_cvt_pk_bf16_f32 v102, v76, v77
  v_add_f32 v229, v229, v78
  s_waitcnt lgkmcnt(4)
  v_add_f32 v229, v229, v79
  v_cvt_pk_bf16_f32 v103, v78, v79
  s_nop 1
  v_mfma_f32_16x16x32_bf16 v[160:163], v[48:51], v[100:103], v[160:163]
  ds_read_b128 v[40:43], v25 offset:22528
  buffer_load_dwordx4 v16, s[12:15], s86 offen offset:3072 sc1 lds
  v_mov_b32 v110, 0
  v_mov_b32 v111, 0
  v_mfma_f32_16x16x32_bf16 v[164:167], v[52:55], v[100:103], v[164:167]
  ds_read_b128 v[44:47], v25 offset:23552
  s_add_u32 m0, s88, 16384
  s_waitcnt lgkmcnt(4)
  v_mfma_f32_16x16x32_bf16 v[168:171], v[56:59], v[100:103], v[168:171]
  ds_read_b128 v[48:51], v25 offset:24576
  s_add_u32 s86, s86, 16384
  buffer_load_dwordx4 v16, s[12:15], s87 offen offset:0 sc1 lds
  v_mfma_f32_16x16x32_bf16 v[172:175], v[60:63], v[100:103], v[172:175]
  ds_read_b128 v[52:55], v25 offset:25600
  buffer_load_dwordx4 v16, s[12:15], s87 offen offset:1024 sc1 lds
  v_exp_f32 v84, v84
  s_waitcnt lgkmcnt(4)
  v_mfma_f32_16x16x32_bf16 v[176:179], v[32:35], v[100:103], v[176:179]
  ds_read_b128 v[56:59], v25 offset:26624
  buffer_load_dwordx4 v16, s[12:15], s87 offen offset:2048 sc1 lds
  v_exp_f32 v85, v85
  v_mfma_f32_16x16x32_bf16 v[180:183], v[36:39], v[100:103], v[180:183]
  ds_read_b128 v[60:63], v25 offset:27648
  buffer_load_dwordx4 v16, s[12:15], s87 offen offset:3072 sc1 lds
  v_exp_f32 v86, v86
  s_waitcnt lgkmcnt(4)
  v_mfma_f32_16x16x32_bf16 v[184:187], v[40:43], v[100:103], v[184:187]
  ds_read_b128 v[32:35], v25 offset:28672
  s_add_u32 s87, s87, 16384
  s_add_u32 s88, s88, 32768
  s_sub_u32 s96, s88, 163840
  s_cselect_b32 s88, s88, s96
  v_exp_f32 v87, v87
  v_mfma_f32_16x16x32_bf16 v[188:191], v[44:47], v[100:103], v[188:191]
  ds_read_b128 v[36:39], v25 offset:29696
  v_add_f32 v229, v229, v84
  v_add_f32 v229, v229, v85
  s_waitcnt lgkmcnt(4)
  v_cvt_pk_bf16_f32 v108, v84, v85
  v_add_f32 v229, v229, v86
  v_add_f32 v229, v229, v87
  v_cvt_pk_bf16_f32 v109, v86, v87
  s_nop 1
  v_mfma_f32_16x16x32_bf16 v[160:163], v[48:51], v[108:111], v[160:163]
  ds_read_b128 v[40:43], v25 offset:30720
  v_mfma_f32_16x16x32_bf16 v[164:167], v[52:55], v[108:111], v[164:167]
  ds_read_b128 v[44:47], v25 offset:31744
  s_waitcnt lgkmcnt(4)
  v_mfma_f32_16x16x32_bf16 v[168:171], v[56:59], v[108:111], v[168:171]
  v_mfma_f32_16x16x32_bf16 v[172:175], v[60:63], v[108:111], v[172:175]
  s_waitcnt lgkmcnt(2)
  v_mfma_f32_16x16x32_bf16 v[176:179], v[32:35], v[108:111], v[176:179]
  v_mfma_f32_16x16x32_bf16 v[180:183], v[36:39], v[108:111], v[180:183]
  s_waitcnt lgkmcnt(0)
  v_mfma_f32_16x16x32_bf16 v[184:187], v[40:43], v[108:111], v[184:187]
  v_mfma_f32_16x16x32_bf16 v[188:191], v[44:47], v[108:111], v[188:191]
  s_branch F_CHK
F_DB2:
  s_waitcnt lgkmcnt(4)
  v_mfma_f32_16x16x32_bf16 v[64:67], v[32:35], v[192:195], v[112:115]
  ds_read_b128 v[56:59], v24 offset:6144
  v_add_f32 v228, v228, v90
  v_mfma_f32_16x16x32_bf16 v[68:71], v[32:35], v[208:211], v[116:119]
  v_exp_f32 v91, v91
  v_mfma_f32_16x16x32_bf16 v[64:67], v[36:39], v[196:199], v[64:67]
  ds_read_b128 v[60:63], v24 offset:7168
  v_add_f32 v228, v228, v91
  v_cvt_pk_bf16_f32 v107, v90, v91
  v_mfma_f32_16x16x32_bf16 v[68:71], v[36:39], v[212:215], v[68:71]
  v_exp_f32 v92, v92
  s_waitcnt lgkmcnt(4)
  v_mfma_f32_16x16x32_bf16 v[64:67], v[40:43], v[200:203], v[64:67]
  ds_read_b128 v[32:35], v25 offset:24576
  v_add_f32 v229, v229, v92
  v_mfma_f32_16x16x32_bf16 v[68:71], v[40:43], v[216:219], v[68:71]
  v_exp_f32 v93, v93
  v_mfma_f32_16x16x32_bf16 v[64:67], v[44:47], v[204:207], v[64:67]
  ds_read_b128 v[36:39], v25 offset:25600
  v_add_f32 v229, v229, v93
  v_cvt_pk_bf16_f32 v110, v92, v93
  v_mfma_f32_16x16x32_bf16 v[68:71], v[44:47], v[220:223], v[68:71]
  v_exp_f32 v94, v94
  s_waitcnt lgkmcnt(4)
  v_mfma_f32_16x16x32_bf16 v[72:75], v[48:51], v[192:195], v[112:115]
  ds_read_b128 v[40:43], v25 offset:26624
  v_add_f32 v229, v229, v94
  v_mfma_f32_16x16x32_bf16 v[76:79], v[48:51], v[208:211], v[116:119]
  v_exp_f32 v95, v95
  v_mfma_f32_16x16x32_bf16 v[72:75], v[52:55], v[196:199], v[72:75]
  ds_read_b128 v[44:47], v25 offset:27648
  v_add_f32 v229, v229, v95
  v_cvt_pk_bf16_f32 v111, v94, v95
  v_mfma_f32_16x16x32_bf16 v[76:79], v[52:55], v[212:215], v[76:79]
  v_exp_f32 v64, v64
  s_waitcnt lgkmcnt(4)
  v_mfma_f32_16x16x32_bf16 v[72:75], v[56:59], v[200:203], v[72:75]
  ds_read_b128 v[48:51], v25 offset:28672
  v_add_f32 v228, v228, v64
  v_mfma_f32_16x16x32_bf16 v[76:79], v[56:59], v[216:219], v[76:79]
  v_exp_f32 v65, v65
  v_mfma_f32_16x16x32_bf16 v[72:75], v[60:63], v[204:207], v[72:75]
  ds_read_b128 v[52:55], v25 offset:29696
  v_add_f32 v228, v228, v65
  v_cvt_pk_bf16_f32 v96, v64, v65
  v_mfma_f32_16x16x32_bf16 v[76:79], v[60:63], v[220:223], v[76:79]
  v_exp_f32 v66, v66
  s_waitcnt lgkmcnt(4)
  v_mfma_f32_16x16x32_bf16 v[128:131], v[32:35], v[104:107], v[128:131]
  ds_read_b128 v[56:59], v25 offset:30720
  v_add_f32 v228, v228, v66
  v_mfma_f32_16x16x32_bf16 v[160:163], v[32:35], v[108:111], v[160:163]
  v_exp_f32 v67, v67
  v_mfma_f32_16x16x32_bf16 v[164:167], v[36:39], v[108:111], v[164:167]
  ds_read_b128 v[60:63], v25 offset:31744
  v_mov_b32 v25, v24
  v_add_f32 v228, v228, v67
  v_cvt_pk_bf16_f32 v97, v66, v67
  v_mfma_f32_16x16x32_bf16 v[132:135], v[36:39], v[104:107], v[132:135]
  v_exp_f32 v68, v68
  s_waitcnt lgkmcnt(4)
  v_mfma_f32_16x16x32_bf16 v[136:139], v[40:43], v[104:107], v[136:139]
  ds_read_b128 v[32:35], v24 offset:8192
  v_add_f32 v229, v229, v68
  v_mfma_f32_16x16x32_bf16 v[168:171], v[40:43], v[108:111], v[168:171]
  v_exp_f32 v69, v69
  v_mfma_f32_16x16x32_bf16 v[172:175], v[44:47], v[108:111], v[172:175]
  ds_read_b128 v[36:39], v24 offset:9216
  v_add_f32 v229, v229, v69
  v_cvt_pk_bf16_f32 v100, v68, v69
  v_mfma_f32_16x16x32_bf16 v[140:143], v[44:47], v[104:107], v[140:143]
  v_exp_f32 v70, v70
  s_waitcnt lgkmcnt(4)
  v_mfma_f32_16x16x32_bf16 v[144:147], v[48:51], v[104:107], v[144:147]
  ds_read_b128 v[40:43], v24 offset:10240
  v_add_f32 v229, v229, v70
  v_mfma_f32_16x16x32_bf16 v[176:179], v[48:51], v[108:111], v[176:179]
  v_exp_f32 v71, v71
  v_mfma_f32_16x16x32_bf16 v[180:183], v[52:55], v[108:111], v[180:183]
  ds_read_b128 v[44:47], v24 offset:11264
  v_add_f32 v229, v229, v71
  v_cvt_pk_bf16_f32 v101, v70, v71
  v_mfma_f32_16x16x32_bf16 v[148:151], v[52:55], v[104:107], v[148:151]
  v_exp_f32 v72, v72
  s_waitcnt lgkmcnt(4)
  v_mfma_f32_16x16x32_bf16 v[152:155], v[56:59], v[104:107], v[152:155]
  ds_read_b128 v[48:51], v24 offset:12288
  v_add_f32 v228, v228, v72
  v_mfma_f32_16x16x32_bf16 v[184:187], v[56:59], v[108:111], v[184:187]
  v_exp_f32 v73, v73
  v_mfma_f32_16x16x32_bf16 v[188:191], v[60:63], v[108:111], v[188:191]
  ds_read_b128 v[52:55], v24 offset:13312
  v_add_f32 v228, v228, v73
  v_cvt_pk_bf16_f32 v98, v72, v73
  v_mfma_f32_16x16x32_bf16 v[156:159], v[60:63], v[104:107], v[156:159]
  s_waitcnt vmcnt(16)
  s_barrier
  v_exp_f32 v74, v74
  s_waitcnt lgkmcnt(4)
  v_mfma_f32_16x16x32_bf16 v[80:83], v[32:35], v[192:195], v[120:123]
  ds_read_b128 v[56:59], v24 offset:14336
  s_mov_b32 m0, s88
  s_nop 0
  buffer_load_dwordx4 v16, s[12:15], s86 offen offset:0 sc1 lds
  v_add_f32 v228, v228, v74
  v_mov_b32 v106, 0
  v_mfma_f32_16x16x32_bf16 v[84:87], v[32:35], v[208:211], v[116:119]
  v_exp_f32 v75, v75
  v_mfma_f32_16x16x32_bf16 v[80:83], v[36:39], v[196:199], v[80:83]
  ds_read_b128 v[60:63], v24 offset:15360
  v_add_u32 v24, s85, v16
  v_add_f32 v228, v228, v75
  v_cvt_pk_bf16_f32 v99, v74, v75
  v_mfma_f32_16x16x32_bf16 v[84:87], v[36:39], v[212:215], v[84:87]
  buffer_load_dwordx4 v16, s[12:15], s86 offen offset:1024 sc1 lds
  v_exp_f32 v76, v76
  s_waitcnt lgkmcnt(4)
  v_mfma_f32_16x16x32_bf16 v[80:83], v[40:43], v[200:203], v[80:83]
  ds_read_b128 v[32:35], v25 offset:16384
  s_add_u32 s85, s85, 32768
  s_sub_u32 s33, s85, 163840
  s_cselect_b32 s85, s85, s33
  v_add_f32 v229, v229, v76
  v_mov_b32 v107, 0
  v_mfma_f32_16x16x32_bf16 v[84:87], v[40:43], v[216:219], v[84:87]
  v_exp_f32 v77, v77
  v_mfma_f32_16x16x32_bf16 v[80:83], v[44:47], v[204:207], v[80:83]
  ds_read_b128 v[36:39], v25 offset:17408
  buffer_load_dwordx4 v16, s[12:15], s86 offen offset:2048 sc1 lds
  v_add_f32 v229, v229, v77
  v_cvt_pk_bf16_f32 v102, v76, v77
  v_mfma_f32_16x16x32_bf16 v[84:87], v[44:47], v[220:223], v[84:87]
  v_exp_f32 v78, v78
  s_waitcnt lgkmcnt(4)
  v_mfma_f32_16x16x32_bf16 v[92:95], v[48:51], v[208:211], v[116:119]
  ds_read_b128 v[40:43], v25 offset:18432
  v_exp_f32 v79, v79
  v_mfma_f32_16x16x32_bf16 v[92:95], v[52:55], v[212:215], v[92:95]
  ds_read_b128 v[44:47], v25 offset:19456
  buffer_load_dwordx4 v16, s[12:15], s86 offen offset:3072 sc1 lds
  v_add_f32 v229, v229, v78
  v_add_f32 v229, v229, v79
  s_waitcnt lgkmcnt(4)
  v_mfma_f32_16x16x32_bf16 v[92:95], v[56:59], v[216:219], v[92:95]
  ds_read_b128 v[48:51], v25 offset:20480
  v_exp_f32 v80, v80
  v_mfma_f32_16x16x32_bf16 v[92:95], v[60:63], v[220:223], v[92:95]
  ds_read_b128 v[52:55], v25 offset:21504
  v_exp_f32 v81, v81
  s_waitcnt lgkmcnt(4)
  v_mfma_f32_16x16x32_bf16 v[128:131], v[32:35], v[96:99], v[128:131]
  ds_read_b128 v[56:59], v25 offset:22528
  s_add_u32 m0, s88, 16384
  v_cvt_pk_bf16_f32 v103, v78, v79
  v_add_f32 v228, v228, v80
  s_nop 0
  v_mfma_f32_16x16x32_bf16 v[160:163], v[32:35], v[100:103], v[160:163]
  v_exp_f32 v82, v82
  v_mfma_f32_16x16x32_bf16 v[164:167], v[36:39], v[100:103], v[164:167]
  ds_read_b128 v[60:63], v25 offset:23552
  v_add_f32 v228, v228, v81
  v_cvt_pk_bf16_f32 v104, v80, v81
  v_mfma_f32_16x16x32_bf16 v[132:135], v[36:39], v[96:99], v[132:135]
  s_add_u32 s86, s86, 16384
  buffer_load_dwordx4 v16, s[12:15], s87 offen offset:0 sc1 lds
  v_exp_f32 v83, v83
  s_waitcnt lgkmcnt(4)
  v_mfma_f32_16x16x32_bf16 v[136:139], v[40:43], v[96:99], v[136:139]
  ds_read_b128 v[32:35], v24 offset:0
  v_add_f32 v228, v228, v82
  v_add_f32 v228, v228, v83
  v_mfma_f32_16x16x32_bf16 v[168:171], v[40:43], v[100:103], v[168:171]
  v_exp_f32 v84, v84
  v_mfma_f32_16x16x32_bf16 v[172:175], v[44:47], v[100:103], v[172:175]
  ds_read_b128 v[36:39], v24 offset:1024
  buffer_load_dwordx4 v16, s[12:15], s87 offen offset:1024 sc1 lds
  v_cvt_pk_bf16_f32 v105, v82, v83
  v_add_f32 v229, v229, v84
  v_mfma_f32_16x16x32_bf16 v[140:143], v[44:47], v[96:99], v[140:143]
  v_exp_f32 v85, v85
  s_waitcnt lgkmcnt(4)
  v_mfma_f32_16x16x32_bf16 v[144:147], v[48:51], v[96:99], v[144:147]
  ds_read_b128 v[40:43], v24 offset:2048
  v_add_f32 v229, v229, v85
  v_cvt_pk_bf16_f32 v108, v84, v85
  v_mfma_f32_16x16x32_bf16 v[176:179], v[48:51], v[100:103], v[176:179]
  buffer_load_dwordx4 v16, s[12:15], s87 offen offset:2048 sc1 lds
  v_exp_f32 v86, v86
  v_mfma_f32_16x16x32_bf16 v[180:183], v[52:55], v[100:103], v[180:183]
  ds_read_b128 v[44:47], v24 offset:3072
  v_add_f32 v229, v229, v86
  v_mfma_f32_16x16x32_bf16 v[148:151], v[52:55], v[96:99], v[148:151]
  v_exp_f32 v87, v87
  s_waitcnt lgkmcnt(4)
  v_mfma_f32_16x16x32_bf16 v[152:155], v[56:59], v[96:99], v[152:155]
  ds_read_b128 v[48:51], v24 offset:4096
  buffer_load_dwordx4 v16, s[12:15], s87 offen offset:3072 sc1 lds
  v_add_f32 v229, v229, v87
  v_cvt_pk_bf16_f32 v109, v86, v87
  v_mfma_f32_16x16x32_bf16 v[184:187], v[56:59], v[100:103], v[184:187]
  v_exp_f32 v92, v92
  v_mfma_f32_16x16x32_bf16 v[188:191], v[60:63], v[100:103], v[188:191]
  ds_read_b128 v[52:55], v24 offset:5120
  v_add_f32 v229, v229, v92
  v_mfma_f32_16x16x32_bf16 v[156:159], v[60:63], v[96:99], v[156:159]
  s_add_u32 s87, s87, 16384
  s_add_u32 s88, s88, 32768
  s_sub_u32 s96, s88, 163840
  s_cselect_b32 s88, s88, s96
  v_exp_f32 v93, v93
  s_waitcnt lgkmcnt(4)
  v_mfma_f32_16x16x32_bf16 v[68:71], v[32:35], v[208:211], v[116:119]
  ds_read_b128 v[56:59], v24 offset:6144
  v_exp_f32 v94, v94
  v_mfma_f32_16x16x32_bf16 v[68:71], v[36:39], v[212:215], v[68:71]
  ds_read_b128 v[60:63], v24 offset:7168
  v_exp_f32 v95, v95
  s_waitcnt lgkmcnt(4)
  v_mfma_f32_16x16x32_bf16 v[68:71], v[40:43], v[216:219], v[68:71]
  ds_read_b128 v[32:35], v25 offset:24576
  v_add_f32 v229, v229, v93
  v_cvt_pk_bf16_f32 v110, v92, v93
  v_mfma_f32_16x16x32_bf16 v[68:71], v[44:47], v[220:223], v[68:71]
  ds_read_b128 v[36:39], v25 offset:25600
  v_add_f32 v229, v229, v94
  v_add_f32 v229, v229, v95
  s_waitcnt lgkmcnt(4)
  v_mfma_f32_16x16x32_bf16 v[76:79], v[48:51], v[208:211], v[124:127]
  ds_read_b128 v[40:43], v25 offset:26624
  v_cvt_pk_bf16_f32 v111, v94, v95
  v_mfma_f32_16x16x32_bf16 v[76:79], v[52:55], v[212:215], v[76:79]
  ds_read_b128 v[44:47], v25 offset:27648
  s_waitcnt lgkmcnt(4)
  v_mfma_f32_16x16x32_bf16 v[76:79], v[56:59], v[216:219], v[76:79]
  ds_read_b128 v[48:51], v25 offset:28672
  v_mfma_f32_16x16x32_bf16 v[76:79], v[60:63], v[220:223], v[76:79]
  ds_read_b128 v[52:55], v25 offset:29696
  v_exp_f32 v68, v68
  s_waitcnt lgkmcnt(4)
  v_mfma_f32_16x16x32_bf16 v[128:131], v[32:35], v[104:107], v[128:131]
  ds_read_b128 v[56:59], v25 offset:30720
  v_add_f32 v229, v229, v68
  v_mfma_f32_16x16x32_bf16 v[160:163], v[32:35], v[108:111], v[160:163]
  v_exp_f32 v69, v69
  v_mfma_f32_16x16x32_bf16 v[164:167], v[36:39], v[108:111], v[164:167]
  ds_read_b128 v[60:63], v25 offset:31744
  v_mov_b32 v25, v24
  v_add_f32 v229, v229, v69
  v_cvt_pk_bf16_f32 v100, v68, v69
  v_mfma_f32_16x16x32_bf16 v[132:135], v[36:39], v[104:107], v[132:135]
  v_exp_f32 v70, v70
  s_waitcnt lgkmcnt(4)
  v_mfma_f32_16x16x32_bf16 v[136:139], v[40:43], v[104:107], v[136:139]
  ds_read_b128 v[32:35], v25 offset:16384
  v_add_f32 v229, v229, v70
  v_mfma_f32_16x16x32_bf16 v[168:171], v[40:43], v[108:111], v[168:171]
  v_exp_f32 v71, v71
  v_mfma_f32_16x16x32_bf16 v[172:175], v[44:47], v[108:111], v[172:175]
  ds_read_b128 v[36:39], v25 offset:17408
  v_add_f32 v229, v229, v71
  v_cvt_pk_bf16_f32 v101, v70, v71
  v_mfma_f32_16x16x32_bf16 v[140:143], v[44:47], v[104:107], v[140:143]
  v_exp_f32 v76, v76
  s_waitcnt lgkmcnt(4)
  v_mfma_f32_16x16x32_bf16 v[144:147], v[48:51], v[104:107], v[144:147]
  ds_read_b128 v[40:43], v25 offset:18432
  v_add_f32 v229, v229, v76
  v_mfma_f32_16x16x32_bf16 v[176:179], v[48:51], v[108:111], v[176:179]
  v_exp_f32 v77, v77
  v_mfma_f32_16x16x32_bf16 v[180:183], v[52:55], v[108:111], v[180:183]
  ds_read_b128 v[44:47], v25 offset:19456
  v_add_f32 v229, v229, v77
  v_cvt_pk_bf16_f32 v102, v76, v77
  v_mfma_f32_16x16x32_bf16 v[148:151], v[52:55], v[104:107], v[148:151]
  v_exp_f32 v78, v78
  s_waitcnt lgkmcnt(4)
  v_mfma_f32_16x16x32_bf16 v[152:155], v[56:59], v[104:107], v[152:155]
  ds_read_b128 v[48:51], v25 offset:20480
  v_add_f32 v229, v229, v78
  v_mfma_f32_16x16x32_bf16 v[184:187], v[56:59], v[108:111], v[184:187]
  v_exp_f32 v79, v79
  v_mfma_f32_16x16x32_bf16 v[188:191], v[60:63], v[108:111], v[188:191]
  ds_read_b128 v[52:55], v25 offset:21504
  v_add_f32 v229, v229, v79
  v_cvt_pk_bf16_f32 v103, v78, v79
  v_mfma_f32_16x16x32_bf16 v[156:159], v[60:63], v[104:107], v[156:159]
  s_waitcnt vmcnt(16)
  s_barrier
  s_waitcnt lgkmcnt(4)
  v_mfma_f32_16x16x32_bf16 v[160:163], v[32:35], v[100:103], v[160:163]
  ds_read_b128 v[56:59], v25 offset:22528
  s_mov_b32 m0, s88
  s_nop 0
  buffer_load_dwordx4 v16, s[12:15], s86 offen offset:0 sc1 lds
  v_mfma_f32_16x16x32_bf16 v[164:167], v[36:39], v[100:103], v[164:167]
  ds_read_b128 v[60:63], v25 offset:23552
  buffer_load_dwordx4 v16, s[12:15], s86 offen offset:1024 sc1 lds
  s_waitcnt lgkmcnt(4)
  v_mfma_f32_16x16x32_bf16 v[168:171], v[40:43], v[100:103], v[168:171]
  buffer_load_dwordx4 v16, s[12:15], s86 offen offset:2048 sc1 lds
  v_mfma_f32_16x16x32_bf16 v[172:175], v[44:47], v[100:103], v[172:175]
  buffer_load_dwordx4 v16, s[12:15], s86 offen offset:3072 sc1 lds
  s_waitcnt lgkmcnt(2)
  v_mfma_f32_16x16x32_bf16 v[176:179], v[48:51], v[100:103], v[176:179]
  s_add_u32 m0, s88, 16384
  v_mfma_f32_16x16x32_bf16 v[180:183], v[52:55], v[100:103], v[180:183]
  s_add_u32 s86, s86, 16384
  buffer_load_dwordx4 v16, s[12:15], s87 offen offset:0 sc1 lds
  s_waitcnt lgkmcnt(0)
  v_mfma_f32_16x16x32_bf16 v[184:187], v[56:59], v[100:103], v[184:187]
  buffer_load_dwordx4 v16, s[12:15], s87 offen offset:1024 sc1 lds
  v_mfma_f32_16x16x32_bf16 v[188:191], v[60:63], v[100:103], v[188:191]
  buffer_load_dwordx4 v16, s[12:15], s87 offen offset:2048 sc1 lds
  buffer_load_dwordx4 v16, s[12:15], s87 offen offset:3072 sc1 lds
  s_add_u32 s87, s87, 16384
  s_add_u32 s88, s88, 32768
  s_sub_u32 s96, s88, 163840
  s_cselect_b32 s88, s88, s96
  s_branch F_CHK
F_HOOKB:
  s_add_u32 s92, s92, 1
  s_cmp_eq_u32 s92, 3
  s_cbranch_scc0 F_HOOKB3
  s_and_b32 s34, s28, 2
  s_mul_i32 s34, s34, 372736
  s_sub_u32 s34, 1118208, s34
  s_add_u32 s34, s34, s93
  buffer_store_dwordx4 v[240:243], v16, s[12:15], s34 offen sc1
  s_branch F_BACKB
F_HOOKB3:
  s_and_b32 s34, s28, 2
  s_mul_i32 s34, s34, 372736
  s_sub_u32 s34, 1304576, s34
  s_add_u32 s34, s34, s93
  buffer_store_dwordx4 v[248:251], v16, s[12:15], s34 offen sc1
  s_branch F_BACKB
F_CHK:
  s_nop 7
  v_mov_b32 v64, v228
  v_mov_b32 v65, v229
  s_nop 0
  v_permlane32_swap_b32 v228, v64
  v_permlane32_swap_b32 v229, v65
  v_add_f32 v228, v228, v64
  v_add_f32 v229, v229, v65
  v_mov_b32 v64, v228
  v_mov_b32 v65, v229
  s_nop 0
  v_permlane16_swap_b32 v228, v64
  v_permlane16_swap_b32 v229, v65
  v_add_f32 v228, v228, v64
  v_add_f32 v229, v229, v65
  s_mov_b32 s33, 0x5f800000
  v_cmp_nlt_f32 vcc, v228, s33
  v_cmp_nlt_f32 s[100:101], v229, s33
  s_nop 0
  s_or_b64 vcc, vcc, s[100:101]
  s_cbranch_scc1 F_SLOW
F_EPI:
  s_waitcnt vmcnt(16)
  v_rcp_f32 v64, v228
  v_rcp_f32 v65, v229
  v_mul_f32 v64, v64, v26
  v_mul_f32 v65, v65, v27
  s_mul_i32 s33, s89, 186368
  s_lshl_b32 s34, s80, 12
  s_add_u32 s33, s33, s34
  s_add_u32 s33, s33, 33554432
  v_mul_f32 v128, v64, v128
  v_mul_f32 v129, v64, v129
  v_mul_f32 v130, v64, v130
  v_mul_f32 v131, v64, v131
  v_mul_f32 v132, v64, v132
  v_mul_f32 v133, v64, v133
  v_mul_f32 v134, v64, v134
  v_mul_f32 v135, v64, v135
  v_cvt_pk_bf16_f32 v128, v128, v129
  v_cvt_pk_bf16_f32 v129, v130, v131
  v_cvt_pk_bf16_f32 v130, v132, v133
  v_cvt_pk_bf16_f32 v131, v134, v135
  buffer_store_dwordx4 v[128:131], v16, s[12:15], s33 offen offset:0 sc1
  v_mul_f32 v136, v64, v136
  v_mul_f32 v137, v64, v137
  v_mul_f32 v138, v64, v138
  v_mul_f32 v139, v64, v139
  v_mul_f32 v140, v64, v140
  v_mul_f32 v141, v64, v141
  v_mul_f32 v142, v64, v142
  v_mul_f32 v143, v64, v143
  v_cvt_pk_bf16_f32 v136, v136, v137
  v_cvt_pk_bf16_f32 v137, v138, v139
  v_cvt_pk_bf16_f32 v138, v140, v141
  v_cvt_pk_bf16_f32 v139, v142, v143
  buffer_store_dwordx4 v[136:139], v16, s[12:15], s33 offen offset:1024 sc1
  v_mul_f32 v144, v64, v144
  v_mul_f32 v145, v64, v145
  v_mul_f32 v146, v64, v146
  v_mul_f32 v147, v64, v147
  v_mul_f32 v148, v64, v148
  v_mul_f32 v149, v64, v149
  v_mul_f32 v150, v64, v150
  v_mul_f32 v151, v64, v151
  v_cvt_pk_bf16_f32 v144, v144, v145
  v_cvt_pk_bf16_f32 v145, v146, v147
  v_cvt_pk_bf16_f32 v146, v148, v149
  v_cvt_pk_bf16_f32 v147, v150, v151
  buffer_store_dwordx4 v[144:147], v16, s[12:15], s33 offen offset:2048 sc1
  v_mul_f32 v152, v64, v152
  v_mul_f32 v153, v64, v153
  v_mul_f32 v154, v64, v154
  v_mul_f32 v155, v64, v155
  v_mul_f32 v156, v64, v156
  v_mul_f32 v157, v64, v157
  v_mul_f32 v158, v64, v158
  v_mul_f32 v159, v64, v159
  v_cvt_pk_bf16_f32 v152, v152, v153
  v_cvt_pk_bf16_f32 v153, v154, v155
  v_cvt_pk_bf16_f32 v154, v156, v157
  v_cvt_pk_bf16_f32 v155, v158, v159
  buffer_store_dwordx4 v[152:155], v16, s[12:15], s33 offen offset:3072 sc1
  s_mul_i32 s33, s90, 186368
  s_lshl_b32 s34, s80, 12
  s_add_u32 s33, s33, s34
  s_add_u32 s33, s33, 33554432
  v_mul_f32 v160, v65, v160
  v_mul_f32 v161, v65, v161
  v_mul_f32 v162, v65, v162
  v_mul_f32 v163, v65, v163
  v_mul_f32 v164, v65, v164
  v_mul_f32 v165, v65, v165
  v_mul_f32 v166, v65, v166
  v_mul_f32 v167, v65, v167
  v_cvt_pk_bf16_f32 v160, v160, v161
  v_cvt_pk_bf16_f32 v161, v162, v163
  v_cvt_pk_bf16_f32 v162, v164, v165
  v_cvt_pk_bf16_f32 v163, v166, v167
  buffer_store_dwordx4 v[160:163], v16, s[12:15], s33 offen offset:0 sc1
  v_mul_f32 v168, v65, v168
  v_mul_f32 v169, v65, v169
  v_mul_f32 v170, v65, v170
  v_mul_f32 v171, v65, v171
  v_mul_f32 v172, v65, v172
  v_mul_f32 v173, v65, v173
  v_mul_f32 v174, v65, v174
  v_mul_f32 v175, v65, v175
  v_cvt_pk_bf16_f32 v168, v168, v169
  v_cvt_pk_bf16_f32 v169, v170, v171
  v_cvt_pk_bf16_f32 v170, v172, v173
  v_cvt_pk_bf16_f32 v171, v174, v175
  buffer_store_dwordx4 v[168:171], v16, s[12:15], s33 offen offset:1024 sc1
  v_mul_f32 v176, v65, v176
  v_mul_f32 v177, v65, v177
  v_mul_f32 v178, v65, v178
  v_mul_f32 v179, v65, v179
  v_mul_f32 v180, v65, v180
  v_mul_f32 v181, v65, v181
  v_mul_f32 v182, v65, v182
  v_mul_f32 v183, v65, v183
  v_cvt_pk_bf16_f32 v176, v176, v177
  v_cvt_pk_bf16_f32 v177, v178, v179
  v_cvt_pk_bf16_f32 v178, v180, v181
  v_cvt_pk_bf16_f32 v179, v182, v183
  buffer_store_dwordx4 v[176:179], v16, s[12:15], s33 offen offset:2048 sc1
  v_mul_f32 v184, v65, v184
  v_mul_f32 v185, v65, v185
  v_mul_f32 v186, v65, v186
  v_mul_f32 v187, v65, v187
  v_mul_f32 v188, v65, v188
  v_mul_f32 v189, v65, v189
  v_mul_f32 v190, v65, v190
  v_mul_f32 v191, v65, v191
  v_cvt_pk_bf16_f32 v184, v184, v185
  v_cvt_pk_bf16_f32 v185, v186, v187
  v_cvt_pk_bf16_f32 v186, v188, v189
  v_cvt_pk_bf16_f32 v187, v190, v191
  buffer_store_dwordx4 v[184:187], v16, s[12:15], s33 offen offset:3072 sc1
  s_cmp_eq_u32 s95, 0
  s_cbranch_scc1 F_P3
  s_cmp_gt_u32 s92, 1
  s_cbranch_scc1 F_HB1
  s_add_u32 s34, s93, 186368
  buffer_store_dwordx4 v[232:235], v16, s[12:15], s34 offen sc1
F_HB1:
  s_cmp_gt_u32 s92, 2
  s_cbranch_scc1 F_HB2
  s_and_b32 s34, s28, 2
  s_mul_i32 s34, s34, 372736
  s_sub_u32 s34, 1118208, s34
  s_add_u32 s34, s34, s93
  buffer_store_dwordx4 v[240:243], v16, s[12:15], s34 offen sc1
F_HB2:
  s_cmp_gt_u32 s92, 3
  s_cbranch_scc1 F_HB3
  s_and_b32 s34, s28, 2
  s_mul_i32 s34, s34, 372736
  s_sub_u32 s34, 1304576, s34
  s_add_u32 s34, s34, s93
  buffer_store_dwordx4 v[248:251], v16, s[12:15], s34 offen sc1
F_HB3:
  s_mov_b32 s91, s82
  s_sub_u32 s83, s83, 1
  s_sub_u32 s84, s83, 1
  s_setprio 0
F_DMAL:
  s_cmp_ge_u32 s91, s84
  s_cbranch_scc1 F_DMAE
  s_add_u32 s33, s91, 3
  s_cmp_le_u32 s33, s83
  s_cbranch_scc1 F_DMA1
F_ET:
  s_sub_u32 s34, 15, s65
  s_min_u32 s34, s34, s65
  s_lshl_b32 s34, s34, 7
  s_add_u32 s34, s34, 87051264
F_HPOLL2:
  buffer_load_dword v12, off, s[12:15], s34 sc1
  s_waitcnt vmcnt(0)
  v_readfirstlane_b32 s33, v12
  s_nop 0
  s_cmp_lt_u32 s33, 32
  s_cbranch_scc1 F_HPOLL2
  s_barrier
  s_cmp_eq_u32 s28, 4
  s_cbranch_scc0 F_CF0b
  s_lshl_b32 s33, s31, 2
  s_add_u32 s33, s33, s64
  s_lshl_b32 s33, s33, 7
  s_add_u32 s33, s33, 87031808
  v_mov_b32 v12, 4
  s_mov_b64 exec, 1
  buffer_atomic_add v12, off, s[12:15], s33 sc1
  s_mov_b64 exec, -1
F_CF0b:
  s_add_u32 m0, s69, 0
  s_nop 0
  buffer_load_dwordx4 v17, s[4:7], s70 offen offset:0 lds
  buffer_load_dwordx4 v18, s[4:7], s70 offen offset:1024 lds
  buffer_load_dwordx4 v19, s[4:7], s70 offen offset:2048 lds
  buffer_load_dwordx4 v20, s[4:7], s70 offen offset:3072 lds
  s_add_u32 m0, s69, 4096
  s_nop 0
  buffer_load_dwordx4 v21, s[4:7], s70 offen lds
  s_sub_u32 s70, s70, 81920
  s_add_u32 m0, s69, 4294946816
  s_nop 0
  buffer_load_dwordx4 v17, s[4:7], s70 offen offset:0 lds
  buffer_load_dwordx4 v18, s[4:7], s70 offen offset:1024 lds
  buffer_load_dwordx4 v19, s[4:7], s70 offen offset:2048 lds
  buffer_load_dwordx4 v20, s[4:7], s70 offen offset:3072 lds
  s_add_u32 m0, s69, 4294950912
  s_nop 0
  buffer_load_dwordx4 v21, s[4:7], s70 offen lds
  s_add_u32 s70, s70, 81920
  s_add_u32 s70, s70, 163840
  buffer_load_dwordx4 v[232:235], v16, s[12:15], s72 offen offset:0 sc1
  buffer_load_dwordx4 v[236:239], v16, s[12:15], s73 offen offset:0 sc1
  buffer_load_dwordx4 v[240:243], v16, s[12:15], s72 offen offset:2048 sc1
  buffer_load_dwordx4 v[244:247], v16, s[12:15], s73 offen offset:2048 sc1
  s_add_u32 s72, s72, 4096
  s_add_u32 s73, s73, 4096
  buffer_load_dwordx4 v[248:251], v16, s[12:15], s72 offen offset:0 sc1
  buffer_load_dwordx4 v[252:255], v16, s[12:15], s73 offen offset:0 sc1
  buffer_load_dword v8, v11, s[12:15], s76 offen offset:4 sc1
  s_xor_b32 s76, s76, 128
  buffer_load_dword v9, v11, s[12:15], s76 offen offset:4 sc1
  s_barrier
  s_add_u32 m0, s69, 40960
  s_nop 0
  buffer_load_dwordx4 v17, s[4:7], s70 offen offset:0 lds
  buffer_load_dwordx4 v18, s[4:7], s70 offen offset:1024 lds
  buffer_load_dwordx4 v19, s[4:7], s70 offen offset:2048 lds
  buffer_load_dwordx4 v20, s[4:7], s70 offen offset:3072 lds
  s_add_u32 m0, s69, 45056
  s_nop 0
  buffer_load_dwordx4 v21, s[4:7], s70 offen lds
  s_sub_u32 s70, s70, 81920
  s_add_u32 m0, s69, 20480
  s_nop 0
  buffer_load_dwordx4 v17, s[4:7], s70 offen offset:0 lds
  buffer_load_dwordx4 v18, s[4:7], s70 offen offset:1024 lds
  buffer_load_dwordx4 v19, s[4:7], s70 offen offset:2048 lds
  buffer_load_dwordx4 v20, s[4:7], s70 offen offset:3072 lds
  s_add_u32 m0, s69, 24576
  s_nop 0
  buffer_load_dwordx4 v21, s[4:7], s70 offen lds
  s_add_u32 s70, s70, 81920
  s_add_u32 s70, s70, 163840
  s_waitcnt vmcnt(0)
  s_branch F_P3
F_DMA1:
  s_waitcnt vmcnt(16)
  s_barrier
  s_add_u32 s91, s91, 1
  s_cmp_ge_u32 s33, s83
  s_cbranch_scc1 F_DMAL
  s_mov_b32 m0, s88
  s_nop 0
  buffer_load_dwordx4 v16, s[12:15], s86 offen offset:0 sc1 lds
  buffer_load_dwordx4 v16, s[12:15], s86 offen offset:1024 sc1 lds
  buffer_load_dwordx4 v16, s[12:15], s86 offen offset:2048 sc1 lds
  buffer_load_dwordx4 v16, s[12:15], s86 offen offset:3072 sc1 lds
  s_add_u32 m0, s88, 16384
  s_add_u32 s86, s86, 16384
  buffer_load_dwordx4 v16, s[12:15], s87 offen offset:0 sc1 lds
  buffer_load_dwordx4 v16, s[12:15], s87 offen offset:1024 sc1 lds
  buffer_load_dwordx4 v16, s[12:15], s87 offen offset:2048 sc1 lds
  buffer_load_dwordx4 v16, s[12:15], s87 offen offset:3072 sc1 lds
  s_add_u32 s87, s87, 16384
  s_add_u32 s88, s88, 32768
  s_sub_u32 s96, s88, 163840
  s_cselect_b32 s88, s88, s96
  s_branch F_DMAL
F_DMAE:
  s_sub_u32 s34, 15, s65
  s_min_u32 s34, s34, s65
  s_lshl_b32 s34, s34, 7
  s_add_u32 s34, s34, 87051264
F_HPOLL:
  buffer_load_dword v12, off, s[12:15], s34 sc1
  s_waitcnt vmcnt(0)
  v_readfirstlane_b32 s33, v12
  s_nop 0
  s_cmp_lt_u32 s33, 32
  s_cbranch_scc1 F_HPOLL
  s_barrier
  s_cmp_eq_u32 s28, 4
  s_cbranch_scc0 F_CF0
  s_lshl_b32 s33, s31, 2
  s_add_u32 s33, s33, s64
  s_lshl_b32 s33, s33, 7
  s_add_u32 s33, s33, 87031808
  v_mov_b32 v12, 4
  s_mov_b64 exec, 1
  buffer_atomic_add v12, off, s[12:15], s33 sc1
  s_mov_b64 exec, -1
F_CF0:
  s_add_u32 m0, s69, 0
  s_nop 0
  buffer_load_dwordx4 v17, s[4:7], s70 offen offset:0 lds
  buffer_load_dwordx4 v18, s[4:7], s70 offen offset:1024 lds
  buffer_load_dwordx4 v19, s[4:7], s70 offen offset:2048 lds
  buffer_load_dwordx4 v20, s[4:7], s70 offen offset:3072 lds
  s_add_u32 m0, s69, 4096
  s_nop 0
  buffer_load_dwordx4 v21, s[4:7], s70 offen lds
  s_sub_u32 s70, s70, 81920
  s_add_u32 m0, s69, 4294946816
  s_nop 0
  buffer_load_dwordx4 v17, s[4:7], s70 offen offset:0 lds
  buffer_load_dwordx4 v18, s[4:7], s70 offen offset:1024 lds
  buffer_load_dwordx4 v19, s[4:7], s70 offen offset:2048 lds
  buffer_load_dwordx4 v20, s[4:7], s70 offen offset:3072 lds
  s_add_u32 m0, s69, 4294950912
  s_nop 0
  buffer_load_dwordx4 v21, s[4:7], s70 offen lds
  s_add_u32 s70, s70, 81920
  s_add_u32 s70, s70, 163840
  buffer_load_dwordx4 v[232:235], v16, s[12:15], s72 offen offset:0 sc1
  buffer_load_dwordx4 v[236:239], v16, s[12:15], s73 offen offset:0 sc1
  buffer_load_dwordx4 v[240:243], v16, s[12:15], s72 offen offset:2048 sc1
  buffer_load_dwordx4 v[244:247], v16, s[12:15], s73 offen offset:2048 sc1
  s_add_u32 s72, s72, 4096
  s_add_u32 s73, s73, 4096
  buffer_load_dwordx4 v[248:251], v16, s[12:15], s72 offen offset:0 sc1
  buffer_load_dwordx4 v[252:255], v16, s[12:15], s73 offen offset:0 sc1
  buffer_load_dword v8, v11, s[12:15], s76 offen offset:4 sc1
  s_xor_b32 s76, s76, 128
  buffer_load_dword v9, v11, s[12:15], s76 offen offset:4 sc1
  s_add_u32 m0, s69, 40960
  s_nop 0
  buffer_load_dwordx4 v17, s[4:7], s70 offen offset:0 lds
  buffer_load_dwordx4 v18, s[4:7], s70 offen offset:1024 lds
  buffer_load_dwordx4 v19, s[4:7], s70 offen offset:2048 lds
  buffer_load_dwordx4 v20, s[4:7], s70 offen offset:3072 lds
  s_add_u32 m0, s69, 45056
  s_nop 0
  buffer_load_dwordx4 v21, s[4:7], s70 offen lds
  s_sub_u32 s70, s70, 81920
  s_add_u32 m0, s69, 20480
  s_nop 0
  buffer_load_dwordx4 v17, s[4:7], s70 offen offset:0 lds
  buffer_load_dwordx4 v18, s[4:7], s70 offen offset:1024 lds
  buffer_load_dwordx4 v19, s[4:7], s70 offen offset:2048 lds
  buffer_load_dwordx4 v20, s[4:7], s70 offen offset:3072 lds
  s_add_u32 m0, s69, 24576
  s_nop 0
  buffer_load_dwordx4 v21, s[4:7], s70 offen lds
  s_add_u32 s70, s70, 81920
  s_add_u32 s70, s70, 163840
  s_waitcnt vmcnt(0)
  s_branch F_P3
F_SLOW:
  s_lshl_b32 s85, s80, 19
  s_lshl_b32 s94, s82, 1
  v_bfe_u32 v85, v16, 4, 4
  v_bfe_u32 v86, v16, 8, 2
  v_lshlrev_b32 v86, 2, v86
  v_sub_u32 v85, v85, v86
  s_lshl_b32 s33, s89, 4
  v_add_u32 v80, s33, v85
  s_lshl_b32 s33, s90, 4
  v_add_u32 v81, s33, v85
  v_mov_b32 v84, 0xf149f2ca
  v_mov_b32 v82, v84
  v_mov_b32 v83, v84
F_SL1:
  s_add_u32 s33, s85, 4096
  buffer_load_dwordx4 v[32:35], v16, s[12:15], s85 offen offset:0 sc1
  buffer_load_dwordx4 v[36:39], v16, s[12:15], s85 offen offset:1024 sc1
  buffer_load_dwordx4 v[40:43], v16, s[12:15], s85 offen offset:2048 sc1
  buffer_load_dwordx4 v[44:47], v16, s[12:15], s85 offen offset:3072 sc1
  buffer_load_dwordx4 v[48:51], v16, s[12:15], s33 offen offset:0 sc1
  buffer_load_dwordx4 v[52:55], v16, s[12:15], s33 offen offset:1024 sc1
  buffer_load_dwordx4 v[56:59], v16, s[12:15], s33 offen offset:2048 sc1
  buffer_load_dwordx4 v[60:63], v16, s[12:15], s33 offen offset:3072 sc1
  s_waitcnt vmcnt(7)
  v_mfma_f32_16x16x32_bf16 v[64:67], v[32:35], v[192:195], 0
  v_mfma_f32_16x16x32_bf16 v[68:71], v[32:35], v[208:211], 0
  s_waitcnt vmcnt(6)
  v_mfma_f32_16x16x32_bf16 v[64:67], v[36:39], v[196:199], v[64:67]
  v_mfma_f32_16x16x32_bf16 v[68:71], v[36:39], v[212:215], v[68:71]
  s_waitcnt vmcnt(5)
  v_mfma_f32_16x16x32_bf16 v[64:67], v[40:43], v[200:203], v[64:67]
  v_mfma_f32_16x16x32_bf16 v[68:71], v[40:43], v[216:219], v[68:71]
  s_waitcnt vmcnt(4)
  v_mfma_f32_16x16x32_bf16 v[64:67], v[44:47], v[204:207], v[64:67]
  v_mfma_f32_16x16x32_bf16 v[68:71], v[44:47], v[220:223], v[68:71]
  s_waitcnt vmcnt(3)
  v_mfma_f32_16x16x32_bf16 v[72:75], v[48:51], v[192:195], 0
  v_mfma_f32_16x16x32_bf16 v[76:79], v[48:51], v[208:211], 0
  s_waitcnt vmcnt(2)
  v_mfma_f32_16x16x32_bf16 v[72:75], v[52:55], v[196:199], v[72:75]
  v_mfma_f32_16x16x32_bf16 v[76:79], v[52:55], v[212:215], v[76:79]
  s_waitcnt vmcnt(1)
  v_mfma_f32_16x16x32_bf16 v[72:75], v[56:59], v[200:203], v[72:75]
  v_mfma_f32_16x16x32_bf16 v[76:79], v[56:59], v[216:219], v[76:79]
  s_waitcnt vmcnt(0)
  v_mfma_f32_16x16x32_bf16 v[72:75], v[60:63], v[204:207], v[72:75]
  v_mfma_f32_16x16x32_bf16 v[76:79], v[60:63], v[220:223], v[76:79]
  v_cmp_le_i32 vcc, 0, v80
  s_nop 1
  v_cndmask_b32 v64, v84, v64, vcc
  v_cmp_le_i32 vcc, 1, v80
  s_nop 1
  v_cndmask_b32 v65, v84, v65, vcc
  v_cmp_le_i32 vcc, 2, v80
  s_nop 1
  v_cndmask_b32 v66, v84, v66, vcc
  v_cmp_le_i32 vcc, 3, v80
  s_nop 1
  v_cndmask_b32 v67, v84, v67, vcc
  v_cmp_le_i32 vcc, 0, v81
  s_nop 1
  v_cndmask_b32 v68, v84, v68, vcc
  v_cmp_le_i32 vcc, 1, v81
  s_nop 1
  v_cndmask_b32 v69, v84, v69, vcc
  v_cmp_le_i32 vcc, 2, v81
  s_nop 1
  v_cndmask_b32 v70, v84, v70, vcc
  v_cmp_le_i32 vcc, 3, v81
  s_nop 1
  v_cndmask_b32 v71, v84, v71, vcc
  v_cmp_le_i32 vcc, 16, v80
  s_nop 1
  v_cndmask_b32 v72, v84, v72, vcc
  v_cmp_le_i32 vcc, 17, v80
  s_nop 1
  v_cndmask_b32 v73, v84, v73, vcc
  v_cmp_le_i32 vcc, 18, v80
  s_nop 1
  v_cndmask_b32 v74, v84, v74, vcc
  v_cmp_le_i32 vcc, 19, v80
  s_nop 1
  v_cndmask_b32 v75, v84, v75, vcc
  v_cmp_le_i32 vcc, 16, v81
  s_nop 1
  v_cndmask_b32 v76, v84, v76, vcc
  v_cmp_le_i32 vcc, 17, v81
  s_nop 1
  v_cndmask_b32 v77, v84, v77, vcc
  v_cmp_le_i32 vcc, 18, v81
  s_nop 1
  v_cndmask_b32 v78, v84, v78, vcc
  v_cmp_le_i32 vcc, 19, v81
  s_nop 1
  v_cndmask_b32 v79, v84, v79, vcc
  v_add_u32 v80, -32, v80
  v_add_u32 v81, -32, v81
  v_max3_f32 v82, v82, v64, v65
  v_max3_f32 v82, v82, v66, v67
  v_max3_f32 v83, v83, v68, v69
  v_max3_f32 v83, v83, v70, v71
  v_max3_f32 v82, v82, v72, v73
  v_max3_f32 v82, v82, v74, v75
  v_max3_f32 v83, v83, v76, v77
  v_max3_f32 v83, v83, v78, v79
  s_add_u32 s85, s85, 8192
  s_sub_u32 s94, s94, 1
  s_cmp_lg_u32 s94, 0
  s_cbranch_scc1 F_SL1
  v_mov_b32 v64, v82
  v_mov_b32 v65, v83
  s_nop 0
  v_permlane32_swap_b32 v82, v64
  v_permlane32_swap_b32 v83, v65
  v_max_f32 v82, v82, v64
  v_max_f32 v83, v83, v65
  v_mov_b32 v64, v82
  v_mov_b32 v65, v83
  s_nop 0
  v_permlane16_swap_b32 v82, v64
  v_permlane16_swap_b32 v83, v65
  v_max_f32 v82, v82, v64
  v_max_f32 v83, v83, v65
  s_lshl_b32 s85, s80, 19
  s_lshl_b32 s94, s82, 1
  v_bfe_u32 v85, v16, 4, 4
  v_bfe_u32 v86, v16, 8, 2
  v_lshlrev_b32 v86, 2, v86
  v_sub_u32 v85, v85, v86
  s_lshl_b32 s33, s89, 4
  v_add_u32 v80, s33, v85
  s_lshl_b32 s33, s90, 4
  v_add_u32 v81, s33, v85
  v_mov_b32 v128, 0
  v_mov_b32 v129, 0
  v_mov_b32 v130, 0
  v_mov_b32 v131, 0
  v_mov_b32 v132, 0
  v_mov_b32 v133, 0
  v_mov_b32 v134, 0
  v_mov_b32 v135, 0
  v_mov_b32 v136, 0
  v_mov_b32 v137, 0
  v_mov_b32 v138, 0
  v_mov_b32 v139, 0
  v_mov_b32 v140, 0
  v_mov_b32 v141, 0
  v_mov_b32 v142, 0
  v_mov_b32 v143, 0
  v_mov_b32 v144, 0
  v_mov_b32 v145, 0
  v_mov_b32 v146, 0
  v_mov_b32 v147, 0
  v_mov_b32 v148, 0
  v_mov_b32 v149, 0
  v_mov_b32 v150, 0
  v_mov_b32 v151, 0
  v_mov_b32 v152, 0
  v_mov_b32 v153, 0
  v_mov_b32 v154, 0
  v_mov_b32 v155, 0
  v_mov_b32 v156, 0
  v_mov_b32 v157, 0
  v_mov_b32 v158, 0
  v_mov_b32 v159, 0
  v_mov_b32 v160, 0
  v_mov_b32 v161, 0
  v_mov_b32 v162, 0
  v_mov_b32 v163, 0
  v_mov_b32 v164, 0
  v_mov_b32 v165, 0
  v_mov_b32 v166, 0
  v_mov_b32 v167, 0
  v_mov_b32 v168, 0
  v_mov_b32 v169, 0
  v_mov_b32 v170, 0
  v_mov_b32 v171, 0
  v_mov_b32 v172, 0
  v_mov_b32 v173, 0
  v_mov_b32 v174, 0
  v_mov_b32 v175, 0
  v_mov_b32 v176, 0
  v_mov_b32 v177, 0
  v_mov_b32 v178, 0
  v_mov_b32 v179, 0
  v_mov_b32 v180, 0
  v_mov_b32 v181, 0
  v_mov_b32 v182, 0
  v_mov_b32 v183, 0
  v_mov_b32 v184, 0
  v_mov_b32 v185, 0
  v_mov_b32 v186, 0
  v_mov_b32 v187, 0
  v_mov_b32 v188, 0
  v_mov_b32 v189, 0
  v_mov_b32 v190, 0
  v_mov_b32 v191, 0
  v_mov_b32 v228, 0
  v_mov_b32 v229, 0
F_SL2:
  s_add_u32 s33, s85, 4096
  buffer_load_dwordx4 v[32:35], v16, s[12:15], s85 offen offset:0 sc1
  buffer_load_dwordx4 v[36:39], v16, s[12:15], s85 offen offset:1024 sc1
  buffer_load_dwordx4 v[40:43], v16, s[12:15], s85 offen offset:2048 sc1
  buffer_load_dwordx4 v[44:47], v16, s[12:15], s85 offen offset:3072 sc1
  buffer_load_dwordx4 v[48:51], v16, s[12:15], s33 offen offset:0 sc1
  buffer_load_dwordx4 v[52:55], v16, s[12:15], s33 offen offset:1024 sc1
  buffer_load_dwordx4 v[56:59], v16, s[12:15], s33 offen offset:2048 sc1
  buffer_load_dwordx4 v[60:63], v16, s[12:15], s33 offen offset:3072 sc1
  s_waitcnt vmcnt(7)
  v_mfma_f32_16x16x32_bf16 v[64:67], v[32:35], v[192:195], 0
  v_mfma_f32_16x16x32_bf16 v[68:71], v[32:35], v[208:211], 0
  s_waitcnt vmcnt(6)
  v_mfma_f32_16x16x32_bf16 v[64:67], v[36:39], v[196:199], v[64:67]
  v_mfma_f32_16x16x32_bf16 v[68:71], v[36:39], v[212:215], v[68:71]
  s_waitcnt vmcnt(5)
  v_mfma_f32_16x16x32_bf16 v[64:67], v[40:43], v[200:203], v[64:67]
  v_mfma_f32_16x16x32_bf16 v[68:71], v[40:43], v[216:219], v[68:71]
  s_waitcnt vmcnt(4)
  v_mfma_f32_16x16x32_bf16 v[64:67], v[44:47], v[204:207], v[64:67]
  v_mfma_f32_16x16x32_bf16 v[68:71], v[44:47], v[220:223], v[68:71]
  s_waitcnt vmcnt(3)
  v_mfma_f32_16x16x32_bf16 v[72:75], v[48:51], v[192:195], 0
  v_mfma_f32_16x16x32_bf16 v[76:79], v[48:51], v[208:211], 0
  s_waitcnt vmcnt(2)
  v_mfma_f32_16x16x32_bf16 v[72:75], v[52:55], v[196:199], v[72:75]
  v_mfma_f32_16x16x32_bf16 v[76:79], v[52:55], v[212:215], v[76:79]
  s_waitcnt vmcnt(1)
  v_mfma_f32_16x16x32_bf16 v[72:75], v[56:59], v[200:203], v[72:75]
  v_mfma_f32_16x16x32_bf16 v[76:79], v[56:59], v[216:219], v[76:79]
  s_waitcnt vmcnt(0)
  v_mfma_f32_16x16x32_bf16 v[72:75], v[60:63], v[204:207], v[72:75]
  v_mfma_f32_16x16x32_bf16 v[76:79], v[60:63], v[220:223], v[76:79]
  s_add_u32 s33, s85, 16777216
  s_add_u32 s34, s33, 4096
  v_cmp_le_i32 vcc, 0, v80
  s_nop 1
  v_cndmask_b32 v64, v84, v64, vcc
  v_cmp_le_i32 vcc, 1, v80
  s_nop 1
  v_cndmask_b32 v65, v84, v65, vcc
  v_cmp_le_i32 vcc, 2, v80
  s_nop 1
  v_cndmask_b32 v66, v84, v66, vcc
  v_cmp_le_i32 vcc, 3, v80
  s_nop 1
  v_cndmask_b32 v67, v84, v67, vcc
  v_cmp_le_i32 vcc, 0, v81
  s_nop 1
  v_cndmask_b32 v68, v84, v68, vcc
  v_cmp_le_i32 vcc, 1, v81
  s_nop 1
  v_cndmask_b32 v69, v84, v69, vcc
  v_cmp_le_i32 vcc, 2, v81
  s_nop 1
  v_cndmask_b32 v70, v84, v70, vcc
  v_cmp_le_i32 vcc, 3, v81
  s_nop 1
  v_cndmask_b32 v71, v84, v71, vcc
  v_cmp_le_i32 vcc, 16, v80
  s_nop 1
  v_cndmask_b32 v72, v84, v72, vcc
  v_cmp_le_i32 vcc, 17, v80
  s_nop 1
  v_cndmask_b32 v73, v84, v73, vcc
  v_cmp_le_i32 vcc, 18, v80
  s_nop 1
  v_cndmask_b32 v74, v84, v74, vcc
  v_cmp_le_i32 vcc, 19, v80
  s_nop 1
  v_cndmask_b32 v75, v84, v75, vcc
  v_cmp_le_i32 vcc, 16, v81
  s_nop 1
  v_cndmask_b32 v76, v84, v76, vcc
  v_cmp_le_i32 vcc, 17, v81
  s_nop 1
  v_cndmask_b32 v77, v84, v77, vcc
  v_cmp_le_i32 vcc, 18, v81
  s_nop 1
  v_cndmask_b32 v78, v84, v78, vcc
  v_cmp_le_i32 vcc, 19, v81
  s_nop 1
  v_cndmask_b32 v79, v84, v79, vcc
  v_add_u32 v80, -32, v80
  v_add_u32 v81, -32, v81
  buffer_load_dwordx4 v[32:35], v16, s[12:15], s33 offen offset:0 sc1
  buffer_load_dwordx4 v[36:39], v16, s[12:15], s33 offen offset:1024 sc1
  buffer_load_dwordx4 v[40:43], v16, s[12:15], s33 offen offset:2048 sc1
  buffer_load_dwordx4 v[44:47], v16, s[12:15], s33 offen offset:3072 sc1
  buffer_load_dwordx4 v[48:51], v16, s[12:15], s34 offen offset:0 sc1
  buffer_load_dwordx4 v[52:55], v16, s[12:15], s34 offen offset:1024 sc1
  buffer_load_dwordx4 v[56:59], v16, s[12:15], s34 offen offset:2048 sc1
  buffer_load_dwordx4 v[60:63], v16, s[12:15], s34 offen offset:3072 sc1
  v_sub_f32 v64, v64, v82
  v_sub_f32 v65, v65, v82
  v_sub_f32 v66, v66, v82
  v_sub_f32 v67, v67, v82
  v_exp_f32 v64, v64
  v_exp_f32 v65, v65
  v_exp_f32 v66, v66
  v_exp_f32 v67, v67
  v_add_f32 v228, v228, v64
  v_add_f32 v228, v228, v65
  v_add_f32 v228, v228, v66
  v_add_f32 v228, v228, v67
  v_cvt_pk_bf16_f32 v96, v64, v65
  v_cvt_pk_bf16_f32 v97, v66, v67
  v_sub_f32 v68, v68, v83
  v_sub_f32 v69, v69, v83
  v_sub_f32 v70, v70, v83
  v_sub_f32 v71, v71, v83
  v_exp_f32 v68, v68
  v_exp_f32 v69, v69
  v_exp_f32 v70, v70
  v_exp_f32 v71, v71
  v_add_f32 v229, v229, v68
  v_add_f32 v229, v229, v69
  v_add_f32 v229, v229, v70
  v_add_f32 v229, v229, v71
  v_cvt_pk_bf16_f32 v100, v68, v69
  v_cvt_pk_bf16_f32 v101, v70, v71
  v_sub_f32 v72, v72, v82
  v_sub_f32 v73, v73, v82
  v_sub_f32 v74, v74, v82
  v_sub_f32 v75, v75, v82
  v_exp_f32 v72, v72
  v_exp_f32 v73, v73
  v_exp_f32 v74, v74
  v_exp_f32 v75, v75
  v_add_f32 v228, v228, v72
  v_add_f32 v228, v228, v73
  v_add_f32 v228, v228, v74
  v_add_f32 v228, v228, v75
  v_cvt_pk_bf16_f32 v98, v72, v73
  v_cvt_pk_bf16_f32 v99, v74, v75
  v_sub_f32 v76, v76, v83
  v_sub_f32 v77, v77, v83
  v_sub_f32 v78, v78, v83
  v_sub_f32 v79, v79, v83
  v_exp_f32 v76, v76
  v_exp_f32 v77, v77
  v_exp_f32 v78, v78
  v_exp_f32 v79, v79
  v_add_f32 v229, v229, v76
  v_add_f32 v229, v229, v77
  v_add_f32 v229, v229, v78
  v_add_f32 v229, v229, v79
  v_cvt_pk_bf16_f32 v102, v76, v77
  v_cvt_pk_bf16_f32 v103, v78, v79
  s_waitcnt vmcnt(7)
  v_mfma_f32_16x16x32_bf16 v[128:131], v[32:35], v[96:99], v[128:131]
  v_mfma_f32_16x16x32_bf16 v[160:163], v[32:35], v[100:103], v[160:163]
  s_waitcnt vmcnt(6)
  v_mfma_f32_16x16x32_bf16 v[132:135], v[36:39], v[96:99], v[132:135]
  v_mfma_f32_16x16x32_bf16 v[164:167], v[36:39], v[100:103], v[164:167]
  s_waitcnt vmcnt(5)
  v_mfma_f32_16x16x32_bf16 v[136:139], v[40:43], v[96:99], v[136:139]
  v_mfma_f32_16x16x32_bf16 v[168:171], v[40:43], v[100:103], v[168:171]
  s_waitcnt vmcnt(4)
  v_mfma_f32_16x16x32_bf16 v[140:143], v[44:47], v[96:99], v[140:143]
  v_mfma_f32_16x16x32_bf16 v[172:175], v[44:47], v[100:103], v[172:175]
  s_waitcnt vmcnt(3)
  v_mfma_f32_16x16x32_bf16 v[144:147], v[48:51], v[96:99], v[144:147]
  v_mfma_f32_16x16x32_bf16 v[176:179], v[48:51], v[100:103], v[176:179]
  s_waitcnt vmcnt(2)
  v_mfma_f32_16x16x32_bf16 v[148:151], v[52:55], v[96:99], v[148:151]
  v_mfma_f32_16x16x32_bf16 v[180:183], v[52:55], v[100:103], v[180:183]
  s_waitcnt vmcnt(1)
  v_mfma_f32_16x16x32_bf16 v[152:155], v[56:59], v[96:99], v[152:155]
  v_mfma_f32_16x16x32_bf16 v[184:187], v[56:59], v[100:103], v[184:187]
  s_waitcnt vmcnt(0)
  v_mfma_f32_16x16x32_bf16 v[156:159], v[60:63], v[96:99], v[156:159]
  v_mfma_f32_16x16x32_bf16 v[188:191], v[60:63], v[100:103], v[188:191]
  s_add_u32 s85, s85, 8192
  s_sub_u32 s94, s94, 1
  s_cmp_lg_u32 s94, 0
  s_nop 7
  s_cbranch_scc1 F_SL2
  v_mov_b32 v64, v228
  v_mov_b32 v65, v229
  s_nop 0
  v_permlane32_swap_b32 v228, v64
  v_permlane32_swap_b32 v229, v65
  v_add_f32 v228, v228, v64
  v_add_f32 v229, v229, v65
  v_mov_b32 v64, v228
  v_mov_b32 v65, v229
  s_nop 0
  v_permlane16_swap_b32 v228, v64
  v_permlane16_swap_b32 v229, v65
  v_add_f32 v228, v228, v64
  v_add_f32 v229, v229, v65
  s_branch F_EPI
F_P3:
  s_setprio 0
  s_barrier
  ds_read_b64_tr_b16 v[32:33], v22 offset:0
  ds_read_b64_tr_b16 v[34:35], v22 offset:5120
  ds_read_b64_tr_b16 v[36:37], v23 offset:0
  ds_read_b64_tr_b16 v[38:39], v23 offset:5120
  ds_read_b64_tr_b16 v[40:41], v22 offset:64
  ds_read_b64_tr_b16 v[42:43], v22 offset:5184
  ds_read_b64_tr_b16 v[44:45], v23 offset:64
  ds_read_b64_tr_b16 v[46:47], v23 offset:5184
  ds_read_b64_tr_b16 v[48:49], v22 offset:128
  ds_read_b64_tr_b16 v[50:51], v22 offset:5248
  ds_read_b64_tr_b16 v[52:53], v23 offset:128
  ds_read_b64_tr_b16 v[54:55], v23 offset:5248
  s_lshl_b32 s86, s65, 2
  s_add_u32 s86, s86, s64
  s_lshl_b32 s86, s86, 7
  s_add_u32 s86, s86, 87031808
  s_lshl_b32 s33, s75, 1
  s_add_u32 s33, s33, s67
  s_mul_i32 s33, s33, 182
  s_lshl_b32 s34, s64, 5
  s_add_u32 s33, s33, s34
  s_add_u32 s33, s33, 32768
  s_lshl_b32 s87, s33, 10
  s_lshl_b32 s34, s68, 9
  s_add_u32 s87, s87, s34
  v_bfe_u32 v14, v16, 6, 2
  v_lshlrev_b32 v14, 11, v14
  v_bfe_u32 v12, v16, 4, 2
  v_lshl_add_u32 v14, v12, 7, v14
  s_waitcnt vmcnt(15) lgkmcnt(10)
  v_mfma_f32_16x16x32_bf16 v[64:67], v[32:35], v[232:235], 0
  ds_read_b64_tr_b16 v[56:57], v22 offset:192
  s_waitcnt vmcnt(14)
  v_mfma_f32_16x16x32_bf16 v[104:107], v[32:35], v[236:239], 0
  ds_read_b64_tr_b16 v[58:59], v22 offset:5312
  s_add_u32 m0, s69, 81920
  s_nop 0
  buffer_load_dwordx4 v17, s[4:7], s70 offen offset:0 lds
  s_waitcnt lgkmcnt(10)
  v_mfma_f32_16x16x32_bf16 v[108:111], v[36:39], v[236:239], 0
  ds_read_b64_tr_b16 v[60:61], v23 offset:192
  v_mfma_f32_16x16x32_bf16 v[68:71], v[36:39], v[232:235], 0
  ds_read_b64_tr_b16 v[62:63], v23 offset:5312
  buffer_load_dwordx4 v18, s[4:7], s70 offen offset:1024 lds
  s_waitcnt lgkmcnt(10)
  v_mfma_f32_16x16x32_bf16 v[72:75], v[40:43], v[232:235], 0
  ds_read_b64_tr_b16 v[32:33], v22 offset:256
  v_mfma_f32_16x16x32_bf16 v[112:115], v[40:43], v[236:239], 0
  ds_read_b64_tr_b16 v[34:35], v22 offset:5376
  buffer_load_dwordx4 v19, s[4:7], s70 offen offset:2048 lds
  s_waitcnt lgkmcnt(10)
  v_mfma_f32_16x16x32_bf16 v[116:119], v[44:47], v[236:239], 0
  ds_read_b64_tr_b16 v[36:37], v23 offset:256
  v_mfma_f32_16x16x32_bf16 v[76:79], v[44:47], v[232:235], 0
  ds_read_b64_tr_b16 v[38:39], v23 offset:5376
  buffer_load_dwordx4 v20, s[4:7], s70 offen offset:3072 lds
  s_add_u32 m0, s69, 86016
  s_waitcnt lgkmcnt(10)
  v_mfma_f32_16x16x32_bf16 v[80:83], v[48:51], v[232:235], 0
  ds_read_b64_tr_b16 v[40:41], v22 offset:20480
  v_mfma_f32_16x16x32_bf16 v[120:123], v[48:51], v[236:239], 0
  ds_read_b64_tr_b16 v[42:43], v22 offset:25600
  buffer_load_dwordx4 v21, s[4:7], s70 offen lds
  s_cmp_eq_u32 s64, 3
  s_cselect_b32 s33, 0, 163840
  s_add_u32 s70, s70, s33
  s_waitcnt lgkmcnt(10)
  v_mfma_f32_16x16x32_bf16 v[124:127], v[52:55], v[236:239], 0
  ds_read_b64_tr_b16 v[44:45], v23 offset:20480
  v_mfma_f32_16x16x32_bf16 v[84:87], v[52:55], v[232:235], 0
  ds_read_b64_tr_b16 v[46:47], v23 offset:25600
  buffer_load_dwordx4 v[144:147], v16, s[12:15], s72 offen offset:2048 sc1
  s_waitcnt lgkmcnt(10)
  v_mfma_f32_16x16x32_bf16 v[88:91], v[56:59], v[232:235], 0
  ds_read_b64_tr_b16 v[48:49], v22 offset:20544
  v_mfma_f32_16x16x32_bf16 v[128:131], v[56:59], v[236:239], 0
  ds_read_b64_tr_b16 v[50:51], v22 offset:25664
  buffer_load_dwordx4 v[148:151], v16, s[12:15], s73 offen offset:2048 sc1
  s_add_u32 s72, s72, 4096
  s_add_u32 s73, s73, 4096
  s_waitcnt lgkmcnt(10)
  v_mfma_f32_16x16x32_bf16 v[132:135], v[60:63], v[236:239], 0
  ds_read_b64_tr_b16 v[52:53], v23 offset:20544
  v_mfma_f32_16x16x32_bf16 v[92:95], v[60:63], v[232:235], 0
  ds_read_b64_tr_b16 v[54:55], v23 offset:25664
  buffer_load_dwordx4 v[152:155], v16, s[12:15], s72 offen offset:0 sc1
  s_waitcnt lgkmcnt(10)
  v_mfma_f32_16x16x32_bf16 v[96:99], v[32:35], v[232:235], 0
  ds_read_b64_tr_b16 v[56:57], v22 offset:20608
  v_mfma_f32_16x16x32_bf16 v[136:139], v[32:35], v[236:239], 0
  ds_read_b64_tr_b16 v[58:59], v22 offset:25728
  buffer_load_dwordx4 v[156:159], v16, s[12:15], s73 offen offset:0 sc1
  s_waitcnt lgkmcnt(10)
  v_mfma_f32_16x16x32_bf16 v[140:143], v[36:39], v[236:239], 0
  ds_read_b64_tr_b16 v[60:61], v23 offset:20608
  v_mfma_f32_16x16x32_bf16 v[100:103], v[36:39], v[232:235], 0
  ds_read_b64_tr_b16 v[62:63], v23 offset:25728
  s_waitcnt vmcnt(22) lgkmcnt(10)
  v_mfma_f32_16x16x32_bf16 v[64:67], v[40:43], v[240:243], v[64:67]
  ds_read_b64_tr_b16 v[32:33], v22 offset:20672
  s_waitcnt vmcnt(21)
  v_mfma_f32_16x16x32_bf16 v[104:107], v[40:43], v[244:247], v[104:107]
  ds_read_b64_tr_b16 v[34:35], v22 offset:25792
  s_add_u32 m0, s69, 122880
  s_nop 0
  buffer_load_dwordx4 v17, s[16:19], s70 offen offset:0 lds
  s_waitcnt lgkmcnt(10)
  v_mfma_f32_16x16x32_bf16 v[108:111], v[44:47], v[244:247], v[108:111]
  ds_read_b64_tr_b16 v[36:37], v23 offset:20672
  v_mfma_f32_16x16x32_bf16 v[68:71], v[44:47], v[240:243], v[68:71]
  ds_read_b64_tr_b16 v[38:39], v23 offset:25792
  buffer_load_dwordx4 v18, s[16:19], s70 offen offset:1024 lds
  s_waitcnt lgkmcnt(10)
  v_mfma_f32_16x16x32_bf16 v[72:75], v[48:51], v[240:243], v[72:75]
  ds_read_b64_tr_b16 v[40:41], v22 offset:20736
  v_mfma_f32_16x16x32_bf16 v[112:115], v[48:51], v[244:247], v[112:115]
  ds_read_b64_tr_b16 v[42:43], v22 offset:25856
  buffer_load_dwordx4 v19, s[16:19], s70 offen offset:2048 lds
  s_waitcnt lgkmcnt(10)
  v_mfma_f32_16x16x32_bf16 v[116:119], v[52:55], v[244:247], v[116:119]
  ds_read_b64_tr_b16 v[44:45], v23 offset:20736
  v_mfma_f32_16x16x32_bf16 v[76:79], v[52:55], v[240:243], v[76:79]
  ds_read_b64_tr_b16 v[46:47], v23 offset:25856
  buffer_load_dwordx4 v20, s[16:19], s70 offen offset:3072 lds
  s_add_u32 m0, s69, 126976
  v_add_u32 v22, 0xa000, v22
  v_add_u32 v23, 0xa000, v23
  s_waitcnt lgkmcnt(10)
  v_mfma_f32_16x16x32_bf16 v[80:83], v[56:59], v[240:243], v[80:83]
  ds_read_b64_tr_b16 v[48:49], v22 offset:0
  v_mfma_f32_16x16x32_bf16 v[120:123], v[56:59], v[244:247], v[120:123]
  ds_read_b64_tr_b16 v[50:51], v22 offset:5120
  buffer_load_dwordx4 v21, s[16:19], s70 offen lds
  s_waitcnt vmcnt(14)
  s_cmp_eq_u32 s67, 0
  s_cbranch_scc0 F_CF1
  s_sub_u32 s33, 15, s31
  s_lshl_b32 s33, s33, 2
  s_add_u32 s33, s33, s64
  s_lshl_b32 s33, s33, 7
  s_add_u32 s33, s33, 87031808
  v_mov_b32 v12, 1
  s_mov_b64 exec, 1
  buffer_atomic_add v12, off, s[12:15], s33 sc1
  s_mov_b64 exec, -1
F_CF1:
  s_waitcnt lgkmcnt(10)
  v_mfma_f32_16x16x32_bf16 v[124:127], v[60:63], v[244:247], v[124:127]
  ds_read_b64_tr_b16 v[52:53], v23 offset:0
  v_mfma_f32_16x16x32_bf16 v[84:87], v[60:63], v[240:243], v[84:87]
  ds_read_b64_tr_b16 v[54:55], v23 offset:5120
  buffer_load_dwordx4 v[160:163], v16, s[12:15], s72 offen offset:2048 sc1
  s_waitcnt lgkmcnt(10)
  v_mfma_f32_16x16x32_bf16 v[88:91], v[32:35], v[240:243], v[88:91]
  ds_read_b64_tr_b16 v[56:57], v22 offset:64
  v_mfma_f32_16x16x32_bf16 v[128:131], v[32:35], v[244:247], v[128:131]
  ds_read_b64_tr_b16 v[58:59], v22 offset:5184
  buffer_load_dwordx4 v[164:167], v16, s[12:15], s73 offen offset:2048 sc1
  s_add_u32 s72, s72, 4096
  s_add_u32 s73, s73, 4096
  s_waitcnt lgkmcnt(10)
  v_mfma_f32_16x16x32_bf16 v[132:135], v[36:39], v[244:247], v[132:135]
  ds_read_b64_tr_b16 v[60:61], v23 offset:64
  v_mfma_f32_16x16x32_bf16 v[92:95], v[36:39], v[240:243], v[92:95]
  ds_read_b64_tr_b16 v[62:63], v23 offset:5184
  buffer_load_dwordx4 v[168:171], v16, s[20:23], s72 offen offset:0 sc1
  s_waitcnt lgkmcnt(10)
  v_mfma_f32_16x16x32_bf16 v[96:99], v[40:43], v[240:243], v[96:99]
  ds_read_b64_tr_b16 v[32:33], v22 offset:128
  v_mfma_f32_16x16x32_bf16 v[136:139], v[40:43], v[244:247], v[136:139]
  ds_read_b64_tr_b16 v[34:35], v22 offset:5248
  buffer_load_dwordx4 v[172:175], v16, s[20:23], s73 offen offset:0 sc1
  s_mul_i32 s33, s64, 18432
  s_add_u32 s72, s72, s33
  s_sub_u32 s72, s72, 143360
  s_add_u32 s73, s72, s77
  s_waitcnt lgkmcnt(10)
  v_mfma_f32_16x16x32_bf16 v[140:143], v[44:47], v[244:247], v[140:143]
  ds_read_b64_tr_b16 v[36:37], v23 offset:128
  v_mfma_f32_16x16x32_bf16 v[100:103], v[44:47], v[240:243], v[100:103]
  ds_read_b64_tr_b16 v[38:39], v23 offset:5248
  s_waitcnt lgkmcnt(10)
  v_mfma_f32_16x16x32_bf16 v[64:67], v[48:51], v[248:251], v[64:67]
  ds_read_b64_tr_b16 v[40:41], v22 offset:192
  v_mfma_f32_16x16x32_bf16 v[104:107], v[48:51], v[252:255], v[104:107]
  ds_read_b64_tr_b16 v[42:43], v22 offset:5312
  s_waitcnt lgkmcnt(10)
  v_mfma_f32_16x16x32_bf16 v[108:111], v[52:55], v[252:255], v[108:111]
  ds_read_b64_tr_b16 v[44:45], v23 offset:192
  v_mfma_f32_16x16x32_bf16 v[68:71], v[52:55], v[248:251], v[68:71]
  ds_read_b64_tr_b16 v[46:47], v23 offset:5312
  s_waitcnt lgkmcnt(10)
  v_mfma_f32_16x16x32_bf16 v[72:75], v[56:59], v[248:251], v[72:75]
  ds_read_b64_tr_b16 v[48:49], v22 offset:256
  v_mfma_f32_16x16x32_bf16 v[112:115], v[56:59], v[252:255], v[112:115]
  ds_read_b64_tr_b16 v[50:51], v22 offset:5376
  s_waitcnt lgkmcnt(10)
  v_mfma_f32_16x16x32_bf16 v[116:119], v[60:63], v[252:255], v[116:119]
  ds_read_b64_tr_b16 v[52:53], v23 offset:256
  v_mfma_f32_16x16x32_bf16 v[76:79], v[60:63], v[248:251], v[76:79]
  ds_read_b64_tr_b16 v[54:55], v23 offset:5376
  s_waitcnt lgkmcnt(10)
  v_mfma_f32_16x16x32_bf16 v[80:83], v[32:35], v[248:251], v[80:83]
  ds_read_b64_tr_b16 v[56:57], v22 offset:20480
  v_mfma_f32_16x16x32_bf16 v[120:123], v[32:35], v[252:255], v[120:123]
  ds_read_b64_tr_b16 v[58:59], v22 offset:25600
  s_waitcnt lgkmcnt(10)
  v_mfma_f32_16x16x32_bf16 v[124:127], v[36:39], v[252:255], v[124:127]
  ds_read_b64_tr_b16 v[60:61], v23 offset:20480
  v_mfma_f32_16x16x32_bf16 v[84:87], v[36:39], v[248:251], v[84:87]
  ds_read_b64_tr_b16 v[62:63], v23 offset:25600
  s_waitcnt lgkmcnt(10)
  v_mfma_f32_16x16x32_bf16 v[88:91], v[40:43], v[248:251], v[88:91]
  ds_read_b64_tr_b16 v[32:33], v22 offset:20544
  v_mfma_f32_16x16x32_bf16 v[128:131], v[40:43], v[252:255], v[128:131]
  ds_read_b64_tr_b16 v[34:35], v22 offset:25664
  s_waitcnt lgkmcnt(10)
  v_mfma_f32_16x16x32_bf16 v[132:135], v[44:47], v[252:255], v[132:135]
  ds_read_b64_tr_b16 v[36:37], v23 offset:20544
  v_mfma_f32_16x16x32_bf16 v[92:95], v[44:47], v[248:251], v[92:95]
  ds_read_b64_tr_b16 v[38:39], v23 offset:25664
  s_waitcnt lgkmcnt(10)
  v_mfma_f32_16x16x32_bf16 v[96:99], v[48:51], v[248:251], v[96:99]
  ds_read_b64_tr_b16 v[40:41], v22 offset:20608
  v_mfma_f32_16x16x32_bf16 v[136:139], v[48:51], v[252:255], v[136:139]
  ds_read_b64_tr_b16 v[42:43], v22 offset:25728
  s_waitcnt lgkmcnt(10)
  v_mfma_f32_16x16x32_bf16 v[140:143], v[52:55], v[252:255], v[140:143]
  ds_read_b64_tr_b16 v[44:45], v23 offset:20608
  v_mfma_f32_16x16x32_bf16 v[100:103], v[52:55], v[248:251], v[100:103]
  ds_read_b64_tr_b16 v[46:47], v23 offset:25728
  s_waitcnt vmcnt(12) lgkmcnt(10)
  v_mfma_f32_16x16x32_bf16 v[64:67], v[56:59], v[144:147], v[64:67]
  ds_read_b64_tr_b16 v[48:49], v22 offset:20672
  s_waitcnt vmcnt(11)
  v_mfma_f32_16x16x32_bf16 v[104:107], v[56:59], v[148:151], v[104:107]
  ds_read_b64_tr_b16 v[50:51], v22 offset:25792
  s_waitcnt lgkmcnt(10)
  v_mfma_f32_16x16x32_bf16 v[108:111], v[60:63], v[148:151], v[108:111]
  ds_read_b64_tr_b16 v[52:53], v23 offset:20672
  v_mfma_f32_16x16x32_bf16 v[68:71], v[60:63], v[144:147], v[68:71]
  ds_read_b64_tr_b16 v[54:55], v23 offset:25792
  s_waitcnt lgkmcnt(10)
  v_mfma_f32_16x16x32_bf16 v[72:75], v[32:35], v[144:147], v[72:75]
  ds_read_b64_tr_b16 v[56:57], v22 offset:20736
  v_mfma_f32_16x16x32_bf16 v[112:115], v[32:35], v[148:151], v[112:115]
  ds_read_b64_tr_b16 v[58:59], v22 offset:25856
  s_waitcnt lgkmcnt(10)
  v_mfma_f32_16x16x32_bf16 v[116:119], v[36:39], v[148:151], v[116:119]
  ds_read_b64_tr_b16 v[60:61], v23 offset:20736
  v_mfma_f32_16x16x32_bf16 v[76:79], v[36:39], v[144:147], v[76:79]
  ds_read_b64_tr_b16 v[62:63], v23 offset:25856
  s_barrier
  v_add_u32 v22, 0xa000, v22
  v_add_u32 v23, 0xa000, v23
  s_waitcnt lgkmcnt(10)
  v_mfma_f32_16x16x32_bf16 v[80:83], v[40:43], v[144:147], v[80:83]
  ds_read_b64_tr_b16 v[32:33], v22 offset:0
  v_mfma_f32_16x16x32_bf16 v[120:123], v[40:43], v[148:151], v[120:123]
  ds_read_b64_tr_b16 v[34:35], v22 offset:5120
  s_add_u32 m0, s69, 0
  s_nop 0
  buffer_load_dwordx4 v17, s[8:11], s71 offen offset:0 lds
  s_waitcnt lgkmcnt(10)
  v_mfma_f32_16x16x32_bf16 v[124:127], v[44:47], v[148:151], v[124:127]
  ds_read_b64_tr_b16 v[36:37], v23 offset:0
  v_mfma_f32_16x16x32_bf16 v[84:87], v[44:47], v[144:147], v[84:87]
  ds_read_b64_tr_b16 v[38:39], v23 offset:5120
  buffer_load_dwordx4 v18, s[8:11], s71 offen offset:1024 lds
  s_waitcnt lgkmcnt(10)
  v_mfma_f32_16x16x32_bf16 v[88:91], v[48:51], v[144:147], v[88:91]
  ds_read_b64_tr_b16 v[40:41], v22 offset:64
  v_mfma_f32_16x16x32_bf16 v[128:131], v[48:51], v[148:151], v[128:131]
  ds_read_b64_tr_b16 v[42:43], v22 offset:5184
  buffer_load_dwordx4 v19, s[8:11], s71 offen offset:2048 lds
  s_waitcnt lgkmcnt(10)
  v_mfma_f32_16x16x32_bf16 v[132:135], v[52:55], v[148:151], v[132:135]
  ds_read_b64_tr_b16 v[44:45], v23 offset:64
  v_mfma_f32_16x16x32_bf16 v[92:95], v[52:55], v[144:147], v[92:95]
  ds_read_b64_tr_b16 v[46:47], v23 offset:5184
  buffer_load_dwordx4 v20, s[8:11], s71 offen offset:3072 lds
  s_add_u32 m0, s69, 4096
  s_waitcnt lgkmcnt(10)
  v_mfma_f32_16x16x32_bf16 v[96:99], v[56:59], v[144:147], v[96:99]
  ds_read_b64_tr_b16 v[48:49], v22 offset:128
  v_mfma_f32_16x16x32_bf16 v[136:139], v[56:59], v[148:151], v[136:139]
  ds_read_b64_tr_b16 v[50:51], v22 offset:5248
  buffer_load_dwordx4 v21, s[8:11], s71 offen lds
  s_add_u32 s71, s71, 163840
  s_waitcnt lgkmcnt(10)
  v_mfma_f32_16x16x32_bf16 v[140:143], v[60:63], v[148:151], v[140:143]
  ds_read_b64_tr_b16 v[52:53], v23 offset:128
  v_mfma_f32_16x16x32_bf16 v[100:103], v[60:63], v[144:147], v[100:103]
  ds_read_b64_tr_b16 v[54:55], v23 offset:5248
  buffer_load_dword v12, off, s[12:15], s86 sc1
  s_waitcnt vmcnt(0)
  v_readfirstlane_b32 s33, v12
  s_nop 0
  s_cmp_ge_u32 s33, 32
  s_cbranch_scc1 F_CGO
F_CPOLL:
  buffer_load_dword v12, off, s[12:15], s86 sc1
  s_waitcnt vmcnt(0)
  v_readfirstlane_b32 s33, v12
  s_nop 0
  s_cmp_lt_u32 s33, 32
  s_cbranch_scc1 F_CPOLL
F_CGO:
  s_waitcnt lgkmcnt(10)
  v_mfma_f32_16x16x32_bf16 v[64:67], v[32:35], v[152:155], v[64:67]
  ds_read_b64_tr_b16 v[56:57], v22 offset:192
  buffer_load_dwordx4 v[176:179], v16, s[12:15], s72 offen offset:0 sc1
  v_mfma_f32_16x16x32_bf16 v[104:107], v[32:35], v[156:159], v[104:107]
  ds_read_b64_tr_b16 v[58:59], v22 offset:5312
  buffer_load_dwordx4 v[180:183], v16, s[12:15], s73 offen offset:0 sc1
  s_waitcnt lgkmcnt(10)
  v_mfma_f32_16x16x32_bf16 v[108:111], v[36:39], v[156:159], v[108:111]
  ds_read_b64_tr_b16 v[60:61], v23 offset:192
  buffer_load_dwordx4 v[184:187], v16, s[12:15], s72 offen offset:2048 sc1
  v_mfma_f32_16x16x32_bf16 v[68:71], v[36:39], v[152:155], v[68:71]
  ds_read_b64_tr_b16 v[62:63], v23 offset:5312
  buffer_load_dwordx4 v[188:191], v16, s[12:15], s73 offen offset:2048 sc1
  s_add_u32 s72, s72, 4096
  s_add_u32 s73, s73, 4096
  s_waitcnt lgkmcnt(10)
  v_mfma_f32_16x16x32_bf16 v[72:75], v[40:43], v[152:155], v[72:75]
  ds_read_b64_tr_b16 v[32:33], v22 offset:256
  v_mfma_f32_16x16x32_bf16 v[112:115], v[40:43], v[156:159], v[112:115]
  ds_read_b64_tr_b16 v[34:35], v22 offset:5376
  s_waitcnt lgkmcnt(10)
  v_mfma_f32_16x16x32_bf16 v[116:119], v[44:47], v[156:159], v[116:119]
  ds_read_b64_tr_b16 v[36:37], v23 offset:256
  v_mfma_f32_16x16x32_bf16 v[76:79], v[44:47], v[152:155], v[76:79]
  ds_read_b64_tr_b16 v[38:39], v23 offset:5376
  s_waitcnt lgkmcnt(10)
  v_mfma_f32_16x16x32_bf16 v[80:83], v[48:51], v[152:155], v[80:83]
  ds_read_b64_tr_b16 v[40:41], v22 offset:20480
  v_mfma_f32_16x16x32_bf16 v[120:123], v[48:51], v[156:159], v[120:123]
  ds_read_b64_tr_b16 v[42:43], v22 offset:25600
  s_waitcnt lgkmcnt(10)
  v_mfma_f32_16x16x32_bf16 v[124:127], v[52:55], v[156:159], v[124:127]
  ds_read_b64_tr_b16 v[44:45], v23 offset:20480
  v_mfma_f32_16x16x32_bf16 v[84:87], v[52:55], v[152:155], v[84:87]
  ds_read_b64_tr_b16 v[46:47], v23 offset:25600
  s_waitcnt lgkmcnt(10)
  v_mfma_f32_16x16x32_bf16 v[88:91], v[56:59], v[152:155], v[88:91]
  ds_read_b64_tr_b16 v[48:49], v22 offset:20544
  v_mfma_f32_16x16x32_bf16 v[128:131], v[56:59], v[156:159], v[128:131]
  ds_read_b64_tr_b16 v[50:51], v22 offset:25664
  s_waitcnt lgkmcnt(10)
  v_mfma_f32_16x16x32_bf16 v[132:135], v[60:63], v[156:159], v[132:135]
  ds_read_b64_tr_b16 v[52:53], v23 offset:20544
  v_mfma_f32_16x16x32_bf16 v[92:95], v[60:63], v[152:155], v[92:95]
  ds_read_b64_tr_b16 v[54:55], v23 offset:25664
  s_waitcnt lgkmcnt(10)
  v_mfma_f32_16x16x32_bf16 v[96:99], v[32:35], v[152:155], v[96:99]
  ds_read_b64_tr_b16 v[56:57], v22 offset:20608
  v_mfma_f32_16x16x32_bf16 v[136:139], v[32:35], v[156:159], v[136:139]
  ds_read_b64_tr_b16 v[58:59], v22 offset:25728
  s_waitcnt lgkmcnt(10)
  v_mfma_f32_16x16x32_bf16 v[140:143], v[36:39], v[156:159], v[140:143]
  ds_read_b64_tr_b16 v[60:61], v23 offset:20608
  v_mfma_f32_16x16x32_bf16 v[100:103], v[36:39], v[152:155], v[100:103]
  ds_read_b64_tr_b16 v[62:63], v23 offset:25728
  s_waitcnt lgkmcnt(10)
  v_mfma_f32_16x16x32_bf16 v[64:67], v[40:43], v[160:163], v[64:67]
  ds_read_b64_tr_b16 v[32:33], v22 offset:20672
  buffer_load_dwordx4 v[192:195], v16, s[12:15], s72 offen offset:0 sc1
  v_mfma_f32_16x16x32_bf16 v[104:107], v[40:43], v[164:167], v[104:107]
  ds_read_b64_tr_b16 v[34:35], v22 offset:25792
  buffer_load_dwordx4 v[196:199], v16, s[12:15], s73 offen offset:0 sc1
  s_waitcnt lgkmcnt(10)
  v_mfma_f32_16x16x32_bf16 v[108:111], v[44:47], v[164:167], v[108:111]
  ds_read_b64_tr_b16 v[36:37], v23 offset:20672
  v_mfma_f32_16x16x32_bf16 v[68:71], v[44:47], v[160:163], v[68:71]
  ds_read_b64_tr_b16 v[38:39], v23 offset:25792
  s_waitcnt lgkmcnt(10)
  v_mfma_f32_16x16x32_bf16 v[72:75], v[48:51], v[160:163], v[72:75]
  ds_read_b64_tr_b16 v[40:41], v22 offset:20736
  v_mfma_f32_16x16x32_bf16 v[112:115], v[48:51], v[164:167], v[112:115]
  ds_read_b64_tr_b16 v[42:43], v22 offset:25856
  s_waitcnt lgkmcnt(10)
  v_mfma_f32_16x16x32_bf16 v[116:119], v[52:55], v[164:167], v[116:119]
  ds_read_b64_tr_b16 v[44:45], v23 offset:20736
  v_mfma_f32_16x16x32_bf16 v[76:79], v[52:55], v[160:163], v[76:79]
  ds_read_b64_tr_b16 v[46:47], v23 offset:25856
  s_barrier
  v_add_u32 v22, 0xa000, v22
  v_add_u32 v23, 0xa000, v23
  s_waitcnt lgkmcnt(10)
  v_mfma_f32_16x16x32_bf16 v[80:83], v[56:59], v[160:163], v[80:83]
  ds_read_b64_tr_b16 v[48:49], v22 offset:0
  s_add_u32 m0, s69, 40960
  s_nop 0
  buffer_load_dwordx4 v17, s[8:11], s71 offen offset:0 lds
  v_mfma_f32_16x16x32_bf16 v[120:123], v[56:59], v[164:167], v[120:123]
  ds_read_b64_tr_b16 v[50:51], v22 offset:5120
  buffer_load_dwordx4 v18, s[8:11], s71 offen offset:1024 lds
  s_waitcnt lgkmcnt(10)
  v_mfma_f32_16x16x32_bf16 v[124:127], v[60:63], v[164:167], v[124:127]
  ds_read_b64_tr_b16 v[52:53], v23 offset:0
  buffer_load_dwordx4 v19, s[8:11], s71 offen offset:2048 lds
  v_mfma_f32_16x16x32_bf16 v[84:87], v[60:63], v[160:163], v[84:87]
  ds_read_b64_tr_b16 v[54:55], v23 offset:5120
  buffer_load_dwordx4 v20, s[8:11], s71 offen offset:3072 lds
  s_add_u32 m0, s69, 45056
  s_waitcnt lgkmcnt(10)
  v_mfma_f32_16x16x32_bf16 v[88:91], v[32:35], v[160:163], v[88:91]
  ds_read_b64_tr_b16 v[56:57], v22 offset:64
  buffer_load_dwordx4 v21, s[8:11], s71 offen lds
  s_add_u32 s71, s71, 163840
  v_mfma_f32_16x16x32_bf16 v[128:131], v[32:35], v[164:167], v[128:131]
  ds_read_b64_tr_b16 v[58:59], v22 offset:5184
  s_waitcnt lgkmcnt(10)
  v_mfma_f32_16x16x32_bf16 v[132:135], v[36:39], v[164:167], v[132:135]
  ds_read_b64_tr_b16 v[60:61], v23 offset:64
  v_mfma_f32_16x16x32_bf16 v[92:95], v[36:39], v[160:163], v[92:95]
  ds_read_b64_tr_b16 v[62:63], v23 offset:5184
  s_waitcnt lgkmcnt(10)
  v_mfma_f32_16x16x32_bf16 v[96:99], v[40:43], v[160:163], v[96:99]
  ds_read_b64_tr_b16 v[32:33], v22 offset:128
  v_mfma_f32_16x16x32_bf16 v[136:139], v[40:43], v[164:167], v[136:139]
  ds_read_b64_tr_b16 v[34:35], v22 offset:5248
  s_waitcnt lgkmcnt(10)
  v_mfma_f32_16x16x32_bf16 v[140:143], v[44:47], v[164:167], v[140:143]
  ds_read_b64_tr_b16 v[36:37], v23 offset:128
  v_mfma_f32_16x16x32_bf16 v[100:103], v[44:47], v[160:163], v[100:103]
  ds_read_b64_tr_b16 v[38:39], v23 offset:5248
  s_waitcnt lgkmcnt(10)
  v_mfma_f32_16x16x32_bf16 v[64:67], v[48:51], v[168:171], v[64:67]
  ds_read_b64_tr_b16 v[40:41], v22 offset:192
  v_mfma_f32_16x16x32_bf16 v[104:107], v[48:51], v[172:175], v[104:107]
  ds_read_b64_tr_b16 v[42:43], v22 offset:5312
  buffer_load_dwordx4 v[200:203], v16, s[12:15], s72 offen offset:2048 sc1
  s_waitcnt lgkmcnt(10)
  v_mfma_f32_16x16x32_bf16 v[108:111], v[52:55], v[172:175], v[108:111]
  ds_read_b64_tr_b16 v[44:45], v23 offset:192
  v_mfma_f32_16x16x32_bf16 v[68:71], v[52:55], v[168:171], v[68:71]
  ds_read_b64_tr_b16 v[46:47], v23 offset:5312
  buffer_load_dwordx4 v[204:207], v16, s[12:15], s73 offen offset:2048 sc1
  s_add_u32 s72, s72, 4096
  s_add_u32 s73, s73, 4096
  s_waitcnt lgkmcnt(10)
  v_mfma_f32_16x16x32_bf16 v[72:75], v[56:59], v[168:171], v[72:75]
  ds_read_b64_tr_b16 v[48:49], v22 offset:256
  v_mfma_f32_16x16x32_bf16 v[112:115], v[56:59], v[172:175], v[112:115]
  ds_read_b64_tr_b16 v[50:51], v22 offset:5376
  v_mul_f32 v64, v8, v64
  v_mul_f32 v65, v8, v65
  v_mul_f32 v66, v8, v66
  v_mul_f32 v67, v8, v67
  s_waitcnt lgkmcnt(10)
  v_mfma_f32_16x16x32_bf16 v[116:119], v[60:63], v[172:175], v[116:119]
  ds_read_b64_tr_b16 v[52:53], v23 offset:256
  v_mul_f32 v104, v9, v104
  v_mul_f32 v105, v9, v105
  v_mul_f32 v106, v9, v106
  v_mul_f32 v107, v9, v107
  v_mfma_f32_16x16x32_bf16 v[76:79], v[60:63], v[168:171], v[76:79]
  ds_read_b64_tr_b16 v[54:55], v23 offset:5376
  v_mul_f32 v108, v9, v108
  v_mul_f32 v109, v9, v109
  v_mul_f32 v110, v9, v110
  v_mul_f32 v111, v9, v111
  s_barrier
  v_add_u32 v22, 0xfffe2000, v22
  v_add_u32 v23, 0xfffe2000, v23
  s_waitcnt lgkmcnt(10)
  v_mfma_f32_16x16x32_bf16 v[80:83], v[32:35], v[168:171], v[80:83]
  ds_read_b64_tr_b16 v[56:57], v22 offset:0
  v_mul_f32 v68, v8, v68
  v_mul_f32 v69, v8, v69
  v_mul_f32 v70, v8, v70
  v_mul_f32 v71, v8, v71
  v_mfma_f32_16x16x32_bf16 v[120:123], v[32:35], v[172:175], v[120:123]
  ds_read_b64_tr_b16 v[58:59], v22 offset:5120
  v_mul_f32 v72, v8, v72
  v_mul_f32 v73, v8, v73
  v_mul_f32 v74, v8, v74
  v_mul_f32 v75, v8, v75
  s_add_u32 m0, s69, 81920
  s_nop 0
  buffer_load_dwordx4 v17, s[8:11], s71 offen offset:0 lds
  s_waitcnt lgkmcnt(10)
  v_mfma_f32_16x16x32_bf16 v[124:127], v[36:39], v[172:175], v[124:127]
  ds_read_b64_tr_b16 v[60:61], v23 offset:0
  v_mul_f32 v112, v9, v112
  v_mul_f32 v113, v9, v113
  v_mul_f32 v114, v9, v114
  v_mul_f32 v115, v9, v115
  v_mfma_f32_16x16x32_bf16 v[84:87], v[36:39], v[168:171], v[84:87]
  ds_read_b64_tr_b16 v[62:63], v23 offset:5120
  v_mul_f32 v116, v9, v116
  v_mul_f32 v117, v9, v117
  v_mul_f32 v118, v9, v118
  v_mul_f32 v119, v9, v119
  buffer_load_dwordx4 v18, s[8:11], s71 offen offset:1024 lds
  s_waitcnt lgkmcnt(10)
  v_mfma_f32_16x16x32_bf16 v[88:91], v[40:43], v[168:171], v[88:91]
  ds_read_b64_tr_b16 v[32:33], v22 offset:64
  v_mul_f32 v76, v8, v76
  v_mul_f32 v77, v8, v77
  v_mul_f32 v78, v8, v78
  v_mul_f32 v79, v8, v79
  v_mfma_f32_16x16x32_bf16 v[128:131], v[40:43], v[172:175], v[128:131]
  ds_read_b64_tr_b16 v[34:35], v22 offset:5184
  v_mul_f32 v80, v8, v80
  v_mul_f32 v81, v8, v81
  v_mul_f32 v82, v8, v82
  v_mul_f32 v83, v8, v83
  buffer_load_dwordx4 v19, s[8:11], s71 offen offset:2048 lds
  s_waitcnt lgkmcnt(10)
  v_mfma_f32_16x16x32_bf16 v[132:135], v[44:47], v[172:175], v[132:135]
  ds_read_b64_tr_b16 v[36:37], v23 offset:64
  v_mul_f32 v120, v9, v120
  v_mul_f32 v121, v9, v121
  v_mul_f32 v122, v9, v122
  v_mul_f32 v123, v9, v123
  v_mfma_f32_16x16x32_bf16 v[92:95], v[44:47], v[168:171], v[92:95]
  ds_read_b64_tr_b16 v[38:39], v23 offset:5184
  v_mul_f32 v124, v9, v124
  v_mul_f32 v125, v9, v125
  v_mul_f32 v126, v9, v126
  v_mul_f32 v127, v9, v127
  buffer_load_dwordx4 v20, s[8:11], s71 offen offset:3072 lds
  s_add_u32 m0, s69, 86016
  s_waitcnt lgkmcnt(10)
  v_mfma_f32_16x16x32_bf16 v[96:99], v[48:51], v[168:171], v[96:99]
  ds_read_b64_tr_b16 v[40:41], v22 offset:128
  v_mul_f32 v84, v8, v84
  v_mul_f32 v85, v8, v85
  v_mul_f32 v86, v8, v86
  v_mul_f32 v87, v8, v87
  v_mfma_f32_16x16x32_bf16 v[136:139], v[48:51], v[172:175], v[136:139]
  ds_read_b64_tr_b16 v[42:43], v22 offset:5248
  v_mul_f32 v88, v8, v88
  v_mul_f32 v89, v8, v89
  v_mul_f32 v90, v8, v90
  v_mul_f32 v91, v8, v91
  buffer_load_dwordx4 v21, s[8:11], s71 offen lds
  s_add_u32 s71, s71, 163840
  s_waitcnt lgkmcnt(10)
  v_mfma_f32_16x16x32_bf16 v[140:143], v[52:55], v[172:175], v[140:143]
  ds_read_b64_tr_b16 v[44:45], v23 offset:128
  v_mul_f32 v128, v9, v128
  v_mul_f32 v129, v9, v129
  v_mul_f32 v130, v9, v130
  v_mul_f32 v131, v9, v131
  v_mfma_f32_16x16x32_bf16 v[100:103], v[52:55], v[168:171], v[100:103]
  ds_read_b64_tr_b16 v[46:47], v23 offset:5248
  v_mul_f32 v132, v9, v132
  v_mul_f32 v133, v9, v133
  v_mul_f32 v134, v9, v134
  v_mul_f32 v135, v9, v135
  s_waitcnt vmcnt(17) lgkmcnt(10)
  v_mfma_f32_16x16x32_bf16 v[64:67], v[56:59], v[176:179], v[64:67]
  ds_read_b64_tr_b16 v[48:49], v22 offset:192
  v_mul_f32 v92, v8, v92
  v_mul_f32 v93, v8, v93
  v_mul_f32 v94, v8, v94
  v_mul_f32 v95, v8, v95
  s_waitcnt vmcnt(16)
  v_mfma_f32_16x16x32_bf16 v[104:107], v[56:59], v[180:183], v[104:107]
  ds_read_b64_tr_b16 v[50:51], v22 offset:5312
  v_mul_f32 v96, v8, v96
  v_mul_f32 v97, v8, v97
  v_mul_f32 v98, v8, v98
  v_mul_f32 v99, v8, v99
  buffer_load_dwordx4 v[208:211], v16, s[12:15], s72 offen offset:0 sc1
  s_waitcnt lgkmcnt(10)
  v_mfma_f32_16x16x32_bf16 v[108:111], v[60:63], v[180:183], v[108:111]
  ds_read_b64_tr_b16 v[52:53], v23 offset:192
  v_mul_f32 v136, v9, v136
  v_mul_f32 v137, v9, v137
  v_mul_f32 v138, v9, v138
  v_mul_f32 v139, v9, v139
  v_mfma_f32_16x16x32_bf16 v[68:71], v[60:63], v[176:179], v[68:71]
  ds_read_b64_tr_b16 v[54:55], v23 offset:5312
  v_mul_f32 v140, v9, v140
  v_mul_f32 v141, v9, v141
  v_mul_f32 v142, v9, v142
  v_mul_f32 v143, v9, v143
  buffer_load_dwordx4 v[212:215], v16, s[12:15], s73 offen offset:0 sc1
  s_waitcnt lgkmcnt(10)
  v_mfma_f32_16x16x32_bf16 v[72:75], v[32:35], v[176:179], v[72:75]
  ds_read_b64_tr_b16 v[56:57], v22 offset:256
  v_mul_f32 v100, v8, v100
  v_mul_f32 v101, v8, v101
  v_mul_f32 v102, v8, v102
  v_mul_f32 v103, v8, v103
  v_mfma_f32_16x16x32_bf16 v[112:115], v[32:35], v[180:183], v[112:115]
  ds_read_b64_tr_b16 v[58:59], v22 offset:5376
  buffer_load_dwordx4 v[216:219], v16, s[12:15], s72 offen offset:2048 sc1
  s_waitcnt lgkmcnt(10)
  v_mfma_f32_16x16x32_bf16 v[116:119], v[36:39], v[180:183], v[116:119]
  ds_read_b64_tr_b16 v[60:61], v23 offset:256
  v_mfma_f32_16x16x32_bf16 v[76:79], v[36:39], v[176:179], v[76:79]
  ds_read_b64_tr_b16 v[62:63], v23 offset:5376
  buffer_load_dwordx4 v[220:223], v16, s[12:15], s73 offen offset:2048 sc1
  s_add_u32 s72, s72, 4096
  s_add_u32 s73, s73, 4096
  s_waitcnt lgkmcnt(10)
  v_mfma_f32_16x16x32_bf16 v[80:83], v[40:43], v[176:179], v[80:83]
  ds_read_b64_tr_b16 v[32:33], v22 offset:20480
  v_mfma_f32_16x16x32_bf16 v[120:123], v[40:43], v[180:183], v[120:123]
  ds_read_b64_tr_b16 v[34:35], v22 offset:25600
  s_waitcnt lgkmcnt(10)
  v_mfma_f32_16x16x32_bf16 v[124:127], v[44:47], v[180:183], v[124:127]
  ds_read_b64_tr_b16 v[36:37], v23 offset:20480
  v_mfma_f32_16x16x32_bf16 v[84:87], v[44:47], v[176:179], v[84:87]
  ds_read_b64_tr_b16 v[38:39], v23 offset:25600
  s_waitcnt lgkmcnt(10)
  v_mfma_f32_16x16x32_bf16 v[88:91], v[48:51], v[176:179], v[88:91]
  ds_read_b64_tr_b16 v[40:41], v22 offset:20544
  v_mfma_f32_16x16x32_bf16 v[128:131], v[48:51], v[180:183], v[128:131]
  ds_read_b64_tr_b16 v[42:43], v22 offset:25664
  s_waitcnt lgkmcnt(10)
  v_mfma_f32_16x16x32_bf16 v[132:135], v[52:55], v[180:183], v[132:135]
  ds_read_b64_tr_b16 v[44:45], v23 offset:20544
  v_mfma_f32_16x16x32_bf16 v[92:95], v[52:55], v[176:179], v[92:95]
  ds_read_b64_tr_b16 v[46:47], v23 offset:25664
  s_waitcnt lgkmcnt(10)
  v_mfma_f32_16x16x32_bf16 v[96:99], v[56:59], v[176:179], v[96:99]
  ds_read_b64_tr_b16 v[48:49], v22 offset:20608
  v_mfma_f32_16x16x32_bf16 v[136:139], v[56:59], v[180:183], v[136:139]
  ds_read_b64_tr_b16 v[50:51], v22 offset:25728
  s_waitcnt lgkmcnt(10)
  v_mfma_f32_16x16x32_bf16 v[140:143], v[60:63], v[180:183], v[140:143]
  ds_read_b64_tr_b16 v[52:53], v23 offset:20608
  v_mfma_f32_16x16x32_bf16 v[100:103], v[60:63], v[176:179], v[100:103]
  ds_read_b64_tr_b16 v[54:55], v23 offset:25728
  s_waitcnt vmcnt(19) lgkmcnt(10)
  v_mfma_f32_16x16x32_bf16 v[64:67], v[32:35], v[184:187], v[64:67]
  ds_read_b64_tr_b16 v[56:57], v22 offset:20672
  s_waitcnt vmcnt(18)
  v_mfma_f32_16x16x32_bf16 v[104:107], v[32:35], v[188:191], v[104:107]
  ds_read_b64_tr_b16 v[58:59], v22 offset:25792
  buffer_load_dwordx4 v[224:227], v16, s[12:15], s72 offen offset:0 sc1
  s_waitcnt lgkmcnt(10)
  v_mfma_f32_16x16x32_bf16 v[108:111], v[36:39], v[188:191], v[108:111]
  ds_read_b64_tr_b16 v[60:61], v23 offset:20672
  v_mfma_f32_16x16x32_bf16 v[68:71], v[36:39], v[184:187], v[68:71]
  ds_read_b64_tr_b16 v[62:63], v23 offset:25792
  buffer_load_dwordx4 v[228:231], v16, s[12:15], s73 offen offset:0 sc1
  s_waitcnt lgkmcnt(10)
  v_mfma_f32_16x16x32_bf16 v[72:75], v[40:43], v[184:187], v[72:75]
  ds_read_b64_tr_b16 v[32:33], v22 offset:20736
  v_mfma_f32_16x16x32_bf16 v[112:115], v[40:43], v[188:191], v[112:115]
  ds_read_b64_tr_b16 v[34:35], v22 offset:25856
  buffer_load_dwordx4 v[232:235], v16, s[12:15], s72 offen offset:2048 sc1
  s_waitcnt lgkmcnt(10)
  v_mfma_f32_16x16x32_bf16 v[116:119], v[44:47], v[188:191], v[116:119]
  ds_read_b64_tr_b16 v[36:37], v23 offset:20736
  v_mfma_f32_16x16x32_bf16 v[76:79], v[44:47], v[184:187], v[76:79]
  ds_read_b64_tr_b16 v[38:39], v23 offset:25856
  buffer_load_dwordx4 v[236:239], v16, s[12:15], s73 offen offset:2048 sc1
  s_add_u32 s72, s72, 4096
  s_add_u32 s73, s73, 4096
  s_waitcnt vmcnt(15)
  s_barrier
  v_add_u32 v22, 0xa000, v22
  v_add_u32 v23, 0xa000, v23
  s_waitcnt lgkmcnt(10)
  v_mfma_f32_16x16x32_bf16 v[80:83], v[48:51], v[184:187], v[80:83]
  ds_read_b64_tr_b16 v[40:41], v22 offset:0
  v_mfma_f32_16x16x32_bf16 v[120:123], v[48:51], v[188:191], v[120:123]
  ds_read_b64_tr_b16 v[42:43], v22 offset:5120
  s_add_u32 m0, s69, 122880
  s_nop 0
  buffer_load_dwordx4 v17, s[8:11], s71 offen offset:0 lds
  s_waitcnt lgkmcnt(10)
  v_mfma_f32_16x16x32_bf16 v[124:127], v[52:55], v[188:191], v[124:127]
  ds_read_b64_tr_b16 v[44:45], v23 offset:0
  v_mfma_f32_16x16x32_bf16 v[84:87], v[52:55], v[184:187], v[84:87]
  ds_read_b64_tr_b16 v[46:47], v23 offset:5120
  buffer_load_dwordx4 v18, s[8:11], s71 offen offset:1024 lds
  s_waitcnt lgkmcnt(10)
  v_mfma_f32_16x16x32_bf16 v[88:91], v[56:59], v[184:187], v[88:91]
  ds_read_b64_tr_b16 v[48:49], v22 offset:64
  v_mfma_f32_16x16x32_bf16 v[128:131], v[56:59], v[188:191], v[128:131]
  ds_read_b64_tr_b16 v[50:51], v22 offset:5184
  buffer_load_dwordx4 v19, s[8:11], s71 offen offset:2048 lds
  s_waitcnt lgkmcnt(10)
  v_mfma_f32_16x16x32_bf16 v[132:135], v[60:63], v[188:191], v[132:135]
  ds_read_b64_tr_b16 v[52:53], v23 offset:64
  v_mfma_f32_16x16x32_bf16 v[92:95], v[60:63], v[184:187], v[92:95]
  ds_read_b64_tr_b16 v[54:55], v23 offset:5184
  buffer_load_dwordx4 v20, s[8:11], s71 offen offset:3072 lds
  s_add_u32 m0, s69, 126976
  s_waitcnt lgkmcnt(10)
  v_mfma_f32_16x16x32_bf16 v[96:99], v[32:35], v[184:187], v[96:99]
  ds_read_b64_tr_b16 v[56:57], v22 offset:128
  v_mfma_f32_16x16x32_bf16 v[136:139], v[32:35], v[188:191], v[136:139]
  ds_read_b64_tr_b16 v[58:59], v22 offset:5248
  buffer_load_dwordx4 v21, s[8:11], s71 offen lds
  s_add_u32 s71, s71, 163840
  s_waitcnt lgkmcnt(10)
  v_mfma_f32_16x16x32_bf16 v[140:143], v[36:39], v[188:191], v[140:143]
  ds_read_b64_tr_b16 v[60:61], v23 offset:128
  v_mfma_f32_16x16x32_bf16 v[100:103], v[36:39], v[184:187], v[100:103]
  ds_read_b64_tr_b16 v[62:63], v23 offset:5248
  s_waitcnt lgkmcnt(10)
  v_mfma_f32_16x16x32_bf16 v[64:67], v[40:43], v[192:195], v[64:67]
  ds_read_b64_tr_b16 v[32:33], v22 offset:192
  v_mfma_f32_16x16x32_bf16 v[104:107], v[40:43], v[196:199], v[104:107]
  ds_read_b64_tr_b16 v[34:35], v22 offset:5312
  buffer_load_dwordx4 v[240:243], v16, s[12:15], s72 offen offset:0 sc1
  s_waitcnt lgkmcnt(10)
  v_mfma_f32_16x16x32_bf16 v[108:111], v[44:47], v[196:199], v[108:111]
  ds_read_b64_tr_b16 v[36:37], v23 offset:192
  v_mfma_f32_16x16x32_bf16 v[68:71], v[44:47], v[192:195], v[68:71]
  ds_read_b64_tr_b16 v[38:39], v23 offset:5312
  buffer_load_dwordx4 v[244:247], v16, s[12:15], s73 offen offset:0 sc1
  s_waitcnt lgkmcnt(10)
  v_mfma_f32_16x16x32_bf16 v[72:75], v[48:51], v[192:195], v[72:75]
  ds_read_b64_tr_b16 v[40:41], v22 offset:256
  v_mfma_f32_16x16x32_bf16 v[112:115], v[48:51], v[196:199], v[112:115]
  ds_read_b64_tr_b16 v[42:43], v22 offset:5376
  s_waitcnt lgkmcnt(10)
  v_mfma_f32_16x16x32_bf16 v[116:119], v[52:55], v[196:199], v[116:119]
  ds_read_b64_tr_b16 v[44:45], v23 offset:256
  v_mfma_f32_16x16x32_bf16 v[76:79], v[52:55], v[192:195], v[76:79]
  ds_read_b64_tr_b16 v[46:47], v23 offset:5376
  s_waitcnt lgkmcnt(10)
  v_mfma_f32_16x16x32_bf16 v[80:83], v[56:59], v[192:195], v[80:83]
  ds_read_b64_tr_b16 v[48:49], v22 offset:20480
  v_mfma_f32_16x16x32_bf16 v[120:123], v[56:59], v[196:199], v[120:123]
  ds_read_b64_tr_b16 v[50:51], v22 offset:25600
  s_waitcnt lgkmcnt(10)
  v_mfma_f32_16x16x32_bf16 v[124:127], v[60:63], v[196:199], v[124:127]
  ds_read_b64_tr_b16 v[52:53], v23 offset:20480
  v_mfma_f32_16x16x32_bf16 v[84:87], v[60:63], v[192:195], v[84:87]
  ds_read_b64_tr_b16 v[54:55], v23 offset:25600
  s_waitcnt lgkmcnt(10)
  v_mfma_f32_16x16x32_bf16 v[88:91], v[32:35], v[192:195], v[88:91]
  ds_read_b64_tr_b16 v[56:57], v22 offset:20544
  v_mfma_f32_16x16x32_bf16 v[128:131], v[32:35], v[196:199], v[128:131]
  ds_read_b64_tr_b16 v[58:59], v22 offset:25664
  s_waitcnt lgkmcnt(10)
  v_mfma_f32_16x16x32_bf16 v[132:135], v[36:39], v[196:199], v[132:135]
  ds_read_b64_tr_b16 v[60:61], v23 offset:20544
  v_mfma_f32_16x16x32_bf16 v[92:95], v[36:39], v[192:195], v[92:95]
  ds_read_b64_tr_b16 v[62:63], v23 offset:25664
  s_waitcnt lgkmcnt(10)
  v_mfma_f32_16x16x32_bf16 v[96:99], v[40:43], v[192:195], v[96:99]
  ds_read_b64_tr_b16 v[32:33], v22 offset:20608
  v_mfma_f32_16x16x32_bf16 v[136:139], v[40:43], v[196:199], v[136:139]
  ds_read_b64_tr_b16 v[34:35], v22 offset:25728
  s_waitcnt lgkmcnt(10)
  v_mfma_f32_16x16x32_bf16 v[140:143], v[44:47], v[196:199], v[140:143]
  ds_read_b64_tr_b16 v[36:37], v23 offset:20608
  v_mfma_f32_16x16x32_bf16 v[100:103], v[44:47], v[192:195], v[100:103]
  ds_read_b64_tr_b16 v[38:39], v23 offset:25728
  s_waitcnt vmcnt(21) lgkmcnt(10)
  v_mfma_f32_16x16x32_bf16 v[64:67], v[48:51], v[200:203], v[64:67]
  ds_read_b64_tr_b16 v[40:41], v22 offset:20672
  s_waitcnt vmcnt(20)
  v_mfma_f32_16x16x32_bf16 v[104:107], v[48:51], v[204:207], v[104:107]
  ds_read_b64_tr_b16 v[42:43], v22 offset:25792
  buffer_load_dwordx4 v[248:251], v16, s[12:15], s72 offen offset:2048 sc1
  s_waitcnt lgkmcnt(10)
  v_mfma_f32_16x16x32_bf16 v[108:111], v[52:55], v[204:207], v[108:111]
  ds_read_b64_tr_b16 v[44:45], v23 offset:20672
  v_mfma_f32_16x16x32_bf16 v[68:71], v[52:55], v[200:203], v[68:71]
  ds_read_b64_tr_b16 v[46:47], v23 offset:25792
  buffer_load_dwordx4 v[252:255], v16, s[12:15], s73 offen offset:2048 sc1
  s_add_u32 s72, s72, 4096
  s_add_u32 s73, s73, 4096
  s_waitcnt lgkmcnt(10)
  v_mfma_f32_16x16x32_bf16 v[72:75], v[56:59], v[200:203], v[72:75]
  ds_read_b64_tr_b16 v[48:49], v22 offset:20736
  v_mfma_f32_16x16x32_bf16 v[112:115], v[56:59], v[204:207], v[112:115]
  ds_read_b64_tr_b16 v[50:51], v22 offset:25856
  s_waitcnt lgkmcnt(10)
  v_mfma_f32_16x16x32_bf16 v[116:119], v[60:63], v[204:207], v[116:119]
  ds_read_b64_tr_b16 v[52:53], v23 offset:20736
  v_mfma_f32_16x16x32_bf16 v[76:79], v[60:63], v[200:203], v[76:79]
  ds_read_b64_tr_b16 v[54:55], v23 offset:25856
  s_waitcnt vmcnt(17)
  s_barrier
  v_add_u32 v22, 0xa000, v22
  v_add_u32 v23, 0xa000, v23
  s_waitcnt lgkmcnt(10)
  v_mfma_f32_16x16x32_bf16 v[80:83], v[32:35], v[200:203], v[80:83]
  ds_read_b64_tr_b16 v[56:57], v22 offset:0
  v_mfma_f32_16x16x32_bf16 v[120:123], v[32:35], v[204:207], v[120:123]
  ds_read_b64_tr_b16 v[58:59], v22 offset:5120
  s_add_u32 m0, s69, 0
  s_nop 0
  buffer_load_dwordx4 v17, s[8:11], s71 offen offset:0 lds
  s_waitcnt lgkmcnt(10)
  v_mfma_f32_16x16x32_bf16 v[124:127], v[36:39], v[204:207], v[124:127]
  ds_read_b64_tr_b16 v[60:61], v23 offset:0
  v_mfma_f32_16x16x32_bf16 v[84:87], v[36:39], v[200:203], v[84:87]
  ds_read_b64_tr_b16 v[62:63], v23 offset:5120
  buffer_load_dwordx4 v18, s[8:11], s71 offen offset:1024 lds
  s_waitcnt lgkmcnt(10)
  v_mfma_f32_16x16x32_bf16 v[88:91], v[40:43], v[200:203], v[88:91]
  ds_read_b64_tr_b16 v[32:33], v22 offset:64
  v_mfma_f32_16x16x32_bf16 v[128:131], v[40:43], v[204:207], v[128:131]
  ds_read_b64_tr_b16 v[34:35], v22 offset:5184
  buffer_load_dwordx4 v19, s[8:11], s71 offen offset:2048 lds
  s_waitcnt lgkmcnt(10)
  v_mfma_f32_16x16x32_bf16 v[132:135], v[44:47], v[204:207], v[132:135]
  ds_read_b64_tr_b16 v[36:37], v23 offset:64
  v_mfma_f32_16x16x32_bf16 v[92:95], v[44:47], v[200:203], v[92:95]
  ds_read_b64_tr_b16 v[38:39], v23 offset:5184
  buffer_load_dwordx4 v20, s[8:11], s71 offen offset:3072 lds
  s_add_u32 m0, s69, 4096
  s_waitcnt lgkmcnt(10)
  v_mfma_f32_16x16x32_bf16 v[96:99], v[48:51], v[200:203], v[96:99]
  ds_read_b64_tr_b16 v[40:41], v22 offset:128
  v_mfma_f32_16x16x32_bf16 v[136:139], v[48:51], v[204:207], v[136:139]
  ds_read_b64_tr_b16 v[42:43], v22 offset:5248
  buffer_load_dwordx4 v21, s[8:11], s71 offen lds
  s_add_u32 s71, s71, 163840
  s_waitcnt lgkmcnt(10)
  v_mfma_f32_16x16x32_bf16 v[140:143], v[52:55], v[204:207], v[140:143]
  ds_read_b64_tr_b16 v[44:45], v23 offset:128
  v_mfma_f32_16x16x32_bf16 v[100:103], v[52:55], v[200:203], v[100:103]
  ds_read_b64_tr_b16 v[46:47], v23 offset:5248
  s_waitcnt vmcnt(21) lgkmcnt(10)
  v_mfma_f32_16x16x32_bf16 v[64:67], v[56:59], v[208:211], v[64:67]
  ds_read_b64_tr_b16 v[48:49], v22 offset:192
  s_waitcnt vmcnt(20)
  v_mfma_f32_16x16x32_bf16 v[104:107], v[56:59], v[212:215], v[104:107]
  ds_read_b64_tr_b16 v[50:51], v22 offset:5312
  buffer_load_dwordx4 v[144:147], v16, s[12:15], s72 offen offset:0 sc1
  s_waitcnt lgkmcnt(10)
  v_mfma_f32_16x16x32_bf16 v[108:111], v[60:63], v[212:215], v[108:111]
  ds_read_b64_tr_b16 v[52:53], v23 offset:192
  v_mfma_f32_16x16x32_bf16 v[68:71], v[60:63], v[208:211], v[68:71]
  ds_read_b64_tr_b16 v[54:55], v23 offset:5312
  buffer_load_dwordx4 v[148:151], v16, s[12:15], s73 offen offset:0 sc1
  s_waitcnt lgkmcnt(10)
  v_mfma_f32_16x16x32_bf16 v[72:75], v[32:35], v[208:211], v[72:75]
  ds_read_b64_tr_b16 v[56:57], v22 offset:256
  v_mfma_f32_16x16x32_bf16 v[112:115], v[32:35], v[212:215], v[112:115]
  ds_read_b64_tr_b16 v[58:59], v22 offset:5376
  s_waitcnt lgkmcnt(10)
  v_mfma_f32_16x16x32_bf16 v[116:119], v[36:39], v[212:215], v[116:119]
  ds_read_b64_tr_b16 v[60:61], v23 offset:256
  v_mfma_f32_16x16x32_bf16 v[76:79], v[36:39], v[208:211], v[76:79]
  ds_read_b64_tr_b16 v[62:63], v23 offset:5376
  s_waitcnt lgkmcnt(10)
  v_mfma_f32_16x16x32_bf16 v[80:83], v[40:43], v[208:211], v[80:83]
  ds_read_b64_tr_b16 v[32:33], v22 offset:20480
  v_mfma_f32_16x16x32_bf16 v[120:123], v[40:43], v[212:215], v[120:123]
  ds_read_b64_tr_b16 v[34:35], v22 offset:25600
  s_waitcnt lgkmcnt(10)
  v_mfma_f32_16x16x32_bf16 v[124:127], v[44:47], v[212:215], v[124:127]
  ds_read_b64_tr_b16 v[36:37], v23 offset:20480
  v_mfma_f32_16x16x32_bf16 v[84:87], v[44:47], v[208:211], v[84:87]
  ds_read_b64_tr_b16 v[38:39], v23 offset:25600
  s_waitcnt lgkmcnt(10)
  v_mfma_f32_16x16x32_bf16 v[88:91], v[48:51], v[208:211], v[88:91]
  ds_read_b64_tr_b16 v[40:41], v22 offset:20544
  v_mfma_f32_16x16x32_bf16 v[128:131], v[48:51], v[212:215], v[128:131]
  ds_read_b64_tr_b16 v[42:43], v22 offset:25664
  s_waitcnt lgkmcnt(10)
  v_mfma_f32_16x16x32_bf16 v[132:135], v[52:55], v[212:215], v[132:135]
  ds_read_b64_tr_b16 v[44:45], v23 offset:20544
  v_mfma_f32_16x16x32_bf16 v[92:95], v[52:55], v[208:211], v[92:95]
  ds_read_b64_tr_b16 v[46:47], v23 offset:25664
  s_waitcnt lgkmcnt(10)
  v_mfma_f32_16x16x32_bf16 v[96:99], v[56:59], v[208:211], v[96:99]
  ds_read_b64_tr_b16 v[48:49], v22 offset:20608
  v_mfma_f32_16x16x32_bf16 v[136:139], v[56:59], v[212:215], v[136:139]
  ds_read_b64_tr_b16 v[50:51], v22 offset:25728
  s_waitcnt lgkmcnt(10)
  v_mfma_f32_16x16x32_bf16 v[140:143], v[60:63], v[212:215], v[140:143]
  ds_read_b64_tr_b16 v[52:53], v23 offset:20608
  v_mfma_f32_16x16x32_bf16 v[100:103], v[60:63], v[208:211], v[100:103]
  ds_read_b64_tr_b16 v[54:55], v23 offset:25728
  s_waitcnt vmcnt(21) lgkmcnt(10)
  v_mfma_f32_16x16x32_bf16 v[64:67], v[32:35], v[216:219], v[64:67]
  ds_read_b64_tr_b16 v[56:57], v22 offset:20672
  s_waitcnt vmcnt(20)
  v_mfma_f32_16x16x32_bf16 v[104:107], v[32:35], v[220:223], v[104:107]
  ds_read_b64_tr_b16 v[58:59], v22 offset:25792
  buffer_load_dwordx4 v[152:155], v16, s[12:15], s72 offen offset:2048 sc1
  s_waitcnt lgkmcnt(10)
  v_mfma_f32_16x16x32_bf16 v[108:111], v[36:39], v[220:223], v[108:111]
  ds_read_b64_tr_b16 v[60:61], v23 offset:20672
  v_mfma_f32_16x16x32_bf16 v[68:71], v[36:39], v[216:219], v[68:71]
  ds_read_b64_tr_b16 v[62:63], v23 offset:25792
  buffer_load_dwordx4 v[156:159], v16, s[12:15], s73 offen offset:2048 sc1
  s_add_u32 s72, s72, 4096
  s_add_u32 s73, s73, 4096
  s_waitcnt lgkmcnt(10)
  v_mfma_f32_16x16x32_bf16 v[72:75], v[40:43], v[216:219], v[72:75]
  ds_read_b64_tr_b16 v[32:33], v22 offset:20736
  v_mfma_f32_16x16x32_bf16 v[112:115], v[40:43], v[220:223], v[112:115]
  ds_read_b64_tr_b16 v[34:35], v22 offset:25856
  s_waitcnt lgkmcnt(10)
  v_mfma_f32_16x16x32_bf16 v[116:119], v[44:47], v[220:223], v[116:119]
  ds_read_b64_tr_b16 v[36:37], v23 offset:20736
  v_mfma_f32_16x16x32_bf16 v[76:79], v[44:47], v[216:219], v[76:79]
  ds_read_b64_tr_b16 v[38:39], v23 offset:25856
  s_waitcnt vmcnt(13)
  s_barrier
  v_add_u32 v22, 0xa000, v22
  v_add_u32 v23, 0xa000, v23
  s_waitcnt lgkmcnt(10)
  v_mfma_f32_16x16x32_bf16 v[80:83], v[48:51], v[216:219], v[80:83]
  ds_read_b64_tr_b16 v[40:41], v22 offset:0
  v_mfma_f32_16x16x32_bf16 v[120:123], v[48:51], v[220:223], v[120:123]
  ds_read_b64_tr_b16 v[42:43], v22 offset:5120
  s_add_u32 m0, s69, 40960
  s_nop 0
  buffer_load_dwordx4 v17, s[8:11], s71 offen offset:0 lds
  s_waitcnt lgkmcnt(10)
  v_mfma_f32_16x16x32_bf16 v[124:127], v[52:55], v[220:223], v[124:127]
  ds_read_b64_tr_b16 v[44:45], v23 offset:0
  v_mfma_f32_16x16x32_bf16 v[84:87], v[52:55], v[216:219], v[84:87]
  ds_read_b64_tr_b16 v[46:47], v23 offset:5120
  buffer_load_dwordx4 v18, s[8:11], s71 offen offset:1024 lds
  s_waitcnt lgkmcnt(10)
  v_mfma_f32_16x16x32_bf16 v[88:91], v[56:59], v[216:219], v[88:91]
  ds_read_b64_tr_b16 v[48:49], v22 offset:64
  v_mfma_f32_16x16x32_bf16 v[128:131], v[56:59], v[220:223], v[128:131]
  ds_read_b64_tr_b16 v[50:51], v22 offset:5184
  buffer_load_dwordx4 v19, s[8:11], s71 offen offset:2048 lds
  s_waitcnt lgkmcnt(10)
  v_mfma_f32_16x16x32_bf16 v[132:135], v[60:63], v[220:223], v[132:135]
  ds_read_b64_tr_b16 v[52:53], v23 offset:64
  v_mfma_f32_16x16x32_bf16 v[92:95], v[60:63], v[216:219], v[92:95]
  ds_read_b64_tr_b16 v[54:55], v23 offset:5184
  buffer_load_dwordx4 v20, s[8:11], s71 offen offset:3072 lds
  s_add_u32 m0, s69, 45056
  s_waitcnt lgkmcnt(10)
  v_mfma_f32_16x16x32_bf16 v[96:99], v[32:35], v[216:219], v[96:99]
  ds_read_b64_tr_b16 v[56:57], v22 offset:128
  v_mfma_f32_16x16x32_bf16 v[136:139], v[32:35], v[220:223], v[136:139]
  ds_read_b64_tr_b16 v[58:59], v22 offset:5248
  buffer_load_dwordx4 v21, s[8:11], s71 offen lds
  s_add_u32 s71, s71, 163840
  s_waitcnt lgkmcnt(10)
  v_mfma_f32_16x16x32_bf16 v[140:143], v[36:39], v[220:223], v[140:143]
  ds_read_b64_tr_b16 v[60:61], v23 offset:128
  v_mfma_f32_16x16x32_bf16 v[100:103], v[36:39], v[216:219], v[100:103]
  ds_read_b64_tr_b16 v[62:63], v23 offset:5248
  s_waitcnt lgkmcnt(10)
  v_mfma_f32_16x16x32_bf16 v[64:67], v[40:43], v[224:227], v[64:67]
  ds_read_b64_tr_b16 v[32:33], v22 offset:192
  v_mfma_f32_16x16x32_bf16 v[104:107], v[40:43], v[228:231], v[104:107]
  ds_read_b64_tr_b16 v[34:35], v22 offset:5312
  buffer_load_dwordx4 v[160:163], v16, s[12:15], s72 offen offset:0 sc1
  s_waitcnt lgkmcnt(10)
  v_mfma_f32_16x16x32_bf16 v[108:111], v[44:47], v[228:231], v[108:111]
  ds_read_b64_tr_b16 v[36:37], v23 offset:192
  v_mfma_f32_16x16x32_bf16 v[68:71], v[44:47], v[224:227], v[68:71]
  ds_read_b64_tr_b16 v[38:39], v23 offset:5312
  buffer_load_dwordx4 v[164:167], v16, s[12:15], s73 offen offset:0 sc1
  s_waitcnt lgkmcnt(10)
  v_mfma_f32_16x16x32_bf16 v[72:75], v[48:51], v[224:227], v[72:75]
  ds_read_b64_tr_b16 v[40:41], v22 offset:256
  v_mfma_f32_16x16x32_bf16 v[112:115], v[48:51], v[228:231], v[112:115]
  ds_read_b64_tr_b16 v[42:43], v22 offset:5376
  s_waitcnt lgkmcnt(10)
  v_mfma_f32_16x16x32_bf16 v[116:119], v[52:55], v[228:231], v[116:119]
  ds_read_b64_tr_b16 v[44:45], v23 offset:256
  v_mfma_f32_16x16x32_bf16 v[76:79], v[52:55], v[224:227], v[76:79]
  ds_read_b64_tr_b16 v[46:47], v23 offset:5376
  s_waitcnt lgkmcnt(10)
  v_mfma_f32_16x16x32_bf16 v[80:83], v[56:59], v[224:227], v[80:83]
  ds_read_b64_tr_b16 v[48:49], v22 offset:20480
  v_mfma_f32_16x16x32_bf16 v[120:123], v[56:59], v[228:231], v[120:123]
  ds_read_b64_tr_b16 v[50:51], v22 offset:25600
  s_waitcnt lgkmcnt(10)
  v_mfma_f32_16x16x32_bf16 v[124:127], v[60:63], v[228:231], v[124:127]
  ds_read_b64_tr_b16 v[52:53], v23 offset:20480
  v_mfma_f32_16x16x32_bf16 v[84:87], v[60:63], v[224:227], v[84:87]
  ds_read_b64_tr_b16 v[54:55], v23 offset:25600
  s_waitcnt lgkmcnt(10)
  v_mfma_f32_16x16x32_bf16 v[88:91], v[32:35], v[224:227], v[88:91]
  ds_read_b64_tr_b16 v[56:57], v22 offset:20544
  v_mfma_f32_16x16x32_bf16 v[128:131], v[32:35], v[228:231], v[128:131]
  ds_read_b64_tr_b16 v[58:59], v22 offset:25664
  s_waitcnt lgkmcnt(10)
  v_mfma_f32_16x16x32_bf16 v[132:135], v[36:39], v[228:231], v[132:135]
  ds_read_b64_tr_b16 v[60:61], v23 offset:20544
  v_mfma_f32_16x16x32_bf16 v[92:95], v[36:39], v[224:227], v[92:95]
  ds_read_b64_tr_b16 v[62:63], v23 offset:25664
  s_waitcnt lgkmcnt(10)
  v_mfma_f32_16x16x32_bf16 v[96:99], v[40:43], v[224:227], v[96:99]
  ds_read_b64_tr_b16 v[32:33], v22 offset:20608
  v_mfma_f32_16x16x32_bf16 v[136:139], v[40:43], v[228:231], v[136:139]
  ds_read_b64_tr_b16 v[34:35], v22 offset:25728
  s_waitcnt lgkmcnt(10)
  v_mfma_f32_16x16x32_bf16 v[140:143], v[44:47], v[228:231], v[140:143]
  ds_read_b64_tr_b16 v[36:37], v23 offset:20608
  v_mfma_f32_16x16x32_bf16 v[100:103], v[44:47], v[224:227], v[100:103]
  ds_read_b64_tr_b16 v[38:39], v23 offset:25728
  s_waitcnt lgkmcnt(10)
  v_mfma_f32_16x16x32_bf16 v[64:67], v[48:51], v[232:235], v[64:67]
  ds_read_b64_tr_b16 v[40:41], v22 offset:20672
  v_mfma_f32_16x16x32_bf16 v[104:107], v[48:51], v[236:239], v[104:107]
  ds_read_b64_tr_b16 v[42:43], v22 offset:25792
  buffer_load_dwordx4 v[168:171], v16, s[12:15], s72 offen offset:2048 sc1
  s_waitcnt lgkmcnt(10)
  v_mfma_f32_16x16x32_bf16 v[108:111], v[52:55], v[236:239], v[108:111]
  ds_read_b64_tr_b16 v[44:45], v23 offset:20672
  v_mfma_f32_16x16x32_bf16 v[68:71], v[52:55], v[232:235], v[68:71]
  ds_read_b64_tr_b16 v[46:47], v23 offset:25792
  buffer_load_dwordx4 v[172:175], v16, s[12:15], s73 offen offset:2048 sc1
  s_add_u32 s72, s72, 4096
  s_add_u32 s73, s73, 4096
  s_waitcnt lgkmcnt(10)
  v_mfma_f32_16x16x32_bf16 v[72:75], v[56:59], v[232:235], v[72:75]
  ds_read_b64_tr_b16 v[48:49], v22 offset:20736
  v_mfma_f32_16x16x32_bf16 v[112:115], v[56:59], v[236:239], v[112:115]
  ds_read_b64_tr_b16 v[50:51], v22 offset:25856
  s_waitcnt lgkmcnt(10)
  v_mfma_f32_16x16x32_bf16 v[116:119], v[60:63], v[236:239], v[116:119]
  ds_read_b64_tr_b16 v[52:53], v23 offset:20736
  v_mfma_f32_16x16x32_bf16 v[76:79], v[60:63], v[232:235], v[76:79]
  ds_read_b64_tr_b16 v[54:55], v23 offset:25856
  s_waitcnt vmcnt(13)
  s_barrier
  v_add_u32 v22, 0xfffe2000, v22
  v_add_u32 v23, 0xfffe2000, v23
  s_waitcnt lgkmcnt(10)
  v_mfma_f32_16x16x32_bf16 v[80:83], v[32:35], v[232:235], v[80:83]
  ds_read_b64_tr_b16 v[56:57], v22 offset:0
  v_mfma_f32_16x16x32_bf16 v[120:123], v[32:35], v[236:239], v[120:123]
  ds_read_b64_tr_b16 v[58:59], v22 offset:5120
  s_add_u32 m0, s69, 81920
  s_nop 0
  buffer_load_dwordx4 v17, s[8:11], s71 offen offset:0 lds
  s_waitcnt lgkmcnt(10)
  v_mfma_f32_16x16x32_bf16 v[124:127], v[36:39], v[236:239], v[124:127]
  ds_read_b64_tr_b16 v[60:61], v23 offset:0
  v_mfma_f32_16x16x32_bf16 v[84:87], v[36:39], v[232:235], v[84:87]
  ds_read_b64_tr_b16 v[62:63], v23 offset:5120
  buffer_load_dwordx4 v18, s[8:11], s71 offen offset:1024 lds
  s_waitcnt lgkmcnt(10)
  v_mfma_f32_16x16x32_bf16 v[88:91], v[40:43], v[232:235], v[88:91]
  ds_read_b64_tr_b16 v[32:33], v22 offset:64
  v_mfma_f32_16x16x32_bf16 v[128:131], v[40:43], v[236:239], v[128:131]
  ds_read_b64_tr_b16 v[34:35], v22 offset:5184
  buffer_load_dwordx4 v19, s[8:11], s71 offen offset:2048 lds
  s_waitcnt lgkmcnt(10)
  v_mfma_f32_16x16x32_bf16 v[132:135], v[44:47], v[236:239], v[132:135]
  ds_read_b64_tr_b16 v[36:37], v23 offset:64
  v_mfma_f32_16x16x32_bf16 v[92:95], v[44:47], v[232:235], v[92:95]
  ds_read_b64_tr_b16 v[38:39], v23 offset:5184
  buffer_load_dwordx4 v20, s[8:11], s71 offen offset:3072 lds
  s_add_u32 m0, s69, 86016
  s_waitcnt lgkmcnt(10)
  v_mfma_f32_16x16x32_bf16 v[96:99], v[48:51], v[232:235], v[96:99]
  ds_read_b64_tr_b16 v[40:41], v22 offset:128
  v_mfma_f32_16x16x32_bf16 v[136:139], v[48:51], v[236:239], v[136:139]
  ds_read_b64_tr_b16 v[42:43], v22 offset:5248
  buffer_load_dwordx4 v21, s[8:11], s71 offen lds
  s_add_u32 s71, s71, 163840
  s_waitcnt lgkmcnt(10)
  v_mfma_f32_16x16x32_bf16 v[140:143], v[52:55], v[236:239], v[140:143]
  ds_read_b64_tr_b16 v[44:45], v23 offset:128
  v_mfma_f32_16x16x32_bf16 v[100:103], v[52:55], v[232:235], v[100:103]
  ds_read_b64_tr_b16 v[46:47], v23 offset:5248
  s_waitcnt lgkmcnt(10)
  v_mfma_f32_16x16x32_bf16 v[64:67], v[56:59], v[240:243], v[64:67]
  ds_read_b64_tr_b16 v[48:49], v22 offset:192
  v_mfma_f32_16x16x32_bf16 v[104:107], v[56:59], v[244:247], v[104:107]
  ds_read_b64_tr_b16 v[50:51], v22 offset:5312
  buffer_load_dwordx4 v[176:179], v16, s[12:15], s72 offen offset:0 sc1
  s_waitcnt lgkmcnt(10)
  v_mfma_f32_16x16x32_bf16 v[108:111], v[60:63], v[244:247], v[108:111]
  ds_read_b64_tr_b16 v[52:53], v23 offset:192
  v_mfma_f32_16x16x32_bf16 v[68:71], v[60:63], v[240:243], v[68:71]
  ds_read_b64_tr_b16 v[54:55], v23 offset:5312
  buffer_load_dwordx4 v[180:183], v16, s[12:15], s73 offen offset:0 sc1
  s_waitcnt lgkmcnt(10)
  v_mfma_f32_16x16x32_bf16 v[72:75], v[32:35], v[240:243], v[72:75]
  ds_read_b64_tr_b16 v[56:57], v22 offset:256
  v_mfma_f32_16x16x32_bf16 v[112:115], v[32:35], v[244:247], v[112:115]
  ds_read_b64_tr_b16 v[58:59], v22 offset:5376
  s_waitcnt lgkmcnt(10)
  v_mfma_f32_16x16x32_bf16 v[116:119], v[36:39], v[244:247], v[116:119]
  ds_read_b64_tr_b16 v[60:61], v23 offset:256
  v_mfma_f32_16x16x32_bf16 v[76:79], v[36:39], v[240:243], v[76:79]
  ds_read_b64_tr_b16 v[62:63], v23 offset:5376
  s_waitcnt lgkmcnt(10)
  v_mfma_f32_16x16x32_bf16 v[80:83], v[40:43], v[240:243], v[80:83]
  ds_read_b64_tr_b16 v[32:33], v22 offset:20480
  v_mfma_f32_16x16x32_bf16 v[120:123], v[40:43], v[244:247], v[120:123]
  ds_read_b64_tr_b16 v[34:35], v22 offset:25600
  s_waitcnt lgkmcnt(10)
  v_mfma_f32_16x16x32_bf16 v[124:127], v[44:47], v[244:247], v[124:127]
  ds_read_b64_tr_b16 v[36:37], v23 offset:20480
  v_mfma_f32_16x16x32_bf16 v[84:87], v[44:47], v[240:243], v[84:87]
  ds_read_b64_tr_b16 v[38:39], v23 offset:25600
  s_waitcnt lgkmcnt(10)
  v_mfma_f32_16x16x32_bf16 v[88:91], v[48:51], v[240:243], v[88:91]
  ds_read_b64_tr_b16 v[40:41], v22 offset:20544
  v_mfma_f32_16x16x32_bf16 v[128:131], v[48:51], v[244:247], v[128:131]
  ds_read_b64_tr_b16 v[42:43], v22 offset:25664
  s_waitcnt lgkmcnt(10)
  v_mfma_f32_16x16x32_bf16 v[132:135], v[52:55], v[244:247], v[132:135]
  ds_read_b64_tr_b16 v[44:45], v23 offset:20544
  v_mfma_f32_16x16x32_bf16 v[92:95], v[52:55], v[240:243], v[92:95]
  ds_read_b64_tr_b16 v[46:47], v23 offset:25664
  s_waitcnt lgkmcnt(10)
  v_mfma_f32_16x16x32_bf16 v[96:99], v[56:59], v[240:243], v[96:99]
  ds_read_b64_tr_b16 v[48:49], v22 offset:20608
  v_mfma_f32_16x16x32_bf16 v[136:139], v[56:59], v[244:247], v[136:139]
  ds_read_b64_tr_b16 v[50:51], v22 offset:25728
  s_waitcnt lgkmcnt(10)
  v_mfma_f32_16x16x32_bf16 v[140:143], v[60:63], v[244:247], v[140:143]
  ds_read_b64_tr_b16 v[52:53], v23 offset:20608
  v_mfma_f32_16x16x32_bf16 v[100:103], v[60:63], v[240:243], v[100:103]
  ds_read_b64_tr_b16 v[54:55], v23 offset:25728
  s_waitcnt lgkmcnt(10)
  v_mfma_f32_16x16x32_bf16 v[64:67], v[32:35], v[248:251], v[64:67]
  ds_read_b64_tr_b16 v[56:57], v22 offset:20672
  v_mfma_f32_16x16x32_bf16 v[104:107], v[32:35], v[252:255], v[104:107]
  ds_read_b64_tr_b16 v[58:59], v22 offset:25792
  buffer_load_dwordx4 v[184:187], v16, s[12:15], s72 offen offset:2048 sc1
  s_waitcnt lgkmcnt(10)
  v_mfma_f32_16x16x32_bf16 v[108:111], v[36:39], v[252:255], v[108:111]
  ds_read_b64_tr_b16 v[60:61], v23 offset:20672
  v_mfma_f32_16x16x32_bf16 v[68:71], v[36:39], v[248:251], v[68:71]
  ds_read_b64_tr_b16 v[62:63], v23 offset:25792
  buffer_load_dwordx4 v[188:191], v16, s[12:15], s73 offen offset:2048 sc1
  s_add_u32 s72, s72, 4096
  s_add_u32 s73, s73, 4096
  s_waitcnt lgkmcnt(10)
  v_mfma_f32_16x16x32_bf16 v[72:75], v[40:43], v[248:251], v[72:75]
  ds_read_b64_tr_b16 v[32:33], v22 offset:20736
  v_mfma_f32_16x16x32_bf16 v[112:115], v[40:43], v[252:255], v[112:115]
  ds_read_b64_tr_b16 v[34:35], v22 offset:25856
  s_waitcnt lgkmcnt(10)
  v_mfma_f32_16x16x32_bf16 v[116:119], v[44:47], v[252:255], v[116:119]
  ds_read_b64_tr_b16 v[36:37], v23 offset:20736
  v_mfma_f32_16x16x32_bf16 v[76:79], v[44:47], v[248:251], v[76:79]
  ds_read_b64_tr_b16 v[38:39], v23 offset:25856
  s_waitcnt vmcnt(13)
  s_barrier
  v_add_u32 v22, 0xa000, v22
  v_add_u32 v23, 0xa000, v23
  s_waitcnt lgkmcnt(10)
  v_mfma_f32_16x16x32_bf16 v[80:83], v[48:51], v[248:251], v[80:83]
  ds_read_b64_tr_b16 v[40:41], v22 offset:0
  v_mfma_f32_16x16x32_bf16 v[120:123], v[48:51], v[252:255], v[120:123]
  ds_read_b64_tr_b16 v[42:43], v22 offset:5120
  s_add_u32 m0, s69, 122880
  s_nop 0
  buffer_load_dwordx4 v17, s[8:11], s71 offen offset:0 lds
  s_waitcnt lgkmcnt(10)
  v_mfma_f32_16x16x32_bf16 v[124:127], v[52:55], v[252:255], v[124:127]
  ds_read_b64_tr_b16 v[44:45], v23 offset:0
  v_mfma_f32_16x16x32_bf16 v[84:87], v[52:55], v[248:251], v[84:87]
  ds_read_b64_tr_b16 v[46:47], v23 offset:5120
  buffer_load_dwordx4 v18, s[8:11], s71 offen offset:1024 lds
  s_waitcnt lgkmcnt(10)
  v_mfma_f32_16x16x32_bf16 v[88:91], v[56:59], v[248:251], v[88:91]
  ds_read_b64_tr_b16 v[48:49], v22 offset:64
  v_mfma_f32_16x16x32_bf16 v[128:131], v[56:59], v[252:255], v[128:131]
  ds_read_b64_tr_b16 v[50:51], v22 offset:5184
  buffer_load_dwordx4 v19, s[8:11], s71 offen offset:2048 lds
  s_waitcnt lgkmcnt(10)
  v_mfma_f32_16x16x32_bf16 v[132:135], v[60:63], v[252:255], v[132:135]
  ds_read_b64_tr_b16 v[52:53], v23 offset:64
  v_mfma_f32_16x16x32_bf16 v[92:95], v[60:63], v[248:251], v[92:95]
  ds_read_b64_tr_b16 v[54:55], v23 offset:5184
  buffer_load_dwordx4 v20, s[8:11], s71 offen offset:3072 lds
  s_add_u32 m0, s69, 126976
  s_waitcnt lgkmcnt(10)
  v_mfma_f32_16x16x32_bf16 v[96:99], v[32:35], v[248:251], v[96:99]
  ds_read_b64_tr_b16 v[56:57], v22 offset:128
  v_mfma_f32_16x16x32_bf16 v[136:139], v[32:35], v[252:255], v[136:139]
  ds_read_b64_tr_b16 v[58:59], v22 offset:5248
  buffer_load_dwordx4 v21, s[8:11], s71 offen lds
  s_waitcnt lgkmcnt(10)
  v_mfma_f32_16x16x32_bf16 v[140:143], v[36:39], v[252:255], v[140:143]
  ds_read_b64_tr_b16 v[60:61], v23 offset:128
  v_mfma_f32_16x16x32_bf16 v[100:103], v[36:39], v[248:251], v[100:103]
  ds_read_b64_tr_b16 v[62:63], v23 offset:5248
  s_waitcnt lgkmcnt(10)
  v_mfma_f32_16x16x32_bf16 v[64:67], v[40:43], v[144:147], v[64:67]
  ds_read_b64_tr_b16 v[32:33], v22 offset:192
  v_mfma_f32_16x16x32_bf16 v[104:107], v[40:43], v[148:151], v[104:107]
  ds_read_b64_tr_b16 v[34:35], v22 offset:5312
  s_waitcnt lgkmcnt(10)
  v_mfma_f32_16x16x32_bf16 v[108:111], v[44:47], v[148:151], v[108:111]
  ds_read_b64_tr_b16 v[36:37], v23 offset:192
  v_mfma_f32_16x16x32_bf16 v[68:71], v[44:47], v[144:147], v[68:71]
  ds_read_b64_tr_b16 v[38:39], v23 offset:5312
  s_waitcnt lgkmcnt(10)
  v_mfma_f32_16x16x32_bf16 v[72:75], v[48:51], v[144:147], v[72:75]
  ds_read_b64_tr_b16 v[40:41], v22 offset:256
  v_mfma_f32_16x16x32_bf16 v[112:115], v[48:51], v[148:151], v[112:115]
  ds_read_b64_tr_b16 v[42:43], v22 offset:5376
  s_waitcnt lgkmcnt(10)
  v_mfma_f32_16x16x32_bf16 v[116:119], v[52:55], v[148:151], v[116:119]
  ds_read_b64_tr_b16 v[44:45], v23 offset:256
  v_mfma_f32_16x16x32_bf16 v[76:79], v[52:55], v[144:147], v[76:79]
  ds_read_b64_tr_b16 v[46:47], v23 offset:5376
  s_waitcnt lgkmcnt(10)
  v_mfma_f32_16x16x32_bf16 v[80:83], v[56:59], v[144:147], v[80:83]
  ds_read_b64_tr_b16 v[48:49], v22 offset:20480
  v_mfma_f32_16x16x32_bf16 v[120:123], v[56:59], v[148:151], v[120:123]
  ds_read_b64_tr_b16 v[50:51], v22 offset:25600
  s_waitcnt lgkmcnt(10)
  v_mfma_f32_16x16x32_bf16 v[124:127], v[60:63], v[148:151], v[124:127]
  ds_read_b64_tr_b16 v[52:53], v23 offset:20480
  v_mfma_f32_16x16x32_bf16 v[84:87], v[60:63], v[144:147], v[84:87]
  ds_read_b64_tr_b16 v[54:55], v23 offset:25600
  s_waitcnt lgkmcnt(10)
  v_mfma_f32_16x16x32_bf16 v[88:91], v[32:35], v[144:147], v[88:91]
  ds_read_b64_tr_b16 v[56:57], v22 offset:20544
  v_mfma_f32_16x16x32_bf16 v[128:131], v[32:35], v[148:151], v[128:131]
  ds_read_b64_tr_b16 v[58:59], v22 offset:25664
  s_waitcnt lgkmcnt(10)
  v_mfma_f32_16x16x32_bf16 v[132:135], v[36:39], v[148:151], v[132:135]
  ds_read_b64_tr_b16 v[60:61], v23 offset:20544
  v_mfma_f32_16x16x32_bf16 v[92:95], v[36:39], v[144:147], v[92:95]
  ds_read_b64_tr_b16 v[62:63], v23 offset:25664
  s_waitcnt lgkmcnt(10)
  v_mfma_f32_16x16x32_bf16 v[96:99], v[40:43], v[144:147], v[96:99]
  ds_read_b64_tr_b16 v[32:33], v22 offset:20608
  v_mfma_f32_16x16x32_bf16 v[136:139], v[40:43], v[148:151], v[136:139]
  ds_read_b64_tr_b16 v[34:35], v22 offset:25728
  s_waitcnt lgkmcnt(10)
  v_mfma_f32_16x16x32_bf16 v[140:143], v[44:47], v[148:151], v[140:143]
  ds_read_b64_tr_b16 v[36:37], v23 offset:20608
  v_mfma_f32_16x16x32_bf16 v[100:103], v[44:47], v[144:147], v[100:103]
  ds_read_b64_tr_b16 v[38:39], v23 offset:25728
  s_waitcnt lgkmcnt(10)
  v_mfma_f32_16x16x32_bf16 v[64:67], v[48:51], v[152:155], v[64:67]
  ds_read_b64_tr_b16 v[40:41], v22 offset:20672
  v_mfma_f32_16x16x32_bf16 v[104:107], v[48:51], v[156:159], v[104:107]
  ds_read_b64_tr_b16 v[42:43], v22 offset:25792
  s_waitcnt lgkmcnt(10)
  v_mfma_f32_16x16x32_bf16 v[108:111], v[52:55], v[156:159], v[108:111]
  ds_read_b64_tr_b16 v[44:45], v23 offset:20672
  v_mfma_f32_16x16x32_bf16 v[68:71], v[52:55], v[152:155], v[68:71]
  ds_read_b64_tr_b16 v[46:47], v23 offset:25792
  s_waitcnt lgkmcnt(10)
  v_mfma_f32_16x16x32_bf16 v[72:75], v[56:59], v[152:155], v[72:75]
  ds_read_b64_tr_b16 v[48:49], v22 offset:20736
  v_mfma_f32_16x16x32_bf16 v[112:115], v[56:59], v[156:159], v[112:115]
  ds_read_b64_tr_b16 v[50:51], v22 offset:25856
  s_waitcnt lgkmcnt(10)
  v_mfma_f32_16x16x32_bf16 v[116:119], v[60:63], v[156:159], v[116:119]
  ds_read_b64_tr_b16 v[52:53], v23 offset:20736
  v_mfma_f32_16x16x32_bf16 v[76:79], v[60:63], v[152:155], v[76:79]
  ds_read_b64_tr_b16 v[54:55], v23 offset:25856
  s_waitcnt vmcnt(9)
  s_barrier
  v_add_u32 v22, 0xa000, v22
  v_add_u32 v23, 0xa000, v23
  s_waitcnt lgkmcnt(10)
  v_mfma_f32_16x16x32_bf16 v[80:83], v[32:35], v[152:155], v[80:83]
  ds_read_b64_tr_b16 v[56:57], v22 offset:0
  v_mfma_f32_16x16x32_bf16 v[120:123], v[32:35], v[156:159], v[120:123]
  ds_read_b64_tr_b16 v[58:59], v22 offset:5120
  s_waitcnt lgkmcnt(10)
  v_mfma_f32_16x16x32_bf16 v[124:127], v[36:39], v[156:159], v[124:127]
  ds_read_b64_tr_b16 v[60:61], v23 offset:0
  v_mfma_f32_16x16x32_bf16 v[84:87], v[36:39], v[152:155], v[84:87]
  ds_read_b64_tr_b16 v[62:63], v23 offset:5120
  s_waitcnt lgkmcnt(10)
  v_mfma_f32_16x16x32_bf16 v[88:91], v[40:43], v[152:155], v[88:91]
  ds_read_b64_tr_b16 v[32:33], v22 offset:64
  v_mfma_f32_16x16x32_bf16 v[128:131], v[40:43], v[156:159], v[128:131]
  ds_read_b64_tr_b16 v[34:35], v22 offset:5184
  s_waitcnt lgkmcnt(10)
  v_mfma_f32_16x16x32_bf16 v[132:135], v[44:47], v[156:159], v[132:135]
  ds_read_b64_tr_b16 v[36:37], v23 offset:64
  v_mfma_f32_16x16x32_bf16 v[92:95], v[44:47], v[152:155], v[92:95]
  ds_read_b64_tr_b16 v[38:39], v23 offset:5184
  s_waitcnt lgkmcnt(10)
  v_mfma_f32_16x16x32_bf16 v[96:99], v[48:51], v[152:155], v[96:99]
  ds_read_b64_tr_b16 v[40:41], v22 offset:128
  v_mfma_f32_16x16x32_bf16 v[136:139], v[48:51], v[156:159], v[136:139]
  ds_read_b64_tr_b16 v[42:43], v22 offset:5248
  s_waitcnt lgkmcnt(10)
  v_mfma_f32_16x16x32_bf16 v[140:143], v[52:55], v[156:159], v[140:143]
  ds_read_b64_tr_b16 v[44:45], v23 offset:128
  v_mfma_f32_16x16x32_bf16 v[100:103], v[52:55], v[152:155], v[100:103]
  ds_read_b64_tr_b16 v[46:47], v23 offset:5248
  s_waitcnt lgkmcnt(10)
  v_mfma_f32_16x16x32_bf16 v[64:67], v[56:59], v[160:163], v[64:67]
  ds_read_b64_tr_b16 v[48:49], v22 offset:192
  v_mfma_f32_16x16x32_bf16 v[104:107], v[56:59], v[164:167], v[104:107]
  ds_read_b64_tr_b16 v[50:51], v22 offset:5312
  s_waitcnt lgkmcnt(10)
  v_mfma_f32_16x16x32_bf16 v[108:111], v[60:63], v[164:167], v[108:111]
  ds_read_b64_tr_b16 v[52:53], v23 offset:192
  v_mfma_f32_16x16x32_bf16 v[68:71], v[60:63], v[160:163], v[68:71]
  ds_read_b64_tr_b16 v[54:55], v23 offset:5312
  s_waitcnt lgkmcnt(10)
  v_mfma_f32_16x16x32_bf16 v[72:75], v[32:35], v[160:163], v[72:75]
  ds_read_b64_tr_b16 v[56:57], v22 offset:256
  v_mfma_f32_16x16x32_bf16 v[112:115], v[32:35], v[164:167], v[112:115]
  ds_read_b64_tr_b16 v[58:59], v22 offset:5376
  s_waitcnt lgkmcnt(10)
  v_mfma_f32_16x16x32_bf16 v[116:119], v[36:39], v[164:167], v[116:119]
  ds_read_b64_tr_b16 v[60:61], v23 offset:256
  v_mfma_f32_16x16x32_bf16 v[76:79], v[36:39], v[160:163], v[76:79]
  ds_read_b64_tr_b16 v[62:63], v23 offset:5376
  s_waitcnt lgkmcnt(10)
  v_mfma_f32_16x16x32_bf16 v[80:83], v[40:43], v[160:163], v[80:83]
  ds_read_b64_tr_b16 v[32:33], v22 offset:20480
  v_mfma_f32_16x16x32_bf16 v[120:123], v[40:43], v[164:167], v[120:123]
  ds_read_b64_tr_b16 v[34:35], v22 offset:25600
  s_waitcnt lgkmcnt(10)
  v_mfma_f32_16x16x32_bf16 v[124:127], v[44:47], v[164:167], v[124:127]
  ds_read_b64_tr_b16 v[36:37], v23 offset:20480
  v_mfma_f32_16x16x32_bf16 v[84:87], v[44:47], v[160:163], v[84:87]
  ds_read_b64_tr_b16 v[38:39], v23 offset:25600
  s_waitcnt lgkmcnt(10)
  v_mfma_f32_16x16x32_bf16 v[88:91], v[48:51], v[160:163], v[88:91]
  ds_read_b64_tr_b16 v[40:41], v22 offset:20544
  v_mfma_f32_16x16x32_bf16 v[128:131], v[48:51], v[164:167], v[128:131]
  ds_read_b64_tr_b16 v[42:43], v22 offset:25664
  s_waitcnt lgkmcnt(10)
  v_mfma_f32_16x16x32_bf16 v[132:135], v[52:55], v[164:167], v[132:135]
  ds_read_b64_tr_b16 v[44:45], v23 offset:20544
  v_mfma_f32_16x16x32_bf16 v[92:95], v[52:55], v[160:163], v[92:95]
  ds_read_b64_tr_b16 v[46:47], v23 offset:25664
  s_waitcnt lgkmcnt(10)
  v_mfma_f32_16x16x32_bf16 v[96:99], v[56:59], v[160:163], v[96:99]
  ds_read_b64_tr_b16 v[48:49], v22 offset:20608
  v_mfma_f32_16x16x32_bf16 v[136:139], v[56:59], v[164:167], v[136:139]
  ds_read_b64_tr_b16 v[50:51], v22 offset:25728
  s_waitcnt lgkmcnt(10)
  v_mfma_f32_16x16x32_bf16 v[140:143], v[60:63], v[164:167], v[140:143]
  ds_read_b64_tr_b16 v[52:53], v23 offset:20608
  v_mfma_f32_16x16x32_bf16 v[100:103], v[60:63], v[160:163], v[100:103]
  ds_read_b64_tr_b16 v[54:55], v23 offset:25728
  s_waitcnt lgkmcnt(10)
  v_mfma_f32_16x16x32_bf16 v[64:67], v[32:35], v[168:171], v[64:67]
  ds_read_b64_tr_b16 v[56:57], v22 offset:20672
  v_mfma_f32_16x16x32_bf16 v[104:107], v[32:35], v[172:175], v[104:107]
  ds_read_b64_tr_b16 v[58:59], v22 offset:25792
  s_waitcnt lgkmcnt(10)
  v_mfma_f32_16x16x32_bf16 v[108:111], v[36:39], v[172:175], v[108:111]
  ds_read_b64_tr_b16 v[60:61], v23 offset:20672
  v_mfma_f32_16x16x32_bf16 v[68:71], v[36:39], v[168:171], v[68:71]
  ds_read_b64_tr_b16 v[62:63], v23 offset:25792
  s_waitcnt lgkmcnt(10)
  v_mfma_f32_16x16x32_bf16 v[72:75], v[40:43], v[168:171], v[72:75]
  ds_read_b64_tr_b16 v[32:33], v22 offset:20736
  v_mfma_f32_16x16x32_bf16 v[112:115], v[40:43], v[172:175], v[112:115]
  ds_read_b64_tr_b16 v[34:35], v22 offset:25856
  s_waitcnt lgkmcnt(10)
  v_mfma_f32_16x16x32_bf16 v[116:119], v[44:47], v[172:175], v[116:119]
  ds_read_b64_tr_b16 v[36:37], v23 offset:20736
  v_mfma_f32_16x16x32_bf16 v[76:79], v[44:47], v[168:171], v[76:79]
  ds_read_b64_tr_b16 v[38:39], v23 offset:25856
  s_waitcnt vmcnt(0)
  s_barrier
  v_add_u32 v22, 0xa000, v22
  v_add_u32 v23, 0xa000, v23
  s_waitcnt lgkmcnt(10)
  v_mfma_f32_16x16x32_bf16 v[80:83], v[48:51], v[168:171], v[80:83]
  ds_read_b64_tr_b16 v[40:41], v22 offset:0
  v_mfma_f32_16x16x32_bf16 v[120:123], v[48:51], v[172:175], v[120:123]
  ds_read_b64_tr_b16 v[42:43], v22 offset:5120
  s_waitcnt lgkmcnt(10)
  v_mfma_f32_16x16x32_bf16 v[124:127], v[52:55], v[172:175], v[124:127]
  ds_read_b64_tr_b16 v[44:45], v23 offset:0
  v_mfma_f32_16x16x32_bf16 v[84:87], v[52:55], v[168:171], v[84:87]
  ds_read_b64_tr_b16 v[46:47], v23 offset:5120
  s_waitcnt lgkmcnt(10)
  v_mfma_f32_16x16x32_bf16 v[88:91], v[56:59], v[168:171], v[88:91]
  ds_read_b64_tr_b16 v[48:49], v22 offset:64
  v_mfma_f32_16x16x32_bf16 v[128:131], v[56:59], v[172:175], v[128:131]
  ds_read_b64_tr_b16 v[50:51], v22 offset:5184
  s_waitcnt lgkmcnt(10)
  v_mfma_f32_16x16x32_bf16 v[132:135], v[60:63], v[172:175], v[132:135]
  ds_read_b64_tr_b16 v[52:53], v23 offset:64
  v_mfma_f32_16x16x32_bf16 v[92:95], v[60:63], v[168:171], v[92:95]
  ds_read_b64_tr_b16 v[54:55], v23 offset:5184
  s_waitcnt lgkmcnt(10)
  v_mfma_f32_16x16x32_bf16 v[96:99], v[32:35], v[168:171], v[96:99]
  ds_read_b64_tr_b16 v[56:57], v22 offset:128
  v_mfma_f32_16x16x32_bf16 v[136:139], v[32:35], v[172:175], v[136:139]
  ds_read_b64_tr_b16 v[58:59], v22 offset:5248
  s_waitcnt lgkmcnt(10)
  v_mfma_f32_16x16x32_bf16 v[140:143], v[36:39], v[172:175], v[140:143]
  ds_read_b64_tr_b16 v[60:61], v23 offset:128
  v_mfma_f32_16x16x32_bf16 v[100:103], v[36:39], v[168:171], v[100:103]
  ds_read_b64_tr_b16 v[62:63], v23 offset:5248
  s_waitcnt lgkmcnt(10)
  v_mfma_f32_16x16x32_bf16 v[64:67], v[40:43], v[176:179], v[64:67]
  ds_read_b64_tr_b16 v[32:33], v22 offset:192
  v_mfma_f32_16x16x32_bf16 v[104:107], v[40:43], v[180:183], v[104:107]
  ds_read_b64_tr_b16 v[34:35], v22 offset:5312
  s_waitcnt lgkmcnt(10)
  v_mfma_f32_16x16x32_bf16 v[108:111], v[44:47], v[180:183], v[108:111]
  ds_read_b64_tr_b16 v[36:37], v23 offset:192
  v_mfma_f32_16x16x32_bf16 v[68:71], v[44:47], v[176:179], v[68:71]
  ds_read_b64_tr_b16 v[38:39], v23 offset:5312
  s_waitcnt lgkmcnt(10)
  v_mfma_f32_16x16x32_bf16 v[72:75], v[48:51], v[176:179], v[72:75]
  ds_read_b64_tr_b16 v[40:41], v22 offset:256
  v_mfma_f32_16x16x32_bf16 v[112:115], v[48:51], v[180:183], v[112:115]
  ds_read_b64_tr_b16 v[42:43], v22 offset:5376
  s_waitcnt lgkmcnt(10)
  v_mfma_f32_16x16x32_bf16 v[116:119], v[52:55], v[180:183], v[116:119]
  ds_read_b64_tr_b16 v[44:45], v23 offset:256
  v_mfma_f32_16x16x32_bf16 v[76:79], v[52:55], v[176:179], v[76:79]
  ds_read_b64_tr_b16 v[46:47], v23 offset:5376
  s_waitcnt lgkmcnt(10)
  v_mfma_f32_16x16x32_bf16 v[80:83], v[56:59], v[176:179], v[80:83]
  ds_read_b64_tr_b16 v[48:49], v22 offset:20480
  v_mfma_f32_16x16x32_bf16 v[120:123], v[56:59], v[180:183], v[120:123]
  ds_read_b64_tr_b16 v[50:51], v22 offset:25600
  s_waitcnt lgkmcnt(10)
  v_mfma_f32_16x16x32_bf16 v[124:127], v[60:63], v[180:183], v[124:127]
  ds_read_b64_tr_b16 v[52:53], v23 offset:20480
  v_mfma_f32_16x16x32_bf16 v[84:87], v[60:63], v[176:179], v[84:87]
  ds_read_b64_tr_b16 v[54:55], v23 offset:25600
  s_waitcnt lgkmcnt(10)
  v_mfma_f32_16x16x32_bf16 v[88:91], v[32:35], v[176:179], v[88:91]
  ds_read_b64_tr_b16 v[56:57], v22 offset:20544
  v_mfma_f32_16x16x32_bf16 v[128:131], v[32:35], v[180:183], v[128:131]
  ds_read_b64_tr_b16 v[58:59], v22 offset:25664
  s_waitcnt lgkmcnt(10)
  v_mfma_f32_16x16x32_bf16 v[132:135], v[36:39], v[180:183], v[132:135]
  ds_read_b64_tr_b16 v[60:61], v23 offset:20544
  v_mfma_f32_16x16x32_bf16 v[92:95], v[36:39], v[176:179], v[92:95]
  ds_read_b64_tr_b16 v[62:63], v23 offset:25664
  s_waitcnt lgkmcnt(10)
  v_mfma_f32_16x16x32_bf16 v[96:99], v[40:43], v[176:179], v[96:99]
  ds_read_b64_tr_b16 v[32:33], v22 offset:20608
  v_mfma_f32_16x16x32_bf16 v[136:139], v[40:43], v[180:183], v[136:139]
  ds_read_b64_tr_b16 v[34:35], v22 offset:25728
  s_waitcnt lgkmcnt(10)
  v_mfma_f32_16x16x32_bf16 v[140:143], v[44:47], v[180:183], v[140:143]
  ds_read_b64_tr_b16 v[36:37], v23 offset:20608
  v_mfma_f32_16x16x32_bf16 v[100:103], v[44:47], v[176:179], v[100:103]
  ds_read_b64_tr_b16 v[38:39], v23 offset:25728
  s_waitcnt lgkmcnt(10)
  v_mfma_f32_16x16x32_bf16 v[64:67], v[48:51], v[184:187], v[64:67]
  ds_read_b64_tr_b16 v[40:41], v22 offset:20672
  v_mfma_f32_16x16x32_bf16 v[104:107], v[48:51], v[188:191], v[104:107]
  ds_read_b64_tr_b16 v[42:43], v22 offset:25792
  s_mul_i32 s33, s28, 10240
  v_add_u32 v3, s33, v16
  s_waitcnt lgkmcnt(10)
  v_mfma_f32_16x16x32_bf16 v[108:111], v[52:55], v[188:191], v[108:111]
  ds_read_b64_tr_b16 v[44:45], v23 offset:20672
  v_mfma_f32_16x16x32_bf16 v[68:71], v[52:55], v[184:187], v[68:71]
  ds_read_b64_tr_b16 v[46:47], v23 offset:25792
  s_waitcnt lgkmcnt(10)
  v_mfma_f32_16x16x32_bf16 v[72:75], v[56:59], v[184:187], v[72:75]
  ds_read_b64_tr_b16 v[48:49], v22 offset:20736
  v_mfma_f32_16x16x32_bf16 v[112:115], v[56:59], v[188:191], v[112:115]
  ds_read_b64_tr_b16 v[50:51], v22 offset:25856
  ds_write_b128 v3, v[104:107] offset:0
  s_waitcnt lgkmcnt(11)
  v_mfma_f32_16x16x32_bf16 v[116:119], v[60:63], v[188:191], v[116:119]
  ds_read_b64_tr_b16 v[52:53], v23 offset:20736
  v_mfma_f32_16x16x32_bf16 v[76:79], v[60:63], v[184:187], v[76:79]
  ds_read_b64_tr_b16 v[54:55], v23 offset:25856
  ds_write_b128 v3, v[108:111] offset:1024
  s_waitcnt lgkmcnt(12)
  v_mfma_f32_16x16x32_bf16 v[80:83], v[32:35], v[184:187], v[80:83]
  v_mfma_f32_16x16x32_bf16 v[120:123], v[32:35], v[188:191], v[120:123]
  ds_write_b128 v3, v[112:115] offset:2048
  s_waitcnt lgkmcnt(11)
  v_mfma_f32_16x16x32_bf16 v[124:127], v[36:39], v[188:191], v[124:127]
  v_mfma_f32_16x16x32_bf16 v[84:87], v[36:39], v[184:187], v[84:87]
  ds_write_b128 v3, v[116:119] offset:3072
  s_waitcnt lgkmcnt(10)
  v_mfma_f32_16x16x32_bf16 v[88:91], v[40:43], v[184:187], v[88:91]
  v_mfma_f32_16x16x32_bf16 v[128:131], v[40:43], v[188:191], v[128:131]
  ds_write_b128 v3, v[120:123] offset:4096
  s_waitcnt lgkmcnt(9)
  v_mfma_f32_16x16x32_bf16 v[132:135], v[44:47], v[188:191], v[132:135]
  v_mfma_f32_16x16x32_bf16 v[92:95], v[44:47], v[184:187], v[92:95]
  ds_write_b128 v3, v[124:127] offset:5120
  s_waitcnt lgkmcnt(8)
  v_mfma_f32_16x16x32_bf16 v[96:99], v[48:51], v[184:187], v[96:99]
  v_mfma_f32_16x16x32_bf16 v[136:139], v[48:51], v[188:191], v[136:139]
  ds_write_b128 v3, v[128:131] offset:6144
  s_waitcnt lgkmcnt(6)
  v_mfma_f32_16x16x32_bf16 v[140:143], v[52:55], v[188:191], v[140:143]
  v_mfma_f32_16x16x32_bf16 v[100:103], v[52:55], v[184:187], v[100:103]
  ds_write_b128 v3, v[132:135] offset:7168
  s_mul_i32 s33, s28, 10240
  v_add_u32 v3, s33, v16
  s_xor_b32 s33, s28, 4
  s_mul_i32 s33, s33, 10240
  v_add_u32 v4, s33, v16
  ds_write_b128 v3, v[136:139] offset:8192
  ds_write_b128 v3, v[140:143] offset:9216
  s_lshl_b32 s76, s75, 2
  s_add_u32 s33, s76, s64
  s_lshl_b32 s33, s33, 3
  s_lshl_b32 s34, s68, 1
  s_add_u32 s33, s33, s34
  s_add_u32 s33, s33, s67
  s_mul_i32 s33, s33, 5120
  s_add_u32 s33, s33, 62914560
  s_add_u32 s35, s33, 4096
  s_mul_i32 s34, s67, 10240
  s_add_u32 s34, s34, 81920
  v_add_u32 v3, s34, v16
  s_add_u32 s86, s76, s68
  s_lshl_b32 s86, s86, 7
  s_add_u32 s86, s86, 87056384
  s_mov_b32 s4, s58
  s_mov_b32 s5, s59
  s_mov_b32 s6, 2621440
  s_mov_b32 s7, 0x20000
  s_mul_i32 s72, s64, 10240
  s_lshl_b32 s34, s28, 10
  s_add_u32 s72, s72, s34
  s_add_u32 s72, s72, 62914560
  s_lshl_b32 s34, s28, 11
  s_add_u32 s34, s34, 81920
  v_add_u32 v2, s34, v16
  v_mov_b32 v5, 1
  s_lshl_b32 s73, s65, 2
  s_add_u32 s73, s73, s64
  s_mul_i32 s73, s73, 40960
  s_mul_i32 s34, s66, 320
  s_add_u32 s73, s73, s34
  s_add_u32 s34, s64, 1
  s_and_b32 s34, s34, 3
  s_add_u32 s34, s34, s76
  s_mul_i32 s34, s34, 40960
  s_add_u32 s70, s34, s72
  s_add_u32 s34, s64, 2
  s_and_b32 s34, s34, 3
  s_add_u32 s34, s34, s76
  s_mul_i32 s34, s34, 40960
  s_add_u32 s71, s34, s72
  s_add_u32 s34, s64, 3
  s_and_b32 s34, s34, 3
  s_add_u32 s34, s34, s76
  s_mul_i32 s34, s34, 40960
  s_add_u32 s69, s34, s72
  s_mov_b32 s87, 0xffff0000
  s_waitcnt lgkmcnt(0)
  s_barrier
  ds_read_b128 v[104:107], v4 offset:0
  ds_read_b128 v[108:111], v4 offset:1024
  ds_read_b128 v[112:115], v4 offset:2048
  ds_read_b128 v[116:119], v4 offset:3072
  ds_read_b128 v[120:123], v4 offset:4096
  ds_read_b128 v[124:127], v4 offset:5120
  ds_read_b128 v[128:131], v4 offset:6144
  ds_read_b128 v[132:135], v4 offset:7168
  ds_read_b128 v[136:139], v4 offset:8192
  ds_read_b128 v[140:143], v4 offset:9216
  s_cmp_eq_u32 s68, s64
  s_cbranch_scc1 F_OWN
  s_waitcnt lgkmcnt(9)
  v_pk_add_f32 v[64:65], v[64:65], v[104:105]
  v_pk_add_f32 v[66:67], v[66:67], v[106:107]
  s_waitcnt lgkmcnt(8)
  v_pk_add_f32 v[68:69], v[68:69], v[108:109]
  v_pk_add_f32 v[70:71], v[70:71], v[110:111]
  v_cvt_pk_bf16_f32 v64, v64, v65
  v_cvt_pk_bf16_f32 v65, v66, v67
  v_cvt_pk_bf16_f32 v66, v68, v69
  v_cvt_pk_bf16_f32 v67, v70, v71
  buffer_store_dwordx4 v[64:67], v16, s[12:15], s33 offen offset:0 sc1
  s_waitcnt lgkmcnt(7)
  v_pk_add_f32 v[72:73], v[72:73], v[112:113]
  v_pk_add_f32 v[74:75], v[74:75], v[114:115]
  s_waitcnt lgkmcnt(6)
  v_pk_add_f32 v[76:77], v[76:77], v[116:117]
  v_pk_add_f32 v[78:79], v[78:79], v[118:119]
  v_cvt_pk_bf16_f32 v72, v72, v73
  v_cvt_pk_bf16_f32 v73, v74, v75
  v_cvt_pk_bf16_f32 v74, v76, v77
  v_cvt_pk_bf16_f32 v75, v78, v79
  buffer_store_dwordx4 v[72:75], v16, s[12:15], s33 offen offset:1024 sc1
  s_waitcnt lgkmcnt(5)
  v_pk_add_f32 v[80:81], v[80:81], v[120:121]
  v_pk_add_f32 v[82:83], v[82:83], v[122:123]
  s_waitcnt lgkmcnt(4)
  v_pk_add_f32 v[84:85], v[84:85], v[124:125]
  v_pk_add_f32 v[86:87], v[86:87], v[126:127]
  v_cvt_pk_bf16_f32 v80, v80, v81
  v_cvt_pk_bf16_f32 v81, v82, v83
  v_cvt_pk_bf16_f32 v82, v84, v85
  v_cvt_pk_bf16_f32 v83, v86, v87
  buffer_store_dwordx4 v[80:83], v16, s[12:15], s33 offen offset:2048 sc1
  s_waitcnt lgkmcnt(3)
  v_pk_add_f32 v[88:89], v[88:89], v[128:129]
  v_pk_add_f32 v[90:91], v[90:91], v[130:131]
  s_waitcnt lgkmcnt(2)
  v_pk_add_f32 v[92:93], v[92:93], v[132:133]
  v_pk_add_f32 v[94:95], v[94:95], v[134:135]
  v_cvt_pk_bf16_f32 v88, v88, v89
  v_cvt_pk_bf16_f32 v89, v90, v91
  v_cvt_pk_bf16_f32 v90, v92, v93
  v_cvt_pk_bf16_f32 v91, v94, v95
  buffer_store_dwordx4 v[88:91], v16, s[12:15], s33 offen offset:3072 sc1
  s_waitcnt lgkmcnt(1)
  v_pk_add_f32 v[96:97], v[96:97], v[136:137]
  v_pk_add_f32 v[98:99], v[98:99], v[138:139]
  s_waitcnt lgkmcnt(0)
  v_pk_add_f32 v[100:101], v[100:101], v[140:141]
  v_pk_add_f32 v[102:103], v[102:103], v[142:143]
  v_cvt_pk_bf16_f32 v96, v96, v97
  v_cvt_pk_bf16_f32 v97, v98, v99
  v_cvt_pk_bf16_f32 v98, v100, v101
  v_cvt_pk_bf16_f32 v99, v102, v103
  buffer_store_dwordx4 v[96:99], v16, s[12:15], s35 offen offset:0 sc1
  s_mov_b64 exec, 1
  s_waitcnt vmcnt(0)
  buffer_atomic_add v5, off, s[12:15], s86 sc1
  s_branch F_GO
F_OWN:
  s_waitcnt lgkmcnt(9)
  v_pk_add_f32 v[64:65], v[64:65], v[104:105]
  v_pk_add_f32 v[66:67], v[66:67], v[106:107]
  ds_write_b128 v3, v[64:67] offset:0
  s_waitcnt lgkmcnt(9)
  v_pk_add_f32 v[68:69], v[68:69], v[108:109]
  v_pk_add_f32 v[70:71], v[70:71], v[110:111]
  ds_write_b128 v3, v[68:71] offset:1024
  s_waitcnt lgkmcnt(9)
  v_pk_add_f32 v[72:73], v[72:73], v[112:113]
  v_pk_add_f32 v[74:75], v[74:75], v[114:115]
  ds_write_b128 v3, v[72:75] offset:2048
  s_waitcnt lgkmcnt(9)
  v_pk_add_f32 v[76:77], v[76:77], v[116:117]
  v_pk_add_f32 v[78:79], v[78:79], v[118:119]
  ds_write_b128 v3, v[76:79] offset:3072
  s_waitcnt lgkmcnt(9)
  v_pk_add_f32 v[80:81], v[80:81], v[120:121]
  v_pk_add_f32 v[82:83], v[82:83], v[122:123]
  ds_write_b128 v3, v[80:83] offset:4096
  s_waitcnt lgkmcnt(9)
  v_pk_add_f32 v[84:85], v[84:85], v[124:125]
  v_pk_add_f32 v[86:87], v[86:87], v[126:127]
  ds_write_b128 v3, v[84:87] offset:5120
  s_waitcnt lgkmcnt(9)
  v_pk_add_f32 v[88:89], v[88:89], v[128:129]
  v_pk_add_f32 v[90:91], v[90:91], v[130:131]
  ds_write_b128 v3, v[88:91] offset:6144
  s_waitcnt lgkmcnt(9)
  v_pk_add_f32 v[92:93], v[92:93], v[132:133]
  v_pk_add_f32 v[94:95], v[94:95], v[134:135]
  ds_write_b128 v3, v[92:95] offset:7168
  s_waitcnt lgkmcnt(9)
  v_pk_add_f32 v[96:97], v[96:97], v[136:137]
  v_pk_add_f32 v[98:99], v[98:99], v[138:139]
  ds_write_b128 v3, v[96:99] offset:8192
  s_waitcnt lgkmcnt(9)
  v_pk_add_f32 v[100:101], v[100:101], v[140:141]
  v_pk_add_f32 v[102:103], v[102:103], v[142:143]
  ds_write_b128 v3, v[100:103] offset:9216
  s_waitcnt lgkmcnt(0)
  s_cmp_eq_u32 s67, 0
  s_cbranch_scc0 F_GO
  s_mov_b64 exec, 1
F_POLL:
  buffer_load_dword v6, off, s[12:15], s86 sc1
  s_waitcnt vmcnt(0)
  v_readfirstlane_b32 s34, v6
  s_nop 0
  s_cmp_lt_u32 s34, 6
  s_cbranch_scc1 F_POLL
F_GO:
  s_mov_b64 exec, -1
  s_barrier
  s_cmp_ge_u32 s28, 2
  s_cbranch_scc1 F_F2
  buffer_load_dwordx4 v[72:75], v16, s[12:15], s70 offen sc1
  buffer_load_dwordx4 v[76:79], v16, s[12:15], s71 offen sc1
  buffer_load_dwordx4 v[80:83], v16, s[12:15], s69 offen sc1
  ds_read_b128 v[64:67], v2 offset:0
  ds_read_b128 v[68:71], v2 offset:1024
  s_add_u32 s70, s70, 8192
  buffer_load_dwordx4 v[104:107], v16, s[12:15], s70 offen sc1
  s_add_u32 s71, s71, 8192
  buffer_load_dwordx4 v[108:111], v16, s[12:15], s71 offen sc1
  s_add_u32 s69, s69, 8192
  buffer_load_dwordx4 v[112:115], v16, s[12:15], s69 offen sc1
  ds_read_b128 v[96:99], v2 offset:16384
  ds_read_b128 v[100:103], v2 offset:17408
  s_add_u32 s33, s28, 0
  s_cmp_ge_u32 s33, 5
  s_cselect_b32 s34, 20160, 0
  s_lshl_b32 s33, s33, 6
  s_add_u32 s33, s33, s34
  s_add_u32 s33, s33, s73
  s_waitcnt vmcnt(5)
  v_lshlrev_b32 v84, 16, v72
  v_and_b32 v85, s87, v72
  v_lshlrev_b32 v86, 16, v73
  v_and_b32 v87, s87, v73
  v_lshlrev_b32 v88, 16, v74
  v_and_b32 v89, s87, v74
  v_lshlrev_b32 v90, 16, v75
  v_and_b32 v91, s87, v75
  s_waitcnt lgkmcnt(3)
  v_pk_add_f32 v[64:65], v[64:65], v[84:85]
  v_pk_add_f32 v[66:67], v[66:67], v[86:87]
  s_waitcnt lgkmcnt(2)
  v_pk_add_f32 v[68:69], v[68:69], v[88:89]
  v_pk_add_f32 v[70:71], v[70:71], v[90:91]
  s_waitcnt vmcnt(4)
  v_lshlrev_b32 v84, 16, v76
  v_and_b32 v85, s87, v76
  v_lshlrev_b32 v86, 16, v77
  v_and_b32 v87, s87, v77
  v_lshlrev_b32 v88, 16, v78
  v_and_b32 v89, s87, v78
  v_lshlrev_b32 v90, 16, v79
  v_and_b32 v91, s87, v79
  v_pk_add_f32 v[64:65], v[64:65], v[84:85]
  v_pk_add_f32 v[66:67], v[66:67], v[86:87]
  v_pk_add_f32 v[68:69], v[68:69], v[88:89]
  v_pk_add_f32 v[70:71], v[70:71], v[90:91]
  s_waitcnt vmcnt(3)
  v_lshlrev_b32 v84, 16, v80
  v_and_b32 v85, s87, v80
  v_lshlrev_b32 v86, 16, v81
  v_and_b32 v87, s87, v81
  v_lshlrev_b32 v88, 16, v82
  v_and_b32 v89, s87, v82
  v_lshlrev_b32 v90, 16, v83
  v_and_b32 v91, s87, v83
  v_pk_add_f32 v[64:65], v[64:65], v[84:85]
  v_pk_add_f32 v[66:67], v[66:67], v[86:87]
  v_pk_add_f32 v[68:69], v[68:69], v[88:89]
  v_pk_add_f32 v[70:71], v[70:71], v[90:91]
  v_cvt_pk_bf16_f32 v64, v64, v65
  v_cvt_pk_bf16_f32 v65, v66, v67
  v_cvt_pk_bf16_f32 v66, v68, v69
  v_cvt_pk_bf16_f32 v67, v70, v71
  buffer_store_dwordx2 v[64:65], v10, s[4:7], s33 offen offset:0
  buffer_store_dwordx2 v[66:67], v10, s[4:7], s33 offen offset:32
  s_add_u32 s33, s28, 8
  s_cmp_ge_u32 s33, 5
  s_cselect_b32 s34, 20160, 0
  s_lshl_b32 s33, s33, 6
  s_add_u32 s33, s33, s34
  s_add_u32 s33, s33, s73
  s_waitcnt vmcnt(4)
  v_lshlrev_b32 v116, 16, v104
  v_and_b32 v117, s87, v104
  v_lshlrev_b32 v118, 16, v105
  v_and_b32 v119, s87, v105
  v_lshlrev_b32 v120, 16, v106
  v_and_b32 v121, s87, v106
  v_lshlrev_b32 v122, 16, v107
  v_and_b32 v123, s87, v107
  s_waitcnt lgkmcnt(1)
  v_pk_add_f32 v[96:97], v[96:97], v[116:117]
  v_pk_add_f32 v[98:99], v[98:99], v[118:119]
  s_waitcnt lgkmcnt(0)
  v_pk_add_f32 v[100:101], v[100:101], v[120:121]
  v_pk_add_f32 v[102:103], v[102:103], v[122:123]
  s_waitcnt vmcnt(3)
  v_lshlrev_b32 v116, 16, v108
  v_and_b32 v117, s87, v108
  v_lshlrev_b32 v118, 16, v109
  v_and_b32 v119, s87, v109
  v_lshlrev_b32 v120, 16, v110
  v_and_b32 v121, s87, v110
  v_lshlrev_b32 v122, 16, v111
  v_and_b32 v123, s87, v111
  v_pk_add_f32 v[96:97], v[96:97], v[116:117]
  v_pk_add_f32 v[98:99], v[98:99], v[118:119]
  v_pk_add_f32 v[100:101], v[100:101], v[120:121]
  v_pk_add_f32 v[102:103], v[102:103], v[122:123]
  s_waitcnt vmcnt(2)
  v_lshlrev_b32 v116, 16, v112
  v_and_b32 v117, s87, v112
  v_lshlrev_b32 v118, 16, v113
  v_and_b32 v119, s87, v113
  v_lshlrev_b32 v120, 16, v114
  v_and_b32 v121, s87, v114
  v_lshlrev_b32 v122, 16, v115
  v_and_b32 v123, s87, v115
  v_pk_add_f32 v[96:97], v[96:97], v[116:117]
  v_pk_add_f32 v[98:99], v[98:99], v[118:119]
  v_pk_add_f32 v[100:101], v[100:101], v[120:121]
  v_pk_add_f32 v[102:103], v[102:103], v[122:123]
  v_cvt_pk_bf16_f32 v96, v96, v97
  v_cvt_pk_bf16_f32 v97, v98, v99
  v_cvt_pk_bf16_f32 v98, v100, v101
  v_cvt_pk_bf16_f32 v99, v102, v103
  buffer_store_dwordx2 v[96:97], v10, s[4:7], s33 offen offset:0
  buffer_store_dwordx2 v[98:99], v10, s[4:7], s33 offen offset:32
  s_branch F_FIN
F_F2:
  buffer_load_dwordx4 v[72:75], v16, s[12:15], s70 offen sc1
  buffer_load_dwordx4 v[76:79], v16, s[12:15], s71 offen sc1
  buffer_load_dwordx4 v[80:83], v16, s[12:15], s69 offen sc1
  ds_read_b128 v[64:67], v2 offset:0
  ds_read_b128 v[68:71], v2 offset:1024
  s_add_u32 s33, s28, 0
  s_cmp_ge_u32 s33, 5
  s_cselect_b32 s34, 20160, 0
  s_lshl_b32 s33, s33, 6
  s_add_u32 s33, s33, s34
  s_add_u32 s33, s33, s73
  s_waitcnt vmcnt(2)
  v_lshlrev_b32 v84, 16, v72
  v_and_b32 v85, s87, v72
  v_lshlrev_b32 v86, 16, v73
  v_and_b32 v87, s87, v73
  v_lshlrev_b32 v88, 16, v74
  v_and_b32 v89, s87, v74
  v_lshlrev_b32 v90, 16, v75
  v_and_b32 v91, s87, v75
  s_waitcnt lgkmcnt(1)
  v_pk_add_f32 v[64:65], v[64:65], v[84:85]
  v_pk_add_f32 v[66:67], v[66:67], v[86:87]
  s_waitcnt lgkmcnt(0)
  v_pk_add_f32 v[68:69], v[68:69], v[88:89]
  v_pk_add_f32 v[70:71], v[70:71], v[90:91]
  s_waitcnt vmcnt(1)
  v_lshlrev_b32 v84, 16, v76
  v_and_b32 v85, s87, v76
  v_lshlrev_b32 v86, 16, v77
  v_and_b32 v87, s87, v77
  v_lshlrev_b32 v88, 16, v78
  v_and_b32 v89, s87, v78
  v_lshlrev_b32 v90, 16, v79
  v_and_b32 v91, s87, v79
  v_pk_add_f32 v[64:65], v[64:65], v[84:85]
  v_pk_add_f32 v[66:67], v[66:67], v[86:87]
  v_pk_add_f32 v[68:69], v[68:69], v[88:89]
  v_pk_add_f32 v[70:71], v[70:71], v[90:91]
  s_waitcnt vmcnt(0)
  v_lshlrev_b32 v84, 16, v80
  v_and_b32 v85, s87, v80
  v_lshlrev_b32 v86, 16, v81
  v_and_b32 v87, s87, v81
  v_lshlrev_b32 v88, 16, v82
  v_and_b32 v89, s87, v82
  v_lshlrev_b32 v90, 16, v83
  v_and_b32 v91, s87, v83
  v_pk_add_f32 v[64:65], v[64:65], v[84:85]
  v_pk_add_f32 v[66:67], v[66:67], v[86:87]
  v_pk_add_f32 v[68:69], v[68:69], v[88:89]
  v_pk_add_f32 v[70:71], v[70:71], v[90:91]
  v_cvt_pk_bf16_f32 v64, v64, v65
  v_cvt_pk_bf16_f32 v65, v66, v67
  v_cvt_pk_bf16_f32 v66, v68, v69
  v_cvt_pk_bf16_f32 v67, v70, v71
  buffer_store_dwordx2 v[64:65], v10, s[4:7], s33 offen offset:0
  buffer_store_dwordx2 v[66:67], v10, s[4:7], s33 offen offset:32
F_FIN:
F_END:
  s_endpgm
.section .rodata,"a"
.p2align 6
.amdhsa_kernel gated_mix__compressed_kv_cla__geglu_ffn__prompt_kernel
  .amdhsa_next_free_vgpr 256
  .amdhsa_next_free_sgpr 102
  .amdhsa_accum_offset 256
  .amdhsa_group_segment_fixed_size 0
  .amdhsa_kernarg_size 112
  .amdhsa_user_sgpr_count 2
  .amdhsa_user_sgpr_kernarg_segment_ptr 1
  .amdhsa_system_sgpr_workgroup_id_x 1
  .amdhsa_float_denorm_mode_32 3
.end_amdhsa_kernel
```
